```python
import torch

def _softmax(x, axis=-1):
    return torch.softmax(x, dim=axis)
def _gelu(x):
    return torch.nn.functional.gelu(x, approximate="tanh")
def _silu(x):
    return torch.nn.functional.silu(x)
def _sigmoid(x):
    return torch.sigmoid(x)
def _layernorm(x, axis=-1, eps=1e-5):
    m = x.mean(dim=axis, keepdim=True)
    v = x.var(dim=axis, keepdim=True, unbiased=False)
    return (x - m) / torch.sqrt(v + eps)
def _scatter_add(tgt, idx, src, axis=0):
    return tgt.clone().index_add_(axis, idx, src)
def _segment_sum(src, seg, n):
    out = torch.zeros((n,) + src.shape[1:], dtype=src.dtype)
    return out.index_add_(0, seg, src)
def _pad(x, pw):
    flat = tuple(v for pair in reversed(pw) for v in pair)
    return torch.nn.functional.pad(x, flat)

kernel_name = 'recurrent_scan__sliding_block_cached__glu_gated_geglu__prompt'

def setup_inputs():

    _w = (lambda a: (lambda t: t.to(torch.bfloat16) if t.is_floating_point() else t)(torch.as_tensor(a)))
    def _A_setup():
        B, Sq, D = 1, 2048, 640
        Hq, Hkv, Sk, Dh = 32, 32, 2048, 192
        assert Hq % Hkv == 0, (Hq, Hkv)
        return {
            "x": _w((lambda *s: torch.randn(*s, dtype=torch.bfloat16) * 0.05)(B, Sq, D)),
            "k_cache": _w((lambda *s: torch.randn(*s, dtype=torch.bfloat16) * 3.2)(B, Hkv, Sk, Dh)),
            "v_cache": _w((lambda *s: torch.randn(*s, dtype=torch.bfloat16) * 3.2)(B, Hkv, Sk, Dh)),
            "wq": _w((lambda *s: torch.randn(*s, dtype=torch.bfloat16) * 3.2)(D, Hq * Dh) * (D ** -0.5)),
            "wo": _w((lambda *s: torch.randn(*s, dtype=torch.bfloat16) * 3.2)(Hq * Dh, D) * ((Hq * Dh) ** -0.5)),
        }
    _A_in = _A_setup()

    def _B_setup():
        B, S, Dm, Df = 1, 2048, 640, 1536
        return {
            "x": _w((lambda *s: torch.randn(*s, dtype=torch.bfloat16) * 0.05)(B, S, Dm)),
            "w_gate": _w((lambda *s: torch.randn(*s, dtype=torch.bfloat16) * 0.4)(Dm, Df) * (Dm ** -0.5)),
            "w_up": _w((lambda *s: torch.randn(*s, dtype=torch.bfloat16) * 0.4)(Dm, Df) * (Dm ** -0.5)),
            "w_down": _w((lambda *s: torch.randn(*s, dtype=torch.bfloat16) * 0.4)(Df, Dm) * (Df ** -0.5)),
        }
    _B_in = _B_setup()

    return {
        "A_x": _A_in["x"],
        "A_k_cache": _A_in["k_cache"],
        "A_v_cache": _A_in["v_cache"],
        "A_wq": _A_in["wq"],
        "A_wo": _A_in["wo"],
        "B_x": _B_in["x"],
        "B_w_gate": _B_in["w_gate"],
        "B_w_up": _B_in["w_up"],
        "B_w_down": _B_in["w_down"],
    }

def reference(A_x, A_k_cache, A_v_cache, A_wq, A_wo, B_x, B_w_gate, B_w_up, B_w_down):
    def _A_ref(x, k_cache, v_cache, wq, wo):
        B, Sq, D = x.shape
        Hq, Dh = 32, 192
        Hkv, Sk = k_cache.shape[1], k_cache.shape[2]
        W = min(4096, max(256, Sk // 4))
        rep = Hq // Hkv
        q = (lambda x, *d: x.permute(*d))((x @ wq).reshape(B, Sq, Hq, Dh), 0, 2, 1, 3)
        k = (lambda x, n, axis: torch.repeat_interleave(x, n, dim=axis))(k_cache[:, :, Sk - W:, :], rep, axis=1)
        v = (lambda x, n, axis: torch.repeat_interleave(x, n, dim=axis))(v_cache[:, :, Sk - W:, :], rep, axis=1)
        scores = torch.einsum("bhqd,bhkd->bhqk", q, k) * (Dh ** -0.5)
        p = _softmax(scores, axis=-1)
        o = torch.einsum("bhqk,bhkd->bhqd", p, v)
        return (lambda x, *d: x.permute(*d))(o, 0, 2, 1, 3).reshape(B, Sq, Hq * Dh) @ wo

    def _B_ref(x, w_gate, w_up, w_down):
        g = torch.einsum("bsd,df->bsf", x, w_gate)
        u = torch.einsum("bsd,df->bsf", x, w_up)
        h = _gelu(g) * u
        return torch.einsum("bsf,fd->bsd", h, w_down)

    x = A_x
    xn = _layernorm(x, axis=-1)
    s = _A_ref(xn, A_k_cache, A_v_cache, A_wq, A_wo)
    g = _silu(_B_ref(xn, B_w_gate, B_w_up, B_w_down))
    return x + s * g
```

```asm
; @launch kernel=k1_ln_kernel grid=(256,1,1) block=(256,1,1) lds=0
; @launch kernel=k2_main_kernel grid=(256,1,1) block=(256,1,1) lds=148224
.amdgcn_target "amdgcn-amd-amdhsa--gfx950"
.text
.globl k1_ln_kernel
.p2align 8
.type k1_ln_kernel,@function
k1_ln_kernel:
  s_cmp_ge_u32 s2, 0x100
  s_cbranch_scc1 L_k1_end
  s_load_dwordx2 s[4:5], s[0:1], 0x0
  s_load_dwordx2 s[6:7], s[0:1], 0x58
  s_load_dwordx2 s[24:25], s[0:1], 0x18
  s_load_dwordx4 s[28:31], s[0:1], 0x30
  v_and_b32 v1, 31, v0
  v_lshrrev_b32 v2, 5, v0
  s_lshl_b32 s3, s2, 3
  v_add_u32 v2, s3, v2
  v_mul_u32_u24 v3, 0x500, v2
  v_lshl_add_u32 v3, v1, 3, v3
  s_waitcnt lgkmcnt(0)
  s_mov_b32 s8, s4
  s_and_b32 s9, s5, 0xffff
  s_mov_b32 s10, 0x280000
  s_mov_b32 s11, 0x20000
  buffer_load_dwordx2 v[8:9], v3, s[8:11], 0 offen
  buffer_load_dwordx2 v[10:11], v3, s[8:11], 0 offen offset:256
  buffer_load_dwordx2 v[12:13], v3, s[8:11], 0 offen offset:512
  buffer_load_dwordx2 v[14:15], v3, s[8:11], 0 offen offset:768
  buffer_load_dwordx2 v[16:17], v3, s[8:11], 0 offen offset:1024
  s_mov_b32 s12, s6
  s_and_b32 s13, s7, 0xffff
  s_mov_b32 s14, 0x10000000
  s_mov_b32 s15, 0x20000
  s_and_b32 s32, s2, 7
  s_lshr_b32 s33, s2, 3
  s_and_b32 s37, s33, 3
  s_lshr_b32 s38, s2, 5
  s_lshl_b32 s34, s32, 5
  s_add_u32 s34, s34, 5
  s_mul_i32 s34, s34, 0xaaab
  s_lshr_b32 s34, s34, 18
  s_add_u32 s34, s34, s37
  s_lshl_b32 s35, s37, 3
  s_lshr_b32 s35, 0xf0a0504, s35
  s_and_b32 s35, s35, 0xff
  s_and_b32 s36, s32, 1
  s_lshl_b32 s36, s36, 4
  s_add_u32 s35, s35, s36
  s_cmp_lt_u32 s32, 6
  s_cselect_b32 s39, s34, s35
  s_mul_i32 s34, s39, 0x180
  s_mul_i32 s35, s38, 0x30000
  s_add_u32 s34, s34, s35
  s_mul_i32 s36, s39, 0x60
  s_mul_i32 s35, s38, 0xc000
  s_add_u32 s36, s36, s35
  s_mov_b32 s40, s24
  s_and_b32 s41, s25, 0xffff
  s_mov_b32 s42, 0x780000
  s_mov_b32 s43, 0x20000
  s_mov_b32 s44, s28
  s_and_b32 s45, s29, 0xffff
  s_mov_b32 s46, 0x1e0000
  s_mov_b32 s47, 0x20000
  s_mov_b32 s48, s30
  s_and_b32 s49, s31, 0xffff
  s_mov_b32 s50, 0x1e0000
  s_mov_b32 s51, 0x20000
  v_add_u32 v56, 0, v0
  v_min_u32 v56, 0x17f, v56
  v_mul_u32_u24 v57, 0xaab, v56
  v_lshrrev_b32 v57, 16, v57
  v_mul_u32_u24 v58, 24, v57
  v_sub_u32 v58, v56, v58
  v_mul_u32_u24 v57, 0x3000, v57
  v_lshl_add_u32 v57, v58, 4, v57
  buffer_load_dwordx4 v[60:63], v57, s[40:43], s34 offen
  v_add_u32 v56, 0x100, v0
  v_min_u32 v56, 0x17f, v56
  v_mul_u32_u24 v57, 0xaab, v56
  v_lshrrev_b32 v57, 16, v57
  v_mul_u32_u24 v58, 24, v57
  v_sub_u32 v58, v56, v58
  v_mul_u32_u24 v57, 0x3000, v57
  v_lshl_add_u32 v57, v58, 4, v57
  buffer_load_dwordx4 v[60:63], v57, s[40:43], s34 offen
  v_add_u32 v56, 0, v0
  v_min_u32 v56, 0x5f, v56
  s_mov_b32 s35, 0xaaab
  v_mul_u32_u24 v57, s35, v56
  v_lshrrev_b32 v57, 18, v57
  v_mul_u32_u24 v58, 6, v57
  v_sub_u32 v58, v56, v58
  v_mul_u32_u24 v57, 0xc00, v57
  v_lshl_add_u32 v57, v58, 4, v57
  buffer_load_dwordx4 v[60:63], v57, s[44:47], s36 offen
  buffer_load_dwordx4 v[60:63], v57, s[48:51], s36 offen
  s_getpc_b64 s[52:53]
L_k1_pc:
  s_add_u32 s52, s52, k2_main_kernel-L_k1_pc
  s_addc_u32 s53, s53, 0
  s_lshl_b32 s54, s33, 12
  v_lshlrev_b32 v56, 4, v0
  v_add_u32 v56, s54, v56
  v_min_u32 v56, CODE_END-k2_main_kernel-16, v56
  global_load_dwordx4 v[60:63], v56, s[52:53]
  v_min_u32 v56, 15, v0
  v_lshlrev_b32 v56, 2, v56
  s_mul_i32 s36, s2, 64
  s_add_u32 s36, s36, 0x300000
  v_mov_b32 v57, 0
  buffer_store_dword v57, v56, s[12:15], s36 offen
  v_lshrrev_b32 v4, 4, v2
  v_mul_u32_u24 v4, 0x5000, v4
  v_lshrrev_b32 v5, 3, v1
  v_lshl_add_u32 v4, v5, 10, v4
  v_and_b32 v5, 15, v2
  v_lshl_add_u32 v4, v5, 4, v4
  v_bfe_u32 v5, v1, 1, 2
  v_lshl_add_u32 v4, v5, 8, v4
  v_and_b32 v5, 1, v1
  v_lshl_add_u32 v4, v5, 3, v4
  s_mov_b32 s20, 0
  s_mov_b32 s21, 0x1000
  s_mov_b32 s22, 0x2000
  s_mov_b32 s23, 0x3000
  s_mov_b32 s26, 0x4000
  s_waitcnt vmcnt(10)
  v_lshlrev_b32 v20, 16, v8
  v_and_b32 v21, 0xffff0000, v8
  v_lshlrev_b32 v22, 16, v9
  v_and_b32 v23, 0xffff0000, v9
  s_waitcnt vmcnt(9)
  v_lshlrev_b32 v24, 16, v10
  v_and_b32 v25, 0xffff0000, v10
  v_lshlrev_b32 v26, 16, v11
  v_and_b32 v27, 0xffff0000, v11
  s_waitcnt vmcnt(8)
  v_lshlrev_b32 v28, 16, v12
  v_and_b32 v29, 0xffff0000, v12
  v_lshlrev_b32 v30, 16, v13
  v_and_b32 v31, 0xffff0000, v13
  s_waitcnt vmcnt(7)
  v_lshlrev_b32 v32, 16, v14
  v_and_b32 v33, 0xffff0000, v14
  v_lshlrev_b32 v34, 16, v15
  v_and_b32 v35, 0xffff0000, v15
  s_waitcnt vmcnt(6)
  v_lshlrev_b32 v36, 16, v16
  v_and_b32 v37, 0xffff0000, v16
  v_lshlrev_b32 v38, 16, v17
  v_and_b32 v39, 0xffff0000, v17
  v_add_f32 v40, v20, v24
  v_add_f32 v41, v21, v25
  v_add_f32 v42, v22, v26
  v_add_f32 v43, v23, v27
  v_add_f32 v40, v40, v28
  v_add_f32 v41, v41, v29
  v_add_f32 v42, v42, v30
  v_add_f32 v43, v43, v31
  v_add_f32 v40, v40, v32
  v_add_f32 v41, v41, v33
  v_add_f32 v42, v42, v34
  v_add_f32 v43, v43, v35
  v_add_f32 v40, v40, v36
  v_add_f32 v41, v41, v37
  v_add_f32 v42, v42, v38
  v_add_f32 v43, v43, v39
  v_add_f32 v40, v40, v41
  v_add_f32 v42, v42, v43
  v_add_f32 v40, v40, v42
  s_nop 1
  v_add_f32_dpp v41, v40, v40 row_ror:8 row_mask:0xf bank_mask:0xf
  v_mov_b32 v40, v41
  s_nop 1
  v_add_f32_dpp v41, v40, v40 row_ror:4 row_mask:0xf bank_mask:0xf
  v_mov_b32 v40, v41
  s_nop 1
  v_add_f32_dpp v41, v40, v40 row_ror:2 row_mask:0xf bank_mask:0xf
  v_mov_b32 v40, v41
  s_nop 1
  v_add_f32_dpp v41, v40, v40 row_ror:1 row_mask:0xf bank_mask:0xf
  v_mov_b32 v40, v41
  s_nop 1
  v_permlane16_swap_b32 v41, v40
  v_add_f32 v40, v40, v41
  v_mul_f32 v40, 0x3acccccd, v40
  v_sub_f32 v48, v20, v40
  v_mul_f32 v44, v48, v48
  v_sub_f32 v49, v21, v40
  v_mul_f32 v45, v49, v49
  v_sub_f32 v50, v22, v40
  v_mul_f32 v46, v50, v50
  v_sub_f32 v51, v23, v40
  v_mul_f32 v47, v51, v51
  v_sub_f32 v52, v24, v40
  v_fmac_f32 v44, v52, v52
  v_sub_f32 v53, v25, v40
  v_fmac_f32 v45, v53, v53
  v_sub_f32 v54, v26, v40
  v_fmac_f32 v46, v54, v54
  v_sub_f32 v55, v27, v40
  v_fmac_f32 v47, v55, v55
  v_sub_f32 v48, v28, v40
  v_fmac_f32 v44, v48, v48
  v_sub_f32 v49, v29, v40
  v_fmac_f32 v45, v49, v49
  v_sub_f32 v50, v30, v40
  v_fmac_f32 v46, v50, v50
  v_sub_f32 v51, v31, v40
  v_fmac_f32 v47, v51, v51
  v_sub_f32 v52, v32, v40
  v_fmac_f32 v44, v52, v52
  v_sub_f32 v53, v33, v40
  v_fmac_f32 v45, v53, v53
  v_sub_f32 v54, v34, v40
  v_fmac_f32 v46, v54, v54
  v_sub_f32 v55, v35, v40
  v_fmac_f32 v47, v55, v55
  v_sub_f32 v48, v36, v40
  v_fmac_f32 v44, v48, v48
  v_sub_f32 v49, v37, v40
  v_fmac_f32 v45, v49, v49
  v_sub_f32 v50, v38, v40
  v_fmac_f32 v46, v50, v50
  v_sub_f32 v51, v39, v40
  v_fmac_f32 v47, v51, v51
  v_add_f32 v44, v44, v45
  v_add_f32 v46, v46, v47
  v_add_f32 v44, v44, v46
  s_nop 1
  v_add_f32_dpp v41, v44, v44 row_ror:8 row_mask:0xf bank_mask:0xf
  v_mov_b32 v44, v41
  s_nop 1
  v_add_f32_dpp v41, v44, v44 row_ror:4 row_mask:0xf bank_mask:0xf
  v_mov_b32 v44, v41
  s_nop 1
  v_add_f32_dpp v41, v44, v44 row_ror:2 row_mask:0xf bank_mask:0xf
  v_mov_b32 v44, v41
  s_nop 1
  v_add_f32_dpp v41, v44, v44 row_ror:1 row_mask:0xf bank_mask:0xf
  v_mov_b32 v44, v41
  s_nop 1
  v_permlane16_swap_b32 v41, v44
  v_add_f32 v44, v44, v41
  v_mul_f32 v44, 0x3acccccd, v44
  v_cvt_pk_bf16_f32 v41, v40, v44
  v_lshlrev_b32 v40, 16, v41
  v_and_b32 v44, 0xffff0000, v41
  v_add_f32 v44, 0x3727c5ac, v44
  v_cvt_pk_bf16_f32 v44, v44, v44
  v_lshlrev_b32 v44, 16, v44
  v_sqrt_f32 v44, v44
  s_nop 0
  v_cvt_pk_bf16_f32 v44, v44, v44
  v_lshlrev_b32 v44, 16, v44
  v_rcp_f32 v45, v44
  v_sub_f32 v20, v20, v40
  v_sub_f32 v21, v21, v40
  v_cvt_pk_bf16_f32 v48, v20, v21
  v_lshlrev_b32 v20, 16, v48
  v_and_b32 v21, 0xffff0000, v48
  v_mul_f32 v48, v20, v45
  v_mul_f32 v49, v21, v45
  v_fma_f32 v50, -v48, v44, v20
  v_fma_f32 v51, -v49, v44, v21
  v_fmac_f32 v48, v50, v45
  v_fmac_f32 v49, v51, v45
  v_cvt_pk_bf16_f32 v8, v48, v49
  v_sub_f32 v22, v22, v40
  v_sub_f32 v23, v23, v40
  v_cvt_pk_bf16_f32 v52, v22, v23
  v_lshlrev_b32 v22, 16, v52
  v_and_b32 v23, 0xffff0000, v52
  v_mul_f32 v52, v22, v45
  v_mul_f32 v53, v23, v45
  v_fma_f32 v54, -v52, v44, v22
  v_fma_f32 v55, -v53, v44, v23
  v_fmac_f32 v52, v54, v45
  v_fmac_f32 v53, v55, v45
  v_cvt_pk_bf16_f32 v9, v52, v53
  buffer_store_dwordx2 v[8:9], v4, s[12:15], s20 offen
  v_sub_f32 v24, v24, v40
  v_sub_f32 v25, v25, v40
  v_cvt_pk_bf16_f32 v48, v24, v25
  v_lshlrev_b32 v24, 16, v48
  v_and_b32 v25, 0xffff0000, v48
  v_mul_f32 v48, v24, v45
  v_mul_f32 v49, v25, v45
  v_fma_f32 v50, -v48, v44, v24
  v_fma_f32 v51, -v49, v44, v25
  v_fmac_f32 v48, v50, v45
  v_fmac_f32 v49, v51, v45
  v_cvt_pk_bf16_f32 v10, v48, v49
  v_sub_f32 v26, v26, v40
  v_sub_f32 v27, v27, v40
  v_cvt_pk_bf16_f32 v52, v26, v27
  v_lshlrev_b32 v26, 16, v52
  v_and_b32 v27, 0xffff0000, v52
  v_mul_f32 v52, v26, v45
  v_mul_f32 v53, v27, v45
  v_fma_f32 v54, -v52, v44, v26
  v_fma_f32 v55, -v53, v44, v27
  v_fmac_f32 v52, v54, v45
  v_fmac_f32 v53, v55, v45
  v_cvt_pk_bf16_f32 v11, v52, v53
  buffer_store_dwordx2 v[10:11], v4, s[12:15], s21 offen
  v_sub_f32 v28, v28, v40
  v_sub_f32 v29, v29, v40
  v_cvt_pk_bf16_f32 v48, v28, v29
  v_lshlrev_b32 v28, 16, v48
  v_and_b32 v29, 0xffff0000, v48
  v_mul_f32 v48, v28, v45
  v_mul_f32 v49, v29, v45
  v_fma_f32 v50, -v48, v44, v28
  v_fma_f32 v51, -v49, v44, v29
  v_fmac_f32 v48, v50, v45
  v_fmac_f32 v49, v51, v45
  v_cvt_pk_bf16_f32 v12, v48, v49
  v_sub_f32 v30, v30, v40
  v_sub_f32 v31, v31, v40
  v_cvt_pk_bf16_f32 v52, v30, v31
  v_lshlrev_b32 v30, 16, v52
  v_and_b32 v31, 0xffff0000, v52
  v_mul_f32 v52, v30, v45
  v_mul_f32 v53, v31, v45
  v_fma_f32 v54, -v52, v44, v30
  v_fma_f32 v55, -v53, v44, v31
  v_fmac_f32 v52, v54, v45
  v_fmac_f32 v53, v55, v45
  v_cvt_pk_bf16_f32 v13, v52, v53
  buffer_store_dwordx2 v[12:13], v4, s[12:15], s22 offen
  v_sub_f32 v32, v32, v40
  v_sub_f32 v33, v33, v40
  v_cvt_pk_bf16_f32 v48, v32, v33
  v_lshlrev_b32 v32, 16, v48
  v_and_b32 v33, 0xffff0000, v48
  v_mul_f32 v48, v32, v45
  v_mul_f32 v49, v33, v45
  v_fma_f32 v50, -v48, v44, v32
  v_fma_f32 v51, -v49, v44, v33
  v_fmac_f32 v48, v50, v45
  v_fmac_f32 v49, v51, v45
  v_cvt_pk_bf16_f32 v14, v48, v49
  v_sub_f32 v34, v34, v40
  v_sub_f32 v35, v35, v40
  v_cvt_pk_bf16_f32 v52, v34, v35
  v_lshlrev_b32 v34, 16, v52
  v_and_b32 v35, 0xffff0000, v52
  v_mul_f32 v52, v34, v45
  v_mul_f32 v53, v35, v45
  v_fma_f32 v54, -v52, v44, v34
  v_fma_f32 v55, -v53, v44, v35
  v_fmac_f32 v52, v54, v45
  v_fmac_f32 v53, v55, v45
  v_cvt_pk_bf16_f32 v15, v52, v53
  buffer_store_dwordx2 v[14:15], v4, s[12:15], s23 offen
  v_sub_f32 v36, v36, v40
  v_sub_f32 v37, v37, v40
  v_cvt_pk_bf16_f32 v48, v36, v37
  v_lshlrev_b32 v36, 16, v48
  v_and_b32 v37, 0xffff0000, v48
  v_mul_f32 v48, v36, v45
  v_mul_f32 v49, v37, v45
  v_fma_f32 v50, -v48, v44, v36
  v_fma_f32 v51, -v49, v44, v37
  v_fmac_f32 v48, v50, v45
  v_fmac_f32 v49, v51, v45
  v_cvt_pk_bf16_f32 v16, v48, v49
  v_sub_f32 v38, v38, v40
  v_sub_f32 v39, v39, v40
  v_cvt_pk_bf16_f32 v52, v38, v39
  v_lshlrev_b32 v38, 16, v52
  v_and_b32 v39, 0xffff0000, v52
  v_mul_f32 v52, v38, v45
  v_mul_f32 v53, v39, v45
  v_fma_f32 v54, -v52, v44, v38
  v_fma_f32 v55, -v53, v44, v39
  v_fmac_f32 v52, v54, v45
  v_fmac_f32 v53, v55, v45
  v_cvt_pk_bf16_f32 v17, v52, v53
  buffer_store_dwordx2 v[16:17], v4, s[12:15], s26 offen
L_k1_end:
  s_endpgm
.globl k2_main_kernel
.p2align 8
.type k2_main_kernel,@function
k2_main_kernel:
  s_cmp_ge_u32 s2, 0x100
  s_cbranch_scc1 L_k2_end
  s_load_dwordx4 s[92:95], s[0:1], 0x18
  s_load_dwordx4 s[96:99], s[0:1], 0x30
  s_load_dwordx2 s[100:101], s[0:1], 0x58
  s_load_dwordx4 s[88:91], s[0:1], 0x8
  s_load_dwordx2 s[36:37], s[0:1], 0x0
  s_load_dwordx4 s[40:43], s[0:1], 0x40
  s_getpc_b64 s[60:61]
L_k2_pc:
  s_add_u32 s60, s60, STAGE_TBL-L_k2_pc
  s_addc_u32 s61, s61, 0
  s_and_b32 s3, s2, 31
  s_lshl_b32 s3, s3, 4
  s_add_u32 s60, s60, s3
  s_addc_u32 s61, s61, 0
  s_load_dwordx4 s[32:35], s[60:61], 0x0
  v_lshrrev_b32 v193, 6, v0
  v_and_b32 v212, 63, v0
  v_readfirstlane_b32 s44, v193
  s_and_b32 s47, s2, 7
  s_lshl_b32 s49, s47, 2
  s_lshr_b32 s50, s2, 3
  s_and_b32 s48, s50, 3
  s_lshr_b32 s46, s2, 5
  s_lshl_b32 s49, s47, 5
  s_add_u32 s49, s49, 5
  s_mul_i32 s49, s49, 0xaaab
  s_lshr_b32 s49, s49, 18
  s_add_u32 s49, s49, s48
  s_lshl_b32 s50, s48, 3
  s_lshr_b32 s50, 0xf0a0504, s50
  s_and_b32 s50, s50, 0xff
  s_and_b32 s51, s47, 1
  s_lshl_b32 s51, s51, 4
  s_add_u32 s50, s50, s51
  s_cmp_lt_u32 s47, 6
  s_cselect_b32 s45, s49, s50
  s_lshl_b32 s49, s46, 4
  s_lshl_b32 s50, s44, 2
  s_add_u32 s53, s49, s50
  s_mul_i32 s50, s53, 0x5000
  v_lshlrev_b32 v193, 4, v212
  v_add_u32 v231, s50, v193
  v_add_u32 v232, 0x5000, v231
  v_add_u32 v233, 0xa000, v231
  v_add_u32 v234, 0xf000, v231
  v_bfe_u32 v194, v212, 2, 2
  v_and_b32 v195, 3, v212
  v_lshlrev_b32 v195, 4, v195
  v_lshrrev_b32 v202, 4, v212
  v_lshl_add_u32 v196, v202, 6, v195
  v_bfe_u32 v197, v212, 4, 1
  v_lshl_add_u32 v197, v197, 6, v195
  v_add_u32 v197, 0x100, v197
  v_lshrrev_b32 v198, 5, v212
  v_lshl_add_u32 v198, v198, 2, v194
  s_lshl_b32 s49, s44, 3
  v_add_u32 v199, s49, v194
  v_add_u32 v200, s49, v198
  v_mul_u32_u24 v199, 0x3000, v199
  v_mul_u32_u24 v200, 0x3000, v200
  v_add_u32 v213, v199, v196
  v_add_u32 v215, v200, v197
  v_add_u32 v214, 0xc000, v213
  s_and_b32 s49, s44, 1
  s_lshl_b32 s51, s49, 6
  s_mov_b32 s50, 0xaaab
  v_add_u32 v199, s51, v212
  v_add_u32 v199, 0, v199
  v_mul_u32_u24 v200, s50, v199
  v_lshrrev_b32 v200, 18, v200
  v_mul_u32_u24 v201, 6, v200
  v_sub_u32 v199, v199, v201
  v_bfe_u32 v201, v200, 2, 2
  v_lshlrev_b32 v201, 3, v201
  v_and_b32 v216, 3, v200
  v_add_u32 v201, v201, v216
  v_lshrrev_b32 v200, 4, v200
  v_lshl_add_u32 v201, v200, 2, v201
  v_mul_u32_u24 v201, 0xc00, v201
  v_lshl_add_u32 v216, v199, 4, v201
  v_add_u32 v199, s51, v212
  v_add_u32 v199, 64, v199
  v_mul_u32_u24 v200, s50, v199
  v_lshrrev_b32 v200, 18, v200
  v_mul_u32_u24 v201, 6, v200
  v_sub_u32 v199, v199, v201
  v_bfe_u32 v201, v200, 2, 2
  v_lshlrev_b32 v201, 3, v201
  v_and_b32 v217, 3, v200
  v_add_u32 v201, v201, v217
  v_lshrrev_b32 v200, 4, v200
  v_lshl_add_u32 v201, v200, 2, v201
  v_mul_u32_u24 v201, 0xc00, v201
  v_lshl_add_u32 v217, v199, 4, v201
  s_lshr_b32 s50, s44, 1
  s_mul_i32 s74, s50, 0xc00
  s_lshl_b32 s51, s49, 10
  s_add_u32 s74, s74, s51
  s_add_u32 s74, s74, 0x3040
  s_mul_i32 s71, s44, 0xc08
  s_mov_b32 s55, 0
  s_mov_b32 s58, 0
  s_mov_b32 s59, 0
  s_mov_b32 s62, 0
  s_waitcnt lgkmcnt(0)
  s_mov_b32 s20, s100
  s_and_b32 s21, s101, 0xffff
  s_mov_b32 s22, 0x10000000
  s_mov_b32 s23, 0x20000
  s_mul_i32 s49, s45, 0x180
  s_add_u32 s92, s92, s49
  s_addc_u32 s93, s93, 0
  s_sub_u32 s50, 0x780000, s49
  s_mov_b32 s4, s92
  s_and_b32 s5, s93, 0xffff
  s_mov_b32 s6, s50
  s_mov_b32 s7, 0x20000
  s_cmp_lt_u32 s44, 2
  s_cselect_b32 s51, s96, s98
  s_cselect_b32 s52, s97, s99
  s_mul_i32 s49, s45, 0x60
  s_add_u32 s51, s51, s49
  s_addc_u32 s52, s52, 0
  s_sub_u32 s50, 0x1e0000, s49
  s_mov_b32 s8, s51
  s_and_b32 s9, s52, 0xffff
  s_mov_b32 s10, s50
  s_mov_b32 s11, 0x20000
  buffer_load_dwordx4 a[96:99], v231, s[20:23], s62 offen
  buffer_load_dwordx4 a[100:103], v232, s[20:23], s62 offen
  buffer_load_dwordx4 a[104:107], v233, s[20:23], s62 offen
  buffer_load_dwordx4 a[108:111], v234, s[20:23], s62 offen
  s_add_u32 s57, s55, s71
  s_add_u32 m0, s57, 0
  s_nop 0
  buffer_load_dwordx4 v213, s[4:7], s58 offen nt lds
  s_add_u32 m0, s57, 0x400
  s_nop 0
  buffer_load_dwordx4 v214, s[4:7], s58 offen nt lds
  s_add_u32 m0, s57, 0x800
  s_nop 0
  buffer_load_dwordx4 v215, s[4:7], s58 offen nt lds
  s_add_u32 s57, s55, s74
  s_add_u32 m0, s57, 0
  s_nop 0
  buffer_load_dwordx4 v216, s[8:11], s59 offen nt lds
  s_add_u32 m0, s57, 0x400
  s_nop 0
  buffer_load_dwordx4 v217, s[8:11], s59 offen nt lds
  s_add_u32 s58, s58, 0x60000
  s_add_u32 s59, s59, 0x18000
  s_add_u32 s55, s55, 0x6080
  s_cmp_ge_u32 s55, 0x24300
  s_cselect_b32 s55, 0, s55
  buffer_load_dwordx4 a[112:115], v231, s[20:23], s62 offen offset:1024
  buffer_load_dwordx4 a[116:119], v232, s[20:23], s62 offen offset:1024
  buffer_load_dwordx4 a[120:123], v233, s[20:23], s62 offen offset:1024
  buffer_load_dwordx4 a[124:127], v234, s[20:23], s62 offen offset:1024
  v_mul_u32_u24 v225, 0xc08, v202
  v_lshl_add_u32 v225, v194, 6, v225
  v_add_u32 v225, v225, v195
  v_lshrrev_b32 v227, 2, v212
  v_mul_u32_u24 v227, 0x60, v227
  v_lshrrev_b32 v199, 1, v195
  v_add_u32 v227, v227, v199
  s_mov_b32 s54, 0x1e280
  s_add_u32 s57, s55, s71
  s_add_u32 m0, s57, 0
  s_nop 0
  buffer_load_dwordx4 v213, s[4:7], s58 offen nt lds
  s_add_u32 m0, s57, 0x400
  s_nop 0
  buffer_load_dwordx4 v214, s[4:7], s58 offen nt lds
  s_add_u32 m0, s57, 0x800
  s_nop 0
  buffer_load_dwordx4 v215, s[4:7], s58 offen nt lds
  s_add_u32 s57, s55, s74
  s_add_u32 m0, s57, 0
  s_nop 0
  buffer_load_dwordx4 v216, s[8:11], s59 offen nt lds
  s_add_u32 m0, s57, 0x400
  s_nop 0
  buffer_load_dwordx4 v217, s[8:11], s59 offen nt lds
  s_add_u32 s58, s58, 0x60000
  s_add_u32 s59, s59, 0x18000
  s_add_u32 s55, s55, 0x6080
  s_cmp_ge_u32 s55, 0x24300
  s_cselect_b32 s55, 0, s55
  s_waitcnt vmcnt(9)
  s_barrier
  s_add_u32 s54, s54, 0x6080
  s_cmp_ge_u32 s54, 0x24300
  s_cselect_b32 s54, 0, s54
  v_add_u32 v228, s54, v225
  v_add_u32 v229, s54, v227
  ds_read_b64_tr_b16 a[208:209], v228
  ds_read_b64_tr_b16 a[210:211], v228 offset:1024
  ds_read_b64_tr_b16 a[212:213], v228 offset:8
  ds_read_b64_tr_b16 a[214:215], v228 offset:1032
  ds_read_b64_tr_b16 a[216:217], v228 offset:256
  ds_read_b64_tr_b16 a[218:219], v228 offset:1280
  ds_read_b64_tr_b16 a[220:221], v228 offset:264
  ds_read_b64_tr_b16 a[222:223], v228 offset:1288
  ds_read_b64_tr_b16 a[224:225], v228 offset:512
  ds_read_b64_tr_b16 a[226:227], v228 offset:1536
  ds_read_b64_tr_b16 a[228:229], v228 offset:520
  ds_read_b64_tr_b16 a[230:231], v228 offset:1544
  s_waitcnt lgkmcnt(10)
  v_mfma_f32_16x16x32_bf16 v[0:3], a[208:211], a[96:99], 0
  ds_read_b64_tr_b16 a[232:233], v228 offset:768
  s_mul_i32 s51, s53, 0x3c000
  v_mfma_f32_16x16x32_bf16 v[8:11], a[208:211], a[100:103], 0
  ds_read_b64_tr_b16 a[234:235], v228 offset:1792
  v_add_u32 v235, s51, v193
  v_mfma_f32_16x16x32_bf16 v[16:19], a[208:211], a[104:107], 0
  buffer_load_dwordx4 a[128:131], v231, s[20:23], s62 offen offset:2048
  v_add_u32 v236, 0x3c000, v235
  v_mfma_f32_16x16x32_bf16 v[24:27], a[208:211], a[108:111], 0
  s_waitcnt lgkmcnt(10)
  v_add_u32 v237, 0x78000, v235
  v_mfma_f32_16x16x32_bf16 v[4:7], a[212:215], a[96:99], 0
  ds_read_b64_tr_b16 a[236:237], v228 offset:776
  v_add_u32 v238, 0xb4000, v235
  v_mfma_f32_16x16x32_bf16 v[12:15], a[212:215], a[100:103], 0
  ds_read_b64_tr_b16 a[238:239], v228 offset:1800
  v_mfma_f32_16x16x32_bf16 v[20:23], a[212:215], a[104:107], 0
  buffer_load_dwordx4 a[132:135], v232, s[20:23], s62 offen offset:2048
  s_lshl_b32 s49, s44, 3
  v_mfma_f32_16x16x32_bf16 v[28:31], a[212:215], a[108:111], 0
  s_waitcnt lgkmcnt(10)
  v_add_u32 v199, s49, v194
  v_mfma_f32_16x16x32_bf16 v[32:35], a[216:219], a[96:99], 0
  ds_read_b64_tr_b16 a[240:241], v228 offset:2048
  v_add_u32 v200, s49, v198
  v_mfma_f32_16x16x32_bf16 v[40:43], a[216:219], a[100:103], 0
  ds_read_b64_tr_b16 a[242:243], v228 offset:2560
  v_mul_u32_u24 v199, 0x180, v199
  v_mfma_f32_16x16x32_bf16 v[48:51], a[216:219], a[104:107], 0
  buffer_load_dwordx4 a[136:139], v233, s[20:23], s62 offen offset:2048
  v_mul_u32_u24 v200, 0x180, v200
  v_mfma_f32_16x16x32_bf16 v[56:59], a[216:219], a[108:111], 0
  s_waitcnt lgkmcnt(10)
  v_add_u32 v223, v199, v196
  v_mfma_f32_16x16x32_bf16 v[36:39], a[220:223], a[96:99], 0
  ds_read_b64_tr_b16 a[244:245], v228 offset:2056
  v_add_u32 v224, v200, v197
  v_mfma_f32_16x16x32_bf16 v[44:47], a[220:223], a[100:103], 0
  ds_read_b64_tr_b16 a[246:247], v228 offset:2568
  v_mfma_f32_16x16x32_bf16 v[52:55], a[220:223], a[104:107], 0
  buffer_load_dwordx4 a[140:143], v234, s[20:23], s62 offen offset:2048
  v_lshrrev_b32 v199, 3, v212
  v_mfma_f32_16x16x32_bf16 v[60:63], a[220:223], a[108:111], 0
  s_waitcnt lgkmcnt(10)
  v_add_u32 v199, s49, v199
  v_mfma_f32_16x16x32_bf16 v[64:67], a[224:227], a[96:99], 0
  ds_read_b64_tr_b16 a[248:249], v228 offset:2304
  v_bfe_u32 v200, v199, 1, 1
  v_mfma_f32_16x16x32_bf16 v[72:75], a[224:227], a[100:103], 0
  ds_read_b64_tr_b16 a[250:251], v228 offset:2816
  v_bfe_u32 v201, v199, 3, 2
  v_mfma_f32_16x16x32_bf16 v[80:83], a[224:227], a[104:107], 0
  s_add_u32 s57, s55, s71
  s_add_u32 m0, s57, 0
  v_lshl_add_u32 v200, v201, 1, v200
  v_mfma_f32_16x16x32_bf16 v[88:91], a[224:227], a[108:111], 0
  buffer_load_dwordx4 v213, s[4:7], s58 offen nt lds
  s_waitcnt lgkmcnt(10)
  v_mfma_f32_16x16x32_bf16 v[68:71], a[228:231], a[96:99], 0
  ds_read_b64_tr_b16 a[252:253], v228 offset:2312
  s_add_u32 m0, s57, 0x400
  v_mfma_f32_16x16x32_bf16 v[76:79], a[228:231], a[100:103], 0
  buffer_load_dwordx4 v214, s[4:7], s58 offen nt lds
  v_and_b32 v201, 7, v212
  v_mfma_f32_16x16x32_bf16 v[84:87], a[228:231], a[104:107], 0
  ds_read_b64_tr_b16 a[254:255], v228 offset:2824
  s_add_u32 m0, s57, 0x800
  v_mfma_f32_16x16x32_bf16 v[92:95], a[228:231], a[108:111], 0
  buffer_load_dwordx4 v215, s[4:7], s58 offen nt lds
  s_waitcnt lgkmcnt(10)
  v_mfma_f32_16x16x32_bf16 v[96:99], a[232:235], a[96:99], 0
  s_add_u32 s57, s55, s74
  s_add_u32 m0, s57, 0
  v_xor_b32 v200, v200, v201
  v_mfma_f32_16x16x32_bf16 v[104:107], a[232:235], a[100:103], 0
  ds_read_b64_tr_b16 a[208:209], v229 offset:12352
  v_mul_u32_u24 v199, 0x180, v199
  v_mfma_f32_16x16x32_bf16 v[112:115], a[232:235], a[104:107], 0
  buffer_load_dwordx4 v216, s[8:11], s59 offen nt lds
  v_lshl_add_u32 v222, v200, 4, v199
  v_mfma_f32_16x16x32_bf16 v[120:123], a[232:235], a[108:111], 0
  ds_read_b64_tr_b16 a[210:211], v229 offset:13888
  s_add_u32 m0, s57, 0x400
  s_waitcnt lgkmcnt(10)
  v_mfma_f32_16x16x32_bf16 v[100:103], a[236:239], a[96:99], 0
  buffer_load_dwordx4 a[144:147], v231, s[20:23], s62 offen offset:3072
  buffer_load_dwordx4 v217, s[8:11], s59 offen nt lds
  v_mfma_f32_16x16x32_bf16 v[108:111], a[236:239], a[100:103], 0
  s_add_u32 s58, s58, 0x60000
  s_add_u32 s59, s59, 0x18000
  v_and_b32 v199, 3, v212
  v_mfma_f32_16x16x32_bf16 v[116:119], a[236:239], a[104:107], 0
  ds_read_b64_tr_b16 a[212:213], v229 offset:15424
  v_lshl_add_u32 v199, v194, 3, v199
  v_mfma_f32_16x16x32_bf16 v[124:127], a[236:239], a[108:111], 0
  ds_read_b64_tr_b16 a[214:215], v229 offset:16960
  s_add_u32 s55, s55, 0x6080
  s_cmp_ge_u32 s55, 0x24300
  s_cselect_b32 s55, 0, s55
  s_waitcnt lgkmcnt(10)
  v_mfma_f32_16x16x32_bf16 v[128:131], a[240:243], a[96:99], 0
  buffer_load_dwordx4 a[148:151], v232, s[20:23], s62 offen offset:3072
  v_bfe_u32 v200, v212, 1, 1
  v_mfma_f32_16x16x32_bf16 v[136:139], a[240:243], a[100:103], 0
  s_add_u32 s57, s55, s71
  s_add_u32 m0, s57, 0
  v_lshl_add_u32 v200, v194, 1, v200
  v_mfma_f32_16x16x32_bf16 v[144:147], a[240:243], a[104:107], 0
  ds_read_b64_tr_b16 a[216:217], v229 offset:12384
  buffer_load_dwordx4 v213, s[4:7], s58 offen nt lds
  v_mfma_f32_16x16x32_bf16 v[152:155], a[240:243], a[108:111], 0
  ds_read_b64_tr_b16 a[218:219], v229 offset:13920
  s_add_u32 m0, s57, 0x400
  s_waitcnt lgkmcnt(10)
  v_mfma_f32_16x16x32_bf16 v[132:135], a[244:247], a[96:99], 0
  buffer_load_dwordx4 a[152:155], v233, s[20:23], s62 offen offset:3072
  buffer_load_dwordx4 v214, s[4:7], s58 offen nt lds
  v_mfma_f32_16x16x32_bf16 v[140:143], a[244:247], a[100:103], 0
  ds_read_b64_tr_b16 a[220:221], v229 offset:15456
  s_add_u32 m0, s57, 0x800
  v_mfma_f32_16x16x32_bf16 v[148:151], a[244:247], a[104:107], 0
  buffer_load_dwordx4 v215, s[4:7], s58 offen nt lds
  v_xor_b32 v200, v200, v202
  v_mfma_f32_16x16x32_bf16 v[156:159], a[244:247], a[108:111], 0
  ds_read_b64_tr_b16 a[222:223], v229 offset:16992
  s_add_u32 s57, s55, s74
  s_add_u32 m0, s57, 0
  s_waitcnt lgkmcnt(10)
  v_mfma_f32_16x16x32_bf16 v[160:163], a[248:251], a[96:99], 0
  buffer_load_dwordx4 a[156:159], v234, s[20:23], s62 offen offset:3072
  buffer_load_dwordx4 v216, s[8:11], s59 offen nt lds
  v_mfma_f32_16x16x32_bf16 v[168:171], a[248:251], a[100:103], 0
  s_add_u32 s62, s62, 0x1000
  s_add_u32 m0, s57, 0x400
  v_lshlrev_b32 v199, 7, v199
  v_mfma_f32_16x16x32_bf16 v[176:179], a[248:251], a[104:107], 0
  ds_read_b64_tr_b16 a[224:225], v229 offset:12416
  buffer_load_dwordx4 v217, s[8:11], s59 offen nt lds
  v_mfma_f32_16x16x32_bf16 v[184:187], a[248:251], a[108:111], 0
  ds_read_b64_tr_b16 a[226:227], v229 offset:13952
  s_add_u32 s58, s58, 0x60000
  s_add_u32 s59, s59, 0x18000
  s_waitcnt lgkmcnt(10)
  v_mfma_f32_16x16x32_bf16 v[164:167], a[252:255], a[96:99], 0
  s_add_u32 s55, s55, 0x6080
  s_cmp_ge_u32 s55, 0x24300
  s_cselect_b32 s55, 0, s55
  v_mfma_f32_16x16x32_bf16 v[172:175], a[252:255], a[100:103], 0
  ds_read_b64_tr_b16 a[228:229], v229 offset:15488
  v_lshl_add_u32 v226, v200, 4, v199
  v_mfma_f32_16x16x32_bf16 v[180:183], a[252:255], a[104:107], 0
  s_add_u32 s54, s54, 0x6080
  s_cmp_ge_u32 s54, 0x24300
  s_cselect_b32 s54, 0, s54
  v_mfma_f32_16x16x32_bf16 v[188:191], a[252:255], a[108:111], 0
  ds_read_b64_tr_b16 a[230:231], v229 offset:17024
  s_waitcnt lgkmcnt(10)
  v_mfma_f32_16x16x32_bf16 a[0:3], a[208:211], a[96:99], 0
  s_waitcnt vmcnt(18)
  s_barrier
  v_add_u32 v228, s54, v225
  v_add_u32 v229, s54, v227
  v_mfma_f32_16x16x32_bf16 a[8:11], a[208:211], a[100:103], 0
  ds_read_b64_tr_b16 a[232:233], v228
  v_mul_u32_u24 v218, 0x808, v202
  v_mfma_f32_16x16x32_bf16 a[16:19], a[208:211], a[104:107], 0
  ds_read_b64_tr_b16 a[234:235], v228 offset:1024
  v_lshl_add_u32 v218, v194, 6, v218
  v_mfma_f32_16x16x32_bf16 a[24:27], a[208:211], a[108:111], 0
  s_waitcnt lgkmcnt(10)
  v_add_u32 v218, v218, v195
  v_and_b32 v199, 1, v202
  v_mfma_f32_16x16x32_bf16 a[4:7], a[212:215], a[96:99], 0
  ds_read_b64_tr_b16 a[236:237], v228 offset:8
  v_mul_u32_u24 v219, 0x408, v199
  v_mfma_f32_16x16x32_bf16 a[12:15], a[212:215], a[100:103], 0
  ds_read_b64_tr_b16 a[238:239], v228 offset:1032
  v_lshrrev_b32 v199, 1, v202
  v_mfma_f32_16x16x32_bf16 a[20:23], a[212:215], a[104:107], 0
  v_lshl_add_u32 v219, v199, 9, v219
  v_lshl_add_u32 v219, v194, 6, v219
  v_mfma_f32_16x16x32_bf16 a[28:31], a[212:215], a[108:111], 0
  s_waitcnt lgkmcnt(10)
  v_add_u32 v219, v219, v195
  v_mfma_f32_16x16x32_bf16 a[32:35], a[216:219], a[96:99], 0
  ds_read_b64_tr_b16 a[240:241], v228 offset:256
  v_mfma_f32_16x16x32_bf16 a[40:43], a[216:219], a[100:103], 0
  ds_read_b64_tr_b16 a[242:243], v228 offset:1280
  v_mfma_f32_16x16x32_bf16 a[48:51], a[216:219], a[104:107], 0
  v_mfma_f32_16x16x32_bf16 a[56:59], a[216:219], a[108:111], 0
  s_waitcnt lgkmcnt(10)
  v_mfma_f32_16x16x32_bf16 a[36:39], a[220:223], a[96:99], 0
  ds_read_b64_tr_b16 a[244:245], v228 offset:264
  v_mfma_f32_16x16x32_bf16 a[44:47], a[220:223], a[100:103], 0
  ds_read_b64_tr_b16 a[246:247], v228 offset:1288
  v_mfma_f32_16x16x32_bf16 a[52:55], a[220:223], a[104:107], 0
  v_mfma_f32_16x16x32_bf16 a[60:63], a[220:223], a[108:111], 0
  s_waitcnt lgkmcnt(10)
  v_mfma_f32_16x16x32_bf16 a[64:67], a[224:227], a[96:99], 0
  ds_read_b64_tr_b16 a[248:249], v228 offset:512
  v_mfma_f32_16x16x32_bf16 a[72:75], a[224:227], a[100:103], 0
  ds_read_b64_tr_b16 a[250:251], v228 offset:1536
  v_mfma_f32_16x16x32_bf16 a[80:83], a[224:227], a[104:107], 0
  v_mfma_f32_16x16x32_bf16 a[88:91], a[224:227], a[108:111], 0
  s_waitcnt lgkmcnt(10)
  v_mfma_f32_16x16x32_bf16 a[68:71], a[228:231], a[96:99], 0
  ds_read_b64_tr_b16 a[252:253], v228 offset:520
  v_mfma_f32_16x16x32_bf16 a[76:79], a[228:231], a[100:103], 0
  ds_read_b64_tr_b16 a[254:255], v228 offset:1544
  v_mfma_f32_16x16x32_bf16 a[84:87], a[228:231], a[104:107], 0
  v_mfma_f32_16x16x32_bf16 a[92:95], a[228:231], a[108:111], 0
  s_waitcnt lgkmcnt(10)
  v_mfma_f32_16x16x32_bf16 v[0:3], a[232:235], a[112:115], v[0:3]
  ds_read_b64_tr_b16 a[208:209], v228 offset:768
  s_mul_i32 s49, s45, 0xc0000
  v_mfma_f32_16x16x32_bf16 v[8:11], a[232:235], a[116:119], v[8:11]
  ds_read_b64_tr_b16 a[210:211], v228 offset:1792
  s_add_u32 s49, s49, 0x90000
  v_mfma_f32_16x16x32_bf16 v[16:19], a[232:235], a[120:123], v[16:19]
  buffer_load_dwordx4 a[96:99], v231, s[20:23], s62 offen
  v_mfma_f32_16x16x32_bf16 v[24:27], a[232:235], a[124:127], v[24:27]
  s_add_u32 s88, s88, s49
  s_addc_u32 s89, s89, 0
  s_waitcnt lgkmcnt(10)
  v_mfma_f32_16x16x32_bf16 v[4:7], a[236:239], a[112:115], v[4:7]
  ds_read_b64_tr_b16 a[212:213], v228 offset:776
  s_mov_b32 s12, s88
  v_mfma_f32_16x16x32_bf16 v[12:15], a[236:239], a[116:119], v[12:15]
  ds_read_b64_tr_b16 a[214:215], v228 offset:1800
  v_mfma_f32_16x16x32_bf16 v[20:23], a[236:239], a[120:123], v[20:23]
  buffer_load_dwordx4 a[100:103], v232, s[20:23], s62 offen
  v_mfma_f32_16x16x32_bf16 v[28:31], a[236:239], a[124:127], v[28:31]
  s_add_u32 s90, s90, s49
  s_addc_u32 s91, s91, 0
  s_waitcnt lgkmcnt(10)
  v_mfma_f32_16x16x32_bf16 v[32:35], a[240:243], a[112:115], v[32:35]
  ds_read_b64_tr_b16 a[216:217], v228 offset:2048
  s_and_b32 s13, s89, 0xffff
  v_mfma_f32_16x16x32_bf16 v[40:43], a[240:243], a[116:119], v[40:43]
  ds_read_b64_tr_b16 a[218:219], v228 offset:2560
  s_mov_b32 s14, 0x30000
  v_mfma_f32_16x16x32_bf16 v[48:51], a[240:243], a[120:123], v[48:51]
  buffer_load_dwordx4 a[104:107], v233, s[20:23], s62 offen
  s_mov_b32 s15, 0x20000
  v_mfma_f32_16x16x32_bf16 v[56:59], a[240:243], a[124:127], v[56:59]
  s_mov_b32 s16, s90
  s_and_b32 s17, s91, 0xffff
  s_waitcnt lgkmcnt(10)
  v_mfma_f32_16x16x32_bf16 v[36:39], a[244:247], a[112:115], v[36:39]
  ds_read_b64_tr_b16 a[220:221], v228 offset:2056
  s_mov_b32 s18, 0x30000
  v_mfma_f32_16x16x32_bf16 v[44:47], a[244:247], a[116:119], v[44:47]
  ds_read_b64_tr_b16 a[222:223], v228 offset:2568
  s_mov_b32 s19, 0x20000
  v_mfma_f32_16x16x32_bf16 v[52:55], a[244:247], a[120:123], v[52:55]
  buffer_load_dwordx4 a[108:111], v234, s[20:23], s62 offen
  v_mfma_f32_16x16x32_bf16 v[60:63], a[244:247], a[124:127], v[60:63]
  s_cmp_lt_u32 s47, 6
  s_cselect_b32 s94, s94, s40
  s_cselect_b32 s95, s95, s41
  s_cselect_b32 s96, 32, 24
  s_cselect_b32 s52, 0, 6
  s_cselect_b32 s97, 0, 0xc0
  s_cselect_b32 s53, 4, 1
  s_waitcnt lgkmcnt(10)
  v_mfma_f32_16x16x32_bf16 v[64:67], a[248:251], a[112:115], v[64:67]
  ds_read_b64_tr_b16 a[224:225], v228 offset:2304
  s_sub_u32 s49, s47, s52
  v_mfma_f32_16x16x32_bf16 v[72:75], a[248:251], a[116:119], v[72:75]
  ds_read_b64_tr_b16 a[226:227], v228 offset:2816
  s_mul_i32 s50, s49, s96
  v_mfma_f32_16x16x32_bf16 v[80:83], a[248:251], a[120:123], v[80:83]
  s_add_u32 s57, s55, s71
  s_add_u32 m0, s57, 0
  s_add_u32 s97, s97, s50
  v_mfma_f32_16x16x32_bf16 v[88:91], a[248:251], a[124:127], v[88:91]
  buffer_load_dwordx4 v213, s[4:7], s58 offen nt lds
  s_waitcnt lgkmcnt(10)
  v_mfma_f32_16x16x32_bf16 v[68:71], a[252:255], a[112:115], v[68:71]
  ds_read_b64_tr_b16 a[228:229], v228 offset:2312
  s_add_u32 m0, s57, 0x400
  v_mfma_f32_16x16x32_bf16 v[76:79], a[252:255], a[116:119], v[76:79]
  buffer_load_dwordx4 v214, s[4:7], s58 offen nt lds
  s_mul_i32 s50, s50, 0xa000
  v_mfma_f32_16x16x32_bf16 v[84:87], a[252:255], a[120:123], v[84:87]
  ds_read_b64_tr_b16 a[230:231], v228 offset:2824
  s_add_u32 m0, s57, 0x800
  v_mfma_f32_16x16x32_bf16 v[92:95], a[252:255], a[124:127], v[92:95]
  buffer_load_dwordx4 v215, s[4:7], s58 offen nt lds
  s_waitcnt lgkmcnt(10)
  v_mfma_f32_16x16x32_bf16 v[96:99], a[208:211], a[112:115], v[96:99]
  s_add_u32 s57, s55, s74
  s_add_u32 m0, s57, 0
  s_mul_i32 s53, s53, 0x1e0000
  v_mfma_f32_16x16x32_bf16 v[104:107], a[208:211], a[116:119], v[104:107]
  ds_read_b64_tr_b16 a[232:233], v229 offset:12352
  s_sub_u32 s53, s53, s50
  v_mfma_f32_16x16x32_bf16 v[112:115], a[208:211], a[120:123], v[112:115]
  buffer_load_dwordx4 v216, s[8:11], s59 offen nt lds
  s_mul_i32 s90, s96, 0x140
  v_mfma_f32_16x16x32_bf16 v[120:123], a[208:211], a[124:127], v[120:123]
  ds_read_b64_tr_b16 a[234:235], v229 offset:13888
  s_add_u32 m0, s57, 0x400
  s_waitcnt lgkmcnt(10)
  v_mfma_f32_16x16x32_bf16 v[100:103], a[212:215], a[112:115], v[100:103]
  buffer_load_dwordx4 v217, s[8:11], s59 offen nt lds
  v_mfma_f32_16x16x32_bf16 v[108:111], a[212:215], a[116:119], v[108:111]
  s_add_u32 s58, s58, 0x60000
  s_add_u32 s59, s59, 0x18000
  v_mfma_f32_16x16x32_bf16 v[116:119], a[212:215], a[120:123], v[116:119]
  ds_read_b64_tr_b16 a[236:237], v229 offset:15424
  s_mul_i32 s49, s48, 0x140
  v_mfma_f32_16x16x32_bf16 v[124:127], a[212:215], a[124:127], v[124:127]
  ds_read_b64_tr_b16 a[238:239], v229 offset:16960
  s_add_u32 s55, s55, 0x6080
  s_cmp_ge_u32 s55, 0x24300
  s_cselect_b32 s55, 0, s55
  s_waitcnt lgkmcnt(10)
  v_mfma_f32_16x16x32_bf16 v[128:131], a[216:219], a[112:115], v[128:131]
  s_add_u32 s57, s55, s71
  s_add_u32 m0, s57, 0
  v_mfma_f32_16x16x32_bf16 v[136:139], a[216:219], a[116:119], v[136:139]
  ds_read_b64_tr_b16 a[240:241], v229 offset:12384
  v_mfma_f32_16x16x32_bf16 v[144:147], a[216:219], a[120:123], v[144:147]
  buffer_load_dwordx4 v213, s[4:7], s58 offen nt lds
  v_mfma_f32_16x16x32_bf16 v[152:155], a[216:219], a[124:127], v[152:155]
  ds_read_b64_tr_b16 a[242:243], v229 offset:13920
  s_add_u32 m0, s57, 0x400
  s_waitcnt lgkmcnt(10)
  v_mfma_f32_16x16x32_bf16 v[132:135], a[220:223], a[112:115], v[132:135]
  buffer_load_dwordx4 v214, s[4:7], s58 offen nt lds
  s_add_u32 m0, s57, 0x800
  v_mfma_f32_16x16x32_bf16 v[140:143], a[220:223], a[116:119], v[140:143]
  ds_read_b64_tr_b16 a[244:245], v229 offset:15456
  v_mfma_f32_16x16x32_bf16 v[148:151], a[220:223], a[120:123], v[148:151]
  buffer_load_dwordx4 v215, s[4:7], s58 offen nt lds
  v_mfma_f32_16x16x32_bf16 v[156:159], a[220:223], a[124:127], v[156:159]
  ds_read_b64_tr_b16 a[246:247], v229 offset:16992
  s_add_u32 s57, s55, s74
  s_add_u32 m0, s57, 0
  s_waitcnt lgkmcnt(10)
  v_mfma_f32_16x16x32_bf16 v[160:163], a[224:227], a[112:115], v[160:163]
  buffer_load_dwordx4 v216, s[8:11], s59 offen nt lds
  s_add_u32 m0, s57, 0x400
  v_mfma_f32_16x16x32_bf16 v[168:171], a[224:227], a[116:119], v[168:171]
  ds_read_b64_tr_b16 a[248:249], v229 offset:12416
  v_mfma_f32_16x16x32_bf16 v[176:179], a[224:227], a[120:123], v[176:179]
  buffer_load_dwordx4 v217, s[8:11], s59 offen nt lds
  v_mfma_f32_16x16x32_bf16 v[184:187], a[224:227], a[124:127], v[184:187]
  ds_read_b64_tr_b16 a[250:251], v229 offset:13952
  s_add_u32 s58, s58, 0x60000
  s_add_u32 s59, s59, 0x18000
  s_waitcnt lgkmcnt(10)
  v_mfma_f32_16x16x32_bf16 v[164:167], a[228:231], a[112:115], v[164:167]
  s_add_u32 s55, s55, 0x6080
  s_cmp_ge_u32 s55, 0x24300
  s_cselect_b32 s55, 0, s55
  v_mfma_f32_16x16x32_bf16 v[172:175], a[228:231], a[116:119], v[172:175]
  ds_read_b64_tr_b16 a[252:253], v229 offset:15488
  v_mfma_f32_16x16x32_bf16 v[180:183], a[228:231], a[120:123], v[180:183]
  s_add_u32 s54, s54, 0x6080
  s_cmp_ge_u32 s54, 0x24300
  s_cselect_b32 s54, 0, s54
  v_mfma_f32_16x16x32_bf16 v[188:191], a[228:231], a[124:127], v[188:191]
  ds_read_b64_tr_b16 a[254:255], v229 offset:17024
  s_waitcnt lgkmcnt(10)
  v_mfma_f32_16x16x32_bf16 a[0:3], a[232:235], a[112:115], a[0:3]
  s_waitcnt vmcnt(22)
  s_barrier
  v_add_u32 v228, s54, v225
  v_add_u32 v229, s54, v227
  v_mfma_f32_16x16x32_bf16 a[8:11], a[232:235], a[116:119], a[8:11]
  ds_read_b64_tr_b16 a[208:209], v228
  v_mfma_f32_16x16x32_bf16 a[16:19], a[232:235], a[120:123], a[16:19]
  ds_read_b64_tr_b16 a[210:211], v228 offset:1024
  v_mfma_f32_16x16x32_bf16 a[24:27], a[232:235], a[124:127], a[24:27]
  s_add_u32 s94, s94, s50
  s_addc_u32 s95, s95, 0
  s_waitcnt lgkmcnt(10)
  v_mfma_f32_16x16x32_bf16 a[4:7], a[236:239], a[112:115], a[4:7]
  ds_read_b64_tr_b16 a[212:213], v228 offset:8
  s_lshr_b32 s52, s2, 3
  v_mfma_f32_16x16x32_bf16 a[12:15], a[236:239], a[116:119], a[12:15]
  ds_read_b64_tr_b16 a[214:215], v228 offset:1032
  s_lshl_b32 s52, s52, 2
  v_mfma_f32_16x16x32_bf16 a[20:23], a[236:239], a[120:123], a[20:23]
  s_add_u32 s52, s52, s44
  s_mul_i32 s52, s52, s90
  s_mov_b32 s27, 0x20000
  v_mfma_f32_16x16x32_bf16 a[28:31], a[236:239], a[124:127], a[28:31]
  s_add_u32 s88, s94, s52
  s_addc_u32 s89, s95, 0
  s_waitcnt lgkmcnt(10)
  v_mfma_f32_16x16x32_bf16 a[32:35], a[240:243], a[112:115], a[32:35]
  ds_read_b64_tr_b16 a[216:217], v228 offset:256
  s_sub_u32 s98, s53, s49
  v_mfma_f32_16x16x32_bf16 a[40:43], a[240:243], a[116:119], a[40:43]
  ds_read_b64_tr_b16 a[218:219], v228 offset:1280
  s_mov_b32 s26, s98
  v_mfma_f32_16x16x32_bf16 a[48:51], a[240:243], a[120:123], a[48:51]
  s_add_u32 s94, s94, s49
  s_addc_u32 s95, s95, 0
  s_mov_b32 s24, s94
  v_mfma_f32_16x16x32_bf16 a[56:59], a[240:243], a[124:127], a[56:59]
  s_and_b32 s25, s95, 0xffff
  s_mov_b32 s40, s42
  s_waitcnt lgkmcnt(10)
  v_mfma_f32_16x16x32_bf16 a[36:39], a[244:247], a[112:115], a[36:39]
  ds_read_b64_tr_b16 a[220:221], v228 offset:264
  s_and_b32 s41, s43, 0xffff
  v_mfma_f32_16x16x32_bf16 a[44:47], a[244:247], a[116:119], a[44:47]
  ds_read_b64_tr_b16 a[222:223], v228 offset:1288
  s_mov_b32 s42, 0x280000
  v_mfma_f32_16x16x32_bf16 a[52:55], a[244:247], a[120:123], a[52:55]
  s_mov_b32 s43, 0x20000
  v_mfma_f32_16x16x32_bf16 a[60:63], a[244:247], a[124:127], a[60:63]
  s_waitcnt lgkmcnt(10)
  v_mfma_f32_16x16x32_bf16 a[64:67], a[248:251], a[112:115], a[64:67]
  ds_read_b64_tr_b16 a[224:225], v228 offset:512
  v_mfma_f32_16x16x32_bf16 a[72:75], a[248:251], a[116:119], a[72:75]
  ds_read_b64_tr_b16 a[226:227], v228 offset:1536
  v_mfma_f32_16x16x32_bf16 a[80:83], a[248:251], a[120:123], a[80:83]
  v_mfma_f32_16x16x32_bf16 a[88:91], a[248:251], a[124:127], a[88:91]
  s_waitcnt lgkmcnt(10)
  v_mfma_f32_16x16x32_bf16 a[68:71], a[252:255], a[112:115], a[68:71]
  ds_read_b64_tr_b16 a[228:229], v228 offset:520
  v_mfma_f32_16x16x32_bf16 a[76:79], a[252:255], a[116:119], a[76:79]
  ds_read_b64_tr_b16 a[230:231], v228 offset:1544
  v_mfma_f32_16x16x32_bf16 a[84:87], a[252:255], a[120:123], a[84:87]
  v_mfma_f32_16x16x32_bf16 a[92:95], a[252:255], a[124:127], a[92:95]
  s_waitcnt lgkmcnt(10)
  v_mfma_f32_16x16x32_bf16 v[0:3], a[208:211], a[128:131], v[0:3]
  ds_read_b64_tr_b16 a[232:233], v228 offset:768
  s_and_b32 s37, s37, 0xffff
  v_mfma_f32_16x16x32_bf16 v[8:11], a[208:211], a[132:135], v[8:11]
  ds_read_b64_tr_b16 a[234:235], v228 offset:1792
  s_mov_b32 s38, 0x280000
  v_mfma_f32_16x16x32_bf16 v[16:19], a[208:211], a[136:139], v[16:19]
  buffer_load_dwordx4 a[112:115], v231, s[20:23], s62 offen offset:1024
  s_mov_b32 s39, 0x20000
  v_mfma_f32_16x16x32_bf16 v[24:27], a[208:211], a[140:143], v[24:27]
  s_lshl_b32 s72, s44, 10
  s_waitcnt lgkmcnt(10)
  v_mfma_f32_16x16x32_bf16 v[4:7], a[212:215], a[128:131], v[4:7]
  ds_read_b64_tr_b16 a[236:237], v228 offset:776
  s_mul_i32 s73, s44, 0xc08
  v_mfma_f32_16x16x32_bf16 v[12:15], a[212:215], a[132:135], v[12:15]
  ds_read_b64_tr_b16 a[238:239], v228 offset:1800
  v_mfma_f32_16x16x32_bf16 v[20:23], a[212:215], a[136:139], v[20:23]
  buffer_load_dwordx4 a[116:119], v232, s[20:23], s62 offen offset:1024
  s_add_u32 s73, s73, 0x3000
  v_mfma_f32_16x16x32_bf16 v[28:31], a[212:215], a[140:143], v[28:31]
  s_and_b32 s49, s44, 1
  s_waitcnt lgkmcnt(10)
  v_mfma_f32_16x16x32_bf16 v[32:35], a[216:219], a[128:131], v[32:35]
  ds_read_b64_tr_b16 a[240:241], v228 offset:2048
  s_lshr_b32 s50, s44, 1
  v_mfma_f32_16x16x32_bf16 v[40:43], a[216:219], a[132:135], v[40:43]
  ds_read_b64_tr_b16 a[242:243], v228 offset:2560
  s_mul_i32 s75, s50, 0x2830
  v_mfma_f32_16x16x32_bf16 v[48:51], a[216:219], a[136:139], v[48:51]
  buffer_load_dwordx4 a[120:123], v233, s[20:23], s62 offen offset:1024
  s_mul_i32 s51, s49, 0x808
  v_mfma_f32_16x16x32_bf16 v[56:59], a[216:219], a[140:143], v[56:59]
  s_add_u32 s75, s75, s51
  s_waitcnt lgkmcnt(10)
  v_mfma_f32_16x16x32_bf16 v[36:39], a[220:223], a[128:131], v[36:39]
  ds_read_b64_tr_b16 a[244:245], v228 offset:2056
  s_mul_i32 s76, s50, 0x2830
  v_mfma_f32_16x16x32_bf16 v[44:47], a[220:223], a[132:135], v[44:47]
  ds_read_b64_tr_b16 a[246:247], v228 offset:2568
  v_mfma_f32_16x16x32_bf16 v[52:55], a[220:223], a[136:139], v[52:55]
  buffer_load_dwordx4 a[124:127], v234, s[20:23], s62 offen offset:1024
  s_mul_i32 s51, s49, 0x408
  v_mfma_f32_16x16x32_bf16 v[60:63], a[220:223], a[140:143], v[60:63]
  s_add_u32 s76, s76, s51
  s_waitcnt lgkmcnt(10)
  v_mfma_f32_16x16x32_bf16 v[64:67], a[224:227], a[128:131], v[64:67]
  ds_read_b64_tr_b16 a[248:249], v228 offset:2304
  s_add_u32 s76, s76, 0x2020
  v_mfma_f32_16x16x32_bf16 v[72:75], a[224:227], a[132:135], v[72:75]
  ds_read_b64_tr_b16 a[250:251], v228 offset:2816
  s_mov_b32 s64, 0x3dd53b95
  v_mfma_f32_16x16x32_bf16 v[80:83], a[224:227], a[136:139], v[80:83]
  s_add_u32 s57, s55, s71
  s_add_u32 m0, s57, 0
  s_mov_b32 s65, 0x3dd53b95
  v_mfma_f32_16x16x32_bf16 v[88:91], a[224:227], a[140:143], v[88:91]
  buffer_load_dwordx4 v213, s[4:7], s58 offen nt lds
  s_waitcnt lgkmcnt(10)
  v_mfma_f32_16x16x32_bf16 v[68:71], a[228:231], a[128:131], v[68:71]
  ds_read_b64_tr_b16 a[252:253], v228 offset:2312
  s_mov_b32 s63, 0x42800000
  v_mfma_f32_16x16x32_bf16 v[76:79], a[228:231], a[132:135], v[76:79]
  ds_read_b64_tr_b16 a[254:255], v228 offset:2824
  s_add_u32 m0, s57, 0x400
  v_mfma_f32_16x16x32_bf16 v[84:87], a[228:231], a[136:139], v[84:87]
  buffer_load_dwordx4 v214, s[4:7], s58 offen nt lds
  s_mov_b32 s66, 0
  v_mfma_f32_16x16x32_bf16 v[92:95], a[228:231], a[140:143], v[92:95]
  s_mul_i32 s49, s45, 0x1800
  s_add_u32 s77, s49, 0x400000
  s_waitcnt lgkmcnt(10)
  v_mfma_f32_16x16x32_bf16 v[96:99], a[232:235], a[128:131], v[96:99]
  ds_read_b64_tr_b16 a[208:209], v229 offset:12352
  s_add_u32 s78, s77, 0x1000
  v_mfma_f32_16x16x32_bf16 v[104:107], a[232:235], a[132:135], v[104:107]
  ds_read_b64_tr_b16 a[210:211], v229 offset:13888
  s_add_u32 m0, s57, 0x800
  v_mfma_f32_16x16x32_bf16 v[112:115], a[232:235], a[136:139], v[112:115]
  buffer_load_dwordx4 v215, s[4:7], s58 offen nt lds
  s_mul_i32 s49, s45, 0x600
  v_mfma_f32_16x16x32_bf16 v[120:123], a[232:235], a[140:143], v[120:123]
  s_add_u32 s79, s49, 0x430000
  s_waitcnt lgkmcnt(10)
  v_mfma_f32_16x16x32_bf16 v[100:103], a[236:239], a[128:131], v[100:103]
  ds_read_b64_tr_b16 a[212:213], v229 offset:15424
  s_mov_b32 s67, 0
  v_mfma_f32_16x16x32_bf16 v[108:111], a[236:239], a[132:135], v[108:111]
  ds_read_b64_tr_b16 a[214:215], v229 offset:16960
  s_mov_b32 s68, 0
  v_mfma_f32_16x16x32_bf16 v[116:119], a[236:239], a[136:139], v[116:119]
  s_add_u32 s57, s55, s74
  s_add_u32 m0, s57, 0
  s_mov_b32 s80, 0xc0135761
  v_mfma_f32_16x16x32_bf16 v[124:127], a[236:239], a[140:143], v[124:127]
  buffer_load_dwordx4 v216, s[8:11], s59 offen nt lds
  s_waitcnt lgkmcnt(10)
  v_mfma_f32_16x16x32_bf16 v[128:131], a[240:243], a[128:131], v[128:131]
  ds_read_b64_tr_b16 a[216:217], v229 offset:12384
  v_mov_b32 v251, 0xbdd2d3e8
  v_mfma_f32_16x16x32_bf16 v[136:139], a[240:243], a[132:135], v[136:139]
  ds_read_b64_tr_b16 a[218:219], v229 offset:13920
  s_add_u32 m0, s57, 0x400
  v_mfma_f32_16x16x32_bf16 v[144:147], a[240:243], a[136:139], v[144:147]
  buffer_load_dwordx4 v217, s[8:11], s59 offen nt lds
  v_lshlrev_b32 v245, 4, v212
  v_mfma_f32_16x16x32_bf16 v[152:155], a[240:243], a[140:143], v[152:155]
  s_waitcnt lgkmcnt(10)
  v_mov_b32 v246, 1
  v_mov_b32 v250, 0
  v_mfma_f32_16x16x32_bf16 v[132:135], a[244:247], a[128:131], v[132:135]
  ds_read_b64_tr_b16 a[220:221], v229 offset:15456
  s_lshl_b32 s83, s46, 2
  v_mfma_f32_16x16x32_bf16 v[140:143], a[244:247], a[132:135], v[140:143]
  ds_read_b64_tr_b16 a[222:223], v229 offset:16992
  s_add_u32 s83, s83, s44
  v_mfma_f32_16x16x32_bf16 v[148:151], a[244:247], a[136:139], v[148:151]
  s_add_u32 s58, s58, 0x60000
  s_add_u32 s59, s59, 0x18000
  s_lshl_b32 s83, s83, 7
  v_mfma_f32_16x16x32_bf16 v[156:159], a[244:247], a[140:143], v[156:159]
  s_add_u32 s83, s83, 0x300000
  s_waitcnt lgkmcnt(10)
  v_mfma_f32_16x16x32_bf16 v[160:163], a[248:251], a[128:131], v[160:163]
  ds_read_b64_tr_b16 a[224:225], v229 offset:12416
  s_lshl_b32 s49, s45, 2
  v_mfma_f32_16x16x32_bf16 v[168:171], a[248:251], a[132:135], v[168:171]
  ds_read_b64_tr_b16 a[226:227], v229 offset:13952
  v_mfma_f32_16x16x32_bf16 v[176:179], a[248:251], a[136:139], v[176:179]
  s_add_u32 s55, s55, 0x6080
  s_cmp_ge_u32 s55, 0x24300
  s_cselect_b32 s55, 0, s55
  v_mfma_f32_16x16x32_bf16 v[184:187], a[248:251], a[140:143], v[184:187]
  s_add_u32 s81, s83, s49
  s_waitcnt lgkmcnt(10)
  v_mfma_f32_16x16x32_bf16 v[164:167], a[252:255], a[128:131], v[164:167]
  ds_read_b64_tr_b16 a[228:229], v229 offset:15488
  v_mfma_f32_16x16x32_bf16 v[172:175], a[252:255], a[132:135], v[172:175]
  s_add_u32 s54, s54, 0x6080
  s_cmp_ge_u32 s54, 0x24300
  s_cselect_b32 s54, 0, s54
  v_mfma_f32_16x16x32_bf16 v[180:183], a[252:255], a[136:139], v[180:183]
  ds_read_b64_tr_b16 a[230:231], v229 offset:17024
  v_mfma_f32_16x16x32_bf16 v[188:191], a[252:255], a[140:143], v[188:191]
  s_waitcnt vmcnt(23)
  s_barrier
  s_waitcnt lgkmcnt(10)
  v_mfma_f32_16x16x32_bf16 a[0:3], a[208:211], a[128:131], a[0:3]
  v_add_u32 v228, s54, v225
  v_add_u32 v229, s54, v227
  v_mfma_f32_16x16x32_bf16 a[8:11], a[208:211], a[132:135], a[8:11]
  ds_read_b64_tr_b16 a[232:233], v228
  v_mfma_f32_16x16x32_bf16 a[16:19], a[208:211], a[136:139], a[16:19]
  ds_read_b64_tr_b16 a[234:235], v228 offset:1024
  v_mfma_f32_16x16x32_bf16 a[24:27], a[208:211], a[140:143], a[24:27]
  s_waitcnt lgkmcnt(10)
  v_mfma_f32_16x16x32_bf16 a[4:7], a[212:215], a[128:131], a[4:7]
  ds_read_b64_tr_b16 a[236:237], v228 offset:8
  v_mfma_f32_16x16x32_bf16 a[12:15], a[212:215], a[132:135], a[12:15]
  ds_read_b64_tr_b16 a[238:239], v228 offset:1032
  v_mfma_f32_16x16x32_bf16 a[20:23], a[212:215], a[136:139], a[20:23]
  v_mfma_f32_16x16x32_bf16 a[28:31], a[212:215], a[140:143], a[28:31]
  s_waitcnt lgkmcnt(10)
  v_mfma_f32_16x16x32_bf16 a[32:35], a[216:219], a[128:131], a[32:35]
  ds_read_b64_tr_b16 a[240:241], v228 offset:256
  v_mfma_f32_16x16x32_bf16 a[40:43], a[216:219], a[132:135], a[40:43]
  ds_read_b64_tr_b16 a[242:243], v228 offset:1280
  v_mfma_f32_16x16x32_bf16 a[48:51], a[216:219], a[136:139], a[48:51]
  v_mfma_f32_16x16x32_bf16 a[56:59], a[216:219], a[140:143], a[56:59]
  s_waitcnt lgkmcnt(10)
  v_mfma_f32_16x16x32_bf16 a[36:39], a[220:223], a[128:131], a[36:39]
  ds_read_b64_tr_b16 a[244:245], v228 offset:264
  v_mfma_f32_16x16x32_bf16 a[44:47], a[220:223], a[132:135], a[44:47]
  ds_read_b64_tr_b16 a[246:247], v228 offset:1288
  v_mfma_f32_16x16x32_bf16 a[52:55], a[220:223], a[136:139], a[52:55]
  v_mfma_f32_16x16x32_bf16 a[60:63], a[220:223], a[140:143], a[60:63]
  s_waitcnt lgkmcnt(10)
  v_mfma_f32_16x16x32_bf16 a[64:67], a[224:227], a[128:131], a[64:67]
  ds_read_b64_tr_b16 a[248:249], v228 offset:512
  v_mfma_f32_16x16x32_bf16 a[72:75], a[224:227], a[132:135], a[72:75]
  ds_read_b64_tr_b16 a[250:251], v228 offset:1536
  v_mfma_f32_16x16x32_bf16 a[80:83], a[224:227], a[136:139], a[80:83]
  v_mfma_f32_16x16x32_bf16 a[88:91], a[224:227], a[140:143], a[88:91]
  s_waitcnt lgkmcnt(10)
  v_mfma_f32_16x16x32_bf16 a[68:71], a[228:231], a[128:131], a[68:71]
  ds_read_b64_tr_b16 a[252:253], v228 offset:520
  v_mfma_f32_16x16x32_bf16 a[76:79], a[228:231], a[132:135], a[76:79]
  ds_read_b64_tr_b16 a[254:255], v228 offset:1544
  v_mfma_f32_16x16x32_bf16 a[84:87], a[228:231], a[136:139], a[84:87]
  v_mfma_f32_16x16x32_bf16 a[92:95], a[228:231], a[140:143], a[92:95]
  s_waitcnt lgkmcnt(10)
  v_mfma_f32_16x16x32_bf16 v[0:3], a[232:235], a[144:147], v[0:3]
  ds_read_b64_tr_b16 a[208:209], v228 offset:768
  s_lshl_b32 s49, s47, 5
  v_mfma_f32_16x16x32_bf16 v[8:11], a[232:235], a[148:151], v[8:11]
  ds_read_b64_tr_b16 a[210:211], v228 offset:1792
  s_mul_i32 s50, s49, 0xaaab
  v_mfma_f32_16x16x32_bf16 v[16:19], a[232:235], a[152:155], v[16:19]
  buffer_load_dwordx4 a[128:131], v231, s[20:23], s62 offen offset:2048
  s_lshr_b32 s50, s50, 18
  v_mfma_f32_16x16x32_bf16 v[24:27], a[232:235], a[156:159], v[24:27]
  s_add_u32 s49, s49, 31
  s_waitcnt lgkmcnt(10)
  v_mfma_f32_16x16x32_bf16 v[4:7], a[236:239], a[144:147], v[4:7]
  ds_read_b64_tr_b16 a[212:213], v228 offset:776
  v_mfma_f32_16x16x32_bf16 v[12:15], a[236:239], a[148:151], v[12:15]
  ds_read_b64_tr_b16 a[214:215], v228 offset:1800
  s_mul_i32 s49, s49, 0xaaab
  v_mfma_f32_16x16x32_bf16 v[20:23], a[236:239], a[152:155], v[20:23]
  buffer_load_dwordx4 a[132:135], v232, s[20:23], s62 offen offset:2048
  s_lshr_b32 s49, s49, 18
  v_mfma_f32_16x16x32_bf16 v[28:31], a[236:239], a[156:159], v[28:31]
  s_and_b32 s51, s47, 1
  s_waitcnt lgkmcnt(10)
  v_mfma_f32_16x16x32_bf16 v[32:35], a[240:243], a[144:147], v[32:35]
  ds_read_b64_tr_b16 a[216:217], v228 offset:2048
  v_mfma_f32_16x16x32_bf16 v[40:43], a[240:243], a[148:151], v[40:43]
  ds_read_b64_tr_b16 a[218:219], v228 offset:2560
  s_lshl_b32 s51, s51, 4
  v_mfma_f32_16x16x32_bf16 v[48:51], a[240:243], a[152:155], v[48:51]
  buffer_load_dwordx4 a[136:139], v233, s[20:23], s62 offen offset:2048
  s_add_u32 s52, s51, 15
  v_mfma_f32_16x16x32_bf16 v[56:59], a[240:243], a[156:159], v[56:59]
  s_add_u32 s53, s83, 0x1000
  s_waitcnt lgkmcnt(10)
  v_mfma_f32_16x16x32_bf16 v[36:39], a[244:247], a[144:147], v[36:39]
  ds_read_b64_tr_b16 a[220:221], v228 offset:2056
  v_mfma_f32_16x16x32_bf16 v[44:47], a[244:247], a[148:151], v[44:47]
  ds_read_b64_tr_b16 a[222:223], v228 offset:2568
  v_mfma_f32_16x16x32_bf16 v[52:55], a[244:247], a[152:155], v[52:55]
  buffer_load_dwordx4 a[140:143], v234, s[20:23], s62 offen offset:2048
  v_mfma_f32_16x16x32_bf16 v[60:63], a[244:247], a[156:159], v[60:63]
  s_cmp_lt_u32 s47, 6
  s_cselect_b32 s50, s50, s51
  s_cselect_b32 s49, s49, s52
  s_cselect_b32 s83, s83, s53
  s_waitcnt lgkmcnt(10)
  v_mfma_f32_16x16x32_bf16 v[64:67], a[248:251], a[144:147], v[64:67]
  ds_read_b64_tr_b16 a[224:225], v228 offset:2304
  v_max_u32 v221, s50, v212
  v_mfma_f32_16x16x32_bf16 v[72:75], a[248:251], a[148:151], v[72:75]
  ds_read_b64_tr_b16 a[226:227], v228 offset:2816
  v_min_u32 v221, s49, v221
  v_mfma_f32_16x16x32_bf16 v[80:83], a[248:251], a[152:155], v[80:83]
  s_add_u32 s57, s55, s71
  s_add_u32 m0, s57, 0
  v_lshlrev_b32 v221, 2, v221
  v_mfma_f32_16x16x32_bf16 v[88:91], a[248:251], a[156:159], v[88:91]
  buffer_load_dwordx4 v213, s[4:7], s58 offen nt lds
  s_waitcnt lgkmcnt(10)
  v_mfma_f32_16x16x32_bf16 v[68:71], a[252:255], a[144:147], v[68:71]
  ds_read_b64_tr_b16 a[228:229], v228 offset:2312
  v_mov_b32 v192, 0
  v_mfma_f32_16x16x32_bf16 v[76:79], a[252:255], a[148:151], v[76:79]
  ds_read_b64_tr_b16 a[230:231], v228 offset:2824
  s_add_u32 m0, s57, 0x400
  v_mfma_f32_16x16x32_bf16 v[84:87], a[252:255], a[152:155], v[84:87]
  buffer_load_dwordx4 v214, s[4:7], s58 offen nt lds
  v_mov_b32 v193, 0
  v_mfma_f32_16x16x32_bf16 v[92:95], a[252:255], a[156:159], v[92:95]
  s_waitcnt lgkmcnt(10)
  v_mov_b32 v194, 0
  v_mov_b32 v195, 0
  v_mfma_f32_16x16x32_bf16 v[96:99], a[208:211], a[144:147], v[96:99]
  ds_read_b64_tr_b16 a[232:233], v229 offset:12352
  v_mov_b32 v196, 0
  v_mfma_f32_16x16x32_bf16 v[104:107], a[208:211], a[148:151], v[104:107]
  ds_read_b64_tr_b16 a[234:235], v229 offset:13888
  s_add_u32 m0, s57, 0x800
  v_mfma_f32_16x16x32_bf16 v[112:115], a[208:211], a[152:155], v[112:115]
  buffer_load_dwordx4 v215, s[4:7], s58 offen nt lds
  v_mov_b32 v197, 0
  v_mfma_f32_16x16x32_bf16 v[120:123], a[208:211], a[156:159], v[120:123]
  s_waitcnt lgkmcnt(10)
  v_mov_b32 v198, 0
  v_mov_b32 v199, 0
  v_mfma_f32_16x16x32_bf16 v[100:103], a[212:215], a[144:147], v[100:103]
  ds_read_b64_tr_b16 a[236:237], v229 offset:15424
  v_mov_b32 v200, 0
  v_mfma_f32_16x16x32_bf16 v[108:111], a[212:215], a[148:151], v[108:111]
  ds_read_b64_tr_b16 a[238:239], v229 offset:16960
  v_mov_b32 v201, 0
  v_mfma_f32_16x16x32_bf16 v[116:119], a[212:215], a[152:155], v[116:119]
  s_add_u32 s57, s55, s74
  s_add_u32 m0, s57, 0
  v_mov_b32 v202, 0
  v_mfma_f32_16x16x32_bf16 v[124:127], a[212:215], a[156:159], v[124:127]
  buffer_load_dwordx4 v216, s[8:11], s59 offen nt lds
  s_waitcnt lgkmcnt(10)
  v_mfma_f32_16x16x32_bf16 v[128:131], a[216:219], a[144:147], v[128:131]
  ds_read_b64_tr_b16 a[240:241], v229 offset:12384
  v_mov_b32 v203, 0
  v_mfma_f32_16x16x32_bf16 v[136:139], a[216:219], a[148:151], v[136:139]
  ds_read_b64_tr_b16 a[242:243], v229 offset:13920
  s_add_u32 m0, s57, 0x400
  v_mfma_f32_16x16x32_bf16 v[144:147], a[216:219], a[152:155], v[144:147]
  buffer_load_dwordx4 v217, s[8:11], s59 offen nt lds
  v_mov_b32 v204, 0
  v_mfma_f32_16x16x32_bf16 v[152:155], a[216:219], a[156:159], v[152:155]
  s_waitcnt lgkmcnt(10)
  v_mov_b32 v205, 0
  v_mov_b32 v206, 0
  v_mfma_f32_16x16x32_bf16 v[132:135], a[220:223], a[144:147], v[132:135]
  ds_read_b64_tr_b16 a[244:245], v229 offset:15456
  v_mov_b32 v207, 0
  v_mfma_f32_16x16x32_bf16 v[140:143], a[220:223], a[148:151], v[140:143]
  ds_read_b64_tr_b16 a[246:247], v229 offset:16992
  v_mfma_f32_16x16x32_bf16 v[148:151], a[220:223], a[152:155], v[148:151]
  s_add_u32 s58, s58, 0x60000
  s_add_u32 s59, s59, 0x18000
  v_mov_b32 v208, 0x3f803f80
  v_mfma_f32_16x16x32_bf16 v[156:159], a[220:223], a[156:159], v[156:159]
  s_waitcnt lgkmcnt(10)
  v_mov_b32 v209, 0x3f803f80
  v_mfma_f32_16x16x32_bf16 v[160:163], a[224:227], a[144:147], v[160:163]
  ds_read_b64_tr_b16 a[248:249], v229 offset:12416
  v_mov_b32 v210, 0x3f803f80
  v_mfma_f32_16x16x32_bf16 v[168:171], a[224:227], a[148:151], v[168:171]
  ds_read_b64_tr_b16 a[250:251], v229 offset:13952
  v_mov_b32 v211, 0x3f803f80
  v_mfma_f32_16x16x32_bf16 v[176:179], a[224:227], a[152:155], v[176:179]
  s_add_u32 s55, s55, 0x6080
  s_cmp_ge_u32 s55, 0x24300
  s_cselect_b32 s55, 0, s55
  v_mfma_f32_16x16x32_bf16 v[184:187], a[224:227], a[156:159], v[184:187]
  s_waitcnt lgkmcnt(10)
  v_mfma_f32_16x16x32_bf16 v[164:167], a[228:231], a[144:147], v[164:167]
  ds_read_b64_tr_b16 a[252:253], v229 offset:15488
  v_mfma_f32_16x16x32_bf16 v[172:175], a[228:231], a[148:151], v[172:175]
  s_add_u32 s54, s54, 0x6080
  s_cmp_ge_u32 s54, 0x24300
  s_cselect_b32 s54, 0, s54
  v_mfma_f32_16x16x32_bf16 v[180:183], a[228:231], a[152:155], v[180:183]
  ds_read_b64_tr_b16 a[254:255], v229 offset:17024
  v_mfma_f32_16x16x32_bf16 v[188:191], a[228:231], a[156:159], v[188:191]
  s_waitcnt vmcnt(23)
  s_barrier
  s_waitcnt lgkmcnt(10)
  v_mfma_f32_16x16x32_bf16 a[0:3], a[232:235], a[144:147], a[0:3]
  v_add_u32 v228, s54, v225
  v_add_u32 v229, s54, v227
  v_mfma_f32_16x16x32_bf16 a[8:11], a[232:235], a[148:151], a[8:11]
  ds_read_b64_tr_b16 a[208:209], v228
  v_mfma_f32_16x16x32_bf16 a[16:19], a[232:235], a[152:155], a[16:19]
  ds_read_b64_tr_b16 a[210:211], v228 offset:1024
  v_mfma_f32_16x16x32_bf16 a[24:27], a[232:235], a[156:159], a[24:27]
  s_waitcnt lgkmcnt(10)
  v_mfma_f32_16x16x32_bf16 a[4:7], a[236:239], a[144:147], a[4:7]
  ds_read_b64_tr_b16 a[212:213], v228 offset:8
  v_mfma_f32_16x16x32_bf16 a[12:15], a[236:239], a[148:151], a[12:15]
  ds_read_b64_tr_b16 a[214:215], v228 offset:1032
  v_mfma_f32_16x16x32_bf16 a[20:23], a[236:239], a[152:155], a[20:23]
  v_mfma_f32_16x16x32_bf16 a[28:31], a[236:239], a[156:159], a[28:31]
  s_waitcnt lgkmcnt(10)
  v_mfma_f32_16x16x32_bf16 a[32:35], a[240:243], a[144:147], a[32:35]
  ds_read_b64_tr_b16 a[216:217], v228 offset:256
  v_mfma_f32_16x16x32_bf16 a[40:43], a[240:243], a[148:151], a[40:43]
  ds_read_b64_tr_b16 a[218:219], v228 offset:1280
  v_mfma_f32_16x16x32_bf16 a[48:51], a[240:243], a[152:155], a[48:51]
  v_mfma_f32_16x16x32_bf16 a[56:59], a[240:243], a[156:159], a[56:59]
  s_waitcnt lgkmcnt(10)
  v_mfma_f32_16x16x32_bf16 a[36:39], a[244:247], a[144:147], a[36:39]
  ds_read_b64_tr_b16 a[220:221], v228 offset:264
  v_mfma_f32_16x16x32_bf16 a[44:47], a[244:247], a[148:151], a[44:47]
  ds_read_b64_tr_b16 a[222:223], v228 offset:1288
  v_mfma_f32_16x16x32_bf16 a[52:55], a[244:247], a[152:155], a[52:55]
  v_mfma_f32_16x16x32_bf16 a[60:63], a[244:247], a[156:159], a[60:63]
  s_waitcnt lgkmcnt(10)
  v_mfma_f32_16x16x32_bf16 a[64:67], a[248:251], a[144:147], a[64:67]
  ds_read_b64_tr_b16 a[224:225], v228 offset:512
  v_mfma_f32_16x16x32_bf16 a[72:75], a[248:251], a[148:151], a[72:75]
  ds_read_b64_tr_b16 a[226:227], v228 offset:1536
  v_mfma_f32_16x16x32_bf16 a[80:83], a[248:251], a[152:155], a[80:83]
  v_mfma_f32_16x16x32_bf16 a[88:91], a[248:251], a[156:159], a[88:91]
  s_waitcnt lgkmcnt(10)
  v_mfma_f32_16x16x32_bf16 a[68:71], a[252:255], a[144:147], a[68:71]
  ds_read_b64_tr_b16 a[228:229], v228 offset:520
  v_mfma_f32_16x16x32_bf16 a[76:79], a[252:255], a[148:151], a[76:79]
  ds_read_b64_tr_b16 a[230:231], v228 offset:1544
  v_mfma_f32_16x16x32_bf16 a[84:87], a[252:255], a[152:155], a[84:87]
  v_mfma_f32_16x16x32_bf16 a[92:95], a[252:255], a[156:159], a[92:95]
  s_mov_b32 s56, 3
L_proj:
  s_waitcnt vmcnt(23) lgkmcnt(10)
  v_mfma_f32_16x16x32_bf16 v[0:3], a[208:211], a[96:99], v[0:3]
  ds_read_b64_tr_b16 a[232:233], v228 offset:768
  v_mfma_f32_16x16x32_bf16 v[8:11], a[208:211], a[100:103], v[8:11]
  ds_read_b64_tr_b16 a[234:235], v228 offset:1792
  v_mfma_f32_16x16x32_bf16 v[16:19], a[208:211], a[104:107], v[16:19]
  buffer_load_dwordx4 a[144:147], v231, s[20:23], s62 offen offset:3072
  v_mfma_f32_16x16x32_bf16 v[24:27], a[208:211], a[108:111], v[24:27]
  s_waitcnt lgkmcnt(10)
  v_mfma_f32_16x16x32_bf16 v[4:7], a[212:215], a[96:99], v[4:7]
  ds_read_b64_tr_b16 a[236:237], v228 offset:776
  v_mfma_f32_16x16x32_bf16 v[12:15], a[212:215], a[100:103], v[12:15]
  ds_read_b64_tr_b16 a[238:239], v228 offset:1800
  v_mfma_f32_16x16x32_bf16 v[20:23], a[212:215], a[104:107], v[20:23]
  buffer_load_dwordx4 a[148:151], v232, s[20:23], s62 offen offset:3072
  v_mfma_f32_16x16x32_bf16 v[28:31], a[212:215], a[108:111], v[28:31]
  s_waitcnt lgkmcnt(10)
  v_mfma_f32_16x16x32_bf16 v[32:35], a[216:219], a[96:99], v[32:35]
  ds_read_b64_tr_b16 a[240:241], v228 offset:2048
  v_mfma_f32_16x16x32_bf16 v[40:43], a[216:219], a[100:103], v[40:43]
  ds_read_b64_tr_b16 a[242:243], v228 offset:2560
  v_mfma_f32_16x16x32_bf16 v[48:51], a[216:219], a[104:107], v[48:51]
  buffer_load_dwordx4 a[152:155], v233, s[20:23], s62 offen offset:3072
  v_mfma_f32_16x16x32_bf16 v[56:59], a[216:219], a[108:111], v[56:59]
  s_waitcnt lgkmcnt(10)
  v_mfma_f32_16x16x32_bf16 v[36:39], a[220:223], a[96:99], v[36:39]
  ds_read_b64_tr_b16 a[244:245], v228 offset:2056
  v_mfma_f32_16x16x32_bf16 v[44:47], a[220:223], a[100:103], v[44:47]
  ds_read_b64_tr_b16 a[246:247], v228 offset:2568
  v_mfma_f32_16x16x32_bf16 v[52:55], a[220:223], a[104:107], v[52:55]
  buffer_load_dwordx4 a[156:159], v234, s[20:23], s62 offen offset:3072
  v_mfma_f32_16x16x32_bf16 v[60:63], a[220:223], a[108:111], v[60:63]
  s_add_u32 s62, s62, 0x1000
  s_waitcnt lgkmcnt(10)
  v_mfma_f32_16x16x32_bf16 v[64:67], a[224:227], a[96:99], v[64:67]
  ds_read_b64_tr_b16 a[248:249], v228 offset:2304
  v_mfma_f32_16x16x32_bf16 v[72:75], a[224:227], a[100:103], v[72:75]
  ds_read_b64_tr_b16 a[250:251], v228 offset:2816
  v_mfma_f32_16x16x32_bf16 v[80:83], a[224:227], a[104:107], v[80:83]
  s_add_u32 s57, s55, s71
  s_add_u32 m0, s57, 0
  v_mfma_f32_16x16x32_bf16 v[88:91], a[224:227], a[108:111], v[88:91]
  buffer_load_dwordx4 v213, s[4:7], s58 offen nt lds
  s_waitcnt lgkmcnt(10)
  v_mfma_f32_16x16x32_bf16 v[68:71], a[228:231], a[96:99], v[68:71]
  ds_read_b64_tr_b16 a[252:253], v228 offset:2312
  v_mfma_f32_16x16x32_bf16 v[76:79], a[228:231], a[100:103], v[76:79]
  ds_read_b64_tr_b16 a[254:255], v228 offset:2824
  s_add_u32 m0, s57, 0x400
  v_mfma_f32_16x16x32_bf16 v[84:87], a[228:231], a[104:107], v[84:87]
  buffer_load_dwordx4 v214, s[4:7], s58 offen nt lds
  v_mfma_f32_16x16x32_bf16 v[92:95], a[228:231], a[108:111], v[92:95]
  s_waitcnt lgkmcnt(10)
  v_mfma_f32_16x16x32_bf16 v[96:99], a[232:235], a[96:99], v[96:99]
  ds_read_b64_tr_b16 a[208:209], v229 offset:12352
  v_mfma_f32_16x16x32_bf16 v[104:107], a[232:235], a[100:103], v[104:107]
  ds_read_b64_tr_b16 a[210:211], v229 offset:13888
  s_add_u32 m0, s57, 0x800
  v_mfma_f32_16x16x32_bf16 v[112:115], a[232:235], a[104:107], v[112:115]
  buffer_load_dwordx4 v215, s[4:7], s58 offen nt lds
  v_mfma_f32_16x16x32_bf16 v[120:123], a[232:235], a[108:111], v[120:123]
  s_waitcnt lgkmcnt(10)
  v_mfma_f32_16x16x32_bf16 v[100:103], a[236:239], a[96:99], v[100:103]
  ds_read_b64_tr_b16 a[212:213], v229 offset:15424
  v_mfma_f32_16x16x32_bf16 v[108:111], a[236:239], a[100:103], v[108:111]
  ds_read_b64_tr_b16 a[214:215], v229 offset:16960
  v_mfma_f32_16x16x32_bf16 v[116:119], a[236:239], a[104:107], v[116:119]
  s_add_u32 s57, s55, s74
  s_add_u32 m0, s57, 0
  v_mfma_f32_16x16x32_bf16 v[124:127], a[236:239], a[108:111], v[124:127]
  buffer_load_dwordx4 v216, s[8:11], s59 offen nt lds
  s_waitcnt lgkmcnt(10)
  v_mfma_f32_16x16x32_bf16 v[128:131], a[240:243], a[96:99], v[128:131]
  ds_read_b64_tr_b16 a[216:217], v229 offset:12384
  v_mfma_f32_16x16x32_bf16 v[136:139], a[240:243], a[100:103], v[136:139]
  ds_read_b64_tr_b16 a[218:219], v229 offset:13920
  s_add_u32 m0, s57, 0x400
  v_mfma_f32_16x16x32_bf16 v[144:147], a[240:243], a[104:107], v[144:147]
  buffer_load_dwordx4 v217, s[8:11], s59 offen nt lds
  v_mfma_f32_16x16x32_bf16 v[152:155], a[240:243], a[108:111], v[152:155]
  s_waitcnt lgkmcnt(10)
  v_mfma_f32_16x16x32_bf16 v[132:135], a[244:247], a[96:99], v[132:135]
  ds_read_b64_tr_b16 a[220:221], v229 offset:15456
  v_mfma_f32_16x16x32_bf16 v[140:143], a[244:247], a[100:103], v[140:143]
  ds_read_b64_tr_b16 a[222:223], v229 offset:16992
  v_mfma_f32_16x16x32_bf16 v[148:151], a[244:247], a[104:107], v[148:151]
  s_add_u32 s58, s58, 0x60000
  s_add_u32 s59, s59, 0x18000
  v_mfma_f32_16x16x32_bf16 v[156:159], a[244:247], a[108:111], v[156:159]
  s_waitcnt lgkmcnt(10)
  v_mfma_f32_16x16x32_bf16 v[160:163], a[248:251], a[96:99], v[160:163]
  ds_read_b64_tr_b16 a[224:225], v229 offset:12416
  v_mfma_f32_16x16x32_bf16 v[168:171], a[248:251], a[100:103], v[168:171]
  ds_read_b64_tr_b16 a[226:227], v229 offset:13952
  v_mfma_f32_16x16x32_bf16 v[176:179], a[248:251], a[104:107], v[176:179]
  s_add_u32 s55, s55, 0x6080
  s_cmp_ge_u32 s55, 0x24300
  s_cselect_b32 s55, 0, s55
  v_mfma_f32_16x16x32_bf16 v[184:187], a[248:251], a[108:111], v[184:187]
  s_waitcnt lgkmcnt(10)
  v_mfma_f32_16x16x32_bf16 v[164:167], a[252:255], a[96:99], v[164:167]
  ds_read_b64_tr_b16 a[228:229], v229 offset:15488
  v_mfma_f32_16x16x32_bf16 v[172:175], a[252:255], a[100:103], v[172:175]
  s_add_u32 s54, s54, 0x6080
  s_cmp_ge_u32 s54, 0x24300
  s_cselect_b32 s54, 0, s54
  v_mfma_f32_16x16x32_bf16 v[180:183], a[252:255], a[104:107], v[180:183]
  ds_read_b64_tr_b16 a[230:231], v229 offset:17024
  v_mfma_f32_16x16x32_bf16 v[188:191], a[252:255], a[108:111], v[188:191]
  s_waitcnt vmcnt(27)
  s_barrier
  s_waitcnt lgkmcnt(10)
  v_mfma_f32_16x16x32_bf16 a[0:3], a[208:211], a[96:99], a[0:3]
  v_add_u32 v228, s54, v225
  v_add_u32 v229, s54, v227
  v_mfma_f32_16x16x32_bf16 a[8:11], a[208:211], a[100:103], a[8:11]
  ds_read_b64_tr_b16 a[232:233], v228
  v_mfma_f32_16x16x32_bf16 a[16:19], a[208:211], a[104:107], a[16:19]
  ds_read_b64_tr_b16 a[234:235], v228 offset:1024
  v_mfma_f32_16x16x32_bf16 a[24:27], a[208:211], a[108:111], a[24:27]
  s_waitcnt lgkmcnt(10)
  v_mfma_f32_16x16x32_bf16 a[4:7], a[212:215], a[96:99], a[4:7]
  ds_read_b64_tr_b16 a[236:237], v228 offset:8
  v_mfma_f32_16x16x32_bf16 a[12:15], a[212:215], a[100:103], a[12:15]
  ds_read_b64_tr_b16 a[238:239], v228 offset:1032
  v_mfma_f32_16x16x32_bf16 a[20:23], a[212:215], a[104:107], a[20:23]
  v_mfma_f32_16x16x32_bf16 a[28:31], a[212:215], a[108:111], a[28:31]
  s_waitcnt lgkmcnt(10)
  v_mfma_f32_16x16x32_bf16 a[32:35], a[216:219], a[96:99], a[32:35]
  ds_read_b64_tr_b16 a[240:241], v228 offset:256
  v_mfma_f32_16x16x32_bf16 a[40:43], a[216:219], a[100:103], a[40:43]
  ds_read_b64_tr_b16 a[242:243], v228 offset:1280
  v_mfma_f32_16x16x32_bf16 a[48:51], a[216:219], a[104:107], a[48:51]
  v_mfma_f32_16x16x32_bf16 a[56:59], a[216:219], a[108:111], a[56:59]
  s_waitcnt lgkmcnt(10)
  v_mfma_f32_16x16x32_bf16 a[36:39], a[220:223], a[96:99], a[36:39]
  ds_read_b64_tr_b16 a[244:245], v228 offset:264
  v_mfma_f32_16x16x32_bf16 a[44:47], a[220:223], a[100:103], a[44:47]
  ds_read_b64_tr_b16 a[246:247], v228 offset:1288
  v_mfma_f32_16x16x32_bf16 a[52:55], a[220:223], a[104:107], a[52:55]
  v_mfma_f32_16x16x32_bf16 a[60:63], a[220:223], a[108:111], a[60:63]
  s_waitcnt lgkmcnt(10)
  v_mfma_f32_16x16x32_bf16 a[64:67], a[224:227], a[96:99], a[64:67]
  ds_read_b64_tr_b16 a[248:249], v228 offset:512
  v_mfma_f32_16x16x32_bf16 a[72:75], a[224:227], a[100:103], a[72:75]
  ds_read_b64_tr_b16 a[250:251], v228 offset:1536
  v_mfma_f32_16x16x32_bf16 a[80:83], a[224:227], a[104:107], a[80:83]
  v_mfma_f32_16x16x32_bf16 a[88:91], a[224:227], a[108:111], a[88:91]
  s_waitcnt lgkmcnt(10)
  v_mfma_f32_16x16x32_bf16 a[68:71], a[228:231], a[96:99], a[68:71]
  ds_read_b64_tr_b16 a[252:253], v228 offset:520
  v_mfma_f32_16x16x32_bf16 a[76:79], a[228:231], a[100:103], a[76:79]
  ds_read_b64_tr_b16 a[254:255], v228 offset:1544
  v_mfma_f32_16x16x32_bf16 a[84:87], a[228:231], a[104:107], a[84:87]
  v_mfma_f32_16x16x32_bf16 a[92:95], a[228:231], a[108:111], a[92:95]
  s_waitcnt vmcnt(23) lgkmcnt(10)
  v_mfma_f32_16x16x32_bf16 v[0:3], a[232:235], a[112:115], v[0:3]
  ds_read_b64_tr_b16 a[208:209], v228 offset:768
  v_mfma_f32_16x16x32_bf16 v[8:11], a[232:235], a[116:119], v[8:11]
  ds_read_b64_tr_b16 a[210:211], v228 offset:1792
  v_mfma_f32_16x16x32_bf16 v[16:19], a[232:235], a[120:123], v[16:19]
  buffer_load_dwordx4 a[96:99], v231, s[20:23], s62 offen
  v_mfma_f32_16x16x32_bf16 v[24:27], a[232:235], a[124:127], v[24:27]
  s_waitcnt lgkmcnt(10)
  v_mfma_f32_16x16x32_bf16 v[4:7], a[236:239], a[112:115], v[4:7]
  ds_read_b64_tr_b16 a[212:213], v228 offset:776
  v_mfma_f32_16x16x32_bf16 v[12:15], a[236:239], a[116:119], v[12:15]
  ds_read_b64_tr_b16 a[214:215], v228 offset:1800
  v_mfma_f32_16x16x32_bf16 v[20:23], a[236:239], a[120:123], v[20:23]
  buffer_load_dwordx4 a[100:103], v232, s[20:23], s62 offen
  v_mfma_f32_16x16x32_bf16 v[28:31], a[236:239], a[124:127], v[28:31]
  s_waitcnt lgkmcnt(10)
  v_mfma_f32_16x16x32_bf16 v[32:35], a[240:243], a[112:115], v[32:35]
  ds_read_b64_tr_b16 a[216:217], v228 offset:2048
  v_mfma_f32_16x16x32_bf16 v[40:43], a[240:243], a[116:119], v[40:43]
  ds_read_b64_tr_b16 a[218:219], v228 offset:2560
  v_mfma_f32_16x16x32_bf16 v[48:51], a[240:243], a[120:123], v[48:51]
  buffer_load_dwordx4 a[104:107], v233, s[20:23], s62 offen
  v_mfma_f32_16x16x32_bf16 v[56:59], a[240:243], a[124:127], v[56:59]
  s_waitcnt lgkmcnt(10)
  v_mfma_f32_16x16x32_bf16 v[36:39], a[244:247], a[112:115], v[36:39]
  ds_read_b64_tr_b16 a[220:221], v228 offset:2056
  v_mfma_f32_16x16x32_bf16 v[44:47], a[244:247], a[116:119], v[44:47]
  ds_read_b64_tr_b16 a[222:223], v228 offset:2568
  v_mfma_f32_16x16x32_bf16 v[52:55], a[244:247], a[120:123], v[52:55]
  buffer_load_dwordx4 a[108:111], v234, s[20:23], s62 offen
  v_mfma_f32_16x16x32_bf16 v[60:63], a[244:247], a[124:127], v[60:63]
  s_waitcnt lgkmcnt(10)
  v_mfma_f32_16x16x32_bf16 v[64:67], a[248:251], a[112:115], v[64:67]
  ds_read_b64_tr_b16 a[224:225], v228 offset:2304
  v_mfma_f32_16x16x32_bf16 v[72:75], a[248:251], a[116:119], v[72:75]
  ds_read_b64_tr_b16 a[226:227], v228 offset:2816
  v_mfma_f32_16x16x32_bf16 v[80:83], a[248:251], a[120:123], v[80:83]
  s_add_u32 s57, s55, s71
  s_add_u32 m0, s57, 0
  v_mfma_f32_16x16x32_bf16 v[88:91], a[248:251], a[124:127], v[88:91]
  buffer_load_dwordx4 v213, s[4:7], s58 offen nt lds
  s_waitcnt lgkmcnt(10)
  v_mfma_f32_16x16x32_bf16 v[68:71], a[252:255], a[112:115], v[68:71]
  ds_read_b64_tr_b16 a[228:229], v228 offset:2312
  v_mfma_f32_16x16x32_bf16 v[76:79], a[252:255], a[116:119], v[76:79]
  ds_read_b64_tr_b16 a[230:231], v228 offset:2824
  s_add_u32 m0, s57, 0x400
  v_mfma_f32_16x16x32_bf16 v[84:87], a[252:255], a[120:123], v[84:87]
  buffer_load_dwordx4 v214, s[4:7], s58 offen nt lds
  v_mfma_f32_16x16x32_bf16 v[92:95], a[252:255], a[124:127], v[92:95]
  s_waitcnt lgkmcnt(10)
  v_mfma_f32_16x16x32_bf16 v[96:99], a[208:211], a[112:115], v[96:99]
  ds_read_b64_tr_b16 a[232:233], v229 offset:12352
  v_mfma_f32_16x16x32_bf16 v[104:107], a[208:211], a[116:119], v[104:107]
  ds_read_b64_tr_b16 a[234:235], v229 offset:13888
  s_add_u32 m0, s57, 0x800
  v_mfma_f32_16x16x32_bf16 v[112:115], a[208:211], a[120:123], v[112:115]
  buffer_load_dwordx4 v215, s[4:7], s58 offen nt lds
  v_mfma_f32_16x16x32_bf16 v[120:123], a[208:211], a[124:127], v[120:123]
  s_waitcnt lgkmcnt(10)
  v_mfma_f32_16x16x32_bf16 v[100:103], a[212:215], a[112:115], v[100:103]
  ds_read_b64_tr_b16 a[236:237], v229 offset:15424
  v_mfma_f32_16x16x32_bf16 v[108:111], a[212:215], a[116:119], v[108:111]
  ds_read_b64_tr_b16 a[238:239], v229 offset:16960
  v_mfma_f32_16x16x32_bf16 v[116:119], a[212:215], a[120:123], v[116:119]
  s_add_u32 s57, s55, s74
  s_add_u32 m0, s57, 0
  v_mfma_f32_16x16x32_bf16 v[124:127], a[212:215], a[124:127], v[124:127]
  buffer_load_dwordx4 v216, s[8:11], s59 offen nt lds
  s_waitcnt lgkmcnt(10)
  v_mfma_f32_16x16x32_bf16 v[128:131], a[216:219], a[112:115], v[128:131]
  ds_read_b64_tr_b16 a[240:241], v229 offset:12384
  v_mfma_f32_16x16x32_bf16 v[136:139], a[216:219], a[116:119], v[136:139]
  ds_read_b64_tr_b16 a[242:243], v229 offset:13920
  s_add_u32 m0, s57, 0x400
  v_mfma_f32_16x16x32_bf16 v[144:147], a[216:219], a[120:123], v[144:147]
  buffer_load_dwordx4 v217, s[8:11], s59 offen nt lds
  v_mfma_f32_16x16x32_bf16 v[152:155], a[216:219], a[124:127], v[152:155]
  s_waitcnt lgkmcnt(10)
  v_mfma_f32_16x16x32_bf16 v[132:135], a[220:223], a[112:115], v[132:135]
  ds_read_b64_tr_b16 a[244:245], v229 offset:15456
  v_mfma_f32_16x16x32_bf16 v[140:143], a[220:223], a[116:119], v[140:143]
  ds_read_b64_tr_b16 a[246:247], v229 offset:16992
  v_mfma_f32_16x16x32_bf16 v[148:151], a[220:223], a[120:123], v[148:151]
  s_add_u32 s58, s58, 0x60000
  s_add_u32 s59, s59, 0x18000
  v_mfma_f32_16x16x32_bf16 v[156:159], a[220:223], a[124:127], v[156:159]
  s_waitcnt lgkmcnt(10)
  v_mfma_f32_16x16x32_bf16 v[160:163], a[224:227], a[112:115], v[160:163]
  ds_read_b64_tr_b16 a[248:249], v229 offset:12416
  v_mfma_f32_16x16x32_bf16 v[168:171], a[224:227], a[116:119], v[168:171]
  ds_read_b64_tr_b16 a[250:251], v229 offset:13952
  v_mfma_f32_16x16x32_bf16 v[176:179], a[224:227], a[120:123], v[176:179]
  s_add_u32 s55, s55, 0x6080
  s_cmp_ge_u32 s55, 0x24300
  s_cselect_b32 s55, 0, s55
  v_mfma_f32_16x16x32_bf16 v[184:187], a[224:227], a[124:127], v[184:187]
  s_waitcnt lgkmcnt(10)
  v_mfma_f32_16x16x32_bf16 v[164:167], a[228:231], a[112:115], v[164:167]
  ds_read_b64_tr_b16 a[252:253], v229 offset:15488
  v_mfma_f32_16x16x32_bf16 v[172:175], a[228:231], a[116:119], v[172:175]
  s_add_u32 s54, s54, 0x6080
  s_cmp_ge_u32 s54, 0x24300
  s_cselect_b32 s54, 0, s54
  v_mfma_f32_16x16x32_bf16 v[180:183], a[228:231], a[120:123], v[180:183]
  ds_read_b64_tr_b16 a[254:255], v229 offset:17024
  v_mfma_f32_16x16x32_bf16 v[188:191], a[228:231], a[124:127], v[188:191]
  s_waitcnt vmcnt(27)
  s_barrier
  s_waitcnt lgkmcnt(10)
  v_mfma_f32_16x16x32_bf16 a[0:3], a[232:235], a[112:115], a[0:3]
  v_add_u32 v228, s54, v225
  v_add_u32 v229, s54, v227
  v_mfma_f32_16x16x32_bf16 a[8:11], a[232:235], a[116:119], a[8:11]
  ds_read_b64_tr_b16 a[208:209], v228
  v_mfma_f32_16x16x32_bf16 a[16:19], a[232:235], a[120:123], a[16:19]
  ds_read_b64_tr_b16 a[210:211], v228 offset:1024
  v_mfma_f32_16x16x32_bf16 a[24:27], a[232:235], a[124:127], a[24:27]
  s_waitcnt lgkmcnt(10)
  v_mfma_f32_16x16x32_bf16 a[4:7], a[236:239], a[112:115], a[4:7]
  ds_read_b64_tr_b16 a[212:213], v228 offset:8
  v_mfma_f32_16x16x32_bf16 a[12:15], a[236:239], a[116:119], a[12:15]
  ds_read_b64_tr_b16 a[214:215], v228 offset:1032
  v_mfma_f32_16x16x32_bf16 a[20:23], a[236:239], a[120:123], a[20:23]
  v_mfma_f32_16x16x32_bf16 a[28:31], a[236:239], a[124:127], a[28:31]
  s_waitcnt lgkmcnt(10)
  v_mfma_f32_16x16x32_bf16 a[32:35], a[240:243], a[112:115], a[32:35]
  ds_read_b64_tr_b16 a[216:217], v228 offset:256
  v_mfma_f32_16x16x32_bf16 a[40:43], a[240:243], a[116:119], a[40:43]
  ds_read_b64_tr_b16 a[218:219], v228 offset:1280
  v_mfma_f32_16x16x32_bf16 a[48:51], a[240:243], a[120:123], a[48:51]
  v_mfma_f32_16x16x32_bf16 a[56:59], a[240:243], a[124:127], a[56:59]
  s_waitcnt lgkmcnt(10)
  v_mfma_f32_16x16x32_bf16 a[36:39], a[244:247], a[112:115], a[36:39]
  ds_read_b64_tr_b16 a[220:221], v228 offset:264
  v_mfma_f32_16x16x32_bf16 a[44:47], a[244:247], a[116:119], a[44:47]
  ds_read_b64_tr_b16 a[222:223], v228 offset:1288
  v_mfma_f32_16x16x32_bf16 a[52:55], a[244:247], a[120:123], a[52:55]
  v_mfma_f32_16x16x32_bf16 a[60:63], a[244:247], a[124:127], a[60:63]
  s_waitcnt lgkmcnt(10)
  v_mfma_f32_16x16x32_bf16 a[64:67], a[248:251], a[112:115], a[64:67]
  ds_read_b64_tr_b16 a[224:225], v228 offset:512
  v_mfma_f32_16x16x32_bf16 a[72:75], a[248:251], a[116:119], a[72:75]
  ds_read_b64_tr_b16 a[226:227], v228 offset:1536
  v_mfma_f32_16x16x32_bf16 a[80:83], a[248:251], a[120:123], a[80:83]
  v_mfma_f32_16x16x32_bf16 a[88:91], a[248:251], a[124:127], a[88:91]
  s_waitcnt lgkmcnt(10)
  v_mfma_f32_16x16x32_bf16 a[68:71], a[252:255], a[112:115], a[68:71]
  ds_read_b64_tr_b16 a[228:229], v228 offset:520
  v_mfma_f32_16x16x32_bf16 a[76:79], a[252:255], a[116:119], a[76:79]
  ds_read_b64_tr_b16 a[230:231], v228 offset:1544
  v_mfma_f32_16x16x32_bf16 a[84:87], a[252:255], a[120:123], a[84:87]
  v_mfma_f32_16x16x32_bf16 a[92:95], a[252:255], a[124:127], a[92:95]
  s_waitcnt vmcnt(23) lgkmcnt(10)
  v_mfma_f32_16x16x32_bf16 v[0:3], a[208:211], a[128:131], v[0:3]
  ds_read_b64_tr_b16 a[232:233], v228 offset:768
  v_mfma_f32_16x16x32_bf16 v[8:11], a[208:211], a[132:135], v[8:11]
  ds_read_b64_tr_b16 a[234:235], v228 offset:1792
  v_mfma_f32_16x16x32_bf16 v[16:19], a[208:211], a[136:139], v[16:19]
  buffer_load_dwordx4 a[112:115], v231, s[20:23], s62 offen offset:1024
  v_mfma_f32_16x16x32_bf16 v[24:27], a[208:211], a[140:143], v[24:27]
  s_waitcnt lgkmcnt(10)
  v_mfma_f32_16x16x32_bf16 v[4:7], a[212:215], a[128:131], v[4:7]
  ds_read_b64_tr_b16 a[236:237], v228 offset:776
  v_mfma_f32_16x16x32_bf16 v[12:15], a[212:215], a[132:135], v[12:15]
  ds_read_b64_tr_b16 a[238:239], v228 offset:1800
  v_mfma_f32_16x16x32_bf16 v[20:23], a[212:215], a[136:139], v[20:23]
  buffer_load_dwordx4 a[116:119], v232, s[20:23], s62 offen offset:1024
  v_mfma_f32_16x16x32_bf16 v[28:31], a[212:215], a[140:143], v[28:31]
  s_waitcnt lgkmcnt(10)
  v_mfma_f32_16x16x32_bf16 v[32:35], a[216:219], a[128:131], v[32:35]
  ds_read_b64_tr_b16 a[240:241], v228 offset:2048
  v_mfma_f32_16x16x32_bf16 v[40:43], a[216:219], a[132:135], v[40:43]
  ds_read_b64_tr_b16 a[242:243], v228 offset:2560
  v_mfma_f32_16x16x32_bf16 v[48:51], a[216:219], a[136:139], v[48:51]
  buffer_load_dwordx4 a[120:123], v233, s[20:23], s62 offen offset:1024
  v_mfma_f32_16x16x32_bf16 v[56:59], a[216:219], a[140:143], v[56:59]
  s_waitcnt lgkmcnt(10)
  v_mfma_f32_16x16x32_bf16 v[36:39], a[220:223], a[128:131], v[36:39]
  ds_read_b64_tr_b16 a[244:245], v228 offset:2056
  v_mfma_f32_16x16x32_bf16 v[44:47], a[220:223], a[132:135], v[44:47]
  ds_read_b64_tr_b16 a[246:247], v228 offset:2568
  v_mfma_f32_16x16x32_bf16 v[52:55], a[220:223], a[136:139], v[52:55]
  buffer_load_dwordx4 a[124:127], v234, s[20:23], s62 offen offset:1024
  v_mfma_f32_16x16x32_bf16 v[60:63], a[220:223], a[140:143], v[60:63]
  s_waitcnt lgkmcnt(10)
  v_mfma_f32_16x16x32_bf16 v[64:67], a[224:227], a[128:131], v[64:67]
  ds_read_b64_tr_b16 a[248:249], v228 offset:2304
  v_mfma_f32_16x16x32_bf16 v[72:75], a[224:227], a[132:135], v[72:75]
  ds_read_b64_tr_b16 a[250:251], v228 offset:2816
  v_mfma_f32_16x16x32_bf16 v[80:83], a[224:227], a[136:139], v[80:83]
  s_add_u32 s57, s55, s71
  s_add_u32 m0, s57, 0
  v_mfma_f32_16x16x32_bf16 v[88:91], a[224:227], a[140:143], v[88:91]
  buffer_load_dwordx4 v213, s[4:7], s58 offen nt lds
  s_waitcnt lgkmcnt(10)
  v_mfma_f32_16x16x32_bf16 v[68:71], a[228:231], a[128:131], v[68:71]
  ds_read_b64_tr_b16 a[252:253], v228 offset:2312
  v_mfma_f32_16x16x32_bf16 v[76:79], a[228:231], a[132:135], v[76:79]
  ds_read_b64_tr_b16 a[254:255], v228 offset:2824
  s_add_u32 m0, s57, 0x400
  v_mfma_f32_16x16x32_bf16 v[84:87], a[228:231], a[136:139], v[84:87]
  buffer_load_dwordx4 v214, s[4:7], s58 offen nt lds
  v_mfma_f32_16x16x32_bf16 v[92:95], a[228:231], a[140:143], v[92:95]
  s_waitcnt lgkmcnt(10)
  v_mfma_f32_16x16x32_bf16 v[96:99], a[232:235], a[128:131], v[96:99]
  ds_read_b64_tr_b16 a[208:209], v229 offset:12352
  v_mfma_f32_16x16x32_bf16 v[104:107], a[232:235], a[132:135], v[104:107]
  ds_read_b64_tr_b16 a[210:211], v229 offset:13888
  s_add_u32 m0, s57, 0x800
  v_mfma_f32_16x16x32_bf16 v[112:115], a[232:235], a[136:139], v[112:115]
  buffer_load_dwordx4 v215, s[4:7], s58 offen nt lds
  v_mfma_f32_16x16x32_bf16 v[120:123], a[232:235], a[140:143], v[120:123]
  s_waitcnt lgkmcnt(10)
  v_mfma_f32_16x16x32_bf16 v[100:103], a[236:239], a[128:131], v[100:103]
  ds_read_b64_tr_b16 a[212:213], v229 offset:15424
  v_mfma_f32_16x16x32_bf16 v[108:111], a[236:239], a[132:135], v[108:111]
  ds_read_b64_tr_b16 a[214:215], v229 offset:16960
  v_mfma_f32_16x16x32_bf16 v[116:119], a[236:239], a[136:139], v[116:119]
  s_add_u32 s57, s55, s74
  s_add_u32 m0, s57, 0
  v_mfma_f32_16x16x32_bf16 v[124:127], a[236:239], a[140:143], v[124:127]
  buffer_load_dwordx4 v216, s[8:11], s59 offen nt lds
  s_waitcnt lgkmcnt(10)
  v_mfma_f32_16x16x32_bf16 v[128:131], a[240:243], a[128:131], v[128:131]
  ds_read_b64_tr_b16 a[216:217], v229 offset:12384
  v_mfma_f32_16x16x32_bf16 v[136:139], a[240:243], a[132:135], v[136:139]
  ds_read_b64_tr_b16 a[218:219], v229 offset:13920
  s_add_u32 m0, s57, 0x400
  v_mfma_f32_16x16x32_bf16 v[144:147], a[240:243], a[136:139], v[144:147]
  buffer_load_dwordx4 v217, s[8:11], s59 offen nt lds
  v_mfma_f32_16x16x32_bf16 v[152:155], a[240:243], a[140:143], v[152:155]
  s_waitcnt lgkmcnt(10)
  v_mfma_f32_16x16x32_bf16 v[132:135], a[244:247], a[128:131], v[132:135]
  ds_read_b64_tr_b16 a[220:221], v229 offset:15456
  v_mfma_f32_16x16x32_bf16 v[140:143], a[244:247], a[132:135], v[140:143]
  ds_read_b64_tr_b16 a[222:223], v229 offset:16992
  v_mfma_f32_16x16x32_bf16 v[148:151], a[244:247], a[136:139], v[148:151]
  s_add_u32 s58, s58, 0x60000
  s_add_u32 s59, s59, 0x18000
  v_mfma_f32_16x16x32_bf16 v[156:159], a[244:247], a[140:143], v[156:159]
  s_waitcnt lgkmcnt(10)
  v_mfma_f32_16x16x32_bf16 v[160:163], a[248:251], a[128:131], v[160:163]
  ds_read_b64_tr_b16 a[224:225], v229 offset:12416
  v_mfma_f32_16x16x32_bf16 v[168:171], a[248:251], a[132:135], v[168:171]
  ds_read_b64_tr_b16 a[226:227], v229 offset:13952
  v_mfma_f32_16x16x32_bf16 v[176:179], a[248:251], a[136:139], v[176:179]
  s_add_u32 s55, s55, 0x6080
  s_cmp_ge_u32 s55, 0x24300
  s_cselect_b32 s55, 0, s55
  v_mfma_f32_16x16x32_bf16 v[184:187], a[248:251], a[140:143], v[184:187]
  s_waitcnt lgkmcnt(10)
  v_mfma_f32_16x16x32_bf16 v[164:167], a[252:255], a[128:131], v[164:167]
  ds_read_b64_tr_b16 a[228:229], v229 offset:15488
  v_mfma_f32_16x16x32_bf16 v[172:175], a[252:255], a[132:135], v[172:175]
  s_add_u32 s54, s54, 0x6080
  s_cmp_ge_u32 s54, 0x24300
  s_cselect_b32 s54, 0, s54
  v_mfma_f32_16x16x32_bf16 v[180:183], a[252:255], a[136:139], v[180:183]
  ds_read_b64_tr_b16 a[230:231], v229 offset:17024
  v_mfma_f32_16x16x32_bf16 v[188:191], a[252:255], a[140:143], v[188:191]
  s_waitcnt vmcnt(27)
  s_barrier
  s_waitcnt lgkmcnt(10)
  v_mfma_f32_16x16x32_bf16 a[0:3], a[208:211], a[128:131], a[0:3]
  v_add_u32 v228, s54, v225
  v_add_u32 v229, s54, v227
  v_mfma_f32_16x16x32_bf16 a[8:11], a[208:211], a[132:135], a[8:11]
  ds_read_b64_tr_b16 a[232:233], v228
  v_mfma_f32_16x16x32_bf16 a[16:19], a[208:211], a[136:139], a[16:19]
  ds_read_b64_tr_b16 a[234:235], v228 offset:1024
  v_mfma_f32_16x16x32_bf16 a[24:27], a[208:211], a[140:143], a[24:27]
  s_waitcnt lgkmcnt(10)
  v_mfma_f32_16x16x32_bf16 a[4:7], a[212:215], a[128:131], a[4:7]
  ds_read_b64_tr_b16 a[236:237], v228 offset:8
  v_mfma_f32_16x16x32_bf16 a[12:15], a[212:215], a[132:135], a[12:15]
  ds_read_b64_tr_b16 a[238:239], v228 offset:1032
  v_mfma_f32_16x16x32_bf16 a[20:23], a[212:215], a[136:139], a[20:23]
  v_mfma_f32_16x16x32_bf16 a[28:31], a[212:215], a[140:143], a[28:31]
  s_waitcnt lgkmcnt(10)
  v_mfma_f32_16x16x32_bf16 a[32:35], a[216:219], a[128:131], a[32:35]
  ds_read_b64_tr_b16 a[240:241], v228 offset:256
  v_mfma_f32_16x16x32_bf16 a[40:43], a[216:219], a[132:135], a[40:43]
  ds_read_b64_tr_b16 a[242:243], v228 offset:1280
  v_mfma_f32_16x16x32_bf16 a[48:51], a[216:219], a[136:139], a[48:51]
  v_mfma_f32_16x16x32_bf16 a[56:59], a[216:219], a[140:143], a[56:59]
  s_waitcnt lgkmcnt(10)
  v_mfma_f32_16x16x32_bf16 a[36:39], a[220:223], a[128:131], a[36:39]
  ds_read_b64_tr_b16 a[244:245], v228 offset:264
  v_mfma_f32_16x16x32_bf16 a[44:47], a[220:223], a[132:135], a[44:47]
  ds_read_b64_tr_b16 a[246:247], v228 offset:1288
  v_mfma_f32_16x16x32_bf16 a[52:55], a[220:223], a[136:139], a[52:55]
  v_mfma_f32_16x16x32_bf16 a[60:63], a[220:223], a[140:143], a[60:63]
  s_waitcnt lgkmcnt(10)
  v_mfma_f32_16x16x32_bf16 a[64:67], a[224:227], a[128:131], a[64:67]
  ds_read_b64_tr_b16 a[248:249], v228 offset:512
  v_mfma_f32_16x16x32_bf16 a[72:75], a[224:227], a[132:135], a[72:75]
  ds_read_b64_tr_b16 a[250:251], v228 offset:1536
  v_mfma_f32_16x16x32_bf16 a[80:83], a[224:227], a[136:139], a[80:83]
  v_mfma_f32_16x16x32_bf16 a[88:91], a[224:227], a[140:143], a[88:91]
  s_waitcnt lgkmcnt(10)
  v_mfma_f32_16x16x32_bf16 a[68:71], a[228:231], a[128:131], a[68:71]
  ds_read_b64_tr_b16 a[252:253], v228 offset:520
  v_mfma_f32_16x16x32_bf16 a[76:79], a[228:231], a[132:135], a[76:79]
  ds_read_b64_tr_b16 a[254:255], v228 offset:1544
  v_mfma_f32_16x16x32_bf16 a[84:87], a[228:231], a[136:139], a[84:87]
  v_mfma_f32_16x16x32_bf16 a[92:95], a[228:231], a[140:143], a[92:95]
  s_waitcnt vmcnt(23) lgkmcnt(10)
  v_mfma_f32_16x16x32_bf16 v[0:3], a[232:235], a[144:147], v[0:3]
  ds_read_b64_tr_b16 a[208:209], v228 offset:768
  v_mfma_f32_16x16x32_bf16 v[8:11], a[232:235], a[148:151], v[8:11]
  ds_read_b64_tr_b16 a[210:211], v228 offset:1792
  v_mfma_f32_16x16x32_bf16 v[16:19], a[232:235], a[152:155], v[16:19]
  buffer_load_dwordx4 a[128:131], v231, s[20:23], s62 offen offset:2048
  v_mfma_f32_16x16x32_bf16 v[24:27], a[232:235], a[156:159], v[24:27]
  s_waitcnt lgkmcnt(10)
  v_mfma_f32_16x16x32_bf16 v[4:7], a[236:239], a[144:147], v[4:7]
  ds_read_b64_tr_b16 a[212:213], v228 offset:776
  v_mfma_f32_16x16x32_bf16 v[12:15], a[236:239], a[148:151], v[12:15]
  ds_read_b64_tr_b16 a[214:215], v228 offset:1800
  v_mfma_f32_16x16x32_bf16 v[20:23], a[236:239], a[152:155], v[20:23]
  buffer_load_dwordx4 a[132:135], v232, s[20:23], s62 offen offset:2048
  v_mfma_f32_16x16x32_bf16 v[28:31], a[236:239], a[156:159], v[28:31]
  s_waitcnt lgkmcnt(10)
  v_mfma_f32_16x16x32_bf16 v[32:35], a[240:243], a[144:147], v[32:35]
  ds_read_b64_tr_b16 a[216:217], v228 offset:2048
  v_mfma_f32_16x16x32_bf16 v[40:43], a[240:243], a[148:151], v[40:43]
  ds_read_b64_tr_b16 a[218:219], v228 offset:2560
  v_mfma_f32_16x16x32_bf16 v[48:51], a[240:243], a[152:155], v[48:51]
  buffer_load_dwordx4 a[136:139], v233, s[20:23], s62 offen offset:2048
  v_mfma_f32_16x16x32_bf16 v[56:59], a[240:243], a[156:159], v[56:59]
  s_waitcnt lgkmcnt(10)
  v_mfma_f32_16x16x32_bf16 v[36:39], a[244:247], a[144:147], v[36:39]
  ds_read_b64_tr_b16 a[220:221], v228 offset:2056
  v_mfma_f32_16x16x32_bf16 v[44:47], a[244:247], a[148:151], v[44:47]
  ds_read_b64_tr_b16 a[222:223], v228 offset:2568
  v_mfma_f32_16x16x32_bf16 v[52:55], a[244:247], a[152:155], v[52:55]
  buffer_load_dwordx4 a[140:143], v234, s[20:23], s62 offen offset:2048
  v_mfma_f32_16x16x32_bf16 v[60:63], a[244:247], a[156:159], v[60:63]
  s_waitcnt lgkmcnt(10)
  v_mfma_f32_16x16x32_bf16 v[64:67], a[248:251], a[144:147], v[64:67]
  ds_read_b64_tr_b16 a[224:225], v228 offset:2304
  v_mfma_f32_16x16x32_bf16 v[72:75], a[248:251], a[148:151], v[72:75]
  ds_read_b64_tr_b16 a[226:227], v228 offset:2816
  v_mfma_f32_16x16x32_bf16 v[80:83], a[248:251], a[152:155], v[80:83]
  s_add_u32 s57, s55, s71
  s_add_u32 m0, s57, 0
  v_mfma_f32_16x16x32_bf16 v[88:91], a[248:251], a[156:159], v[88:91]
  buffer_load_dwordx4 v213, s[4:7], s58 offen nt lds
  s_waitcnt lgkmcnt(10)
  v_mfma_f32_16x16x32_bf16 v[68:71], a[252:255], a[144:147], v[68:71]
  ds_read_b64_tr_b16 a[228:229], v228 offset:2312
  v_mfma_f32_16x16x32_bf16 v[76:79], a[252:255], a[148:151], v[76:79]
  ds_read_b64_tr_b16 a[230:231], v228 offset:2824
  s_add_u32 m0, s57, 0x400
  v_mfma_f32_16x16x32_bf16 v[84:87], a[252:255], a[152:155], v[84:87]
  buffer_load_dwordx4 v214, s[4:7], s58 offen nt lds
  v_mfma_f32_16x16x32_bf16 v[92:95], a[252:255], a[156:159], v[92:95]
  s_waitcnt lgkmcnt(10)
  v_mfma_f32_16x16x32_bf16 v[96:99], a[208:211], a[144:147], v[96:99]
  ds_read_b64_tr_b16 a[232:233], v229 offset:12352
  v_mfma_f32_16x16x32_bf16 v[104:107], a[208:211], a[148:151], v[104:107]
  ds_read_b64_tr_b16 a[234:235], v229 offset:13888
  s_add_u32 m0, s57, 0x800
  v_mfma_f32_16x16x32_bf16 v[112:115], a[208:211], a[152:155], v[112:115]
  buffer_load_dwordx4 v215, s[4:7], s58 offen nt lds
  v_mfma_f32_16x16x32_bf16 v[120:123], a[208:211], a[156:159], v[120:123]
  s_waitcnt lgkmcnt(10)
  v_mfma_f32_16x16x32_bf16 v[100:103], a[212:215], a[144:147], v[100:103]
  ds_read_b64_tr_b16 a[236:237], v229 offset:15424
  v_mfma_f32_16x16x32_bf16 v[108:111], a[212:215], a[148:151], v[108:111]
  ds_read_b64_tr_b16 a[238:239], v229 offset:16960
  v_mfma_f32_16x16x32_bf16 v[116:119], a[212:215], a[152:155], v[116:119]
  s_add_u32 s57, s55, s74
  s_add_u32 m0, s57, 0
  v_mfma_f32_16x16x32_bf16 v[124:127], a[212:215], a[156:159], v[124:127]
  buffer_load_dwordx4 v216, s[8:11], s59 offen nt lds
  s_waitcnt lgkmcnt(10)
  v_mfma_f32_16x16x32_bf16 v[128:131], a[216:219], a[144:147], v[128:131]
  ds_read_b64_tr_b16 a[240:241], v229 offset:12384
  v_mfma_f32_16x16x32_bf16 v[136:139], a[216:219], a[148:151], v[136:139]
  ds_read_b64_tr_b16 a[242:243], v229 offset:13920
  s_add_u32 m0, s57, 0x400
  v_mfma_f32_16x16x32_bf16 v[144:147], a[216:219], a[152:155], v[144:147]
  buffer_load_dwordx4 v217, s[8:11], s59 offen nt lds
  v_mfma_f32_16x16x32_bf16 v[152:155], a[216:219], a[156:159], v[152:155]
  s_waitcnt lgkmcnt(10)
  v_mfma_f32_16x16x32_bf16 v[132:135], a[220:223], a[144:147], v[132:135]
  ds_read_b64_tr_b16 a[244:245], v229 offset:15456
  v_mfma_f32_16x16x32_bf16 v[140:143], a[220:223], a[148:151], v[140:143]
  ds_read_b64_tr_b16 a[246:247], v229 offset:16992
  v_mfma_f32_16x16x32_bf16 v[148:151], a[220:223], a[152:155], v[148:151]
  s_add_u32 s58, s58, 0x60000
  s_add_u32 s59, s59, 0x18000
  v_mfma_f32_16x16x32_bf16 v[156:159], a[220:223], a[156:159], v[156:159]
  s_waitcnt lgkmcnt(10)
  v_mfma_f32_16x16x32_bf16 v[160:163], a[224:227], a[144:147], v[160:163]
  ds_read_b64_tr_b16 a[248:249], v229 offset:12416
  v_mfma_f32_16x16x32_bf16 v[168:171], a[224:227], a[148:151], v[168:171]
  ds_read_b64_tr_b16 a[250:251], v229 offset:13952
  v_mfma_f32_16x16x32_bf16 v[176:179], a[224:227], a[152:155], v[176:179]
  s_add_u32 s55, s55, 0x6080
  s_cmp_ge_u32 s55, 0x24300
  s_cselect_b32 s55, 0, s55
  v_mfma_f32_16x16x32_bf16 v[184:187], a[224:227], a[156:159], v[184:187]
  s_waitcnt lgkmcnt(10)
  v_mfma_f32_16x16x32_bf16 v[164:167], a[228:231], a[144:147], v[164:167]
  ds_read_b64_tr_b16 a[252:253], v229 offset:15488
  v_mfma_f32_16x16x32_bf16 v[172:175], a[228:231], a[148:151], v[172:175]
  s_add_u32 s54, s54, 0x6080
  s_cmp_ge_u32 s54, 0x24300
  s_cselect_b32 s54, 0, s54
  v_mfma_f32_16x16x32_bf16 v[180:183], a[228:231], a[152:155], v[180:183]
  ds_read_b64_tr_b16 a[254:255], v229 offset:17024
  v_mfma_f32_16x16x32_bf16 v[188:191], a[228:231], a[156:159], v[188:191]
  s_waitcnt vmcnt(27)
  s_barrier
  s_waitcnt lgkmcnt(10)
  v_mfma_f32_16x16x32_bf16 a[0:3], a[232:235], a[144:147], a[0:3]
  v_add_u32 v228, s54, v225
  v_add_u32 v229, s54, v227
  v_mfma_f32_16x16x32_bf16 a[8:11], a[232:235], a[148:151], a[8:11]
  ds_read_b64_tr_b16 a[208:209], v228
  v_mfma_f32_16x16x32_bf16 a[16:19], a[232:235], a[152:155], a[16:19]
  ds_read_b64_tr_b16 a[210:211], v228 offset:1024
  v_mfma_f32_16x16x32_bf16 a[24:27], a[232:235], a[156:159], a[24:27]
  s_waitcnt lgkmcnt(10)
  v_mfma_f32_16x16x32_bf16 a[4:7], a[236:239], a[144:147], a[4:7]
  ds_read_b64_tr_b16 a[212:213], v228 offset:8
  v_mfma_f32_16x16x32_bf16 a[12:15], a[236:239], a[148:151], a[12:15]
  ds_read_b64_tr_b16 a[214:215], v228 offset:1032
  v_mfma_f32_16x16x32_bf16 a[20:23], a[236:239], a[152:155], a[20:23]
  v_mfma_f32_16x16x32_bf16 a[28:31], a[236:239], a[156:159], a[28:31]
  s_waitcnt lgkmcnt(10)
  v_mfma_f32_16x16x32_bf16 a[32:35], a[240:243], a[144:147], a[32:35]
  ds_read_b64_tr_b16 a[216:217], v228 offset:256
  v_mfma_f32_16x16x32_bf16 a[40:43], a[240:243], a[148:151], a[40:43]
  ds_read_b64_tr_b16 a[218:219], v228 offset:1280
  v_mfma_f32_16x16x32_bf16 a[48:51], a[240:243], a[152:155], a[48:51]
  v_mfma_f32_16x16x32_bf16 a[56:59], a[240:243], a[156:159], a[56:59]
  s_waitcnt lgkmcnt(10)
  v_mfma_f32_16x16x32_bf16 a[36:39], a[244:247], a[144:147], a[36:39]
  ds_read_b64_tr_b16 a[220:221], v228 offset:264
  v_mfma_f32_16x16x32_bf16 a[44:47], a[244:247], a[148:151], a[44:47]
  ds_read_b64_tr_b16 a[222:223], v228 offset:1288
  v_mfma_f32_16x16x32_bf16 a[52:55], a[244:247], a[152:155], a[52:55]
  v_mfma_f32_16x16x32_bf16 a[60:63], a[244:247], a[156:159], a[60:63]
  s_waitcnt lgkmcnt(10)
  v_mfma_f32_16x16x32_bf16 a[64:67], a[248:251], a[144:147], a[64:67]
  ds_read_b64_tr_b16 a[224:225], v228 offset:512
  v_mfma_f32_16x16x32_bf16 a[72:75], a[248:251], a[148:151], a[72:75]
  ds_read_b64_tr_b16 a[226:227], v228 offset:1536
  v_mfma_f32_16x16x32_bf16 a[80:83], a[248:251], a[152:155], a[80:83]
  v_mfma_f32_16x16x32_bf16 a[88:91], a[248:251], a[156:159], a[88:91]
  s_waitcnt lgkmcnt(10)
  v_mfma_f32_16x16x32_bf16 a[68:71], a[252:255], a[144:147], a[68:71]
  ds_read_b64_tr_b16 a[228:229], v228 offset:520
  v_mfma_f32_16x16x32_bf16 a[76:79], a[252:255], a[148:151], a[76:79]
  ds_read_b64_tr_b16 a[230:231], v228 offset:1544
  v_mfma_f32_16x16x32_bf16 a[84:87], a[252:255], a[152:155], a[84:87]
  v_mfma_f32_16x16x32_bf16 a[92:95], a[252:255], a[156:159], a[92:95]
  s_sub_u32 s56, s56, 1
  s_cmp_lg_u32 s56, 0
  s_cbranch_scc1 L_proj
  s_waitcnt vmcnt(23) lgkmcnt(10)
  v_mfma_f32_16x16x32_bf16 v[0:3], a[208:211], a[96:99], v[0:3]
  ds_read_b64_tr_b16 a[232:233], v228 offset:768
  v_mfma_f32_16x16x32_bf16 v[8:11], a[208:211], a[100:103], v[8:11]
  ds_read_b64_tr_b16 a[234:235], v228 offset:1792
  v_mfma_f32_16x16x32_bf16 v[16:19], a[208:211], a[104:107], v[16:19]
  buffer_load_dwordx4 a[144:147], v231, s[20:23], s62 offen offset:3072
  v_mfma_f32_16x16x32_bf16 v[24:27], a[208:211], a[108:111], v[24:27]
  s_waitcnt lgkmcnt(10)
  v_mfma_f32_16x16x32_bf16 v[4:7], a[212:215], a[96:99], v[4:7]
  ds_read_b64_tr_b16 a[236:237], v228 offset:776
  v_mfma_f32_16x16x32_bf16 v[12:15], a[212:215], a[100:103], v[12:15]
  ds_read_b64_tr_b16 a[238:239], v228 offset:1800
  v_mfma_f32_16x16x32_bf16 v[20:23], a[212:215], a[104:107], v[20:23]
  buffer_load_dwordx4 a[148:151], v232, s[20:23], s62 offen offset:3072
  v_mfma_f32_16x16x32_bf16 v[28:31], a[212:215], a[108:111], v[28:31]
  s_waitcnt lgkmcnt(10)
  v_mfma_f32_16x16x32_bf16 v[32:35], a[216:219], a[96:99], v[32:35]
  ds_read_b64_tr_b16 a[240:241], v228 offset:2048
  v_mfma_f32_16x16x32_bf16 v[40:43], a[216:219], a[100:103], v[40:43]
  ds_read_b64_tr_b16 a[242:243], v228 offset:2560
  v_mfma_f32_16x16x32_bf16 v[48:51], a[216:219], a[104:107], v[48:51]
  buffer_load_dwordx4 a[152:155], v233, s[20:23], s62 offen offset:3072
  v_mfma_f32_16x16x32_bf16 v[56:59], a[216:219], a[108:111], v[56:59]
  s_waitcnt lgkmcnt(10)
  v_mfma_f32_16x16x32_bf16 v[36:39], a[220:223], a[96:99], v[36:39]
  ds_read_b64_tr_b16 a[244:245], v228 offset:2056
  v_mfma_f32_16x16x32_bf16 v[44:47], a[220:223], a[100:103], v[44:47]
  ds_read_b64_tr_b16 a[246:247], v228 offset:2568
  v_mfma_f32_16x16x32_bf16 v[52:55], a[220:223], a[104:107], v[52:55]
  buffer_load_dwordx4 a[156:159], v234, s[20:23], s62 offen offset:3072
  v_mfma_f32_16x16x32_bf16 v[60:63], a[220:223], a[108:111], v[60:63]
  s_add_u32 s62, s62, 0x1000
  s_waitcnt lgkmcnt(10)
  v_mfma_f32_16x16x32_bf16 v[64:67], a[224:227], a[96:99], v[64:67]
  ds_read_b64_tr_b16 a[248:249], v228 offset:2304
  v_mfma_f32_16x16x32_bf16 v[72:75], a[224:227], a[100:103], v[72:75]
  ds_read_b64_tr_b16 a[250:251], v228 offset:2816
  v_mfma_f32_16x16x32_bf16 v[80:83], a[224:227], a[104:107], v[80:83]
  s_add_u32 s57, s55, s72
  s_add_u32 m0, s57, 0
  v_mfma_f32_16x16x32_bf16 v[88:91], a[224:227], a[108:111], v[88:91]
  buffer_load_dwordx4 v222, s[12:15], s67 offen nt lds
  s_waitcnt lgkmcnt(10)
  v_mfma_f32_16x16x32_bf16 v[68:71], a[228:231], a[96:99], v[68:71]
  ds_read_b64_tr_b16 a[252:253], v228 offset:2312
  v_mfma_f32_16x16x32_bf16 v[76:79], a[228:231], a[100:103], v[76:79]
  ds_read_b64_tr_b16 a[254:255], v228 offset:2824
  v_mfma_f32_16x16x32_bf16 v[84:87], a[228:231], a[104:107], v[84:87]
  v_mfma_f32_16x16x32_bf16 v[92:95], a[228:231], a[108:111], v[92:95]
  s_waitcnt lgkmcnt(10)
  v_mfma_f32_16x16x32_bf16 v[96:99], a[232:235], a[96:99], v[96:99]
  ds_read_b64_tr_b16 a[208:209], v229 offset:12352
  v_mfma_f32_16x16x32_bf16 v[104:107], a[232:235], a[100:103], v[104:107]
  ds_read_b64_tr_b16 a[210:211], v229 offset:13888
  s_add_u32 m0, s57, 0xf80
  v_mfma_f32_16x16x32_bf16 v[112:115], a[232:235], a[104:107], v[112:115]
  buffer_load_dwordx4 v222, s[12:15], s67 offen offset:128 nt lds
  v_mfma_f32_16x16x32_bf16 v[120:123], a[232:235], a[108:111], v[120:123]
  s_waitcnt lgkmcnt(10)
  v_mfma_f32_16x16x32_bf16 v[100:103], a[236:239], a[96:99], v[100:103]
  ds_read_b64_tr_b16 a[212:213], v229 offset:15424
  v_mfma_f32_16x16x32_bf16 v[108:111], a[236:239], a[100:103], v[108:111]
  ds_read_b64_tr_b16 a[214:215], v229 offset:16960
  v_mfma_f32_16x16x32_bf16 v[116:119], a[236:239], a[104:107], v[116:119]
  v_mfma_f32_16x16x32_bf16 v[124:127], a[236:239], a[108:111], v[124:127]
  s_waitcnt lgkmcnt(10)
  v_mfma_f32_16x16x32_bf16 v[128:131], a[240:243], a[96:99], v[128:131]
  ds_read_b64_tr_b16 a[216:217], v229 offset:12384
  v_mfma_f32_16x16x32_bf16 v[136:139], a[240:243], a[100:103], v[136:139]
  ds_read_b64_tr_b16 a[218:219], v229 offset:13920
  s_add_u32 m0, s57, 0x1f00
  v_mfma_f32_16x16x32_bf16 v[144:147], a[240:243], a[104:107], v[144:147]
  buffer_load_dwordx4 v222, s[12:15], s67 offen offset:256 nt lds
  v_mfma_f32_16x16x32_bf16 v[152:155], a[240:243], a[108:111], v[152:155]
  s_waitcnt lgkmcnt(10)
  v_mfma_f32_16x16x32_bf16 v[132:135], a[244:247], a[96:99], v[132:135]
  ds_read_b64_tr_b16 a[220:221], v229 offset:15456
  v_mfma_f32_16x16x32_bf16 v[140:143], a[244:247], a[100:103], v[140:143]
  ds_read_b64_tr_b16 a[222:223], v229 offset:16992
  v_mfma_f32_16x16x32_bf16 v[148:151], a[244:247], a[104:107], v[148:151]
  v_mfma_f32_16x16x32_bf16 v[156:159], a[244:247], a[108:111], v[156:159]
  s_waitcnt lgkmcnt(10)
  v_mfma_f32_16x16x32_bf16 v[160:163], a[248:251], a[96:99], v[160:163]
  ds_read_b64_tr_b16 a[224:225], v229 offset:12416
  v_mfma_f32_16x16x32_bf16 v[168:171], a[248:251], a[100:103], v[168:171]
  ds_read_b64_tr_b16 a[226:227], v229 offset:13952
  s_add_u32 s67, s67, 0x3000
  v_mfma_f32_16x16x32_bf16 v[176:179], a[248:251], a[104:107], v[176:179]
  v_mfma_f32_16x16x32_bf16 v[184:187], a[248:251], a[108:111], v[184:187]
  s_waitcnt lgkmcnt(10)
  v_mfma_f32_16x16x32_bf16 v[164:167], a[252:255], a[96:99], v[164:167]
  ds_read_b64_tr_b16 a[228:229], v229 offset:15488
  v_mfma_f32_16x16x32_bf16 v[172:175], a[252:255], a[100:103], v[172:175]
  s_add_u32 s54, s54, 0x6080
  s_cmp_ge_u32 s54, 0x24300
  s_cselect_b32 s54, 0, s54
  v_mfma_f32_16x16x32_bf16 v[180:183], a[252:255], a[104:107], v[180:183]
  ds_read_b64_tr_b16 a[230:231], v229 offset:17024
  v_mfma_f32_16x16x32_bf16 v[188:191], a[252:255], a[108:111], v[188:191]
  s_waitcnt vmcnt(25)
  s_barrier
  s_waitcnt lgkmcnt(10)
  v_mfma_f32_16x16x32_bf16 a[0:3], a[208:211], a[96:99], a[0:3]
  v_add_u32 v228, s54, v225
  v_add_u32 v229, s54, v227
  v_mfma_f32_16x16x32_bf16 a[8:11], a[208:211], a[100:103], a[8:11]
  ds_read_b64_tr_b16 a[232:233], v228
  v_mfma_f32_16x16x32_bf16 a[16:19], a[208:211], a[104:107], a[16:19]
  ds_read_b64_tr_b16 a[234:235], v228 offset:1024
  v_mfma_f32_16x16x32_bf16 a[24:27], a[208:211], a[108:111], a[24:27]
  s_add_u32 s55, s55, 0x6080
  s_cmp_ge_u32 s55, 0x24300
  s_cselect_b32 s55, 0, s55
  s_waitcnt lgkmcnt(10)
  v_mfma_f32_16x16x32_bf16 a[4:7], a[212:215], a[96:99], a[4:7]
  ds_read_b64_tr_b16 a[236:237], v228 offset:8
  v_mfma_f32_16x16x32_bf16 a[12:15], a[212:215], a[100:103], a[12:15]
  ds_read_b64_tr_b16 a[238:239], v228 offset:1032
  v_mfma_f32_16x16x32_bf16 a[20:23], a[212:215], a[104:107], a[20:23]
  v_mfma_f32_16x16x32_bf16 a[28:31], a[212:215], a[108:111], a[28:31]
  s_waitcnt lgkmcnt(10)
  v_mfma_f32_16x16x32_bf16 a[32:35], a[216:219], a[96:99], a[32:35]
  ds_read_b64_tr_b16 a[240:241], v228 offset:256
  v_mfma_f32_16x16x32_bf16 a[40:43], a[216:219], a[100:103], a[40:43]
  ds_read_b64_tr_b16 a[242:243], v228 offset:1280
  v_mfma_f32_16x16x32_bf16 a[48:51], a[216:219], a[104:107], a[48:51]
  v_mfma_f32_16x16x32_bf16 a[56:59], a[216:219], a[108:111], a[56:59]
  s_waitcnt lgkmcnt(10)
  v_mfma_f32_16x16x32_bf16 a[36:39], a[220:223], a[96:99], a[36:39]
  ds_read_b64_tr_b16 a[244:245], v228 offset:264
  v_mfma_f32_16x16x32_bf16 a[44:47], a[220:223], a[100:103], a[44:47]
  ds_read_b64_tr_b16 a[246:247], v228 offset:1288
  v_mfma_f32_16x16x32_bf16 a[52:55], a[220:223], a[104:107], a[52:55]
  v_mfma_f32_16x16x32_bf16 a[60:63], a[220:223], a[108:111], a[60:63]
  s_waitcnt lgkmcnt(10)
  v_mfma_f32_16x16x32_bf16 a[64:67], a[224:227], a[96:99], a[64:67]
  ds_read_b64_tr_b16 a[248:249], v228 offset:512
  v_mfma_f32_16x16x32_bf16 a[72:75], a[224:227], a[100:103], a[72:75]
  ds_read_b64_tr_b16 a[250:251], v228 offset:1536
  v_mfma_f32_16x16x32_bf16 a[80:83], a[224:227], a[104:107], a[80:83]
  v_mfma_f32_16x16x32_bf16 a[88:91], a[224:227], a[108:111], a[88:91]
  s_waitcnt lgkmcnt(10)
  v_mfma_f32_16x16x32_bf16 a[68:71], a[228:231], a[96:99], a[68:71]
  ds_read_b64_tr_b16 a[252:253], v228 offset:520
  v_mfma_f32_16x16x32_bf16 a[76:79], a[228:231], a[100:103], a[76:79]
  ds_read_b64_tr_b16 a[254:255], v228 offset:1544
  v_mfma_f32_16x16x32_bf16 a[84:87], a[228:231], a[104:107], a[84:87]
  v_mfma_f32_16x16x32_bf16 a[92:95], a[228:231], a[108:111], a[92:95]
  s_waitcnt vmcnt(21) lgkmcnt(10)
  v_mfma_f32_16x16x32_bf16 v[0:3], a[232:235], a[112:115], v[0:3]
  ds_read_b64_tr_b16 a[208:209], v228 offset:768
  v_bfe_u32 v239, v212, 2, 2
  v_mfma_f32_16x16x32_bf16 v[8:11], a[232:235], a[116:119], v[8:11]
  ds_read_b64_tr_b16 a[210:211], v228 offset:1792
  v_and_b32 v240, 3, v212
  v_mfma_f32_16x16x32_bf16 v[16:19], a[232:235], a[120:123], v[16:19]
  v_lshlrev_b32 v240, 4, v240
  v_lshrrev_b32 v241, 4, v212
  v_mfma_f32_16x16x32_bf16 v[24:27], a[232:235], a[124:127], v[24:27]
  s_lshr_b32 s49, s44, 1
  s_waitcnt lgkmcnt(10)
  v_mfma_f32_16x16x32_bf16 v[4:7], a[236:239], a[112:115], v[4:7]
  ds_read_b64_tr_b16 a[212:213], v228 offset:776
  s_lshl_b32 s49, s49, 5
  v_mfma_f32_16x16x32_bf16 v[12:15], a[236:239], a[116:119], v[12:15]
  ds_read_b64_tr_b16 a[214:215], v228 offset:1800
  s_and_b32 s50, s44, 1
  v_mfma_f32_16x16x32_bf16 v[20:23], a[236:239], a[120:123], v[20:23]
  s_lshl_b32 s50, s50, 3
  s_add_u32 s49, s49, s50
  v_mfma_f32_16x16x32_bf16 v[28:31], a[236:239], a[124:127], v[28:31]
  s_waitcnt lgkmcnt(10)
  v_add_u32 v242, s49, v239
  v_mfma_f32_16x16x32_bf16 v[32:35], a[240:243], a[112:115], v[32:35]
  ds_read_b64_tr_b16 a[216:217], v228 offset:2048
  v_mul_u32_u24 v242, 0x500, v242
  v_mfma_f32_16x16x32_bf16 v[40:43], a[240:243], a[116:119], v[40:43]
  ds_read_b64_tr_b16 a[218:219], v228 offset:2560
  v_lshl_add_u32 v213, v241, 6, v242
  v_mfma_f32_16x16x32_bf16 v[48:51], a[240:243], a[120:123], v[48:51]
  v_add_u32 v213, v213, v240
  v_add_u32 v214, 0x1400, v213
  v_mfma_f32_16x16x32_bf16 v[56:59], a[240:243], a[124:127], v[56:59]
  s_waitcnt lgkmcnt(10)
  v_add_u32 v215, 0x5000, v213
  v_mfma_f32_16x16x32_bf16 v[36:39], a[244:247], a[112:115], v[36:39]
  ds_read_b64_tr_b16 a[220:221], v228 offset:2056
  v_add_u32 v216, 0x6400, v213
  v_mfma_f32_16x16x32_bf16 v[44:47], a[244:247], a[116:119], v[44:47]
  ds_read_b64_tr_b16 a[222:223], v228 offset:2568
  v_lshrrev_b32 v239, 5, v212
  v_mfma_f32_16x16x32_bf16 v[52:55], a[244:247], a[120:123], v[52:55]
  v_mul_u32_u24 v239, 0x5000, v239
  v_mfma_f32_16x16x32_bf16 v[60:63], a[244:247], a[124:127], v[60:63]
  s_waitcnt lgkmcnt(10)
  v_add_u32 v242, v242, v239
  v_bfe_u32 v239, v212, 4, 1
  v_mfma_f32_16x16x32_bf16 v[64:67], a[248:251], a[112:115], v[64:67]
  ds_read_b64_tr_b16 a[224:225], v228 offset:2304
  v_mul_u32_u24 v239, 0x1400, v239
  v_mfma_f32_16x16x32_bf16 v[72:75], a[248:251], a[116:119], v[72:75]
  ds_read_b64_tr_b16 a[226:227], v228 offset:2816
  v_add_u32 v242, v242, v239
  v_mfma_f32_16x16x32_bf16 v[80:83], a[248:251], a[120:123], v[80:83]
  s_add_u32 s57, s55, s72
  s_add_u32 m0, s57, 0
  v_add_u32 v242, v242, v240
  v_mfma_f32_16x16x32_bf16 v[88:91], a[248:251], a[124:127], v[88:91]
  buffer_load_dwordx4 v222, s[12:15], s67 offen nt lds
  s_waitcnt lgkmcnt(10)
  v_mfma_f32_16x16x32_bf16 v[68:71], a[252:255], a[112:115], v[68:71]
  ds_read_b64_tr_b16 a[228:229], v228 offset:2312
  v_add_u32 v217, 0x100, v242
  v_mfma_f32_16x16x32_bf16 v[76:79], a[252:255], a[116:119], v[76:79]
  ds_read_b64_tr_b16 a[230:231], v228 offset:2824
  s_mul_i32 s49, s45, 6
  v_mfma_f32_16x16x32_bf16 v[84:87], a[252:255], a[120:123], v[84:87]
  s_sub_u32 s49, s49, s97
  v_mfma_f32_16x16x32_bf16 v[92:95], a[252:255], a[124:127], v[92:95]
  s_cmp_lt_u32 s47, 6
  s_cselect_b32 s101, s49, 64
  s_cselect_b32 s26, s98, 0
  s_cselect_b32 s49, s49, 0
  s_waitcnt lgkmcnt(10)
  v_mfma_f32_16x16x32_bf16 v[96:99], a[208:211], a[112:115], v[96:99]
  ds_read_b64_tr_b16 a[232:233], v229 offset:12352
  s_mul_i32 s59, s49, 0xa000
  v_mfma_f32_16x16x32_bf16 v[104:107], a[208:211], a[116:119], v[104:107]
  ds_read_b64_tr_b16 a[234:235], v229 offset:13888
  s_add_u32 m0, s57, 0xf80
  v_mfma_f32_16x16x32_bf16 v[112:115], a[208:211], a[120:123], v[112:115]
  buffer_load_dwordx4 v222, s[12:15], s67 offen offset:128 nt lds
  s_lshl_b32 s97, s97, 10
  v_mfma_f32_16x16x32_bf16 v[120:123], a[208:211], a[124:127], v[120:123]
  s_add_u32 s97, s97, 0x400000
  s_waitcnt lgkmcnt(10)
  v_mov_b32 v244, 0
  v_mfma_f32_16x16x32_bf16 v[100:103], a[212:215], a[112:115], v[100:103]
  ds_read_b64_tr_b16 a[236:237], v229 offset:15424
  s_mov_b32 s28, s88
  v_mfma_f32_16x16x32_bf16 v[108:111], a[212:215], a[116:119], v[108:111]
  ds_read_b64_tr_b16 a[238:239], v229 offset:16960
  s_and_b32 s29, s89, 0xffff
  v_mfma_f32_16x16x32_bf16 v[116:119], a[212:215], a[120:123], v[116:119]
  s_mov_b32 s30, s90
  s_mov_b32 s31, 0x20000
  s_mov_b32 s69, 0
  v_mfma_f32_16x16x32_bf16 v[124:127], a[212:215], a[124:127], v[124:127]
  s_mov_b32 s8, s20
  s_mov_b32 s9, s21
  s_waitcnt lgkmcnt(10)
  v_mfma_f32_16x16x32_bf16 v[128:131], a[216:219], a[112:115], v[128:131]
  ds_read_b64_tr_b16 a[240:241], v229 offset:12384
  s_mov_b32 s10, s22
  v_mfma_f32_16x16x32_bf16 v[136:139], a[216:219], a[116:119], v[136:139]
  ds_read_b64_tr_b16 a[242:243], v229 offset:13920
  s_add_u32 m0, s57, 0x1f00
  v_mfma_f32_16x16x32_bf16 v[144:147], a[216:219], a[120:123], v[144:147]
  buffer_load_dwordx4 v222, s[12:15], s67 offen offset:256 nt lds
  s_mov_b32 s11, 0x20000
  v_mfma_f32_16x16x32_bf16 v[152:155], a[216:219], a[124:127], v[152:155]
  s_waitcnt lgkmcnt(10)
  v_and_b32 v242, 15, v212
  v_lshlrev_b32 v242, 4, v242
  v_mfma_f32_16x16x32_bf16 v[132:135], a[220:223], a[112:115], v[132:135]
  ds_read_b64_tr_b16 a[244:245], v229 offset:15456
  v_lshrrev_b32 v239, 5, v212
  v_mfma_f32_16x16x32_bf16 v[140:143], a[220:223], a[116:119], v[140:143]
  ds_read_b64_tr_b16 a[246:247], v229 offset:16992
  v_lshl_add_u32 v242, v239, 8, v242
  v_mfma_f32_16x16x32_bf16 v[148:151], a[220:223], a[120:123], v[148:151]
  v_bfe_u32 v239, v212, 4, 1
  v_lshl_add_u32 v242, v239, 3, v242
  v_mfma_f32_16x16x32_bf16 v[156:159], a[220:223], a[124:127], v[156:159]
  s_waitcnt lgkmcnt(10)
  v_lshlrev_b32 v239, 4, v212
  v_sub_u32 v242, v242, v239
  v_mfma_f32_16x16x32_bf16 v[160:163], a[224:227], a[112:115], v[160:163]
  ds_read_b64_tr_b16 a[248:249], v229 offset:12416
  v_add_u32 v231, v235, v242
  v_mfma_f32_16x16x32_bf16 v[168:171], a[224:227], a[116:119], v[168:171]
  ds_read_b64_tr_b16 a[250:251], v229 offset:13952
  s_add_u32 s67, s67, 0x3000
  v_mfma_f32_16x16x32_bf16 v[176:179], a[224:227], a[120:123], v[176:179]
  v_add_u32 v232, v236, v242
  v_add_u32 v233, v237, v242
  v_mfma_f32_16x16x32_bf16 v[184:187], a[224:227], a[124:127], v[184:187]
  s_waitcnt lgkmcnt(10)
  v_add_u32 v234, v238, v242
  v_mfma_f32_16x16x32_bf16 v[164:167], a[228:231], a[112:115], v[164:167]
  ds_read_b64_tr_b16 a[252:253], v229 offset:15488
  v_mfma_f32_16x16x32_bf16 v[172:175], a[228:231], a[116:119], v[172:175]
  s_add_u32 s54, s54, 0x6080
  s_cmp_ge_u32 s54, 0x24300
  s_cselect_b32 s54, 0, s54
  v_mfma_f32_16x16x32_bf16 v[180:183], a[228:231], a[120:123], v[180:183]
  ds_read_b64_tr_b16 a[254:255], v229 offset:17024
  v_mfma_f32_16x16x32_bf16 v[188:191], a[228:231], a[124:127], v[188:191]
  s_waitcnt vmcnt(19)
  s_barrier
  s_waitcnt lgkmcnt(10)
  v_mfma_f32_16x16x32_bf16 a[0:3], a[232:235], a[112:115], a[0:3]
  v_add_u32 v228, s54, v225
  v_add_u32 v229, s54, v227
  v_mfma_f32_16x16x32_bf16 a[8:11], a[232:235], a[116:119], a[8:11]
  ds_read_b64_tr_b16 a[208:209], v228
  v_mfma_f32_16x16x32_bf16 a[16:19], a[232:235], a[120:123], a[16:19]
  ds_read_b64_tr_b16 a[210:211], v228 offset:1024
  v_mfma_f32_16x16x32_bf16 a[24:27], a[232:235], a[124:127], a[24:27]
  s_add_u32 s55, s55, 0x6080
  s_cmp_ge_u32 s55, 0x24300
  s_cselect_b32 s55, 0, s55
  s_waitcnt lgkmcnt(10)
  v_mfma_f32_16x16x32_bf16 a[4:7], a[236:239], a[112:115], a[4:7]
  ds_read_b64_tr_b16 a[212:213], v228 offset:8
  v_mfma_f32_16x16x32_bf16 a[12:15], a[236:239], a[116:119], a[12:15]
  ds_read_b64_tr_b16 a[214:215], v228 offset:1032
  v_mfma_f32_16x16x32_bf16 a[20:23], a[236:239], a[120:123], a[20:23]
  v_mfma_f32_16x16x32_bf16 a[28:31], a[236:239], a[124:127], a[28:31]
  s_waitcnt lgkmcnt(10)
  v_mfma_f32_16x16x32_bf16 a[32:35], a[240:243], a[112:115], a[32:35]
  ds_read_b64_tr_b16 a[216:217], v228 offset:256
  v_mfma_f32_16x16x32_bf16 a[40:43], a[240:243], a[116:119], a[40:43]
  ds_read_b64_tr_b16 a[218:219], v228 offset:1280
  v_mfma_f32_16x16x32_bf16 a[48:51], a[240:243], a[120:123], a[48:51]
  v_mfma_f32_16x16x32_bf16 a[56:59], a[240:243], a[124:127], a[56:59]
  s_waitcnt lgkmcnt(10)
  v_mfma_f32_16x16x32_bf16 a[36:39], a[244:247], a[112:115], a[36:39]
  ds_read_b64_tr_b16 a[220:221], v228 offset:264
  v_mfma_f32_16x16x32_bf16 a[44:47], a[244:247], a[116:119], a[44:47]
  ds_read_b64_tr_b16 a[222:223], v228 offset:1288
  v_mfma_f32_16x16x32_bf16 a[52:55], a[244:247], a[120:123], a[52:55]
  v_mfma_f32_16x16x32_bf16 a[60:63], a[244:247], a[124:127], a[60:63]
  s_waitcnt lgkmcnt(10)
  v_mfma_f32_16x16x32_bf16 a[64:67], a[248:251], a[112:115], a[64:67]
  ds_read_b64_tr_b16 a[224:225], v228 offset:512
  v_mfma_f32_16x16x32_bf16 a[72:75], a[248:251], a[116:119], a[72:75]
  ds_read_b64_tr_b16 a[226:227], v228 offset:1536
  v_mfma_f32_16x16x32_bf16 a[80:83], a[248:251], a[120:123], a[80:83]
  v_mfma_f32_16x16x32_bf16 a[88:91], a[248:251], a[124:127], a[88:91]
  s_waitcnt lgkmcnt(10)
  v_mfma_f32_16x16x32_bf16 a[68:71], a[252:255], a[112:115], a[68:71]
  ds_read_b64_tr_b16 a[228:229], v228 offset:520
  v_mfma_f32_16x16x32_bf16 a[76:79], a[252:255], a[116:119], a[76:79]
  ds_read_b64_tr_b16 a[230:231], v228 offset:1544
  v_mfma_f32_16x16x32_bf16 a[84:87], a[252:255], a[120:123], a[84:87]
  v_mfma_f32_16x16x32_bf16 a[92:95], a[252:255], a[124:127], a[92:95]
  s_waitcnt vmcnt(15) lgkmcnt(10)
  v_mfma_f32_16x16x32_bf16 v[0:3], a[208:211], a[128:131], v[0:3]
  ds_read_b64_tr_b16 a[232:233], v228 offset:768
  v_mfma_f32_16x16x32_bf16 v[8:11], a[208:211], a[132:135], v[8:11]
  ds_read_b64_tr_b16 a[234:235], v228 offset:1792
  v_mfma_f32_16x16x32_bf16 v[16:19], a[208:211], a[136:139], v[16:19]
  v_mfma_f32_16x16x32_bf16 v[24:27], a[208:211], a[140:143], v[24:27]
  s_waitcnt lgkmcnt(10)
  v_mfma_f32_16x16x32_bf16 v[4:7], a[212:215], a[128:131], v[4:7]
  ds_read_b64_tr_b16 a[236:237], v228 offset:776
  v_mfma_f32_16x16x32_bf16 v[12:15], a[212:215], a[132:135], v[12:15]
  ds_read_b64_tr_b16 a[238:239], v228 offset:1800
  v_mfma_f32_16x16x32_bf16 v[20:23], a[212:215], a[136:139], v[20:23]
  v_mfma_f32_16x16x32_bf16 v[28:31], a[212:215], a[140:143], v[28:31]
  s_waitcnt lgkmcnt(10)
  v_mfma_f32_16x16x32_bf16 v[32:35], a[216:219], a[128:131], v[32:35]
  ds_read_b64_tr_b16 a[240:241], v228 offset:2048
  v_mfma_f32_16x16x32_bf16 v[40:43], a[216:219], a[132:135], v[40:43]
  ds_read_b64_tr_b16 a[242:243], v228 offset:2560
  v_mfma_f32_16x16x32_bf16 v[48:51], a[216:219], a[136:139], v[48:51]
  v_mfma_f32_16x16x32_bf16 v[56:59], a[216:219], a[140:143], v[56:59]
  s_waitcnt lgkmcnt(10)
  v_mfma_f32_16x16x32_bf16 v[36:39], a[220:223], a[128:131], v[36:39]
  ds_read_b64_tr_b16 a[244:245], v228 offset:2056
  v_mfma_f32_16x16x32_bf16 v[44:47], a[220:223], a[132:135], v[44:47]
  ds_read_b64_tr_b16 a[246:247], v228 offset:2568
  v_mfma_f32_16x16x32_bf16 v[52:55], a[220:223], a[136:139], v[52:55]
  v_mfma_f32_16x16x32_bf16 v[60:63], a[220:223], a[140:143], v[60:63]
  s_waitcnt lgkmcnt(10)
  v_mfma_f32_16x16x32_bf16 v[64:67], a[224:227], a[128:131], v[64:67]
  ds_read_b64_tr_b16 a[248:249], v228 offset:2304
  v_mfma_f32_16x16x32_bf16 v[72:75], a[224:227], a[132:135], v[72:75]
  ds_read_b64_tr_b16 a[250:251], v228 offset:2816
  v_mfma_f32_16x16x32_bf16 v[80:83], a[224:227], a[136:139], v[80:83]
  s_add_u32 s57, s55, s72
  s_add_u32 m0, s57, 0
  v_mfma_f32_16x16x32_bf16 v[88:91], a[224:227], a[140:143], v[88:91]
  buffer_load_dwordx4 v222, s[12:15], s67 offen nt lds
  s_waitcnt lgkmcnt(10)
  v_mfma_f32_16x16x32_bf16 v[68:71], a[228:231], a[128:131], v[68:71]
  ds_read_b64_tr_b16 a[252:253], v228 offset:2312
  v_mfma_f32_16x16x32_bf16 v[76:79], a[228:231], a[132:135], v[76:79]
  ds_read_b64_tr_b16 a[254:255], v228 offset:2824
  s_add_u32 m0, s57, 0xf80
  v_mfma_f32_16x16x32_bf16 v[84:87], a[228:231], a[136:139], v[84:87]
  buffer_load_dwordx4 v222, s[12:15], s67 offen offset:128 nt lds
  v_mfma_f32_16x16x32_bf16 v[92:95], a[228:231], a[140:143], v[92:95]
  s_waitcnt lgkmcnt(10)
  v_mfma_f32_16x16x32_bf16 v[96:99], a[232:235], a[128:131], v[96:99]
  ds_read_b64_tr_b16 a[208:209], v229 offset:12352
  v_mfma_f32_16x16x32_bf16 v[104:107], a[232:235], a[132:135], v[104:107]
  ds_read_b64_tr_b16 a[210:211], v229 offset:13888
  s_add_u32 m0, s57, 0x1f00
  v_mfma_f32_16x16x32_bf16 v[112:115], a[232:235], a[136:139], v[112:115]
  buffer_load_dwordx4 v222, s[12:15], s67 offen offset:256 nt lds
  v_mfma_f32_16x16x32_bf16 v[120:123], a[232:235], a[140:143], v[120:123]
  s_waitcnt lgkmcnt(10)
  v_mfma_f32_16x16x32_bf16 v[100:103], a[236:239], a[128:131], v[100:103]
  ds_read_b64_tr_b16 a[212:213], v229 offset:15424
  v_mfma_f32_16x16x32_bf16 v[108:111], a[236:239], a[132:135], v[108:111]
  ds_read_b64_tr_b16 a[214:215], v229 offset:16960
  s_add_u32 s67, s67, 0x3000
  v_mfma_f32_16x16x32_bf16 v[116:119], a[236:239], a[136:139], v[116:119]
  v_mfma_f32_16x16x32_bf16 v[124:127], a[236:239], a[140:143], v[124:127]
  s_waitcnt lgkmcnt(10)
  v_mfma_f32_16x16x32_bf16 v[128:131], a[240:243], a[128:131], v[128:131]
  ds_read_b64_tr_b16 a[216:217], v229 offset:12384
  v_mfma_f32_16x16x32_bf16 v[136:139], a[240:243], a[132:135], v[136:139]
  ds_read_b64_tr_b16 a[218:219], v229 offset:13920
  v_mfma_f32_16x16x32_bf16 v[144:147], a[240:243], a[136:139], v[144:147]
  s_add_u32 s57, s55, s73
  s_mov_b32 m0, s57
  v_mfma_f32_16x16x32_bf16 v[152:155], a[240:243], a[140:143], v[152:155]
  buffer_load_dwordx4 v223, s[16:19], s68 offen nt lds
  s_waitcnt lgkmcnt(10)
  v_mfma_f32_16x16x32_bf16 v[132:135], a[244:247], a[128:131], v[132:135]
  ds_read_b64_tr_b16 a[220:221], v229 offset:15456
  v_mfma_f32_16x16x32_bf16 v[140:143], a[244:247], a[132:135], v[140:143]
  ds_read_b64_tr_b16 a[222:223], v229 offset:16992
  s_sub_u32 m0, s57, 0x200
  v_mfma_f32_16x16x32_bf16 v[148:151], a[244:247], a[136:139], v[148:151]
  buffer_load_dwordx4 v223, s[16:19], s68 offen offset:1536 nt lds
  v_mfma_f32_16x16x32_bf16 v[156:159], a[244:247], a[140:143], v[156:159]
  s_waitcnt lgkmcnt(10)
  v_mfma_f32_16x16x32_bf16 v[160:163], a[248:251], a[128:131], v[160:163]
  ds_read_b64_tr_b16 a[224:225], v229 offset:12416
  v_mfma_f32_16x16x32_bf16 v[168:171], a[248:251], a[132:135], v[168:171]
  ds_read_b64_tr_b16 a[226:227], v229 offset:13952
  s_add_u32 m0, s57, 0x800
  v_mfma_f32_16x16x32_bf16 v[176:179], a[248:251], a[136:139], v[176:179]
  buffer_load_dwordx4 v224, s[16:19], s68 offen nt lds
  v_mfma_f32_16x16x32_bf16 v[184:187], a[248:251], a[140:143], v[184:187]
  s_waitcnt lgkmcnt(10)
  v_mfma_f32_16x16x32_bf16 v[164:167], a[252:255], a[128:131], v[164:167]
  ds_read_b64_tr_b16 a[228:229], v229 offset:15488
  v_mfma_f32_16x16x32_bf16 v[172:175], a[252:255], a[132:135], v[172:175]
  s_add_u32 s54, s54, 0x6080
  s_cmp_ge_u32 s54, 0x24300
  s_cselect_b32 s54, 0, s54
  v_mfma_f32_16x16x32_bf16 v[180:183], a[252:255], a[136:139], v[180:183]
  ds_read_b64_tr_b16 a[230:231], v229 offset:17024
  s_add_u32 s68, s68, 0x3000
  v_mfma_f32_16x16x32_bf16 v[188:191], a[252:255], a[140:143], v[188:191]
  s_waitcnt vmcnt(16)
  s_barrier
  s_waitcnt lgkmcnt(10)
  v_mfma_f32_16x16x32_bf16 a[0:3], a[208:211], a[128:131], a[0:3]
  v_add_u32 v228, s54, v225
  v_add_u32 v229, s54, v227
  v_mfma_f32_16x16x32_bf16 a[8:11], a[208:211], a[132:135], a[8:11]
  ds_read_b64_tr_b16 a[232:233], v228
  v_mfma_f32_16x16x32_bf16 a[16:19], a[208:211], a[136:139], a[16:19]
  ds_read_b64_tr_b16 a[234:235], v228 offset:1024
  v_mfma_f32_16x16x32_bf16 a[24:27], a[208:211], a[140:143], a[24:27]
  s_add_u32 s55, s55, 0x6080
  s_cmp_ge_u32 s55, 0x24300
  s_cselect_b32 s55, 0, s55
  s_waitcnt lgkmcnt(10)
  v_mfma_f32_16x16x32_bf16 a[4:7], a[212:215], a[128:131], a[4:7]
  ds_read_b64_tr_b16 a[236:237], v228 offset:8
  v_mfma_f32_16x16x32_bf16 a[12:15], a[212:215], a[132:135], a[12:15]
  ds_read_b64_tr_b16 a[238:239], v228 offset:1032
  v_mfma_f32_16x16x32_bf16 a[20:23], a[212:215], a[136:139], a[20:23]
  v_mfma_f32_16x16x32_bf16 a[28:31], a[212:215], a[140:143], a[28:31]
  s_waitcnt lgkmcnt(10)
  v_mfma_f32_16x16x32_bf16 a[32:35], a[216:219], a[128:131], a[32:35]
  ds_read_b64_tr_b16 a[240:241], v228 offset:256
  v_mfma_f32_16x16x32_bf16 a[40:43], a[216:219], a[132:135], a[40:43]
  ds_read_b64_tr_b16 a[242:243], v228 offset:1280
  v_mfma_f32_16x16x32_bf16 a[48:51], a[216:219], a[136:139], a[48:51]
  v_mfma_f32_16x16x32_bf16 a[56:59], a[216:219], a[140:143], a[56:59]
  s_waitcnt lgkmcnt(10)
  v_mfma_f32_16x16x32_bf16 a[36:39], a[220:223], a[128:131], a[36:39]
  ds_read_b64_tr_b16 a[244:245], v228 offset:264
  v_mfma_f32_16x16x32_bf16 a[44:47], a[220:223], a[132:135], a[44:47]
  ds_read_b64_tr_b16 a[246:247], v228 offset:1288
  v_mfma_f32_16x16x32_bf16 a[52:55], a[220:223], a[136:139], a[52:55]
  v_mfma_f32_16x16x32_bf16 a[60:63], a[220:223], a[140:143], a[60:63]
  s_waitcnt lgkmcnt(10)
  v_mfma_f32_16x16x32_bf16 a[64:67], a[224:227], a[128:131], a[64:67]
  ds_read_b64_tr_b16 a[248:249], v228 offset:512
  v_mfma_f32_16x16x32_bf16 a[72:75], a[224:227], a[132:135], a[72:75]
  ds_read_b64_tr_b16 a[250:251], v228 offset:1536
  v_mfma_f32_16x16x32_bf16 a[80:83], a[224:227], a[136:139], a[80:83]
  v_mfma_f32_16x16x32_bf16 a[88:91], a[224:227], a[140:143], a[88:91]
  s_waitcnt lgkmcnt(10)
  v_mfma_f32_16x16x32_bf16 a[68:71], a[228:231], a[128:131], a[68:71]
  ds_read_b64_tr_b16 a[252:253], v228 offset:520
  v_mfma_f32_16x16x32_bf16 a[76:79], a[228:231], a[132:135], a[76:79]
  ds_read_b64_tr_b16 a[254:255], v228 offset:1544
  v_mfma_f32_16x16x32_bf16 a[84:87], a[228:231], a[136:139], a[84:87]
  v_mfma_f32_16x16x32_bf16 a[92:95], a[228:231], a[140:143], a[92:95]
  s_waitcnt vmcnt(12) lgkmcnt(10)
  v_mfma_f32_16x16x32_bf16 v[0:3], a[232:235], a[144:147], v[0:3]
  ds_read_b64_tr_b16 a[208:209], v228 offset:768
  v_mfma_f32_16x16x32_bf16 v[8:11], a[232:235], a[148:151], v[8:11]
  ds_read_b64_tr_b16 a[210:211], v228 offset:1792
  v_mfma_f32_16x16x32_bf16 v[16:19], a[232:235], a[152:155], v[16:19]
  v_mfma_f32_16x16x32_bf16 v[24:27], a[232:235], a[156:159], v[24:27]
  s_waitcnt lgkmcnt(10)
  v_mfma_f32_16x16x32_bf16 v[4:7], a[236:239], a[144:147], v[4:7]
  ds_read_b64_tr_b16 a[212:213], v228 offset:776
  v_mfma_f32_16x16x32_bf16 v[12:15], a[236:239], a[148:151], v[12:15]
  ds_read_b64_tr_b16 a[214:215], v228 offset:1800
  v_mfma_f32_16x16x32_bf16 v[20:23], a[236:239], a[152:155], v[20:23]
  v_mfma_f32_16x16x32_bf16 v[28:31], a[236:239], a[156:159], v[28:31]
  s_waitcnt lgkmcnt(10)
  v_mfma_f32_16x16x32_bf16 v[32:35], a[240:243], a[144:147], v[32:35]
  ds_read_b64_tr_b16 a[216:217], v228 offset:2048
  v_mfma_f32_16x16x32_bf16 v[40:43], a[240:243], a[148:151], v[40:43]
  ds_read_b64_tr_b16 a[218:219], v228 offset:2560
  v_mfma_f32_16x16x32_bf16 v[48:51], a[240:243], a[152:155], v[48:51]
  v_mfma_f32_16x16x32_bf16 v[56:59], a[240:243], a[156:159], v[56:59]
  s_waitcnt lgkmcnt(10)
  v_mfma_f32_16x16x32_bf16 v[36:39], a[244:247], a[144:147], v[36:39]
  ds_read_b64_tr_b16 a[220:221], v228 offset:2056
  v_mfma_f32_16x16x32_bf16 v[44:47], a[244:247], a[148:151], v[44:47]
  ds_read_b64_tr_b16 a[222:223], v228 offset:2568
  v_mul_f32 v0, s64, v0
  v_mfma_f32_16x16x32_bf16 v[52:55], a[244:247], a[152:155], v[52:55]
  v_mul_f32 v1, s64, v1
  v_cvt_pk_bf16_f32 v0, v0, v1
  v_mfma_f32_16x16x32_bf16 v[60:63], a[244:247], a[156:159], v[60:63]
  s_waitcnt lgkmcnt(10)
  v_mul_f32 v2, s64, v2
  v_mul_f32 v3, s64, v3
  v_mfma_f32_16x16x32_bf16 v[64:67], a[248:251], a[144:147], v[64:67]
  ds_read_b64_tr_b16 a[224:225], v228 offset:2304
  v_cvt_pk_bf16_f32 v1, v2, v3
  v_mfma_f32_16x16x32_bf16 v[72:75], a[248:251], a[148:151], v[72:75]
  ds_read_b64_tr_b16 a[226:227], v228 offset:2816
  v_mul_f32 v4, s64, v4
  v_mfma_f32_16x16x32_bf16 v[80:83], a[248:251], a[152:155], v[80:83]
  s_add_u32 s57, s55, s72
  s_add_u32 m0, s57, 0
  v_mul_f32 v5, s64, v5
  v_mfma_f32_16x16x32_bf16 v[88:91], a[248:251], a[156:159], v[88:91]
  buffer_load_dwordx4 v222, s[12:15], s67 offen nt lds
  s_waitcnt lgkmcnt(10)
  v_mfma_f32_16x16x32_bf16 v[68:71], a[252:255], a[144:147], v[68:71]
  ds_read_b64_tr_b16 a[228:229], v228 offset:2312
  v_cvt_pk_bf16_f32 v2, v4, v5
  v_mfma_f32_16x16x32_bf16 v[76:79], a[252:255], a[148:151], v[76:79]
  ds_read_b64_tr_b16 a[230:231], v228 offset:2824
  s_add_u32 m0, s57, 0xf80
  v_mfma_f32_16x16x32_bf16 v[84:87], a[252:255], a[152:155], v[84:87]
  buffer_load_dwordx4 v222, s[12:15], s67 offen offset:128 nt lds
  v_mul_f32 v6, s64, v6
  v_mfma_f32_16x16x32_bf16 v[92:95], a[252:255], a[156:159], v[92:95]
  s_waitcnt lgkmcnt(10)
  v_mul_f32 v7, s64, v7
  v_cvt_pk_bf16_f32 v3, v6, v7
  v_mfma_f32_16x16x32_bf16 v[96:99], a[208:211], a[144:147], v[96:99]
  ds_read_b64_tr_b16 a[232:233], v229 offset:12352
  v_mul_f32 v8, s64, v8
  v_mfma_f32_16x16x32_bf16 v[104:107], a[208:211], a[148:151], v[104:107]
  ds_read_b64_tr_b16 a[234:235], v229 offset:13888
  s_add_u32 m0, s57, 0x1f00
  v_mfma_f32_16x16x32_bf16 v[112:115], a[208:211], a[152:155], v[112:115]
  buffer_load_dwordx4 v222, s[12:15], s67 offen offset:256 nt lds
  v_mul_f32 v9, s64, v9
  v_mfma_f32_16x16x32_bf16 v[120:123], a[208:211], a[156:159], v[120:123]
  s_waitcnt lgkmcnt(10)
  v_cvt_pk_bf16_f32 v4, v8, v9
  v_mul_f32 v10, s64, v10
  v_mfma_f32_16x16x32_bf16 v[100:103], a[212:215], a[144:147], v[100:103]
  ds_read_b64_tr_b16 a[236:237], v229 offset:15424
  v_mul_f32 v11, s64, v11
  v_mfma_f32_16x16x32_bf16 v[108:111], a[212:215], a[148:151], v[108:111]
  ds_read_b64_tr_b16 a[238:239], v229 offset:16960
  s_add_u32 s67, s67, 0x3000
  v_mfma_f32_16x16x32_bf16 v[116:119], a[212:215], a[152:155], v[116:119]
  v_cvt_pk_bf16_f32 v5, v10, v11
  v_mul_f32 v12, s64, v12
  v_mfma_f32_16x16x32_bf16 v[124:127], a[212:215], a[156:159], v[124:127]
  s_waitcnt lgkmcnt(10)
  v_mul_f32 v13, s64, v13
  v_cvt_pk_bf16_f32 v6, v12, v13
  v_mfma_f32_16x16x32_bf16 v[128:131], a[216:219], a[144:147], v[128:131]
  ds_read_b64_tr_b16 a[240:241], v229 offset:12384
  v_mul_f32 v14, s64, v14
  v_mfma_f32_16x16x32_bf16 v[136:139], a[216:219], a[148:151], v[136:139]
  ds_read_b64_tr_b16 a[242:243], v229 offset:13920
  v_mul_f32 v15, s64, v15
  v_mfma_f32_16x16x32_bf16 v[144:147], a[216:219], a[152:155], v[144:147]
  s_add_u32 s57, s55, s73
  s_mov_b32 m0, s57
  v_cvt_pk_bf16_f32 v7, v14, v15
  v_mfma_f32_16x16x32_bf16 v[152:155], a[216:219], a[156:159], v[152:155]
  buffer_load_dwordx4 v223, s[16:19], s68 offen nt lds
  s_waitcnt lgkmcnt(10)
  v_mfma_f32_16x16x32_bf16 v[132:135], a[220:223], a[144:147], v[132:135]
  ds_read_b64_tr_b16 a[244:245], v229 offset:15456
  v_mul_f32 v16, s64, v16
  v_mfma_f32_16x16x32_bf16 v[140:143], a[220:223], a[148:151], v[140:143]
  ds_read_b64_tr_b16 a[246:247], v229 offset:16992
  s_sub_u32 m0, s57, 0x200
  v_mfma_f32_16x16x32_bf16 v[148:151], a[220:223], a[152:155], v[148:151]
  buffer_load_dwordx4 v223, s[16:19], s68 offen offset:1536 nt lds
  v_mul_f32 v17, s64, v17
  v_mfma_f32_16x16x32_bf16 v[156:159], a[220:223], a[156:159], v[156:159]
  s_waitcnt lgkmcnt(10)
  v_cvt_pk_bf16_f32 v8, v16, v17
  v_mul_f32 v18, s64, v18
  v_mfma_f32_16x16x32_bf16 v[160:163], a[224:227], a[144:147], v[160:163]
  ds_read_b64_tr_b16 a[248:249], v229 offset:12416
  v_mul_f32 v19, s64, v19
  v_mfma_f32_16x16x32_bf16 v[168:171], a[224:227], a[148:151], v[168:171]
  ds_read_b64_tr_b16 a[250:251], v229 offset:13952
  s_add_u32 m0, s57, 0x800
  v_mfma_f32_16x16x32_bf16 v[176:179], a[224:227], a[152:155], v[176:179]
  buffer_load_dwordx4 v224, s[16:19], s68 offen nt lds
  v_cvt_pk_bf16_f32 v9, v18, v19
  v_mfma_f32_16x16x32_bf16 v[184:187], a[224:227], a[156:159], v[184:187]
  s_waitcnt lgkmcnt(10)
  v_mul_f32 v20, s64, v20
  v_mul_f32 v21, s64, v21
  v_mfma_f32_16x16x32_bf16 v[164:167], a[228:231], a[144:147], v[164:167]
  ds_read_b64_tr_b16 a[252:253], v229 offset:15488
  v_cvt_pk_bf16_f32 v10, v20, v21
  v_mfma_f32_16x16x32_bf16 v[172:175], a[228:231], a[148:151], v[172:175]
  s_add_u32 s54, s54, 0x6080
  s_cmp_ge_u32 s54, 0x24300
  s_cselect_b32 s54, 0, s54
  v_mfma_f32_16x16x32_bf16 v[180:183], a[228:231], a[152:155], v[180:183]
  ds_read_b64_tr_b16 a[254:255], v229 offset:17024
  s_add_u32 s68, s68, 0x3000
  v_mfma_f32_16x16x32_bf16 v[188:191], a[228:231], a[156:159], v[188:191]
  s_waitcnt vmcnt(15)
  s_barrier
  s_waitcnt lgkmcnt(10)
  v_mfma_f32_16x16x32_bf16 a[0:3], a[232:235], a[144:147], a[0:3]
  v_add_u32 v229, s54, v226
  v_add_u32 v228, s54, v225
  v_xor_b32 v230, 64, v229
  v_mfma_f32_16x16x32_bf16 a[8:11], a[232:235], a[148:151], a[8:11]
  ds_read_b128 a[208:211], v229
  v_mul_f32 v22, s64, v22
  v_mfma_f32_16x16x32_bf16 a[16:19], a[232:235], a[152:155], a[16:19]
  s_add_u32 s55, s55, 0x6080
  s_cmp_ge_u32 s55, 0x24300
  s_cselect_b32 s55, 0, s55
  v_mfma_f32_16x16x32_bf16 a[24:27], a[232:235], a[156:159], a[24:27]
  s_waitcnt lgkmcnt(9)
  v_mul_f32 v23, s64, v23
  v_cvt_pk_bf16_f32 v11, v22, v23
  v_mfma_f32_16x16x32_bf16 a[4:7], a[236:239], a[144:147], a[4:7]
  ds_read_b128 a[212:215], v229 offset:512
  v_mul_f32 v24, s64, v24
  v_mfma_f32_16x16x32_bf16 a[12:15], a[236:239], a[148:151], a[12:15]
  v_mul_f32 v25, s64, v25
  v_cvt_pk_bf16_f32 v12, v24, v25
  v_mfma_f32_16x16x32_bf16 a[20:23], a[236:239], a[152:155], a[20:23]
  v_mul_f32 v26, s64, v26
  v_mul_f32 v27, s64, v27
  v_mfma_f32_16x16x32_bf16 a[28:31], a[236:239], a[156:159], a[28:31]
  s_waitcnt lgkmcnt(8)
  v_cvt_pk_bf16_f32 v13, v26, v27
  v_mul_f32 v28, s64, v28
  v_mfma_f32_16x16x32_bf16 a[32:35], a[240:243], a[144:147], a[32:35]
  ds_read_b128 a[216:219], v230
  v_mul_f32 v29, s64, v29
  v_mfma_f32_16x16x32_bf16 a[40:43], a[240:243], a[148:151], a[40:43]
  v_cvt_pk_bf16_f32 v14, v28, v29
  v_mul_f32 v30, s64, v30
  v_mfma_f32_16x16x32_bf16 a[48:51], a[240:243], a[152:155], a[48:51]
  v_mul_f32 v31, s64, v31
  v_cvt_pk_bf16_f32 v15, v30, v31
  v_mfma_f32_16x16x32_bf16 a[56:59], a[240:243], a[156:159], a[56:59]
  s_waitcnt lgkmcnt(7)
  v_mul_f32 v32, s64, v32
  v_mul_f32 v33, s64, v33
  v_mfma_f32_16x16x32_bf16 a[36:39], a[244:247], a[144:147], a[36:39]
  ds_read_b128 a[220:223], v230 offset:512
  v_cvt_pk_bf16_f32 v16, v32, v33
  v_mfma_f32_16x16x32_bf16 a[44:47], a[244:247], a[148:151], a[44:47]
  v_mul_f32 v34, s64, v34
  v_mul_f32 v35, s64, v35
  v_mfma_f32_16x16x32_bf16 a[52:55], a[244:247], a[152:155], a[52:55]
  v_cvt_pk_bf16_f32 v17, v34, v35
  v_mul_f32 v36, s64, v36
  v_mfma_f32_16x16x32_bf16 a[60:63], a[244:247], a[156:159], a[60:63]
  s_waitcnt lgkmcnt(6)
  v_mul_f32 v37, s64, v37
  v_cvt_pk_bf16_f32 v18, v36, v37
  v_mfma_f32_16x16x32_bf16 a[64:67], a[248:251], a[144:147], a[64:67]
  ds_read_b128 a[224:227], v229 offset:4096
  v_mul_f32 v38, s64, v38
  v_mfma_f32_16x16x32_bf16 a[72:75], a[248:251], a[148:151], a[72:75]
  v_mul_f32 v39, s64, v39
  v_cvt_pk_bf16_f32 v19, v38, v39
  v_mfma_f32_16x16x32_bf16 a[80:83], a[248:251], a[152:155], a[80:83]
  v_mul_f32 v40, s64, v40
  v_mul_f32 v41, s64, v41
  v_mfma_f32_16x16x32_bf16 a[88:91], a[248:251], a[156:159], a[88:91]
  s_waitcnt lgkmcnt(5)
  v_cvt_pk_bf16_f32 v20, v40, v41
  v_mul_f32 v42, s64, v42
  v_mfma_f32_16x16x32_bf16 a[68:71], a[252:255], a[144:147], a[68:71]
  ds_read_b128 a[228:231], v229 offset:4608
  v_mul_f32 v43, s64, v43
  v_mfma_f32_16x16x32_bf16 a[76:79], a[252:255], a[148:151], a[76:79]
  v_cvt_pk_bf16_f32 v21, v42, v43
  v_mul_f32 v44, s64, v44
  v_mfma_f32_16x16x32_bf16 a[84:87], a[252:255], a[152:155], a[84:87]
  v_mul_f32 v45, s64, v45
  v_cvt_pk_bf16_f32 v22, v44, v45
  v_mfma_f32_16x16x32_bf16 a[92:95], a[252:255], a[156:159], a[92:95]
  v_mul_f32 v46, s64, v46
  v_mul_f32 v47, s64, v47
  v_cvt_pk_bf16_f32 v23, v46, v47
  v_mul_f32 v48, s64, v48
  v_mul_f32 v49, s64, v49
  v_cvt_pk_bf16_f32 v24, v48, v49
  v_mul_f32 v50, s64, v50
  v_mul_f32 v51, s64, v51
  v_cvt_pk_bf16_f32 v25, v50, v51
  v_mul_f32 v52, s64, v52
  v_mul_f32 v53, s64, v53
  v_cvt_pk_bf16_f32 v26, v52, v53
  v_mul_f32 v54, s64, v54
  v_mul_f32 v55, s64, v55
  v_cvt_pk_bf16_f32 v27, v54, v55
  v_mul_f32 v56, s64, v56
  v_mul_f32 v57, s64, v57
  v_cvt_pk_bf16_f32 v28, v56, v57
  v_mul_f32 v58, s64, v58
  v_mul_f32 v59, s64, v59
  v_cvt_pk_bf16_f32 v29, v58, v59
  v_mul_f32 v60, s64, v60
  v_mul_f32 v61, s64, v61
  v_cvt_pk_bf16_f32 v30, v60, v61
  v_mul_f32 v62, s64, v62
  v_mul_f32 v63, s64, v63
  v_cvt_pk_bf16_f32 v31, v62, v63
  v_mul_f32 v64, s64, v64
  v_mul_f32 v65, s64, v65
  v_cvt_pk_bf16_f32 v32, v64, v65
  v_mul_f32 v66, s64, v66
  v_mul_f32 v67, s64, v67
  v_cvt_pk_bf16_f32 v33, v66, v67
  v_mul_f32 v68, s64, v68
  v_mul_f32 v69, s64, v69
  v_cvt_pk_bf16_f32 v34, v68, v69
  v_mul_f32 v70, s64, v70
  v_mul_f32 v71, s64, v71
  v_cvt_pk_bf16_f32 v35, v70, v71
  v_mul_f32 v72, s64, v72
  v_mul_f32 v73, s64, v73
  v_cvt_pk_bf16_f32 v36, v72, v73
  v_mul_f32 v74, s64, v74
  v_mul_f32 v75, s64, v75
  v_cvt_pk_bf16_f32 v37, v74, v75
  v_mul_f32 v76, s64, v76
  v_mul_f32 v77, s64, v77
  v_cvt_pk_bf16_f32 v38, v76, v77
  v_mul_f32 v78, s64, v78
  v_mul_f32 v79, s64, v79
  v_cvt_pk_bf16_f32 v39, v78, v79
  v_mul_f32 v80, s64, v80
  v_mul_f32 v81, s64, v81
  v_cvt_pk_bf16_f32 v40, v80, v81
  v_mul_f32 v82, s64, v82
  v_mul_f32 v83, s64, v83
  v_cvt_pk_bf16_f32 v41, v82, v83
  v_mul_f32 v84, s64, v84
  v_mul_f32 v85, s64, v85
  v_cvt_pk_bf16_f32 v42, v84, v85
  v_mul_f32 v86, s64, v86
  v_mul_f32 v87, s64, v87
  v_cvt_pk_bf16_f32 v43, v86, v87
  v_mul_f32 v88, s64, v88
  v_mul_f32 v89, s64, v89
  v_cvt_pk_bf16_f32 v44, v88, v89
  v_mul_f32 v90, s64, v90
  v_mul_f32 v91, s64, v91
  v_cvt_pk_bf16_f32 v45, v90, v91
  v_mul_f32 v92, s64, v92
  v_mul_f32 v93, s64, v93
  v_cvt_pk_bf16_f32 v46, v92, v93
  v_mul_f32 v94, s64, v94
  v_mul_f32 v95, s64, v95
  v_cvt_pk_bf16_f32 v47, v94, v95
  v_mul_f32 v96, s64, v96
  v_mul_f32 v97, s64, v97
  v_cvt_pk_bf16_f32 v48, v96, v97
  v_mul_f32 v98, s64, v98
  v_mul_f32 v99, s64, v99
  v_cvt_pk_bf16_f32 v49, v98, v99
  v_mul_f32 v100, s64, v100
  v_mul_f32 v101, s64, v101
  v_cvt_pk_bf16_f32 v50, v100, v101
  v_mul_f32 v102, s64, v102
  v_mul_f32 v103, s64, v103
  v_cvt_pk_bf16_f32 v51, v102, v103
  v_mul_f32 v104, s64, v104
  v_mul_f32 v105, s64, v105
  v_cvt_pk_bf16_f32 v52, v104, v105
  v_mul_f32 v106, s64, v106
  v_mul_f32 v107, s64, v107
  v_cvt_pk_bf16_f32 v53, v106, v107
  v_mul_f32 v108, s64, v108
  v_mul_f32 v109, s64, v109
  v_cvt_pk_bf16_f32 v54, v108, v109
  v_mul_f32 v110, s64, v110
  v_mul_f32 v111, s64, v111
  v_cvt_pk_bf16_f32 v55, v110, v111
  v_mul_f32 v112, s64, v112
  v_mul_f32 v113, s64, v113
  v_cvt_pk_bf16_f32 v56, v112, v113
  v_mul_f32 v114, s64, v114
  v_mul_f32 v115, s64, v115
  v_cvt_pk_bf16_f32 v57, v114, v115
  v_mul_f32 v116, s64, v116
  v_mul_f32 v117, s64, v117
  v_cvt_pk_bf16_f32 v58, v116, v117
  v_mul_f32 v118, s64, v118
  v_mul_f32 v119, s64, v119
  v_cvt_pk_bf16_f32 v59, v118, v119
  v_mul_f32 v120, s64, v120
  v_mul_f32 v121, s64, v121
  v_cvt_pk_bf16_f32 v60, v120, v121
  v_mul_f32 v122, s64, v122
  v_mul_f32 v123, s64, v123
  v_cvt_pk_bf16_f32 v61, v122, v123
  v_mul_f32 v124, s64, v124
  v_mul_f32 v125, s64, v125
  v_cvt_pk_bf16_f32 v62, v124, v125
  v_mul_f32 v126, s64, v126
  v_mul_f32 v127, s64, v127
  v_cvt_pk_bf16_f32 v63, v126, v127
  v_mul_f32 v128, s64, v128
  v_mul_f32 v129, s64, v129
  v_cvt_pk_bf16_f32 v64, v128, v129
  v_mul_f32 v130, s64, v130
  v_mul_f32 v131, s64, v131
  v_cvt_pk_bf16_f32 v65, v130, v131
  v_mul_f32 v132, s64, v132
  v_mul_f32 v133, s64, v133
  v_cvt_pk_bf16_f32 v66, v132, v133
  v_mul_f32 v134, s64, v134
  v_mul_f32 v135, s64, v135
  v_cvt_pk_bf16_f32 v67, v134, v135
  v_mul_f32 v136, s64, v136
  v_mul_f32 v137, s64, v137
  v_cvt_pk_bf16_f32 v68, v136, v137
  v_mul_f32 v138, s64, v138
  v_mul_f32 v139, s64, v139
  v_cvt_pk_bf16_f32 v69, v138, v139
  v_mul_f32 v140, s64, v140
  v_mul_f32 v141, s64, v141
  v_cvt_pk_bf16_f32 v70, v140, v141
  v_mul_f32 v142, s64, v142
  v_mul_f32 v143, s64, v143
  v_cvt_pk_bf16_f32 v71, v142, v143
  v_mul_f32 v144, s64, v144
  v_mul_f32 v145, s64, v145
  v_cvt_pk_bf16_f32 v72, v144, v145
  v_mul_f32 v146, s64, v146
  v_mul_f32 v147, s64, v147
  v_cvt_pk_bf16_f32 v73, v146, v147
  v_mul_f32 v148, s64, v148
  v_mul_f32 v149, s64, v149
  v_cvt_pk_bf16_f32 v74, v148, v149
  v_mul_f32 v150, s64, v150
  v_mul_f32 v151, s64, v151
  v_cvt_pk_bf16_f32 v75, v150, v151
  v_mul_f32 v152, s64, v152
  v_mul_f32 v153, s64, v153
  v_cvt_pk_bf16_f32 v76, v152, v153
  v_mul_f32 v154, s64, v154
  v_mul_f32 v155, s64, v155
  v_cvt_pk_bf16_f32 v77, v154, v155
  v_mul_f32 v156, s64, v156
  v_mul_f32 v157, s64, v157
  v_cvt_pk_bf16_f32 v78, v156, v157
  v_mul_f32 v158, s64, v158
  v_mul_f32 v159, s64, v159
  v_cvt_pk_bf16_f32 v79, v158, v159
  v_mul_f32 v160, s64, v160
  v_mul_f32 v161, s64, v161
  v_cvt_pk_bf16_f32 v80, v160, v161
  v_mul_f32 v162, s64, v162
  v_mul_f32 v163, s64, v163
  v_cvt_pk_bf16_f32 v81, v162, v163
  v_mul_f32 v164, s64, v164
  v_mul_f32 v165, s64, v165
  v_cvt_pk_bf16_f32 v82, v164, v165
  v_mul_f32 v166, s64, v166
  v_mul_f32 v167, s64, v167
  v_cvt_pk_bf16_f32 v83, v166, v167
  v_mul_f32 v168, s64, v168
  v_mul_f32 v169, s64, v169
  v_cvt_pk_bf16_f32 v84, v168, v169
  v_mul_f32 v170, s64, v170
  v_mul_f32 v171, s64, v171
  v_cvt_pk_bf16_f32 v85, v170, v171
  v_mul_f32 v172, s64, v172
  v_mul_f32 v173, s64, v173
  v_cvt_pk_bf16_f32 v86, v172, v173
  v_mul_f32 v174, s64, v174
  v_mul_f32 v175, s64, v175
  v_cvt_pk_bf16_f32 v87, v174, v175
  v_mul_f32 v176, s64, v176
  v_mul_f32 v177, s64, v177
  v_cvt_pk_bf16_f32 v88, v176, v177
  v_mul_f32 v178, s64, v178
  v_mul_f32 v179, s64, v179
  v_cvt_pk_bf16_f32 v89, v178, v179
  v_mul_f32 v180, s64, v180
  v_mul_f32 v181, s64, v181
  v_cvt_pk_bf16_f32 v90, v180, v181
  v_mul_f32 v182, s64, v182
  v_mul_f32 v183, s64, v183
  v_cvt_pk_bf16_f32 v91, v182, v183
  v_mul_f32 v184, s64, v184
  v_mul_f32 v185, s64, v185
  v_cvt_pk_bf16_f32 v92, v184, v185
  v_mul_f32 v186, s64, v186
  v_mul_f32 v187, s64, v187
  v_cvt_pk_bf16_f32 v93, v186, v187
  v_mul_f32 v188, s64, v188
  v_mul_f32 v189, s64, v189
  v_cvt_pk_bf16_f32 v94, v188, v189
  s_waitcnt lgkmcnt(5)
  v_mul_f32 v190, s64, v190
  v_mul_f32 v191, s64, v191
  v_cvt_pk_bf16_f32 v95, v190, v191
  v_mfma_f32_16x16x32_bf16 v[96:99], a[208:211], v[0:3], v[192:195]
  ds_read_b128 a[232:235], v230 offset:4096
  v_accvgpr_read_b32 v176, a0
  v_mfma_f32_16x16x32_bf16 v[104:107], a[208:211], v[4:7], v[196:199]
  s_add_u32 s57, s55, s72
  s_add_u32 m0, s57, 0
  v_accvgpr_read_b32 v177, a1
  v_mfma_f32_16x16x32_bf16 v[112:115], a[208:211], v[8:11], v[200:203]
  buffer_load_dwordx4 v222, s[12:15], s67 offen nt lds
  v_accvgpr_read_b32 v178, a2
  v_mfma_f32_16x16x32_bf16 v[120:123], a[208:211], v[12:15], v[204:207]
  s_waitcnt lgkmcnt(5)
  v_accvgpr_read_b32 v179, a3
  v_accvgpr_read_b32 v180, a4
  v_mfma_f32_16x16x32_bf16 v[100:103], a[212:215], v[0:3], v[192:195]
  ds_read_b128 a[236:239], v230 offset:4608
  v_accvgpr_read_b32 v181, a5
  v_mfma_f32_16x16x32_bf16 v[108:111], a[212:215], v[4:7], v[196:199]
  s_add_u32 m0, s57, 0xf80
  v_accvgpr_read_b32 v182, a6
  v_accvgpr_read_b32 v183, a7
  v_mfma_f32_16x16x32_bf16 v[116:119], a[212:215], v[8:11], v[200:203]
  buffer_load_dwordx4 v222, s[12:15], s67 offen offset:128 nt lds
  v_mul_f32 v184, v176, v176
  v_mfma_f32_16x16x32_bf16 v[124:127], a[212:215], v[12:15], v[204:207]
  s_waitcnt lgkmcnt(5)
  v_mul_f32 v185, v177, v177
  v_mul_f32 v186, v178, v178
  v_mfma_f32_16x16x32_bf16 v[96:99], a[216:219], v[16:19], v[96:99]
  ds_read_b128 a[240:243], v229 offset:8192
  v_mul_f32 v187, v179, v179
  v_mfma_f32_16x16x32_bf16 v[104:107], a[216:219], v[20:23], v[104:107]
  s_add_u32 m0, s57, 0x1f00
  v_fma_f32 v184, v184, v251, s80
  v_fma_f32 v185, v185, v251, s80
  v_mfma_f32_16x16x32_bf16 v[112:115], a[216:219], v[24:27], v[112:115]
  buffer_load_dwordx4 v222, s[12:15], s67 offen offset:256 nt lds
  v_fma_f32 v186, v186, v251, s80
  v_mfma_f32_16x16x32_bf16 v[120:123], a[216:219], v[28:31], v[120:123]
  s_waitcnt lgkmcnt(5)
  v_fma_f32 v187, v187, v251, s80
  v_mul_f32 v184, v184, v176
  v_mfma_f32_16x16x32_bf16 v[100:103], a[220:223], v[16:19], v[100:103]
  ds_read_b128 a[244:247], v229 offset:8704
  v_mul_f32 v185, v185, v177
  v_mfma_f32_16x16x32_bf16 v[108:111], a[220:223], v[20:23], v[108:111]
  s_add_u32 s67, s67, 0x3000
  v_mul_f32 v186, v186, v178
  v_mul_f32 v187, v187, v179
  v_mfma_f32_16x16x32_bf16 v[116:119], a[220:223], v[24:27], v[116:119]
  v_exp_f32 v184, v184
  v_mfma_f32_16x16x32_bf16 v[124:127], a[220:223], v[28:31], v[124:127]
  s_waitcnt lgkmcnt(5)
  v_exp_f32 v185, v185
  v_mfma_f32_16x16x32_bf16 v[96:99], a[224:227], v[32:35], v[96:99]
  ds_read_b128 a[248:251], v230 offset:8192
  v_mul_f32 v176, v176, v180
  v_mfma_f32_16x16x32_bf16 v[104:107], a[224:227], v[36:39], v[104:107]
  s_add_u32 s57, s55, s73
  s_mov_b32 m0, s57
  v_mul_f32 v177, v177, v181
  v_mfma_f32_16x16x32_bf16 v[112:115], a[224:227], v[40:43], v[112:115]
  buffer_load_dwordx4 v223, s[16:19], s68 offen nt lds
  v_mul_f32 v178, v178, v182
  v_mfma_f32_16x16x32_bf16 v[120:123], a[224:227], v[44:47], v[120:123]
  s_waitcnt lgkmcnt(5)
  v_exp_f32 v186, v186
  v_mfma_f32_16x16x32_bf16 v[100:103], a[228:231], v[32:35], v[100:103]
  ds_read_b128 a[252:255], v230 offset:8704
  v_mul_f32 v179, v179, v183
  v_mfma_f32_16x16x32_bf16 v[108:111], a[228:231], v[36:39], v[108:111]
  s_add_u32 s54, s54, 0x6080
  s_cmp_ge_u32 s54, 0x24300
  s_cselect_b32 s54, 0, s54
  v_mfma_f32_16x16x32_bf16 v[116:119], a[228:231], v[40:43], v[116:119]
  s_sub_u32 m0, s57, 0x200
  s_waitcnt vmcnt(16)
  s_barrier
  v_mfma_f32_16x16x32_bf16 v[124:127], a[228:231], v[44:47], v[124:127]
  s_waitcnt lgkmcnt(5)
  v_add_u32 v229, s54, v226
  v_add_u32 v228, s54, v225
  v_mfma_f32_16x16x32_bf16 v[96:99], a[232:235], v[48:51], v[96:99]
  buffer_load_dwordx4 v223, s[16:19], s68 offen offset:1536 nt lds
  v_xor_b32 v230, 64, v229
  v_mfma_f32_16x16x32_bf16 v[104:107], a[232:235], v[52:55], v[104:107]
  ds_read_b128 a[208:211], v229
  s_add_u32 m0, s57, 0x800
  v_mfma_f32_16x16x32_bf16 v[112:115], a[232:235], v[56:59], v[112:115]
  buffer_load_dwordx4 v224, s[16:19], s68 offen nt lds
  v_add_f32 v184, 1.0, v184
  v_mfma_f32_16x16x32_bf16 v[120:123], a[232:235], v[60:63], v[120:123]
  s_waitcnt lgkmcnt(5)
  v_exp_f32 v187, v187
  v_mfma_f32_16x16x32_bf16 v[100:103], a[236:239], v[48:51], v[100:103]
  ds_read_b128 a[212:215], v229 offset:512
  v_add_f32 v185, 1.0, v185
  v_mfma_f32_16x16x32_bf16 v[108:111], a[236:239], v[52:55], v[108:111]
  s_add_u32 s68, s68, 0x3000
  v_add_f32 v186, 1.0, v186
  v_add_f32 v187, 1.0, v187
  v_mfma_f32_16x16x32_bf16 v[116:119], a[236:239], v[56:59], v[116:119]
  v_rcp_f32 v184, v184
  v_mfma_f32_16x16x32_bf16 v[124:127], a[236:239], v[60:63], v[124:127]
  s_waitcnt lgkmcnt(5)
  v_rcp_f32 v185, v185
  v_mfma_f32_16x16x32_bf16 v[96:99], a[240:243], v[64:67], v[96:99]
  ds_read_b128 a[216:219], v230
  v_mul_f32 v184, v184, v176
  v_mfma_f32_16x16x32_bf16 v[104:107], a[240:243], v[68:71], v[104:107]
  s_add_u32 s55, s55, 0x6080
  s_cmp_ge_u32 s55, 0x24300
  s_cselect_b32 s55, 0, s55
  v_mfma_f32_16x16x32_bf16 v[112:115], a[240:243], v[72:75], v[112:115]
  v_rcp_f32 v186, v186
  v_mfma_f32_16x16x32_bf16 v[120:123], a[240:243], v[76:79], v[120:123]
  s_waitcnt lgkmcnt(5)
  v_rcp_f32 v187, v187
  v_mfma_f32_16x16x32_bf16 v[100:103], a[244:247], v[64:67], v[100:103]
  ds_read_b128 a[220:223], v230 offset:512
  v_mul_f32 v185, v185, v177
  v_mfma_f32_16x16x32_bf16 v[108:111], a[244:247], v[68:71], v[108:111]
  v_mul_f32 v186, v186, v178
  v_mul_f32 v187, v187, v179
  v_mfma_f32_16x16x32_bf16 v[116:119], a[244:247], v[72:75], v[116:119]
  v_cvt_pk_bf16_f32 v188, v184, v185
  v_cvt_pk_bf16_f32 v189, v186, v187
  v_mfma_f32_16x16x32_bf16 v[124:127], a[244:247], v[76:79], v[124:127]
  buffer_store_dwordx2 v[188:189], v231, s[20:23], s79 offen sc1
  s_waitcnt lgkmcnt(5)
  v_mfma_f32_16x16x32_bf16 v[96:99], a[248:251], v[80:83], v[96:99]
  ds_read_b128 a[224:227], v229 offset:4096
  v_accvgpr_read_b32 v176, a8
  v_mfma_f32_16x16x32_bf16 v[104:107], a[248:251], v[84:87], v[104:107]
  v_accvgpr_read_b32 v177, a9
  v_accvgpr_read_b32 v178, a10
  v_mfma_f32_16x16x32_bf16 v[112:115], a[248:251], v[88:91], v[112:115]
  v_accvgpr_read_b32 v179, a11
  v_accvgpr_read_b32 v180, a12
  v_mfma_f32_16x16x32_bf16 v[120:123], a[248:251], v[92:95], v[120:123]
  s_waitcnt lgkmcnt(5)
  v_accvgpr_read_b32 v181, a13
  v_accvgpr_read_b32 v182, a14
  v_mfma_f32_16x16x32_bf16 v[100:103], a[252:255], v[80:83], v[100:103]
  ds_read_b128 a[228:231], v229 offset:4608
  v_accvgpr_read_b32 v183, a15
  v_mfma_f32_16x16x32_bf16 v[108:111], a[252:255], v[84:87], v[108:111]
  v_mul_f32 v184, v176, v176
  v_mul_f32 v185, v177, v177
  v_mfma_f32_16x16x32_bf16 v[116:119], a[252:255], v[88:91], v[116:119]
  v_mul_f32 v186, v178, v178
  v_mul_f32 v187, v179, v179
  v_mfma_f32_16x16x32_bf16 v[124:127], a[252:255], v[92:95], v[124:127]
  v_fma_f32 v184, v184, v251, s80
  v_fma_f32 v185, v185, v251, s80
  v_fma_f32 v186, v186, v251, s80
  v_fma_f32 v187, v187, v251, s80
  v_mul_f32 v184, v184, v176
  v_mul_f32 v185, v185, v177
  v_mul_f32 v186, v186, v178
  v_mul_f32 v187, v187, v179
  v_exp_f32 v184, v184
  v_exp_f32 v185, v185
  v_exp_f32 v186, v186
  v_exp_f32 v187, v187
  v_mul_f32 v176, v176, v180
  v_mul_f32 v177, v177, v181
  v_mul_f32 v178, v178, v182
  v_mul_f32 v179, v179, v183
  v_add_f32 v184, 1.0, v184
  v_add_f32 v185, 1.0, v185
  v_add_f32 v186, 1.0, v186
  v_add_f32 v187, 1.0, v187
  v_rcp_f32 v184, v184
  v_rcp_f32 v185, v185
  v_rcp_f32 v186, v186
  v_rcp_f32 v187, v187
  v_mul_f32 v184, v184, v176
  v_mul_f32 v185, v185, v177
  v_mul_f32 v186, v186, v178
  v_mul_f32 v187, v187, v179
  v_cvt_pk_bf16_f32 v190, v184, v185
  v_cvt_pk_bf16_f32 v191, v186, v187
  buffer_store_dwordx2 v[190:191], v232, s[20:23], s79 offen sc1
  v_accvgpr_read_b32 v176, a16
  v_accvgpr_read_b32 v177, a17
  v_accvgpr_read_b32 v178, a18
  v_accvgpr_read_b32 v179, a19
  v_accvgpr_read_b32 v180, a20
  v_accvgpr_read_b32 v181, a21
  v_accvgpr_read_b32 v182, a22
  v_accvgpr_read_b32 v183, a23
  v_mul_f32 v184, v176, v176
  v_mul_f32 v185, v177, v177
  v_mul_f32 v186, v178, v178
  v_mul_f32 v187, v179, v179
  v_fma_f32 v184, v184, v251, s80
  v_fma_f32 v185, v185, v251, s80
  v_fma_f32 v186, v186, v251, s80
  v_fma_f32 v187, v187, v251, s80
  v_mul_f32 v184, v184, v176
  v_mul_f32 v185, v185, v177
  v_mul_f32 v186, v186, v178
  v_mul_f32 v187, v187, v179
  v_exp_f32 v184, v184
  v_exp_f32 v185, v185
  v_exp_f32 v186, v186
  v_exp_f32 v187, v187
  v_mul_f32 v176, v176, v180
  v_mul_f32 v177, v177, v181
  v_mul_f32 v178, v178, v182
  v_mul_f32 v179, v179, v183
  v_add_f32 v184, 1.0, v184
  v_add_f32 v185, 1.0, v185
  v_add_f32 v186, 1.0, v186
  v_add_f32 v187, 1.0, v187
  v_rcp_f32 v184, v184
  v_rcp_f32 v185, v185
  v_rcp_f32 v186, v186
  v_rcp_f32 v187, v187
  v_mul_f32 v184, v184, v176
  v_mul_f32 v185, v185, v177
  v_mul_f32 v186, v186, v178
  v_mul_f32 v187, v187, v179
  v_cvt_pk_bf16_f32 v188, v184, v185
  v_cvt_pk_bf16_f32 v189, v186, v187
  buffer_store_dwordx2 v[188:189], v233, s[20:23], s79 offen sc1
  v_accvgpr_read_b32 v176, a24
  v_accvgpr_read_b32 v177, a25
  v_accvgpr_read_b32 v178, a26
  v_accvgpr_read_b32 v179, a27
  v_accvgpr_read_b32 v180, a28
  v_accvgpr_read_b32 v181, a29
  v_accvgpr_read_b32 v182, a30
  v_accvgpr_read_b32 v183, a31
  v_mul_f32 v184, v176, v176
  v_mul_f32 v185, v177, v177
  v_mul_f32 v186, v178, v178
  v_mul_f32 v187, v179, v179
  v_fma_f32 v184, v184, v251, s80
  v_fma_f32 v185, v185, v251, s80
  v_fma_f32 v186, v186, v251, s80
  v_fma_f32 v187, v187, v251, s80
  v_mul_f32 v184, v184, v176
  v_mul_f32 v185, v185, v177
  v_mul_f32 v186, v186, v178
  v_mul_f32 v187, v187, v179
  v_exp_f32 v184, v184
  v_exp_f32 v185, v185
  v_exp_f32 v186, v186
  v_exp_f32 v187, v187
  v_mul_f32 v176, v176, v180
  v_mul_f32 v177, v177, v181
  v_mul_f32 v178, v178, v182
  v_mul_f32 v179, v179, v183
  v_add_f32 v184, 1.0, v184
  v_add_f32 v185, 1.0, v185
  v_add_f32 v186, 1.0, v186
  v_add_f32 v187, 1.0, v187
  v_rcp_f32 v184, v184
  v_rcp_f32 v185, v185
  v_rcp_f32 v186, v186
  v_rcp_f32 v187, v187
  v_mul_f32 v184, v184, v176
  v_mul_f32 v185, v185, v177
  v_mul_f32 v186, v186, v178
  v_mul_f32 v187, v187, v179
  v_cvt_pk_bf16_f32 v190, v184, v185
  v_cvt_pk_bf16_f32 v191, v186, v187
  buffer_store_dwordx2 v[190:191], v234, s[20:23], s79 offen sc1
  v_accvgpr_read_b32 v176, a32
  v_accvgpr_read_b32 v177, a33
  v_accvgpr_read_b32 v178, a34
  v_accvgpr_read_b32 v179, a35
  v_accvgpr_read_b32 v180, a36
  v_accvgpr_read_b32 v181, a37
  v_accvgpr_read_b32 v182, a38
  v_accvgpr_read_b32 v183, a39
  v_mul_f32 v184, v176, v176
  v_mul_f32 v185, v177, v177
  v_mul_f32 v186, v178, v178
  v_mul_f32 v187, v179, v179
  v_fma_f32 v184, v184, v251, s80
  v_fma_f32 v185, v185, v251, s80
  v_fma_f32 v186, v186, v251, s80
  v_fma_f32 v187, v187, v251, s80
  v_mul_f32 v184, v184, v176
  v_mul_f32 v185, v185, v177
  v_mul_f32 v186, v186, v178
  v_mul_f32 v187, v187, v179
  v_exp_f32 v184, v184
  v_exp_f32 v185, v185
  v_exp_f32 v186, v186
  v_exp_f32 v187, v187
  v_mul_f32 v176, v176, v180
  v_mul_f32 v177, v177, v181
  v_mul_f32 v178, v178, v182
  v_mul_f32 v179, v179, v183
  v_add_f32 v184, 1.0, v184
  v_add_f32 v185, 1.0, v185
  v_add_f32 v186, 1.0, v186
  v_add_f32 v187, 1.0, v187
  v_rcp_f32 v184, v184
  v_rcp_f32 v185, v185
  v_rcp_f32 v186, v186
  v_rcp_f32 v187, v187
  v_mul_f32 v184, v184, v176
  v_mul_f32 v185, v185, v177
  v_mul_f32 v186, v186, v178
  v_mul_f32 v187, v187, v179
  v_cvt_pk_bf16_f32 v188, v184, v185
  v_cvt_pk_bf16_f32 v189, v186, v187
  buffer_store_dwordx2 v[188:189], v231, s[20:23], s79 offen offset:512 sc1
  s_waitcnt lgkmcnt(5)
  v_accvgpr_read_b32 v176, a40
  v_mfma_f32_16x16x32_bf16 v[128:131], a[208:211], v[0:3], v[192:195]
  ds_read_b128 a[232:235], v230 offset:4096
  v_accvgpr_read_b32 v177, a41
  v_mfma_f32_16x16x32_bf16 v[136:139], a[208:211], v[4:7], v[196:199]
  s_add_u32 s57, s55, s72
  s_add_u32 m0, s57, 0
  v_accvgpr_read_b32 v178, a42
  v_mfma_f32_16x16x32_bf16 v[144:147], a[208:211], v[8:11], v[200:203]
  buffer_load_dwordx4 v222, s[12:15], s67 offen nt lds
  v_accvgpr_read_b32 v179, a43
  v_mfma_f32_16x16x32_bf16 v[152:155], a[208:211], v[12:15], v[204:207]
  s_waitcnt lgkmcnt(5)
  v_accvgpr_read_b32 v180, a44
  v_accvgpr_read_b32 v181, a45
  v_mfma_f32_16x16x32_bf16 v[132:135], a[212:215], v[0:3], v[192:195]
  ds_read_b128 a[236:239], v230 offset:4608
  v_accvgpr_read_b32 v182, a46
  v_mfma_f32_16x16x32_bf16 v[140:143], a[212:215], v[4:7], v[196:199]
  s_add_u32 m0, s57, 0xf80
  v_accvgpr_read_b32 v183, a47
  v_mul_f32 v184, v176, v176
  v_mfma_f32_16x16x32_bf16 v[148:151], a[212:215], v[8:11], v[200:203]
  buffer_load_dwordx4 v222, s[12:15], s67 offen offset:128 nt lds
  v_mul_f32 v185, v177, v177
  v_mfma_f32_16x16x32_bf16 v[156:159], a[212:215], v[12:15], v[204:207]
  s_waitcnt lgkmcnt(5)
  v_mul_f32 v186, v178, v178
  v_mul_f32 v187, v179, v179
  v_mfma_f32_16x16x32_bf16 v[128:131], a[216:219], v[16:19], v[128:131]
  ds_read_b128 a[240:243], v229 offset:8192
  v_fma_f32 v184, v184, v251, s80
  v_mfma_f32_16x16x32_bf16 v[136:139], a[216:219], v[20:23], v[136:139]
  s_add_u32 m0, s57, 0x1f00
  v_fma_f32 v185, v185, v251, s80
  v_fma_f32 v186, v186, v251, s80
  v_mfma_f32_16x16x32_bf16 v[144:147], a[216:219], v[24:27], v[144:147]
  buffer_load_dwordx4 v222, s[12:15], s67 offen offset:256 nt lds
  v_fma_f32 v187, v187, v251, s80
  v_mfma_f32_16x16x32_bf16 v[152:155], a[216:219], v[28:31], v[152:155]
  s_waitcnt lgkmcnt(5)
  v_mul_f32 v184, v184, v176
  v_mul_f32 v185, v185, v177
  v_mfma_f32_16x16x32_bf16 v[132:135], a[220:223], v[16:19], v[132:135]
  ds_read_b128 a[244:247], v229 offset:8704
  v_mul_f32 v186, v186, v178
  v_mfma_f32_16x16x32_bf16 v[140:143], a[220:223], v[20:23], v[140:143]
  s_add_u32 s67, s67, 0x3000
  v_mul_f32 v187, v187, v179
  v_max3_f32 v239, v96, v97, v98
  v_mfma_f32_16x16x32_bf16 v[148:151], a[220:223], v[24:27], v[148:151]
  v_exp_f32 v184, v184
  v_mfma_f32_16x16x32_bf16 v[156:159], a[220:223], v[28:31], v[156:159]
  s_waitcnt lgkmcnt(5)
  v_exp_f32 v185, v185
  v_mfma_f32_16x16x32_bf16 v[128:131], a[224:227], v[32:35], v[128:131]
  ds_read_b128 a[248:251], v230 offset:8192
  v_max3_f32 v240, v104, v105, v106
  v_mfma_f32_16x16x32_bf16 v[136:139], a[224:227], v[36:39], v[136:139]
  s_add_u32 s57, s55, s73
  s_mov_b32 m0, s57
  v_max3_f32 v241, v112, v113, v114
  v_mfma_f32_16x16x32_bf16 v[144:147], a[224:227], v[40:43], v[144:147]
  buffer_load_dwordx4 v223, s[16:19], s68 offen nt lds
  v_max3_f32 v242, v120, v121, v122
  v_mfma_f32_16x16x32_bf16 v[152:155], a[224:227], v[44:47], v[152:155]
  s_waitcnt lgkmcnt(5)
  v_exp_f32 v186, v186
  v_mfma_f32_16x16x32_bf16 v[132:135], a[228:231], v[32:35], v[132:135]
  ds_read_b128 a[252:255], v230 offset:8704
  v_max3_f32 v239, v239, v99, v100
  v_mfma_f32_16x16x32_bf16 v[140:143], a[228:231], v[36:39], v[140:143]
  s_add_u32 s54, s54, 0x6080
  s_cmp_ge_u32 s54, 0x24300
  s_cselect_b32 s54, 0, s54
  v_mfma_f32_16x16x32_bf16 v[148:151], a[228:231], v[40:43], v[148:151]
  s_sub_u32 m0, s57, 0x200
  s_waitcnt vmcnt(21)
  s_barrier
  v_mfma_f32_16x16x32_bf16 v[156:159], a[228:231], v[44:47], v[156:159]
  s_waitcnt lgkmcnt(5)
  v_add_u32 v229, s54, v226
  v_add_u32 v228, s54, v225
  v_mfma_f32_16x16x32_bf16 v[128:131], a[232:235], v[48:51], v[128:131]
  buffer_load_dwordx4 v223, s[16:19], s68 offen offset:1536 nt lds
  v_xor_b32 v230, 64, v229
  v_mfma_f32_16x16x32_bf16 v[136:139], a[232:235], v[52:55], v[136:139]
  ds_read_b128 a[208:211], v229
  s_add_u32 m0, s57, 0x800
  v_mfma_f32_16x16x32_bf16 v[144:147], a[232:235], v[56:59], v[144:147]
  buffer_load_dwordx4 v224, s[16:19], s68 offen nt lds
  v_max3_f32 v240, v240, v107, v108
  v_mfma_f32_16x16x32_bf16 v[152:155], a[232:235], v[60:63], v[152:155]
  s_waitcnt lgkmcnt(5)
  v_max3_f32 v241, v241, v115, v116
  v_max3_f32 v242, v242, v123, v124
  v_mfma_f32_16x16x32_bf16 v[132:135], a[236:239], v[48:51], v[132:135]
  ds_read_b128 a[212:215], v229 offset:512
  v_max3_f32 v239, v239, v101, v102
  v_mfma_f32_16x16x32_bf16 v[140:143], a[236:239], v[52:55], v[140:143]
  s_add_u32 s68, s68, 0x3000
  v_max3_f32 v240, v240, v109, v110
  v_max3_f32 v241, v241, v117, v118
  v_mfma_f32_16x16x32_bf16 v[148:151], a[236:239], v[56:59], v[148:151]
  v_max3_f32 v242, v242, v125, v126
  v_max_f32 v239, v239, v103
  v_mfma_f32_16x16x32_bf16 v[156:159], a[236:239], v[60:63], v[156:159]
  s_waitcnt lgkmcnt(5)
  v_max_f32 v240, v240, v111
  v_max_f32 v241, v241, v119
  v_mfma_f32_16x16x32_bf16 v[128:131], a[240:243], v[64:67], v[128:131]
  ds_read_b128 a[216:219], v230
  v_max_f32 v242, v242, v127
  v_mfma_f32_16x16x32_bf16 v[136:139], a[240:243], v[68:71], v[136:139]
  s_add_u32 s55, s55, 0x6080
  s_cmp_ge_u32 s55, 0x24300
  s_cselect_b32 s55, 0, s55
  v_mfma_f32_16x16x32_bf16 v[144:147], a[240:243], v[72:75], v[144:147]
  v_mov_b32 v247, v239
  v_mov_b32 v248, v240
  v_mfma_f32_16x16x32_bf16 v[152:155], a[240:243], v[76:79], v[152:155]
  s_waitcnt lgkmcnt(5)
  v_mov_b32 v249, v241
  v_mov_b32 v243, v242
  v_mfma_f32_16x16x32_bf16 v[132:135], a[244:247], v[64:67], v[132:135]
  ds_read_b128 a[220:223], v230 offset:512
  v_permlane16_swap_b32 v247, v239
  v_mfma_f32_16x16x32_bf16 v[140:143], a[244:247], v[68:71], v[140:143]
  v_permlane16_swap_b32 v248, v240
  v_permlane16_swap_b32 v249, v241
  v_mfma_f32_16x16x32_bf16 v[148:151], a[244:247], v[72:75], v[148:151]
  v_permlane16_swap_b32 v243, v242
  v_max_f32 v239, v239, v247
  v_mfma_f32_16x16x32_bf16 v[156:159], a[244:247], v[76:79], v[156:159]
  s_waitcnt lgkmcnt(5)
  v_max_f32 v240, v240, v248
  v_max_f32 v241, v241, v249
  v_mfma_f32_16x16x32_bf16 v[128:131], a[248:251], v[80:83], v[128:131]
  ds_read_b128 a[224:227], v229 offset:4096
  v_max_f32 v242, v242, v243
  v_mfma_f32_16x16x32_bf16 v[136:139], a[248:251], v[84:87], v[136:139]
  v_mov_b32 v247, v239
  v_mov_b32 v248, v240
  v_mfma_f32_16x16x32_bf16 v[144:147], a[248:251], v[88:91], v[144:147]
  v_mov_b32 v249, v241
  v_mov_b32 v243, v242
  v_mfma_f32_16x16x32_bf16 v[152:155], a[248:251], v[92:95], v[152:155]
  v_permlane32_swap_b32 v247, v239
  v_permlane32_swap_b32 v248, v240
  s_waitcnt lgkmcnt(5)
  v_mfma_f32_16x16x32_bf16 v[132:135], a[252:255], v[80:83], v[132:135]
  ds_read_b128 a[228:231], v229 offset:4608
  v_permlane32_swap_b32 v249, v241
  v_mfma_f32_16x16x32_bf16 v[140:143], a[252:255], v[84:87], v[140:143]
  v_permlane32_swap_b32 v243, v242
  v_max_f32 v239, v239, v247
  v_mfma_f32_16x16x32_bf16 v[148:151], a[252:255], v[88:91], v[148:151]
  v_max_f32 v240, v240, v248
  v_max_f32 v241, v241, v249
  v_mfma_f32_16x16x32_bf16 v[156:159], a[252:255], v[92:95], v[156:159]
  v_max_f32 v242, v242, v243
  v_sub_f32 v96, v96, v239
  v_sub_f32 v97, v97, v239
  v_sub_f32 v98, v98, v239
  v_sub_f32 v99, v99, v239
  v_sub_f32 v100, v100, v239
  v_sub_f32 v101, v101, v239
  v_sub_f32 v102, v102, v239
  v_sub_f32 v103, v103, v239
  v_sub_f32 v104, v104, v240
  v_sub_f32 v105, v105, v240
  v_sub_f32 v106, v106, v240
  v_sub_f32 v107, v107, v240
  v_sub_f32 v108, v108, v240
  v_sub_f32 v109, v109, v240
  v_sub_f32 v110, v110, v240
  v_sub_f32 v111, v111, v240
  v_sub_f32 v112, v112, v241
  v_sub_f32 v113, v113, v241
  v_sub_f32 v114, v114, v241
  v_sub_f32 v115, v115, v241
  v_sub_f32 v116, v116, v241
  v_sub_f32 v117, v117, v241
  v_sub_f32 v118, v118, v241
  v_sub_f32 v119, v119, v241
  v_sub_f32 v120, v120, v242
  v_sub_f32 v121, v121, v242
  v_sub_f32 v122, v122, v242
  v_sub_f32 v123, v123, v242
  v_sub_f32 v124, v124, v242
  v_sub_f32 v125, v125, v242
  v_sub_f32 v126, v126, v242
  v_sub_f32 v127, v127, v242
  v_sub_f32 v192, v192, v239
  v_sub_f32 v193, v193, v239
  v_sub_f32 v194, v194, v239
  v_sub_f32 v195, v195, v239
  v_sub_f32 v196, v196, v240
  v_sub_f32 v197, v197, v240
  v_sub_f32 v198, v198, v240
  v_sub_f32 v199, v199, v240
  v_sub_f32 v200, v200, v241
  v_sub_f32 v201, v201, v241
  v_sub_f32 v202, v202, v241
  v_sub_f32 v203, v203, v241
  v_sub_f32 v204, v204, v242
  v_sub_f32 v205, v205, v242
  v_sub_f32 v206, v206, v242
  v_sub_f32 v207, v207, v242
  v_exp_f32 v96, v96
  v_exp_f32 v97, v97
  v_exp_f32 v98, v98
  v_cvt_pk_bf16_f32 v160, v96, v97
  v_exp_f32 v99, v99
  v_exp_f32 v100, v100
  v_cvt_pk_bf16_f32 v161, v98, v99
  v_exp_f32 v101, v101
  v_exp_f32 v102, v102
  v_cvt_pk_bf16_f32 v162, v100, v101
  v_exp_f32 v103, v103
  v_exp_f32 v104, v104
  v_cvt_pk_bf16_f32 v163, v102, v103
  v_exp_f32 v105, v105
  v_exp_f32 v106, v106
  v_cvt_pk_bf16_f32 v164, v104, v105
  v_exp_f32 v107, v107
  v_exp_f32 v108, v108
  v_cvt_pk_bf16_f32 v165, v106, v107
  v_exp_f32 v109, v109
  v_exp_f32 v110, v110
  v_cvt_pk_bf16_f32 v166, v108, v109
  v_exp_f32 v111, v111
  v_exp_f32 v112, v112
  v_cvt_pk_bf16_f32 v167, v110, v111
  v_exp_f32 v113, v113
  v_exp_f32 v114, v114
  v_cvt_pk_bf16_f32 v168, v112, v113
  v_exp_f32 v115, v115
  v_exp_f32 v116, v116
  v_cvt_pk_bf16_f32 v169, v114, v115
  v_exp_f32 v117, v117
  v_exp_f32 v118, v118
  v_cvt_pk_bf16_f32 v170, v116, v117
  v_exp_f32 v119, v119
  v_exp_f32 v120, v120
  v_cvt_pk_bf16_f32 v171, v118, v119
  v_exp_f32 v121, v121
  v_exp_f32 v122, v122
  v_cvt_pk_bf16_f32 v172, v120, v121
  v_exp_f32 v123, v123
  v_exp_f32 v124, v124
  v_cvt_pk_bf16_f32 v173, v122, v123
  v_exp_f32 v125, v125
  v_exp_f32 v126, v126
  v_cvt_pk_bf16_f32 v174, v124, v125
  v_exp_f32 v127, v127
  s_nop 0
  v_cvt_pk_bf16_f32 v175, v126, v127
  v_exp_f32 v187, v187
  v_mul_f32 v176, v176, v180
  v_mul_f32 v177, v177, v181
  v_mul_f32 v178, v178, v182
  v_mul_f32 v179, v179, v183
  v_add_f32 v184, 1.0, v184
  v_add_f32 v185, 1.0, v185
  v_add_f32 v186, 1.0, v186
  v_add_f32 v187, 1.0, v187
  v_rcp_f32 v184, v184
  v_rcp_f32 v185, v185
  v_rcp_f32 v186, v186
  v_rcp_f32 v187, v187
  v_mul_f32 v184, v184, v176
  v_mul_f32 v185, v185, v177
  v_mul_f32 v186, v186, v178
  v_mul_f32 v187, v187, v179
  v_cvt_pk_bf16_f32 v190, v184, v185
  v_cvt_pk_bf16_f32 v191, v186, v187
  buffer_store_dwordx2 v[190:191], v232, s[20:23], s79 offen offset:512 sc1
  v_accvgpr_read_b32 v176, a48
  v_accvgpr_read_b32 v177, a49
  v_accvgpr_read_b32 v178, a50
  v_accvgpr_read_b32 v179, a51
  v_accvgpr_read_b32 v180, a52
  v_accvgpr_read_b32 v181, a53
  v_accvgpr_read_b32 v182, a54
  v_accvgpr_read_b32 v183, a55
  v_mul_f32 v184, v176, v176
  v_mul_f32 v185, v177, v177
  v_mul_f32 v186, v178, v178
  v_mul_f32 v187, v179, v179
  v_fma_f32 v184, v184, v251, s80
  v_fma_f32 v185, v185, v251, s80
  v_fma_f32 v186, v186, v251, s80
  v_fma_f32 v187, v187, v251, s80
  v_mul_f32 v184, v184, v176
  v_mul_f32 v185, v185, v177
  v_mul_f32 v186, v186, v178
  v_mul_f32 v187, v187, v179
  v_exp_f32 v184, v184
  v_exp_f32 v185, v185
  v_exp_f32 v186, v186
  v_exp_f32 v187, v187
  v_mul_f32 v176, v176, v180
  v_mul_f32 v177, v177, v181
  v_mul_f32 v178, v178, v182
  v_mul_f32 v179, v179, v183
  v_add_f32 v184, 1.0, v184
  v_add_f32 v185, 1.0, v185
  v_add_f32 v186, 1.0, v186
  v_add_f32 v187, 1.0, v187
  v_rcp_f32 v184, v184
  v_rcp_f32 v185, v185
  v_rcp_f32 v186, v186
  v_rcp_f32 v187, v187
  v_mul_f32 v184, v184, v176
  v_mul_f32 v185, v185, v177
  v_mul_f32 v186, v186, v178
  v_mul_f32 v187, v187, v179
  v_cvt_pk_bf16_f32 v188, v184, v185
  v_cvt_pk_bf16_f32 v189, v186, v187
  buffer_store_dwordx2 v[188:189], v233, s[20:23], s79 offen offset:512 sc1
  v_accvgpr_read_b32 v176, a56
  v_accvgpr_read_b32 v177, a57
  v_accvgpr_read_b32 v178, a58
  v_accvgpr_read_b32 v179, a59
  v_accvgpr_read_b32 v180, a60
  v_accvgpr_read_b32 v181, a61
  v_accvgpr_read_b32 v182, a62
  v_accvgpr_read_b32 v183, a63
  v_mul_f32 v184, v176, v176
  v_mul_f32 v185, v177, v177
  v_mul_f32 v186, v178, v178
  v_mul_f32 v187, v179, v179
  v_fma_f32 v184, v184, v251, s80
  v_fma_f32 v185, v185, v251, s80
  v_fma_f32 v186, v186, v251, s80
  v_fma_f32 v187, v187, v251, s80
  v_mul_f32 v184, v184, v176
  v_mul_f32 v185, v185, v177
  v_mul_f32 v186, v186, v178
  v_mul_f32 v187, v187, v179
  v_exp_f32 v184, v184
  v_exp_f32 v185, v185
  v_exp_f32 v186, v186
  v_exp_f32 v187, v187
  v_mul_f32 v176, v176, v180
  v_mul_f32 v177, v177, v181
  v_mul_f32 v178, v178, v182
  v_mul_f32 v179, v179, v183
  v_add_f32 v184, 1.0, v184
  v_add_f32 v185, 1.0, v185
  v_add_f32 v186, 1.0, v186
  v_add_f32 v187, 1.0, v187
  v_rcp_f32 v184, v184
  v_rcp_f32 v185, v185
  v_rcp_f32 v186, v186
  v_rcp_f32 v187, v187
  v_mul_f32 v184, v184, v176
  v_mul_f32 v185, v185, v177
  v_mul_f32 v186, v186, v178
  v_mul_f32 v187, v187, v179
  v_cvt_pk_bf16_f32 v190, v184, v185
  v_cvt_pk_bf16_f32 v191, v186, v187
  buffer_store_dwordx2 v[190:191], v234, s[20:23], s79 offen offset:512 sc1
  v_accvgpr_read_b32 v176, a64
  v_accvgpr_read_b32 v177, a65
  v_accvgpr_read_b32 v178, a66
  v_accvgpr_read_b32 v179, a67
  v_accvgpr_read_b32 v180, a68
  v_accvgpr_read_b32 v181, a69
  v_accvgpr_read_b32 v182, a70
  v_accvgpr_read_b32 v183, a71
  v_mul_f32 v184, v176, v176
  v_mul_f32 v185, v177, v177
  v_mul_f32 v186, v178, v178
  v_mul_f32 v187, v179, v179
  v_fma_f32 v184, v184, v251, s80
  v_fma_f32 v185, v185, v251, s80
  v_fma_f32 v186, v186, v251, s80
  v_fma_f32 v187, v187, v251, s80
  v_mul_f32 v184, v184, v176
  v_mul_f32 v185, v185, v177
  v_mul_f32 v186, v186, v178
  v_mul_f32 v187, v187, v179
  v_exp_f32 v184, v184
  v_exp_f32 v185, v185
  v_exp_f32 v186, v186
  v_exp_f32 v187, v187
  v_mul_f32 v176, v176, v180
  v_mul_f32 v177, v177, v181
  v_mul_f32 v178, v178, v182
  v_mul_f32 v179, v179, v183
  v_add_f32 v184, 1.0, v184
  v_add_f32 v185, 1.0, v185
  v_add_f32 v186, 1.0, v186
  v_add_f32 v187, 1.0, v187
  v_rcp_f32 v184, v184
  v_rcp_f32 v185, v185
  v_rcp_f32 v186, v186
  v_rcp_f32 v187, v187
  v_mul_f32 v184, v184, v176
  v_mul_f32 v185, v185, v177
  v_mul_f32 v186, v186, v178
  v_mul_f32 v187, v187, v179
  v_cvt_pk_bf16_f32 v188, v184, v185
  v_cvt_pk_bf16_f32 v189, v186, v187
  buffer_store_dwordx2 v[188:189], v231, s[20:23], s79 offen offset:1024 sc1
  v_accvgpr_read_b32 v176, a72
  v_accvgpr_read_b32 v177, a73
  v_accvgpr_read_b32 v178, a74
  v_accvgpr_read_b32 v179, a75
  v_accvgpr_read_b32 v180, a76
  v_accvgpr_read_b32 v181, a77
  v_accvgpr_read_b32 v182, a78
  v_accvgpr_read_b32 v183, a79
  v_mul_f32 v184, v176, v176
  v_mul_f32 v185, v177, v177
  v_mul_f32 v186, v178, v178
  v_mul_f32 v187, v179, v179
  v_fma_f32 v184, v184, v251, s80
  v_fma_f32 v185, v185, v251, s80
  v_fma_f32 v186, v186, v251, s80
  v_fma_f32 v187, v187, v251, s80
  v_mul_f32 v184, v184, v176
  v_mul_f32 v185, v185, v177
  v_mul_f32 v186, v186, v178
  v_mul_f32 v187, v187, v179
  v_exp_f32 v184, v184
  v_exp_f32 v185, v185
  v_exp_f32 v186, v186
  v_exp_f32 v187, v187
  v_mul_f32 v176, v176, v180
  v_mul_f32 v177, v177, v181
  v_mul_f32 v178, v178, v182
  v_mul_f32 v179, v179, v183
  v_add_f32 v184, 1.0, v184
  v_add_f32 v185, 1.0, v185
  v_add_f32 v186, 1.0, v186
  v_add_f32 v187, 1.0, v187
  v_rcp_f32 v184, v184
  v_rcp_f32 v185, v185
  v_rcp_f32 v186, v186
  v_rcp_f32 v187, v187
  v_mul_f32 v184, v184, v176
  v_mul_f32 v185, v185, v177
  v_mul_f32 v186, v186, v178
  v_mul_f32 v187, v187, v179
  v_cvt_pk_bf16_f32 v190, v184, v185
  v_cvt_pk_bf16_f32 v191, v186, v187
  buffer_store_dwordx2 v[190:191], v232, s[20:23], s79 offen offset:1024 sc1
  v_accvgpr_read_b32 v176, a80
  v_accvgpr_read_b32 v177, a81
  v_accvgpr_read_b32 v178, a82
  v_accvgpr_read_b32 v179, a83
  v_accvgpr_read_b32 v180, a84
  v_accvgpr_read_b32 v181, a85
  v_accvgpr_read_b32 v182, a86
  v_accvgpr_read_b32 v183, a87
  v_mul_f32 v184, v176, v176
  v_mul_f32 v185, v177, v177
  v_mul_f32 v186, v178, v178
  v_mul_f32 v187, v179, v179
  v_fma_f32 v184, v184, v251, s80
  v_fma_f32 v185, v185, v251, s80
  v_fma_f32 v186, v186, v251, s80
  v_fma_f32 v187, v187, v251, s80
  v_mul_f32 v184, v184, v176
  v_mul_f32 v185, v185, v177
  v_mul_f32 v186, v186, v178
  v_mul_f32 v187, v187, v179
  v_exp_f32 v184, v184
  v_exp_f32 v185, v185
  v_exp_f32 v186, v186
  v_exp_f32 v187, v187
  v_mul_f32 v176, v176, v180
  v_mul_f32 v177, v177, v181
  v_mul_f32 v178, v178, v182
  v_mul_f32 v179, v179, v183
  v_add_f32 v184, 1.0, v184
  v_add_f32 v185, 1.0, v185
  v_add_f32 v186, 1.0, v186
  v_add_f32 v187, 1.0, v187
  v_rcp_f32 v184, v184
  v_rcp_f32 v185, v185
  v_rcp_f32 v186, v186
  v_rcp_f32 v187, v187
  v_mul_f32 v184, v184, v176
  v_mul_f32 v185, v185, v177
  v_mul_f32 v186, v186, v178
  v_mul_f32 v187, v187, v179
  v_cvt_pk_bf16_f32 v188, v184, v185
  v_cvt_pk_bf16_f32 v189, v186, v187
  buffer_store_dwordx2 v[188:189], v233, s[20:23], s79 offen offset:1024 sc1
  v_accvgpr_read_b32 v176, a88
  v_accvgpr_read_b32 v177, a89
  v_accvgpr_read_b32 v178, a90
  v_accvgpr_read_b32 v179, a91
  v_accvgpr_read_b32 v180, a92
  v_accvgpr_read_b32 v181, a93
  v_accvgpr_read_b32 v182, a94
  v_accvgpr_read_b32 v183, a95
  v_mul_f32 v184, v176, v176
  v_mul_f32 v185, v177, v177
  v_mul_f32 v186, v178, v178
  v_mul_f32 v187, v179, v179
  v_fma_f32 v184, v184, v251, s80
  v_fma_f32 v185, v185, v251, s80
  v_fma_f32 v186, v186, v251, s80
  v_fma_f32 v187, v187, v251, s80
  v_mul_f32 v184, v184, v176
  v_mul_f32 v185, v185, v177
  v_mul_f32 v186, v186, v178
  v_mul_f32 v187, v187, v179
  v_exp_f32 v184, v184
  v_exp_f32 v185, v185
  v_exp_f32 v186, v186
  v_exp_f32 v187, v187
  v_mul_f32 v176, v176, v180
  v_mul_f32 v177, v177, v181
  v_mul_f32 v178, v178, v182
  v_mul_f32 v179, v179, v183
  v_add_f32 v184, 1.0, v184
  v_add_f32 v185, 1.0, v185
  v_add_f32 v186, 1.0, v186
  v_add_f32 v187, 1.0, v187
  v_rcp_f32 v184, v184
  v_rcp_f32 v185, v185
  v_rcp_f32 v186, v186
  v_rcp_f32 v187, v187
  v_mul_f32 v184, v184, v176
  v_mul_f32 v185, v185, v177
  v_mul_f32 v186, v186, v178
  v_mul_f32 v187, v187, v179
  v_cvt_pk_bf16_f32 v190, v184, v185
  v_cvt_pk_bf16_f32 v191, v186, v187
  buffer_store_dwordx2 v[190:191], v234, s[20:23], s79 offen offset:1024 sc1
  v_mov_b32 v231, v235
  s_waitcnt lgkmcnt(5)
  v_mov_b32 v232, v236
  v_mov_b32 v233, v237
  v_mov_b32 v234, v238
  v_mfma_f32_16x16x32_bf16 v[96:99], a[208:211], v[0:3], v[192:195]
  ds_read_b128 a[232:235], v230 offset:4096
  v_sub_f32 v128, v128, v239
  v_mfma_f32_16x16x32_bf16 v[104:107], a[208:211], v[4:7], v[196:199]
  v_sub_f32 v129, v129, v239
  v_sub_f32 v130, v130, v239
  v_mfma_f32_16x16x32_bf16 v[112:115], a[208:211], v[8:11], v[200:203]
  v_sub_f32 v131, v131, v239
  v_sub_f32 v132, v132, v239
  v_mfma_f32_16x16x32_bf16 v[120:123], a[208:211], v[12:15], v[204:207]
  s_waitcnt lgkmcnt(5)
  v_sub_f32 v133, v133, v239
  v_sub_f32 v134, v134, v239
  v_mfma_f32_16x16x32_bf16 v[100:103], a[212:215], v[0:3], v[192:195]
  ds_read_b128 a[236:239], v230 offset:4608
  v_sub_f32 v135, v135, v239
  v_mfma_f32_16x16x32_bf16 v[108:111], a[212:215], v[4:7], v[196:199]
  v_sub_f32 v136, v136, v240
  v_sub_f32 v137, v137, v240
  v_mfma_f32_16x16x32_bf16 v[116:119], a[212:215], v[8:11], v[200:203]
  v_sub_f32 v138, v138, v240
  v_sub_f32 v139, v139, v240
  v_mfma_f32_16x16x32_bf16 v[124:127], a[212:215], v[12:15], v[204:207]
  s_waitcnt lgkmcnt(5)
  v_sub_f32 v140, v140, v240
  v_sub_f32 v141, v141, v240
  v_mfma_f32_16x16x32_bf16 v[96:99], a[216:219], v[16:19], v[96:99]
  ds_read_b128 a[240:243], v229 offset:8192
  v_sub_f32 v142, v142, v240
  v_mfma_f32_16x16x32_bf16 v[104:107], a[216:219], v[20:23], v[104:107]
  v_sub_f32 v143, v143, v240
  v_sub_f32 v144, v144, v241
  v_mfma_f32_16x16x32_bf16 v[112:115], a[216:219], v[24:27], v[112:115]
  v_sub_f32 v145, v145, v241
  v_sub_f32 v146, v146, v241
  v_mfma_f32_16x16x32_bf16 v[120:123], a[216:219], v[28:31], v[120:123]
  s_waitcnt lgkmcnt(5)
  v_sub_f32 v147, v147, v241
  v_sub_f32 v148, v148, v241
  v_mfma_f32_16x16x32_bf16 v[100:103], a[220:223], v[16:19], v[100:103]
  ds_read_b128 a[244:247], v229 offset:8704
  v_sub_f32 v149, v149, v241
  v_mfma_f32_16x16x32_bf16 v[108:111], a[220:223], v[20:23], v[108:111]
  v_sub_f32 v150, v150, v241
  v_sub_f32 v151, v151, v241
  v_mfma_f32_16x16x32_bf16 v[116:119], a[220:223], v[24:27], v[116:119]
  v_sub_f32 v152, v152, v242
  v_sub_f32 v153, v153, v242
  v_mfma_f32_16x16x32_bf16 v[124:127], a[220:223], v[28:31], v[124:127]
  s_waitcnt lgkmcnt(5)
  v_sub_f32 v154, v154, v242
  v_sub_f32 v155, v155, v242
  v_mfma_f32_16x16x32_bf16 v[96:99], a[224:227], v[32:35], v[96:99]
  ds_read_b128 a[248:251], v230 offset:8192
  v_sub_f32 v156, v156, v242
  v_mfma_f32_16x16x32_bf16 v[104:107], a[224:227], v[36:39], v[104:107]
  s_add_u32 s57, s55, s72
  s_add_u32 m0, s57, 0
  v_sub_f32 v157, v157, v242
  v_mfma_f32_16x16x32_bf16 v[112:115], a[224:227], v[40:43], v[112:115]
  buffer_load_dwordx4 v222, s[12:15], s67 offen nt lds
  v_sub_f32 v158, v158, v242
  v_mfma_f32_16x16x32_bf16 v[120:123], a[224:227], v[44:47], v[120:123]
  s_waitcnt lgkmcnt(5)
  v_sub_f32 v159, v159, v242
  v_max3_f32 v243, v128, v129, v130
  v_mfma_f32_16x16x32_bf16 v[100:103], a[228:231], v[32:35], v[100:103]
  ds_read_b128 a[252:255], v230 offset:8704
  v_max3_f32 v249, v131, v132, v133
  v_mfma_f32_16x16x32_bf16 v[108:111], a[228:231], v[36:39], v[108:111]
  v_max3_f32 v243, v243, v134, v135
  v_max3_f32 v249, v249, v136, v137
  v_mfma_f32_16x16x32_bf16 v[116:119], a[228:231], v[40:43], v[116:119]
  v_max3_f32 v243, v243, v138, v139
  v_max3_f32 v249, v249, v140, v141
  v_mfma_f32_16x16x32_bf16 v[124:127], a[228:231], v[44:47], v[124:127]
  s_waitcnt lgkmcnt(5)
  v_max3_f32 v243, v243, v142, v143
  v_max3_f32 v249, v249, v144, v145
  v_mfma_f32_16x16x32_bf16 v[96:99], a[232:235], v[48:51], v[96:99]
  ds_read_b64_tr_b16 a[208:209], v228 offset:12288
  v_max3_f32 v243, v243, v146, v147
  v_mfma_f32_16x16x32_bf16 v[104:107], a[232:235], v[52:55], v[104:107]
  ds_read_b64_tr_b16 a[210:211], v228 offset:13312
  s_add_u32 m0, s57, 0xf80
  v_mfma_f32_16x16x32_bf16 v[112:115], a[232:235], v[56:59], v[112:115]
  buffer_load_dwordx4 v222, s[12:15], s67 offen offset:128 nt lds
  v_max3_f32 v249, v249, v148, v149
  v_mfma_f32_16x16x32_bf16 v[120:123], a[232:235], v[60:63], v[120:123]
  s_waitcnt lgkmcnt(6)
  v_max3_f32 v243, v243, v150, v151
  v_max3_f32 v249, v249, v152, v153
  v_mfma_f32_16x16x32_bf16 v[100:103], a[236:239], v[48:51], v[100:103]
  ds_read_b64_tr_b16 a[212:213], v228 offset:12296
  v_max3_f32 v243, v243, v154, v155
  v_mfma_f32_16x16x32_bf16 v[108:111], a[236:239], v[52:55], v[108:111]
  ds_read_b64_tr_b16 a[214:215], v228 offset:13320
  v_max3_f32 v249, v249, v156, v157
  v_mfma_f32_16x16x32_bf16 v[116:119], a[236:239], v[56:59], v[116:119]
  v_max3_f32 v243, v243, v158, v159
  v_max_f32 v243, v243, v249
  v_mfma_f32_16x16x32_bf16 v[124:127], a[236:239], v[60:63], v[124:127]
  v_cmp_lt_f32 vcc, s63, v243
  s_cbranch_vccnz L_sk0_far
L_sk0:
  s_waitcnt lgkmcnt(7)
  v_mfma_f32_16x16x32_bf16 v[96:99], a[240:243], v[64:67], v[96:99]
  ds_read_b64_tr_b16 a[216:217], v228 offset:12544
  v_mfma_f32_16x16x32_bf16 v[104:107], a[240:243], v[68:71], v[104:107]
  ds_read_b64_tr_b16 a[218:219], v228 offset:13568
  s_add_u32 m0, s57, 0x1f00
  v_mfma_f32_16x16x32_bf16 v[112:115], a[240:243], v[72:75], v[112:115]
  buffer_load_dwordx4 v222, s[12:15], s67 offen offset:256 nt lds
  v_mfma_f32_16x16x32_bf16 v[120:123], a[240:243], v[76:79], v[120:123]
  s_waitcnt lgkmcnt(8)
  v_exp_f32 v128, v128
  v_mfma_f32_16x16x32_bf16 v[100:103], a[244:247], v[64:67], v[100:103]
  ds_read_b64_tr_b16 a[220:221], v228 offset:12552
  v_mfma_f32_16x16x32_bf16 v[108:111], a[244:247], v[68:71], v[108:111]
  ds_read_b64_tr_b16 a[222:223], v228 offset:13576
  v_mfma_f32_16x16x32_bf16 v[116:119], a[244:247], v[72:75], v[116:119]
  v_exp_f32 v129, v129
  v_mfma_f32_16x16x32_bf16 v[124:127], a[244:247], v[76:79], v[124:127]
  s_waitcnt lgkmcnt(9)
  v_exp_f32 v130, v130
  v_mfma_f32_16x16x32_bf16 v[96:99], a[248:251], v[80:83], v[96:99]
  ds_read_b64_tr_b16 a[224:225], v228 offset:12800
  v_cvt_pk_bf16_f32 v176, v128, v129
  v_mfma_f32_16x16x32_bf16 v[104:107], a[248:251], v[84:87], v[104:107]
  ds_read_b64_tr_b16 a[226:227], v228 offset:13824
  s_add_u32 s67, s67, 0x3000
  v_mfma_f32_16x16x32_bf16 v[112:115], a[248:251], v[88:91], v[112:115]
  v_exp_f32 v131, v131
  v_mfma_f32_16x16x32_bf16 v[120:123], a[248:251], v[92:95], v[120:123]
  s_waitcnt lgkmcnt(10)
  v_exp_f32 v132, v132
  v_mfma_f32_16x16x32_bf16 v[100:103], a[252:255], v[80:83], v[100:103]
  ds_read_b64_tr_b16 a[228:229], v228 offset:12808
  v_cvt_pk_bf16_f32 v177, v130, v131
  v_mfma_f32_16x16x32_bf16 v[108:111], a[252:255], v[84:87], v[108:111]
  ds_read_b64_tr_b16 a[230:231], v228 offset:13832
  v_mfma_f32_16x16x32_bf16 v[116:119], a[252:255], v[88:91], v[116:119]
  v_exp_f32 v133, v133
  v_mfma_f32_16x16x32_bf16 v[124:127], a[252:255], v[92:95], v[124:127]
  s_waitcnt lgkmcnt(10)
  v_exp_f32 v134, v134
  v_mfma_f32_16x16x32_bf16 a[0:3], a[208:211], v[160:163], 0
  ds_read_b64_tr_b16 a[232:233], v228 offset:13056
  v_cvt_pk_bf16_f32 v178, v132, v133
  v_mfma_f32_16x16x32_bf16 a[8:11], a[208:211], v[164:167], 0
  ds_read_b64_tr_b16 a[234:235], v228 offset:14080
  v_mfma_f32_16x16x32_bf16 a[16:19], a[208:211], v[168:171], 0
  s_add_u32 s57, s55, s73
  s_mov_b32 m0, s57
  v_mfma_f32_16x16x32_bf16 a[24:27], a[208:211], v[172:175], 0
  buffer_load_dwordx4 v223, s[16:19], s68 offen nt lds
  s_waitcnt lgkmcnt(10)
  v_mfma_f32_16x16x32_bf16 a[4:7], a[212:215], v[160:163], 0
  ds_read_b64_tr_b16 a[236:237], v228 offset:13064
  v_mfma_f32_16x16x32_bf16 a[12:15], a[212:215], v[164:167], 0
  ds_read_b64_tr_b16 a[238:239], v228 offset:14088
  v_mfma_f32_16x16x32_bf16 a[20:23], a[212:215], v[168:171], 0
  v_exp_f32 v135, v135
  v_mfma_f32_16x16x32_bf16 a[28:31], a[212:215], v[172:175], 0
  s_waitcnt lgkmcnt(10)
  v_exp_f32 v136, v136
  v_mfma_f32_16x16x32_bf16 a[32:35], a[216:219], v[160:163], 0
  ds_read_b64_tr_b16 a[240:241], v228 offset:14336
  v_cvt_pk_bf16_f32 v179, v134, v135
  v_mfma_f32_16x16x32_bf16 a[40:43], a[216:219], v[164:167], 0
  ds_read_b64_tr_b16 a[242:243], v228 offset:14848
  s_sub_u32 m0, s57, 0x200
  v_mfma_f32_16x16x32_bf16 a[48:51], a[216:219], v[168:171], 0
  buffer_load_dwordx4 v223, s[16:19], s68 offen offset:1536 nt lds
  v_mfma_f32_16x16x32_bf16 a[56:59], a[216:219], v[172:175], 0
  s_waitcnt lgkmcnt(10)
  v_exp_f32 v137, v137
  v_mfma_f32_16x16x32_bf16 a[36:39], a[220:223], v[160:163], 0
  ds_read_b64_tr_b16 a[244:245], v228 offset:14344
  v_cvt_pk_bf16_f32 v180, v136, v137
  v_mfma_f32_16x16x32_bf16 a[44:47], a[220:223], v[164:167], 0
  buffer_load_dwordx4 v[252:255], v245, s[28:31], s69 offen
  s_add_u32 s69, s69, 0x400
  v_mfma_f32_16x16x32_bf16 a[52:55], a[220:223], v[168:171], 0
  ds_read_b64_tr_b16 a[246:247], v228 offset:14856
  v_mfma_f32_16x16x32_bf16 a[60:63], a[220:223], v[172:175], 0
  s_waitcnt lgkmcnt(10)
  v_exp_f32 v138, v138
  v_mfma_f32_16x16x32_bf16 a[64:67], a[224:227], v[160:163], 0
  ds_read_b64_tr_b16 a[248:249], v228 offset:14592
  v_mfma_f32_16x16x32_bf16 a[72:75], a[224:227], v[164:167], 0
  ds_read_b64_tr_b16 a[250:251], v228 offset:15104
  s_add_u32 m0, s57, 0x800
  v_mfma_f32_16x16x32_bf16 a[80:83], a[224:227], v[168:171], 0
  buffer_load_dwordx4 v224, s[16:19], s68 offen nt lds
  v_mfma_f32_16x16x32_bf16 a[88:91], a[224:227], v[172:175], 0
  s_waitcnt lgkmcnt(10)
  v_exp_f32 v139, v139
  v_mfma_f32_16x16x32_bf16 a[68:71], a[228:231], v[160:163], 0
  ds_read_b64_tr_b16 a[252:253], v228 offset:14600
  v_cvt_pk_bf16_f32 v181, v138, v139
  v_mfma_f32_16x16x32_bf16 a[76:79], a[228:231], v[164:167], 0
  s_add_u32 s54, s54, 0x6080
  s_cmp_ge_u32 s54, 0x24300
  s_cselect_b32 s54, 0, s54
  v_mfma_f32_16x16x32_bf16 a[84:87], a[228:231], v[168:171], 0
  ds_read_b64_tr_b16 a[254:255], v228 offset:15112
  v_mfma_f32_16x16x32_bf16 a[92:95], a[228:231], v[172:175], 0
  s_waitcnt vmcnt(31)
  s_barrier
  s_waitcnt lgkmcnt(10)
  v_mfma_f32_16x16x32_bf16 a[96:99], a[232:235], v[160:163], 0
  v_add_u32 v229, s54, v226
  v_add_u32 v228, s54, v225
  v_xor_b32 v230, 64, v229
  v_mfma_f32_16x16x32_bf16 a[104:107], a[232:235], v[164:167], 0
  ds_read_b128 a[208:211], v229
  s_add_u32 s68, s68, 0x3000
  v_mfma_f32_16x16x32_bf16 a[112:115], a[232:235], v[168:171], 0
  v_exp_f32 v140, v140
  v_mfma_f32_16x16x32_bf16 a[120:123], a[232:235], v[172:175], 0
  s_waitcnt lgkmcnt(9)
  v_exp_f32 v141, v141
  v_mfma_f32_16x16x32_bf16 a[100:103], a[236:239], v[160:163], 0
  ds_read_b128 a[212:215], v229 offset:512
  v_cvt_pk_bf16_f32 v182, v140, v141
  v_mfma_f32_16x16x32_bf16 a[108:111], a[236:239], v[164:167], 0
  v_exp_f32 v142, v142
  v_mfma_f32_16x16x32_bf16 a[116:119], a[236:239], v[168:171], 0
  v_exp_f32 v143, v143
  v_mfma_f32_16x16x32_bf16 a[124:127], a[236:239], v[172:175], 0
  s_waitcnt lgkmcnt(8)
  v_exp_f32 v144, v144
  v_mfma_f32_16x16x32_bf16 a[128:131], a[240:243], v[160:163], 0
  ds_read_b128 a[216:219], v230
  v_cvt_pk_bf16_f32 v183, v142, v143
  v_mfma_f32_16x16x32_bf16 a[136:139], a[240:243], v[164:167], 0
  s_add_u32 s55, s55, 0x6080
  s_cmp_ge_u32 s55, 0x24300
  s_cselect_b32 s55, 0, s55
  v_mfma_f32_16x16x32_bf16 a[144:147], a[240:243], v[168:171], 0
  v_exp_f32 v145, v145
  v_mfma_f32_16x16x32_bf16 a[152:155], a[240:243], v[172:175], 0
  s_waitcnt lgkmcnt(7)
  v_exp_f32 v146, v146
  v_mfma_f32_16x16x32_bf16 a[132:135], a[244:247], v[160:163], 0
  ds_read_b128 a[220:223], v230 offset:512
  v_cvt_pk_bf16_f32 v184, v144, v145
  v_mfma_f32_16x16x32_bf16 a[140:143], a[244:247], v[164:167], 0
  v_exp_f32 v147, v147
  v_mfma_f32_16x16x32_bf16 a[148:151], a[244:247], v[168:171], 0
  v_exp_f32 v148, v148
  v_mfma_f32_16x16x32_bf16 a[156:159], a[244:247], v[172:175], 0
  s_waitcnt lgkmcnt(6)
  v_cvt_pk_bf16_f32 v185, v146, v147
  v_mfma_f32_16x16x32_bf16 a[160:163], a[248:251], v[160:163], 0
  ds_read_b128 a[224:227], v229 offset:4096
  s_waitcnt vmcnt(7)
  v_mfma_f32_16x16x32_bf16 a[168:171], a[248:251], v[164:167], 0
  s_add_u32 s49, s81, 0x1000
  v_mov_b32 v220, 3
  v_mfma_f32_16x16x32_bf16 a[176:179], a[248:251], v[168:171], 0
  buffer_store_dword v220, v250, s[20:23], s49 offen sc1
  v_mfma_f32_16x16x32_bf16 a[184:187], a[248:251], v[172:175], 0
  s_waitcnt lgkmcnt(5)
  v_exp_f32 v149, v149
  v_mfma_f32_16x16x32_bf16 a[164:167], a[252:255], v[160:163], 0
  ds_read_b128 a[228:231], v229 offset:4608
  v_cvt_pk_bf16_f32 v186, v148, v149
  v_mfma_f32_16x16x32_bf16 a[172:175], a[252:255], v[164:167], 0
  v_exp_f32 v150, v150
  v_mfma_f32_16x16x32_bf16 a[180:183], a[252:255], v[168:171], 0
  v_exp_f32 v151, v151
  v_mfma_f32_16x16x32_bf16 a[188:191], a[252:255], v[172:175], 0
  v_exp_f32 v152, v152
  v_mfma_f32_16x16x32_bf16 a[192:195], v[208:211], v[160:163], 0
  v_cvt_pk_bf16_f32 v187, v150, v151
  v_mfma_f32_16x16x32_bf16 a[196:199], v[208:211], v[164:167], 0
  v_exp_f32 v153, v153
  v_mfma_f32_16x16x32_bf16 a[200:203], v[208:211], v[168:171], 0
  v_exp_f32 v154, v154
  v_mfma_f32_16x16x32_bf16 a[204:207], v[208:211], v[172:175], 0
  v_cvt_pk_bf16_f32 v188, v152, v153
  v_exp_f32 v155, v155
  v_exp_f32 v156, v156
  v_cvt_pk_bf16_f32 v189, v154, v155
  v_exp_f32 v157, v157
  v_exp_f32 v158, v158
  v_cvt_pk_bf16_f32 v190, v156, v157
  v_exp_f32 v159, v159
  s_nop 0
  v_cvt_pk_bf16_f32 v191, v158, v159
  s_cmp_lg_u32 s66, 0
  s_cbranch_scc1 L_rs1_far
L_rs1:
  s_mov_b32 s56, 5
L_att:
  s_waitcnt lgkmcnt(5)
  v_mfma_f32_16x16x32_bf16 v[128:131], a[208:211], v[0:3], v[192:195]
  ds_read_b128 a[232:235], v230 offset:4096
  v_max3_f32 v243, v96, v97, v98
  v_mfma_f32_16x16x32_bf16 v[136:139], a[208:211], v[4:7], v[196:199]
  v_max3_f32 v249, v99, v100, v101
  v_max3_f32 v243, v243, v102, v103
  v_mfma_f32_16x16x32_bf16 v[144:147], a[208:211], v[8:11], v[200:203]
  v_max3_f32 v249, v249, v104, v105
  v_max3_f32 v243, v243, v106, v107
  v_mfma_f32_16x16x32_bf16 v[152:155], a[208:211], v[12:15], v[204:207]
  s_waitcnt lgkmcnt(5)
  v_max3_f32 v249, v249, v108, v109
  v_max3_f32 v243, v243, v110, v111
  v_mfma_f32_16x16x32_bf16 v[132:135], a[212:215], v[0:3], v[192:195]
  ds_read_b128 a[236:239], v230 offset:4608
  v_max3_f32 v249, v249, v112, v113
  v_mfma_f32_16x16x32_bf16 v[140:143], a[212:215], v[4:7], v[196:199]
  v_max3_f32 v243, v243, v114, v115
  v_max3_f32 v249, v249, v116, v117
  v_mfma_f32_16x16x32_bf16 v[148:151], a[212:215], v[8:11], v[200:203]
  v_max3_f32 v243, v243, v118, v119
  v_max3_f32 v249, v249, v120, v121
  v_mfma_f32_16x16x32_bf16 v[156:159], a[212:215], v[12:15], v[204:207]
  s_waitcnt lgkmcnt(5)
  v_max3_f32 v243, v243, v122, v123
  v_mfma_f32_16x16x32_bf16 v[128:131], a[216:219], v[16:19], v[128:131]
  ds_read_b128 a[240:243], v229 offset:8192
  v_max3_f32 v249, v249, v124, v125
  v_mfma_f32_16x16x32_bf16 v[136:139], a[216:219], v[20:23], v[136:139]
  v_max3_f32 v243, v243, v126, v127
  v_max_f32 v243, v243, v249
  v_mfma_f32_16x16x32_bf16 v[144:147], a[216:219], v[24:27], v[144:147]
  v_cmp_lt_f32 vcc, s63, v243
  s_cbranch_vccnz L_sk2_far
L_sk2:
  v_mfma_f32_16x16x32_bf16 v[152:155], a[216:219], v[28:31], v[152:155]
  s_waitcnt lgkmcnt(5)
  v_exp_f32 v96, v96
  v_mfma_f32_16x16x32_bf16 v[132:135], a[220:223], v[16:19], v[132:135]
  ds_read_b128 a[244:247], v229 offset:8704
  v_mfma_f32_16x16x32_bf16 v[140:143], a[220:223], v[20:23], v[140:143]
  v_exp_f32 v97, v97
  v_mfma_f32_16x16x32_bf16 v[148:151], a[220:223], v[24:27], v[148:151]
  v_exp_f32 v98, v98
  v_mfma_f32_16x16x32_bf16 v[156:159], a[220:223], v[28:31], v[156:159]
  s_waitcnt lgkmcnt(5)
  v_cvt_pk_bf16_f32 v160, v96, v97
  v_mfma_f32_16x16x32_bf16 v[128:131], a[224:227], v[32:35], v[128:131]
  ds_read_b128 a[248:251], v230 offset:8192
  v_mfma_f32_16x16x32_bf16 v[136:139], a[224:227], v[36:39], v[136:139]
  s_add_u32 s57, s55, s72
  s_add_u32 m0, s57, 0
  v_mfma_f32_16x16x32_bf16 v[144:147], a[224:227], v[40:43], v[144:147]
  buffer_load_dwordx4 v222, s[12:15], s67 offen nt lds
  v_mfma_f32_16x16x32_bf16 v[152:155], a[224:227], v[44:47], v[152:155]
  s_waitcnt lgkmcnt(5)
  v_exp_f32 v99, v99
  v_mfma_f32_16x16x32_bf16 v[132:135], a[228:231], v[32:35], v[132:135]
  ds_read_b128 a[252:255], v230 offset:8704
  v_cvt_pk_bf16_f32 v161, v98, v99
  v_mfma_f32_16x16x32_bf16 v[140:143], a[228:231], v[36:39], v[140:143]
  v_exp_f32 v100, v100
  v_mfma_f32_16x16x32_bf16 v[148:151], a[228:231], v[40:43], v[148:151]
  v_exp_f32 v101, v101
  v_mfma_f32_16x16x32_bf16 v[156:159], a[228:231], v[44:47], v[156:159]
  s_waitcnt lgkmcnt(5)
  v_exp_f32 v102, v102
  v_mfma_f32_16x16x32_bf16 v[128:131], a[232:235], v[48:51], v[128:131]
  ds_read_b64_tr_b16 a[208:209], v228 offset:12288
  v_cvt_pk_bf16_f32 v162, v100, v101
  v_mfma_f32_16x16x32_bf16 v[136:139], a[232:235], v[52:55], v[136:139]
  ds_read_b64_tr_b16 a[210:211], v228 offset:13312
  s_add_u32 m0, s57, 0xf80
  v_mfma_f32_16x16x32_bf16 v[144:147], a[232:235], v[56:59], v[144:147]
  buffer_load_dwordx4 v222, s[12:15], s67 offen offset:128 nt lds
  v_mfma_f32_16x16x32_bf16 v[152:155], a[232:235], v[60:63], v[152:155]
  s_waitcnt lgkmcnt(6)
  v_exp_f32 v103, v103
  v_mfma_f32_16x16x32_bf16 v[132:135], a[236:239], v[48:51], v[132:135]
  ds_read_b64_tr_b16 a[212:213], v228 offset:12296
  v_cvt_pk_bf16_f32 v163, v102, v103
  v_mfma_f32_16x16x32_bf16 v[140:143], a[236:239], v[52:55], v[140:143]
  ds_read_b64_tr_b16 a[214:215], v228 offset:13320
  v_mfma_f32_16x16x32_bf16 v[148:151], a[236:239], v[56:59], v[148:151]
  v_exp_f32 v104, v104
  v_mfma_f32_16x16x32_bf16 v[156:159], a[236:239], v[60:63], v[156:159]
  s_waitcnt lgkmcnt(7)
  v_exp_f32 v105, v105
  v_mfma_f32_16x16x32_bf16 v[128:131], a[240:243], v[64:67], v[128:131]
  ds_read_b64_tr_b16 a[216:217], v228 offset:12544
  v_cvt_pk_bf16_f32 v164, v104, v105
  v_mfma_f32_16x16x32_bf16 v[136:139], a[240:243], v[68:71], v[136:139]
  ds_read_b64_tr_b16 a[218:219], v228 offset:13568
  s_add_u32 m0, s57, 0x1f00
  v_mfma_f32_16x16x32_bf16 v[144:147], a[240:243], v[72:75], v[144:147]
  buffer_load_dwordx4 v222, s[12:15], s67 offen offset:256 nt lds
  v_mfma_f32_16x16x32_bf16 v[152:155], a[240:243], v[76:79], v[152:155]
  s_waitcnt lgkmcnt(8)
  v_exp_f32 v106, v106
  v_mfma_f32_16x16x32_bf16 v[132:135], a[244:247], v[64:67], v[132:135]
  ds_read_b64_tr_b16 a[220:221], v228 offset:12552
  v_mfma_f32_16x16x32_bf16 v[140:143], a[244:247], v[68:71], v[140:143]
  ds_read_b64_tr_b16 a[222:223], v228 offset:13576
  v_mfma_f32_16x16x32_bf16 v[148:151], a[244:247], v[72:75], v[148:151]
  v_exp_f32 v107, v107
  v_mfma_f32_16x16x32_bf16 v[156:159], a[244:247], v[76:79], v[156:159]
  s_waitcnt lgkmcnt(9)
  v_exp_f32 v108, v108
  v_mfma_f32_16x16x32_bf16 v[128:131], a[248:251], v[80:83], v[128:131]
  ds_read_b64_tr_b16 a[224:225], v228 offset:12800
  v_cvt_pk_bf16_f32 v165, v106, v107
  v_mfma_f32_16x16x32_bf16 v[136:139], a[248:251], v[84:87], v[136:139]
  ds_read_b64_tr_b16 a[226:227], v228 offset:13824
  s_add_u32 s67, s67, 0x3000
  v_mfma_f32_16x16x32_bf16 v[144:147], a[248:251], v[88:91], v[144:147]
  v_exp_f32 v109, v109
  v_mfma_f32_16x16x32_bf16 v[152:155], a[248:251], v[92:95], v[152:155]
  s_waitcnt lgkmcnt(10)
  v_exp_f32 v110, v110
  v_mfma_f32_16x16x32_bf16 v[132:135], a[252:255], v[80:83], v[132:135]
  ds_read_b64_tr_b16 a[228:229], v228 offset:12808
  v_cvt_pk_bf16_f32 v166, v108, v109
  v_mfma_f32_16x16x32_bf16 v[140:143], a[252:255], v[84:87], v[140:143]
  ds_read_b64_tr_b16 a[230:231], v228 offset:13832
  v_mfma_f32_16x16x32_bf16 v[148:151], a[252:255], v[88:91], v[148:151]
  v_exp_f32 v111, v111
  v_mfma_f32_16x16x32_bf16 v[156:159], a[252:255], v[92:95], v[156:159]
  s_waitcnt lgkmcnt(10)
  v_exp_f32 v112, v112
  v_mfma_f32_16x16x32_bf16 a[0:3], a[208:211], v[176:179], a[0:3]
  ds_read_b64_tr_b16 a[232:233], v228 offset:13056
  v_cvt_pk_bf16_f32 v167, v110, v111
  v_mfma_f32_16x16x32_bf16 a[8:11], a[208:211], v[180:183], a[8:11]
  ds_read_b64_tr_b16 a[234:235], v228 offset:14080
  v_mfma_f32_16x16x32_bf16 a[16:19], a[208:211], v[184:187], a[16:19]
  s_add_u32 s57, s55, s73
  s_mov_b32 m0, s57
  v_mfma_f32_16x16x32_bf16 a[24:27], a[208:211], v[188:191], a[24:27]
  buffer_load_dwordx4 v223, s[16:19], s68 offen nt lds
  s_waitcnt lgkmcnt(10)
  v_mfma_f32_16x16x32_bf16 a[4:7], a[212:215], v[176:179], a[4:7]
  ds_read_b64_tr_b16 a[236:237], v228 offset:13064
  v_mfma_f32_16x16x32_bf16 a[12:15], a[212:215], v[180:183], a[12:15]
  ds_read_b64_tr_b16 a[238:239], v228 offset:14088
  v_mfma_f32_16x16x32_bf16 a[20:23], a[212:215], v[184:187], a[20:23]
  v_exp_f32 v113, v113
  v_mfma_f32_16x16x32_bf16 a[28:31], a[212:215], v[188:191], a[28:31]
  s_waitcnt lgkmcnt(10)
  v_exp_f32 v114, v114
  v_mfma_f32_16x16x32_bf16 a[32:35], a[216:219], v[176:179], a[32:35]
  ds_read_b64_tr_b16 a[240:241], v228 offset:14336
  v_cvt_pk_bf16_f32 v168, v112, v113
  v_mfma_f32_16x16x32_bf16 a[40:43], a[216:219], v[180:183], a[40:43]
  ds_read_b64_tr_b16 a[242:243], v228 offset:14848
  s_sub_u32 m0, s57, 0x200
  v_mfma_f32_16x16x32_bf16 a[48:51], a[216:219], v[184:187], a[48:51]
  buffer_load_dwordx4 v223, s[16:19], s68 offen offset:1536 nt lds
  v_mfma_f32_16x16x32_bf16 a[56:59], a[216:219], v[188:191], a[56:59]
  s_waitcnt lgkmcnt(10)
  v_exp_f32 v115, v115
  v_mfma_f32_16x16x32_bf16 a[36:39], a[220:223], v[176:179], a[36:39]
  ds_read_b64_tr_b16 a[244:245], v228 offset:14344
  v_cvt_pk_bf16_f32 v169, v114, v115
  v_mfma_f32_16x16x32_bf16 a[44:47], a[220:223], v[180:183], a[44:47]
  buffer_load_dwordx4 v[252:255], v245, s[28:31], s69 offen
  s_add_u32 s69, s69, 0x400
  v_mfma_f32_16x16x32_bf16 a[52:55], a[220:223], v[184:187], a[52:55]
  ds_read_b64_tr_b16 a[246:247], v228 offset:14856
  v_mfma_f32_16x16x32_bf16 a[60:63], a[220:223], v[188:191], a[60:63]
  s_waitcnt lgkmcnt(10)
  v_exp_f32 v116, v116
  v_mfma_f32_16x16x32_bf16 a[64:67], a[224:227], v[176:179], a[64:67]
  ds_read_b64_tr_b16 a[248:249], v228 offset:14592
  v_mfma_f32_16x16x32_bf16 a[72:75], a[224:227], v[180:183], a[72:75]
  ds_read_b64_tr_b16 a[250:251], v228 offset:15104
  s_add_u32 m0, s57, 0x800
  v_mfma_f32_16x16x32_bf16 a[80:83], a[224:227], v[184:187], a[80:83]
  buffer_load_dwordx4 v224, s[16:19], s68 offen nt lds
  v_mfma_f32_16x16x32_bf16 a[88:91], a[224:227], v[188:191], a[88:91]
  s_waitcnt lgkmcnt(10)
  v_exp_f32 v117, v117
  v_mfma_f32_16x16x32_bf16 a[68:71], a[228:231], v[176:179], a[68:71]
  ds_read_b64_tr_b16 a[252:253], v228 offset:14600
  v_cvt_pk_bf16_f32 v170, v116, v117
  v_mfma_f32_16x16x32_bf16 a[76:79], a[228:231], v[180:183], a[76:79]
  s_add_u32 s54, s54, 0x6080
  s_cmp_ge_u32 s54, 0x24300
  s_cselect_b32 s54, 0, s54
  v_mfma_f32_16x16x32_bf16 a[84:87], a[228:231], v[184:187], a[84:87]
  ds_read_b64_tr_b16 a[254:255], v228 offset:15112
  v_mfma_f32_16x16x32_bf16 a[92:95], a[228:231], v[188:191], a[92:95]
  s_waitcnt vmcnt(21)
  s_barrier
  s_waitcnt lgkmcnt(10)
  v_mfma_f32_16x16x32_bf16 a[96:99], a[232:235], v[176:179], a[96:99]
  v_add_u32 v229, s54, v226
  v_add_u32 v228, s54, v225
  v_xor_b32 v230, 64, v229
  v_mfma_f32_16x16x32_bf16 a[104:107], a[232:235], v[180:183], a[104:107]
  ds_read_b128 a[208:211], v229
  s_add_u32 s68, s68, 0x3000
  v_mfma_f32_16x16x32_bf16 a[112:115], a[232:235], v[184:187], a[112:115]
  v_exp_f32 v118, v118
  v_mfma_f32_16x16x32_bf16 a[120:123], a[232:235], v[188:191], a[120:123]
  s_waitcnt lgkmcnt(9)
  v_exp_f32 v119, v119
  v_mfma_f32_16x16x32_bf16 a[100:103], a[236:239], v[176:179], a[100:103]
  ds_read_b128 a[212:215], v229 offset:512
  v_cvt_pk_bf16_f32 v171, v118, v119
  v_mfma_f32_16x16x32_bf16 a[108:111], a[236:239], v[180:183], a[108:111]
  v_exp_f32 v120, v120
  v_mfma_f32_16x16x32_bf16 a[116:119], a[236:239], v[184:187], a[116:119]
  v_exp_f32 v121, v121
  v_mfma_f32_16x16x32_bf16 a[124:127], a[236:239], v[188:191], a[124:127]
  s_waitcnt lgkmcnt(8)
  v_exp_f32 v122, v122
  v_mfma_f32_16x16x32_bf16 a[128:131], a[240:243], v[176:179], a[128:131]
  ds_read_b128 a[216:219], v230
  v_cvt_pk_bf16_f32 v172, v120, v121
  v_mfma_f32_16x16x32_bf16 a[136:139], a[240:243], v[180:183], a[136:139]
  s_add_u32 s55, s55, 0x6080
  s_cmp_ge_u32 s55, 0x24300
  s_cselect_b32 s55, 0, s55
  v_mfma_f32_16x16x32_bf16 a[144:147], a[240:243], v[184:187], a[144:147]
  v_exp_f32 v123, v123
  v_mfma_f32_16x16x32_bf16 a[152:155], a[240:243], v[188:191], a[152:155]
  s_waitcnt lgkmcnt(7)
  v_exp_f32 v124, v124
  v_mfma_f32_16x16x32_bf16 a[132:135], a[244:247], v[176:179], a[132:135]
  ds_read_b128 a[220:223], v230 offset:512
  v_cvt_pk_bf16_f32 v173, v122, v123
  v_mfma_f32_16x16x32_bf16 a[140:143], a[244:247], v[180:183], a[140:143]
  v_exp_f32 v125, v125
  v_mfma_f32_16x16x32_bf16 a[148:151], a[244:247], v[184:187], a[148:151]
  v_exp_f32 v126, v126
  v_mfma_f32_16x16x32_bf16 a[156:159], a[244:247], v[188:191], a[156:159]
  s_waitcnt lgkmcnt(6)
  v_cvt_pk_bf16_f32 v174, v124, v125
  v_mfma_f32_16x16x32_bf16 a[160:163], a[248:251], v[176:179], a[160:163]
  ds_read_b128 a[224:227], v229 offset:4096
  v_mfma_f32_16x16x32_bf16 a[168:171], a[248:251], v[180:183], a[168:171]
  v_exp_f32 v127, v127
  v_mfma_f32_16x16x32_bf16 a[176:179], a[248:251], v[184:187], a[176:179]
  v_cvt_pk_bf16_f32 v175, v126, v127
  v_mfma_f32_16x16x32_bf16 a[184:187], a[248:251], v[188:191], a[184:187]
  s_waitcnt lgkmcnt(5)
  v_mfma_f32_16x16x32_bf16 a[164:167], a[252:255], v[176:179], a[164:167]
  ds_read_b128 a[228:231], v229 offset:4608
  v_mfma_f32_16x16x32_bf16 a[172:175], a[252:255], v[180:183], a[172:175]
  v_mfma_f32_16x16x32_bf16 a[180:183], a[252:255], v[184:187], a[180:183]
  v_mfma_f32_16x16x32_bf16 a[188:191], a[252:255], v[188:191], a[188:191]
  v_mfma_f32_16x16x32_bf16 a[192:195], v[208:211], v[176:179], a[192:195]
  v_mfma_f32_16x16x32_bf16 a[196:199], v[208:211], v[180:183], a[196:199]
  v_mfma_f32_16x16x32_bf16 a[200:203], v[208:211], v[184:187], a[200:203]
  v_mfma_f32_16x16x32_bf16 a[204:207], v[208:211], v[188:191], a[204:207]
  s_cmp_lg_u32 s66, 0
  s_cbranch_scc1 L_rs3_far
L_rs3:
  s_waitcnt lgkmcnt(5)
  v_mfma_f32_16x16x32_bf16 v[96:99], a[208:211], v[0:3], v[192:195]
  ds_read_b128 a[232:235], v230 offset:4096
  v_max3_f32 v243, v128, v129, v130
  v_mfma_f32_16x16x32_bf16 v[104:107], a[208:211], v[4:7], v[196:199]
  v_max3_f32 v249, v131, v132, v133
  v_max3_f32 v243, v243, v134, v135
  v_mfma_f32_16x16x32_bf16 v[112:115], a[208:211], v[8:11], v[200:203]
  v_max3_f32 v249, v249, v136, v137
  v_max3_f32 v243, v243, v138, v139
  v_mfma_f32_16x16x32_bf16 v[120:123], a[208:211], v[12:15], v[204:207]
  s_waitcnt lgkmcnt(5)
  v_max3_f32 v249, v249, v140, v141
  v_max3_f32 v243, v243, v142, v143
  v_mfma_f32_16x16x32_bf16 v[100:103], a[212:215], v[0:3], v[192:195]
  ds_read_b128 a[236:239], v230 offset:4608
  v_max3_f32 v249, v249, v144, v145
  v_mfma_f32_16x16x32_bf16 v[108:111], a[212:215], v[4:7], v[196:199]
  v_max3_f32 v243, v243, v146, v147
  v_max3_f32 v249, v249, v148, v149
  v_mfma_f32_16x16x32_bf16 v[116:119], a[212:215], v[8:11], v[200:203]
  v_max3_f32 v243, v243, v150, v151
  v_max3_f32 v249, v249, v152, v153
  v_mfma_f32_16x16x32_bf16 v[124:127], a[212:215], v[12:15], v[204:207]
  s_waitcnt lgkmcnt(5)
  v_max3_f32 v243, v243, v154, v155
  v_mfma_f32_16x16x32_bf16 v[96:99], a[216:219], v[16:19], v[96:99]
  ds_read_b128 a[240:243], v229 offset:8192
  v_max3_f32 v249, v249, v156, v157
  v_mfma_f32_16x16x32_bf16 v[104:107], a[216:219], v[20:23], v[104:107]
  v_max3_f32 v243, v243, v158, v159
  v_max_f32 v243, v243, v249
  v_mfma_f32_16x16x32_bf16 v[112:115], a[216:219], v[24:27], v[112:115]
  v_cmp_lt_f32 vcc, s63, v243
  s_cbranch_vccnz L_sk4_far
L_sk4:
  v_mfma_f32_16x16x32_bf16 v[120:123], a[216:219], v[28:31], v[120:123]
  s_waitcnt lgkmcnt(5)
  v_exp_f32 v128, v128
  v_mfma_f32_16x16x32_bf16 v[100:103], a[220:223], v[16:19], v[100:103]
  ds_read_b128 a[244:247], v229 offset:8704
  v_mfma_f32_16x16x32_bf16 v[108:111], a[220:223], v[20:23], v[108:111]
  v_exp_f32 v129, v129
  v_mfma_f32_16x16x32_bf16 v[116:119], a[220:223], v[24:27], v[116:119]
  v_exp_f32 v130, v130
  v_mfma_f32_16x16x32_bf16 v[124:127], a[220:223], v[28:31], v[124:127]
  s_waitcnt lgkmcnt(5)
  v_cvt_pk_bf16_f32 v176, v128, v129
  v_mfma_f32_16x16x32_bf16 v[96:99], a[224:227], v[32:35], v[96:99]
  ds_read_b128 a[248:251], v230 offset:8192
  v_mfma_f32_16x16x32_bf16 v[104:107], a[224:227], v[36:39], v[104:107]
  s_add_u32 s57, s55, s72
  s_add_u32 m0, s57, 0
  v_mfma_f32_16x16x32_bf16 v[112:115], a[224:227], v[40:43], v[112:115]
  buffer_load_dwordx4 v222, s[12:15], s67 offen nt lds
  v_mfma_f32_16x16x32_bf16 v[120:123], a[224:227], v[44:47], v[120:123]
  s_waitcnt lgkmcnt(5)
  v_exp_f32 v131, v131
  v_mfma_f32_16x16x32_bf16 v[100:103], a[228:231], v[32:35], v[100:103]
  ds_read_b128 a[252:255], v230 offset:8704
  v_cvt_pk_bf16_f32 v177, v130, v131
  v_mfma_f32_16x16x32_bf16 v[108:111], a[228:231], v[36:39], v[108:111]
  v_exp_f32 v132, v132
  v_mfma_f32_16x16x32_bf16 v[116:119], a[228:231], v[40:43], v[116:119]
  v_exp_f32 v133, v133
  v_mfma_f32_16x16x32_bf16 v[124:127], a[228:231], v[44:47], v[124:127]
  s_waitcnt lgkmcnt(5)
  v_exp_f32 v134, v134
  v_mfma_f32_16x16x32_bf16 v[96:99], a[232:235], v[48:51], v[96:99]
  ds_read_b64_tr_b16 a[208:209], v228 offset:12288
  v_cvt_pk_bf16_f32 v178, v132, v133
  v_mfma_f32_16x16x32_bf16 v[104:107], a[232:235], v[52:55], v[104:107]
  ds_read_b64_tr_b16 a[210:211], v228 offset:13312
  s_add_u32 m0, s57, 0xf80
  v_mfma_f32_16x16x32_bf16 v[112:115], a[232:235], v[56:59], v[112:115]
  buffer_load_dwordx4 v222, s[12:15], s67 offen offset:128 nt lds
  v_mfma_f32_16x16x32_bf16 v[120:123], a[232:235], v[60:63], v[120:123]
  s_waitcnt lgkmcnt(6)
  v_exp_f32 v135, v135
  v_mfma_f32_16x16x32_bf16 v[100:103], a[236:239], v[48:51], v[100:103]
  ds_read_b64_tr_b16 a[212:213], v228 offset:12296
  v_cvt_pk_bf16_f32 v179, v134, v135
  v_mfma_f32_16x16x32_bf16 v[108:111], a[236:239], v[52:55], v[108:111]
  ds_read_b64_tr_b16 a[214:215], v228 offset:13320
  v_mfma_f32_16x16x32_bf16 v[116:119], a[236:239], v[56:59], v[116:119]
  v_exp_f32 v136, v136
  v_mfma_f32_16x16x32_bf16 v[124:127], a[236:239], v[60:63], v[124:127]
  s_waitcnt lgkmcnt(7)
  v_exp_f32 v137, v137
  v_mfma_f32_16x16x32_bf16 v[96:99], a[240:243], v[64:67], v[96:99]
  ds_read_b64_tr_b16 a[216:217], v228 offset:12544
  v_cvt_pk_bf16_f32 v180, v136, v137
  v_mfma_f32_16x16x32_bf16 v[104:107], a[240:243], v[68:71], v[104:107]
  ds_read_b64_tr_b16 a[218:219], v228 offset:13568
  s_add_u32 m0, s57, 0x1f00
  v_mfma_f32_16x16x32_bf16 v[112:115], a[240:243], v[72:75], v[112:115]
  buffer_load_dwordx4 v222, s[12:15], s67 offen offset:256 nt lds
  v_mfma_f32_16x16x32_bf16 v[120:123], a[240:243], v[76:79], v[120:123]
  s_waitcnt lgkmcnt(8)
  v_exp_f32 v138, v138
  v_mfma_f32_16x16x32_bf16 v[100:103], a[244:247], v[64:67], v[100:103]
  ds_read_b64_tr_b16 a[220:221], v228 offset:12552
  v_mfma_f32_16x16x32_bf16 v[108:111], a[244:247], v[68:71], v[108:111]
  ds_read_b64_tr_b16 a[222:223], v228 offset:13576
  v_mfma_f32_16x16x32_bf16 v[116:119], a[244:247], v[72:75], v[116:119]
  v_exp_f32 v139, v139
  v_mfma_f32_16x16x32_bf16 v[124:127], a[244:247], v[76:79], v[124:127]
  s_waitcnt lgkmcnt(9)
  v_exp_f32 v140, v140
  v_mfma_f32_16x16x32_bf16 v[96:99], a[248:251], v[80:83], v[96:99]
  ds_read_b64_tr_b16 a[224:225], v228 offset:12800
  v_cvt_pk_bf16_f32 v181, v138, v139
  v_mfma_f32_16x16x32_bf16 v[104:107], a[248:251], v[84:87], v[104:107]
  ds_read_b64_tr_b16 a[226:227], v228 offset:13824
  s_add_u32 s67, s67, 0x3000
  v_mfma_f32_16x16x32_bf16 v[112:115], a[248:251], v[88:91], v[112:115]
  v_exp_f32 v141, v141
  v_mfma_f32_16x16x32_bf16 v[120:123], a[248:251], v[92:95], v[120:123]
  s_waitcnt lgkmcnt(10)
  v_exp_f32 v142, v142
  v_mfma_f32_16x16x32_bf16 v[100:103], a[252:255], v[80:83], v[100:103]
  ds_read_b64_tr_b16 a[228:229], v228 offset:12808
  v_cvt_pk_bf16_f32 v182, v140, v141
  v_mfma_f32_16x16x32_bf16 v[108:111], a[252:255], v[84:87], v[108:111]
  ds_read_b64_tr_b16 a[230:231], v228 offset:13832
  v_mfma_f32_16x16x32_bf16 v[116:119], a[252:255], v[88:91], v[116:119]
  v_exp_f32 v143, v143
  v_mfma_f32_16x16x32_bf16 v[124:127], a[252:255], v[92:95], v[124:127]
  s_waitcnt lgkmcnt(10)
  v_exp_f32 v144, v144
  v_mfma_f32_16x16x32_bf16 a[0:3], a[208:211], v[160:163], a[0:3]
  ds_read_b64_tr_b16 a[232:233], v228 offset:13056
  v_cvt_pk_bf16_f32 v183, v142, v143
  v_mfma_f32_16x16x32_bf16 a[8:11], a[208:211], v[164:167], a[8:11]
  ds_read_b64_tr_b16 a[234:235], v228 offset:14080
  v_mfma_f32_16x16x32_bf16 a[16:19], a[208:211], v[168:171], a[16:19]
  s_add_u32 s57, s55, s73
  s_mov_b32 m0, s57
  v_mfma_f32_16x16x32_bf16 a[24:27], a[208:211], v[172:175], a[24:27]
  buffer_load_dwordx4 v223, s[16:19], s68 offen nt lds
  s_waitcnt lgkmcnt(10)
  v_mfma_f32_16x16x32_bf16 a[4:7], a[212:215], v[160:163], a[4:7]
  ds_read_b64_tr_b16 a[236:237], v228 offset:13064
  v_mfma_f32_16x16x32_bf16 a[12:15], a[212:215], v[164:167], a[12:15]
  ds_read_b64_tr_b16 a[238:239], v228 offset:14088
  v_mfma_f32_16x16x32_bf16 a[20:23], a[212:215], v[168:171], a[20:23]
  v_exp_f32 v145, v145
  v_mfma_f32_16x16x32_bf16 a[28:31], a[212:215], v[172:175], a[28:31]
  s_waitcnt lgkmcnt(10)
  v_exp_f32 v146, v146
  v_mfma_f32_16x16x32_bf16 a[32:35], a[216:219], v[160:163], a[32:35]
  ds_read_b64_tr_b16 a[240:241], v228 offset:14336
  v_cvt_pk_bf16_f32 v184, v144, v145
  v_mfma_f32_16x16x32_bf16 a[40:43], a[216:219], v[164:167], a[40:43]
  ds_read_b64_tr_b16 a[242:243], v228 offset:14848
  s_sub_u32 m0, s57, 0x200
  v_mfma_f32_16x16x32_bf16 a[48:51], a[216:219], v[168:171], a[48:51]
  buffer_load_dwordx4 v223, s[16:19], s68 offen offset:1536 nt lds
  v_mfma_f32_16x16x32_bf16 a[56:59], a[216:219], v[172:175], a[56:59]
  s_waitcnt lgkmcnt(10)
  v_exp_f32 v147, v147
  v_mfma_f32_16x16x32_bf16 a[36:39], a[220:223], v[160:163], a[36:39]
  ds_read_b64_tr_b16 a[244:245], v228 offset:14344
  v_cvt_pk_bf16_f32 v185, v146, v147
  v_mfma_f32_16x16x32_bf16 a[44:47], a[220:223], v[164:167], a[44:47]
  buffer_load_dwordx4 v[252:255], v245, s[28:31], s69 offen
  s_add_u32 s69, s69, 0x400
  v_mfma_f32_16x16x32_bf16 a[52:55], a[220:223], v[168:171], a[52:55]
  ds_read_b64_tr_b16 a[246:247], v228 offset:14856
  v_mfma_f32_16x16x32_bf16 a[60:63], a[220:223], v[172:175], a[60:63]
  s_waitcnt lgkmcnt(10)
  v_exp_f32 v148, v148
  v_mfma_f32_16x16x32_bf16 a[64:67], a[224:227], v[160:163], a[64:67]
  ds_read_b64_tr_b16 a[248:249], v228 offset:14592
  v_mfma_f32_16x16x32_bf16 a[72:75], a[224:227], v[164:167], a[72:75]
  ds_read_b64_tr_b16 a[250:251], v228 offset:15104
  s_add_u32 m0, s57, 0x800
  v_mfma_f32_16x16x32_bf16 a[80:83], a[224:227], v[168:171], a[80:83]
  buffer_load_dwordx4 v224, s[16:19], s68 offen nt lds
  v_mfma_f32_16x16x32_bf16 a[88:91], a[224:227], v[172:175], a[88:91]
  s_waitcnt lgkmcnt(10)
  v_exp_f32 v149, v149
  v_mfma_f32_16x16x32_bf16 a[68:71], a[228:231], v[160:163], a[68:71]
  ds_read_b64_tr_b16 a[252:253], v228 offset:14600
  v_cvt_pk_bf16_f32 v186, v148, v149
  v_mfma_f32_16x16x32_bf16 a[76:79], a[228:231], v[164:167], a[76:79]
  s_add_u32 s54, s54, 0x6080
  s_cmp_ge_u32 s54, 0x24300
  s_cselect_b32 s54, 0, s54
  v_mfma_f32_16x16x32_bf16 a[84:87], a[228:231], v[168:171], a[84:87]
  ds_read_b64_tr_b16 a[254:255], v228 offset:15112
  v_mfma_f32_16x16x32_bf16 a[92:95], a[228:231], v[172:175], a[92:95]
  s_waitcnt vmcnt(21)
  s_barrier
  s_waitcnt lgkmcnt(10)
  v_mfma_f32_16x16x32_bf16 a[96:99], a[232:235], v[160:163], a[96:99]
  v_add_u32 v229, s54, v226
  v_add_u32 v228, s54, v225
  v_xor_b32 v230, 64, v229
  v_mfma_f32_16x16x32_bf16 a[104:107], a[232:235], v[164:167], a[104:107]
  ds_read_b128 a[208:211], v229
  s_add_u32 s68, s68, 0x3000
  v_mfma_f32_16x16x32_bf16 a[112:115], a[232:235], v[168:171], a[112:115]
  v_exp_f32 v150, v150
  v_mfma_f32_16x16x32_bf16 a[120:123], a[232:235], v[172:175], a[120:123]
  s_waitcnt lgkmcnt(9)
  v_exp_f32 v151, v151
  v_mfma_f32_16x16x32_bf16 a[100:103], a[236:239], v[160:163], a[100:103]
  ds_read_b128 a[212:215], v229 offset:512
  v_cvt_pk_bf16_f32 v187, v150, v151
  v_mfma_f32_16x16x32_bf16 a[108:111], a[236:239], v[164:167], a[108:111]
  v_exp_f32 v152, v152
  v_mfma_f32_16x16x32_bf16 a[116:119], a[236:239], v[168:171], a[116:119]
  v_exp_f32 v153, v153
  v_mfma_f32_16x16x32_bf16 a[124:127], a[236:239], v[172:175], a[124:127]
  s_waitcnt lgkmcnt(8)
  v_exp_f32 v154, v154
  v_mfma_f32_16x16x32_bf16 a[128:131], a[240:243], v[160:163], a[128:131]
  ds_read_b128 a[216:219], v230
  v_cvt_pk_bf16_f32 v188, v152, v153
  v_mfma_f32_16x16x32_bf16 a[136:139], a[240:243], v[164:167], a[136:139]
  s_add_u32 s55, s55, 0x6080
  s_cmp_ge_u32 s55, 0x24300
  s_cselect_b32 s55, 0, s55
  v_mfma_f32_16x16x32_bf16 a[144:147], a[240:243], v[168:171], a[144:147]
  v_exp_f32 v155, v155
  v_mfma_f32_16x16x32_bf16 a[152:155], a[240:243], v[172:175], a[152:155]
  s_waitcnt lgkmcnt(7)
  v_exp_f32 v156, v156
  v_mfma_f32_16x16x32_bf16 a[132:135], a[244:247], v[160:163], a[132:135]
  ds_read_b128 a[220:223], v230 offset:512
  v_cvt_pk_bf16_f32 v189, v154, v155
  v_mfma_f32_16x16x32_bf16 a[140:143], a[244:247], v[164:167], a[140:143]
  v_exp_f32 v157, v157
  v_mfma_f32_16x16x32_bf16 a[148:151], a[244:247], v[168:171], a[148:151]
  v_exp_f32 v158, v158
  v_mfma_f32_16x16x32_bf16 a[156:159], a[244:247], v[172:175], a[156:159]
  s_waitcnt lgkmcnt(6)
  v_cvt_pk_bf16_f32 v190, v156, v157
  v_mfma_f32_16x16x32_bf16 a[160:163], a[248:251], v[160:163], a[160:163]
  ds_read_b128 a[224:227], v229 offset:4096
  v_mfma_f32_16x16x32_bf16 a[168:171], a[248:251], v[164:167], a[168:171]
  v_exp_f32 v159, v159
  v_mfma_f32_16x16x32_bf16 a[176:179], a[248:251], v[168:171], a[176:179]
  v_cvt_pk_bf16_f32 v191, v158, v159
  v_mfma_f32_16x16x32_bf16 a[184:187], a[248:251], v[172:175], a[184:187]
  s_waitcnt lgkmcnt(5)
  v_mfma_f32_16x16x32_bf16 a[164:167], a[252:255], v[160:163], a[164:167]
  ds_read_b128 a[228:231], v229 offset:4608
  v_mfma_f32_16x16x32_bf16 a[172:175], a[252:255], v[164:167], a[172:175]
  v_mfma_f32_16x16x32_bf16 a[180:183], a[252:255], v[168:171], a[180:183]
  v_mfma_f32_16x16x32_bf16 a[188:191], a[252:255], v[172:175], a[188:191]
  v_mfma_f32_16x16x32_bf16 a[192:195], v[208:211], v[160:163], a[192:195]
  v_mfma_f32_16x16x32_bf16 a[196:199], v[208:211], v[164:167], a[196:199]
  v_mfma_f32_16x16x32_bf16 a[200:203], v[208:211], v[168:171], a[200:203]
  v_mfma_f32_16x16x32_bf16 a[204:207], v[208:211], v[172:175], a[204:207]
  s_cmp_lg_u32 s66, 0
  s_cbranch_scc1 L_rs5_far
L_rs5:
  s_sub_u32 s56, s56, 1
  s_cmp_lg_u32 s56, 0
  s_cbranch_scc1 L_att
  s_waitcnt lgkmcnt(5)
  v_mfma_f32_16x16x32_bf16 v[128:131], a[208:211], v[0:3], v[192:195]
  ds_read_b128 a[232:235], v230 offset:4096
  v_max3_f32 v243, v96, v97, v98
  v_mfma_f32_16x16x32_bf16 v[136:139], a[208:211], v[4:7], v[196:199]
  v_max3_f32 v249, v99, v100, v101
  v_max3_f32 v243, v243, v102, v103
  v_mfma_f32_16x16x32_bf16 v[144:147], a[208:211], v[8:11], v[200:203]
  v_max3_f32 v249, v249, v104, v105
  v_max3_f32 v243, v243, v106, v107
  v_mfma_f32_16x16x32_bf16 v[152:155], a[208:211], v[12:15], v[204:207]
  s_waitcnt lgkmcnt(5)
  v_max3_f32 v249, v249, v108, v109
  v_max3_f32 v243, v243, v110, v111
  v_mfma_f32_16x16x32_bf16 v[132:135], a[212:215], v[0:3], v[192:195]
  ds_read_b128 a[236:239], v230 offset:4608
  v_max3_f32 v249, v249, v112, v113
  v_mfma_f32_16x16x32_bf16 v[140:143], a[212:215], v[4:7], v[196:199]
  v_max3_f32 v243, v243, v114, v115
  v_max3_f32 v249, v249, v116, v117
  v_mfma_f32_16x16x32_bf16 v[148:151], a[212:215], v[8:11], v[200:203]
  v_max3_f32 v243, v243, v118, v119
  v_max3_f32 v249, v249, v120, v121
  v_mfma_f32_16x16x32_bf16 v[156:159], a[212:215], v[12:15], v[204:207]
  s_waitcnt lgkmcnt(5)
  v_max3_f32 v243, v243, v122, v123
  v_mfma_f32_16x16x32_bf16 v[128:131], a[216:219], v[16:19], v[128:131]
  ds_read_b128 a[240:243], v229 offset:8192
  v_max3_f32 v249, v249, v124, v125
  v_mfma_f32_16x16x32_bf16 v[136:139], a[216:219], v[20:23], v[136:139]
  v_max3_f32 v243, v243, v126, v127
  v_max_f32 v243, v243, v249
  v_mfma_f32_16x16x32_bf16 v[144:147], a[216:219], v[24:27], v[144:147]
  v_cmp_lt_f32 vcc, s63, v243
  s_cbranch_vccnz L_sk6_far
L_sk6:
  v_mfma_f32_16x16x32_bf16 v[152:155], a[216:219], v[28:31], v[152:155]
  s_waitcnt lgkmcnt(5)
  v_exp_f32 v96, v96
  v_mfma_f32_16x16x32_bf16 v[132:135], a[220:223], v[16:19], v[132:135]
  ds_read_b128 a[244:247], v229 offset:8704
  v_mfma_f32_16x16x32_bf16 v[140:143], a[220:223], v[20:23], v[140:143]
  v_exp_f32 v97, v97
  v_mfma_f32_16x16x32_bf16 v[148:151], a[220:223], v[24:27], v[148:151]
  v_exp_f32 v98, v98
  v_mfma_f32_16x16x32_bf16 v[156:159], a[220:223], v[28:31], v[156:159]
  s_waitcnt lgkmcnt(5)
  v_cvt_pk_bf16_f32 v160, v96, v97
  v_mfma_f32_16x16x32_bf16 v[128:131], a[224:227], v[32:35], v[128:131]
  ds_read_b128 a[248:251], v230 offset:8192
  v_mfma_f32_16x16x32_bf16 v[136:139], a[224:227], v[36:39], v[136:139]
  s_add_u32 s57, s55, s73
  s_mov_b32 m0, s57
  v_mfma_f32_16x16x32_bf16 v[144:147], a[224:227], v[40:43], v[144:147]
  buffer_load_dwordx4 v223, s[16:19], s68 offen nt lds
  v_mfma_f32_16x16x32_bf16 v[152:155], a[224:227], v[44:47], v[152:155]
  s_waitcnt lgkmcnt(5)
  v_exp_f32 v99, v99
  v_mfma_f32_16x16x32_bf16 v[132:135], a[228:231], v[32:35], v[132:135]
  ds_read_b128 a[252:255], v230 offset:8704
  v_cvt_pk_bf16_f32 v161, v98, v99
  v_mfma_f32_16x16x32_bf16 v[140:143], a[228:231], v[36:39], v[140:143]
  v_exp_f32 v100, v100
  v_mfma_f32_16x16x32_bf16 v[148:151], a[228:231], v[40:43], v[148:151]
  v_exp_f32 v101, v101
  v_mfma_f32_16x16x32_bf16 v[156:159], a[228:231], v[44:47], v[156:159]
  s_waitcnt lgkmcnt(5)
  v_exp_f32 v102, v102
  v_mfma_f32_16x16x32_bf16 v[128:131], a[232:235], v[48:51], v[128:131]
  ds_read_b64_tr_b16 a[208:209], v228 offset:12288
  v_cvt_pk_bf16_f32 v162, v100, v101
  v_mfma_f32_16x16x32_bf16 v[136:139], a[232:235], v[52:55], v[136:139]
  ds_read_b64_tr_b16 a[210:211], v228 offset:13312
  v_mfma_f32_16x16x32_bf16 v[144:147], a[232:235], v[56:59], v[144:147]
  v_exp_f32 v103, v103
  v_mfma_f32_16x16x32_bf16 v[152:155], a[232:235], v[60:63], v[152:155]
  s_waitcnt lgkmcnt(6)
  v_exp_f32 v104, v104
  v_mfma_f32_16x16x32_bf16 v[132:135], a[236:239], v[48:51], v[132:135]
  ds_read_b64_tr_b16 a[212:213], v228 offset:12296
  v_cvt_pk_bf16_f32 v163, v102, v103
  v_mfma_f32_16x16x32_bf16 v[140:143], a[236:239], v[52:55], v[140:143]
  ds_read_b64_tr_b16 a[214:215], v228 offset:13320
  s_sub_u32 m0, s57, 0x200
  v_mfma_f32_16x16x32_bf16 v[148:151], a[236:239], v[56:59], v[148:151]
  buffer_load_dwordx4 v223, s[16:19], s68 offen offset:1536 nt lds
  v_mfma_f32_16x16x32_bf16 v[156:159], a[236:239], v[60:63], v[156:159]
  s_waitcnt lgkmcnt(7)
  v_exp_f32 v105, v105
  v_mfma_f32_16x16x32_bf16 v[128:131], a[240:243], v[64:67], v[128:131]
  ds_read_b64_tr_b16 a[216:217], v228 offset:12544
  v_cvt_pk_bf16_f32 v164, v104, v105
  v_mfma_f32_16x16x32_bf16 v[136:139], a[240:243], v[68:71], v[136:139]
  ds_read_b64_tr_b16 a[218:219], v228 offset:13568
  v_mfma_f32_16x16x32_bf16 v[144:147], a[240:243], v[72:75], v[144:147]
  v_exp_f32 v106, v106
  v_mfma_f32_16x16x32_bf16 v[152:155], a[240:243], v[76:79], v[152:155]
  s_waitcnt lgkmcnt(8)
  v_exp_f32 v107, v107
  v_mfma_f32_16x16x32_bf16 v[132:135], a[244:247], v[64:67], v[132:135]
  ds_read_b64_tr_b16 a[220:221], v228 offset:12552
  v_cvt_pk_bf16_f32 v165, v106, v107
  v_mfma_f32_16x16x32_bf16 v[140:143], a[244:247], v[68:71], v[140:143]
  ds_read_b64_tr_b16 a[222:223], v228 offset:13576
  v_mfma_f32_16x16x32_bf16 v[148:151], a[244:247], v[72:75], v[148:151]
  v_exp_f32 v108, v108
  v_mfma_f32_16x16x32_bf16 v[156:159], a[244:247], v[76:79], v[156:159]
  s_waitcnt lgkmcnt(9)
  v_exp_f32 v109, v109
  v_mfma_f32_16x16x32_bf16 v[128:131], a[248:251], v[80:83], v[128:131]
  ds_read_b64_tr_b16 a[224:225], v228 offset:12800
  v_cvt_pk_bf16_f32 v166, v108, v109
  v_mfma_f32_16x16x32_bf16 v[136:139], a[248:251], v[84:87], v[136:139]
  ds_read_b64_tr_b16 a[226:227], v228 offset:13824
  s_add_u32 m0, s57, 0x800
  v_mfma_f32_16x16x32_bf16 v[144:147], a[248:251], v[88:91], v[144:147]
  buffer_load_dwordx4 v224, s[16:19], s68 offen nt lds
  v_mfma_f32_16x16x32_bf16 v[152:155], a[248:251], v[92:95], v[152:155]
  s_waitcnt lgkmcnt(10)
  v_exp_f32 v110, v110
  v_mfma_f32_16x16x32_bf16 v[132:135], a[252:255], v[80:83], v[132:135]
  ds_read_b64_tr_b16 a[228:229], v228 offset:12808
  v_mfma_f32_16x16x32_bf16 v[140:143], a[252:255], v[84:87], v[140:143]
  ds_read_b64_tr_b16 a[230:231], v228 offset:13832
  v_mfma_f32_16x16x32_bf16 v[148:151], a[252:255], v[88:91], v[148:151]
  v_exp_f32 v111, v111
  v_mfma_f32_16x16x32_bf16 v[156:159], a[252:255], v[92:95], v[156:159]
  s_waitcnt lgkmcnt(10)
  v_exp_f32 v112, v112
  v_mfma_f32_16x16x32_bf16 a[0:3], a[208:211], v[176:179], a[0:3]
  ds_read_b64_tr_b16 a[232:233], v228 offset:13056
  v_cvt_pk_bf16_f32 v167, v110, v111
  v_mfma_f32_16x16x32_bf16 a[8:11], a[208:211], v[180:183], a[8:11]
  ds_read_b64_tr_b16 a[234:235], v228 offset:14080
  v_mfma_f32_16x16x32_bf16 a[16:19], a[208:211], v[184:187], a[16:19]
  v_exp_f32 v113, v113
  v_mfma_f32_16x16x32_bf16 a[24:27], a[208:211], v[188:191], a[24:27]
  s_waitcnt lgkmcnt(10)
  v_exp_f32 v114, v114
  v_mfma_f32_16x16x32_bf16 a[4:7], a[212:215], v[176:179], a[4:7]
  ds_read_b64_tr_b16 a[236:237], v228 offset:13064
  v_cvt_pk_bf16_f32 v168, v112, v113
  v_mfma_f32_16x16x32_bf16 a[12:15], a[212:215], v[180:183], a[12:15]
  ds_read_b64_tr_b16 a[238:239], v228 offset:14088
  s_add_u32 s68, s68, 0x3000
  v_mfma_f32_16x16x32_bf16 a[20:23], a[212:215], v[184:187], a[20:23]
  v_exp_f32 v115, v115
  v_mfma_f32_16x16x32_bf16 a[28:31], a[212:215], v[188:191], a[28:31]
  s_waitcnt lgkmcnt(10)
  v_exp_f32 v116, v116
  v_mfma_f32_16x16x32_bf16 a[32:35], a[216:219], v[176:179], a[32:35]
  ds_read_b64_tr_b16 a[240:241], v228 offset:14336
  v_cvt_pk_bf16_f32 v169, v114, v115
  v_mfma_f32_16x16x32_bf16 a[40:43], a[216:219], v[180:183], a[40:43]
  ds_read_b64_tr_b16 a[242:243], v228 offset:14848
  v_mfma_f32_16x16x32_bf16 a[48:51], a[216:219], v[184:187], a[48:51]
  v_exp_f32 v117, v117
  v_mfma_f32_16x16x32_bf16 a[56:59], a[216:219], v[188:191], a[56:59]
  s_waitcnt lgkmcnt(10)
  v_exp_f32 v118, v118
  v_mfma_f32_16x16x32_bf16 a[36:39], a[220:223], v[176:179], a[36:39]
  ds_read_b64_tr_b16 a[244:245], v228 offset:14344
  v_cvt_pk_bf16_f32 v170, v116, v117
  v_mfma_f32_16x16x32_bf16 a[44:47], a[220:223], v[180:183], a[44:47]
  ds_read_b64_tr_b16 a[246:247], v228 offset:14856
  v_mfma_f32_16x16x32_bf16 a[52:55], a[220:223], v[184:187], a[52:55]
  v_exp_f32 v119, v119
  v_mfma_f32_16x16x32_bf16 a[60:63], a[220:223], v[188:191], a[60:63]
  s_waitcnt lgkmcnt(10)
  v_exp_f32 v120, v120
  v_mfma_f32_16x16x32_bf16 a[64:67], a[224:227], v[176:179], a[64:67]
  ds_read_b64_tr_b16 a[248:249], v228 offset:14592
  v_cvt_pk_bf16_f32 v171, v118, v119
  v_mfma_f32_16x16x32_bf16 a[72:75], a[224:227], v[180:183], a[72:75]
  ds_read_b64_tr_b16 a[250:251], v228 offset:15104
  v_mfma_f32_16x16x32_bf16 a[80:83], a[224:227], v[184:187], a[80:83]
  s_add_u32 s55, s55, 0x6080
  s_cmp_ge_u32 s55, 0x24300
  s_cselect_b32 s55, 0, s55
  v_mfma_f32_16x16x32_bf16 a[88:91], a[224:227], v[188:191], a[88:91]
  s_waitcnt lgkmcnt(10)
  v_exp_f32 v121, v121
  v_mfma_f32_16x16x32_bf16 a[68:71], a[228:231], v[176:179], a[68:71]
  ds_read_b64_tr_b16 a[252:253], v228 offset:14600
  v_cvt_pk_bf16_f32 v172, v120, v121
  v_mfma_f32_16x16x32_bf16 a[76:79], a[228:231], v[180:183], a[76:79]
  s_add_u32 s54, s54, 0x6080
  s_cmp_ge_u32 s54, 0x24300
  s_cselect_b32 s54, 0, s54
  v_mfma_f32_16x16x32_bf16 a[84:87], a[228:231], v[184:187], a[84:87]
  ds_read_b64_tr_b16 a[254:255], v228 offset:15112
  v_mfma_f32_16x16x32_bf16 a[92:95], a[228:231], v[188:191], a[92:95]
  s_waitcnt vmcnt(17)
  s_barrier
  s_waitcnt lgkmcnt(10)
  v_mfma_f32_16x16x32_bf16 a[96:99], a[232:235], v[176:179], a[96:99]
  v_add_u32 v229, s54, v226
  v_add_u32 v228, s54, v225
  v_xor_b32 v230, 64, v229
  v_mfma_f32_16x16x32_bf16 a[104:107], a[232:235], v[180:183], a[104:107]
  ds_read_b128 a[208:211], v229
  v_mfma_f32_16x16x32_bf16 a[112:115], a[232:235], v[184:187], a[112:115]
  v_exp_f32 v122, v122
  v_mfma_f32_16x16x32_bf16 a[120:123], a[232:235], v[188:191], a[120:123]
  s_waitcnt lgkmcnt(9)
  v_exp_f32 v123, v123
  v_mfma_f32_16x16x32_bf16 a[100:103], a[236:239], v[176:179], a[100:103]
  ds_read_b128 a[212:215], v229 offset:512
  v_cvt_pk_bf16_f32 v173, v122, v123
  v_mfma_f32_16x16x32_bf16 a[108:111], a[236:239], v[180:183], a[108:111]
  v_exp_f32 v124, v124
  v_mfma_f32_16x16x32_bf16 a[116:119], a[236:239], v[184:187], a[116:119]
  v_exp_f32 v125, v125
  v_mfma_f32_16x16x32_bf16 a[124:127], a[236:239], v[188:191], a[124:127]
  s_waitcnt lgkmcnt(8)
  v_exp_f32 v126, v126
  v_mfma_f32_16x16x32_bf16 a[128:131], a[240:243], v[176:179], a[128:131]
  ds_read_b128 a[216:219], v230
  v_cvt_pk_bf16_f32 v174, v124, v125
  v_mfma_f32_16x16x32_bf16 a[136:139], a[240:243], v[180:183], a[136:139]
  v_exp_f32 v127, v127
  v_mfma_f32_16x16x32_bf16 a[144:147], a[240:243], v[184:187], a[144:147]
  v_cvt_pk_bf16_f32 v175, v126, v127
  v_mfma_f32_16x16x32_bf16 a[152:155], a[240:243], v[188:191], a[152:155]
  s_waitcnt lgkmcnt(7)
  v_mfma_f32_16x16x32_bf16 a[132:135], a[244:247], v[176:179], a[132:135]
  ds_read_b128 a[220:223], v230 offset:512
  v_mfma_f32_16x16x32_bf16 a[140:143], a[244:247], v[180:183], a[140:143]
  v_mfma_f32_16x16x32_bf16 a[148:151], a[244:247], v[184:187], a[148:151]
  v_mfma_f32_16x16x32_bf16 a[156:159], a[244:247], v[188:191], a[156:159]
  s_waitcnt lgkmcnt(6)
  v_mfma_f32_16x16x32_bf16 a[160:163], a[248:251], v[176:179], a[160:163]
  ds_read_b128 a[224:227], v229 offset:4096
  v_mfma_f32_16x16x32_bf16 a[168:171], a[248:251], v[180:183], a[168:171]
  v_mfma_f32_16x16x32_bf16 a[176:179], a[248:251], v[184:187], a[176:179]
  v_mfma_f32_16x16x32_bf16 a[184:187], a[248:251], v[188:191], a[184:187]
  s_waitcnt lgkmcnt(5)
  v_mfma_f32_16x16x32_bf16 a[164:167], a[252:255], v[176:179], a[164:167]
  ds_read_b128 a[228:231], v229 offset:4608
  v_mfma_f32_16x16x32_bf16 a[172:175], a[252:255], v[180:183], a[172:175]
  v_mfma_f32_16x16x32_bf16 a[180:183], a[252:255], v[184:187], a[180:183]
  v_mfma_f32_16x16x32_bf16 a[188:191], a[252:255], v[188:191], a[188:191]
  v_mfma_f32_16x16x32_bf16 a[192:195], v[208:211], v[176:179], a[192:195]
  v_mfma_f32_16x16x32_bf16 a[196:199], v[208:211], v[180:183], a[196:199]
  v_mfma_f32_16x16x32_bf16 a[200:203], v[208:211], v[184:187], a[200:203]
  v_mfma_f32_16x16x32_bf16 a[204:207], v[208:211], v[188:191], a[204:207]
  s_cmp_lg_u32 s66, 0
  s_cbranch_scc1 L_rs7_far
L_rs7:
  s_waitcnt lgkmcnt(5)
  v_mfma_f32_16x16x32_bf16 v[96:99], a[208:211], v[0:3], v[192:195]
  ds_read_b128 a[232:235], v230 offset:4096
  v_max3_f32 v243, v128, v129, v130
  v_mfma_f32_16x16x32_bf16 v[104:107], a[208:211], v[4:7], v[196:199]
  v_max3_f32 v249, v131, v132, v133
  v_max3_f32 v243, v243, v134, v135
  v_mfma_f32_16x16x32_bf16 v[112:115], a[208:211], v[8:11], v[200:203]
  v_max3_f32 v249, v249, v136, v137
  v_max3_f32 v243, v243, v138, v139
  v_mfma_f32_16x16x32_bf16 v[120:123], a[208:211], v[12:15], v[204:207]
  s_waitcnt lgkmcnt(5)
  v_max3_f32 v249, v249, v140, v141
  v_max3_f32 v243, v243, v142, v143
  v_mfma_f32_16x16x32_bf16 v[100:103], a[212:215], v[0:3], v[192:195]
  ds_read_b128 a[236:239], v230 offset:4608
  v_max3_f32 v249, v249, v144, v145
  v_mfma_f32_16x16x32_bf16 v[108:111], a[212:215], v[4:7], v[196:199]
  v_max3_f32 v243, v243, v146, v147
  v_max3_f32 v249, v249, v148, v149
  v_mfma_f32_16x16x32_bf16 v[116:119], a[212:215], v[8:11], v[200:203]
  v_max3_f32 v243, v243, v150, v151
  v_max3_f32 v249, v249, v152, v153
  v_mfma_f32_16x16x32_bf16 v[124:127], a[212:215], v[12:15], v[204:207]
  s_waitcnt lgkmcnt(5)
  v_max3_f32 v243, v243, v154, v155
  v_mfma_f32_16x16x32_bf16 v[96:99], a[216:219], v[16:19], v[96:99]
  ds_read_b128 a[240:243], v229 offset:8192
  v_max3_f32 v249, v249, v156, v157
  v_mfma_f32_16x16x32_bf16 v[104:107], a[216:219], v[20:23], v[104:107]
  v_max3_f32 v243, v243, v158, v159
  v_max_f32 v243, v243, v249
  v_mfma_f32_16x16x32_bf16 v[112:115], a[216:219], v[24:27], v[112:115]
  v_cmp_lt_f32 vcc, s63, v243
  s_cbranch_vccnz L_sk8_far
L_sk8:
  v_mfma_f32_16x16x32_bf16 v[120:123], a[216:219], v[28:31], v[120:123]
  s_waitcnt lgkmcnt(5)
  v_exp_f32 v128, v128
  v_mfma_f32_16x16x32_bf16 v[100:103], a[220:223], v[16:19], v[100:103]
  ds_read_b128 a[244:247], v229 offset:8704
  v_mfma_f32_16x16x32_bf16 v[108:111], a[220:223], v[20:23], v[108:111]
  v_exp_f32 v129, v129
  v_mfma_f32_16x16x32_bf16 v[116:119], a[220:223], v[24:27], v[116:119]
  v_exp_f32 v130, v130
  v_mfma_f32_16x16x32_bf16 v[124:127], a[220:223], v[28:31], v[124:127]
  s_waitcnt lgkmcnt(5)
  v_cvt_pk_bf16_f32 v176, v128, v129
  v_mfma_f32_16x16x32_bf16 v[96:99], a[224:227], v[32:35], v[96:99]
  ds_read_b128 a[248:251], v230 offset:8192
  v_mfma_f32_16x16x32_bf16 v[104:107], a[224:227], v[36:39], v[104:107]
  s_add_u32 s57, s55, s75
  s_add_u32 m0, s57, 0
  v_mfma_f32_16x16x32_bf16 v[112:115], a[224:227], v[40:43], v[112:115]
  buffer_load_dwordx4 v213, s[24:27], s59 offen lds
  v_mfma_f32_16x16x32_bf16 v[120:123], a[224:227], v[44:47], v[120:123]
  s_waitcnt lgkmcnt(5)
  v_exp_f32 v131, v131
  v_mfma_f32_16x16x32_bf16 v[100:103], a[228:231], v[32:35], v[100:103]
  ds_read_b128 a[252:255], v230 offset:8704
  v_cvt_pk_bf16_f32 v177, v130, v131
  v_mfma_f32_16x16x32_bf16 v[108:111], a[228:231], v[36:39], v[108:111]
  v_exp_f32 v132, v132
  v_mfma_f32_16x16x32_bf16 v[116:119], a[228:231], v[40:43], v[116:119]
  v_exp_f32 v133, v133
  v_mfma_f32_16x16x32_bf16 v[124:127], a[228:231], v[44:47], v[124:127]
  s_waitcnt lgkmcnt(5)
  v_exp_f32 v134, v134
  v_mfma_f32_16x16x32_bf16 v[96:99], a[232:235], v[48:51], v[96:99]
  ds_read_b64_tr_b16 a[208:209], v228 offset:12288
  v_cvt_pk_bf16_f32 v178, v132, v133
  v_mfma_f32_16x16x32_bf16 v[104:107], a[232:235], v[52:55], v[104:107]
  ds_read_b64_tr_b16 a[210:211], v228 offset:13312
  s_add_u32 m0, s57, 0x400
  v_mfma_f32_16x16x32_bf16 v[112:115], a[232:235], v[56:59], v[112:115]
  buffer_load_dwordx4 v214, s[24:27], s59 offen lds
  v_mfma_f32_16x16x32_bf16 v[120:123], a[232:235], v[60:63], v[120:123]
  s_waitcnt lgkmcnt(6)
  v_exp_f32 v135, v135
  v_mfma_f32_16x16x32_bf16 v[100:103], a[236:239], v[48:51], v[100:103]
  ds_read_b64_tr_b16 a[212:213], v228 offset:12296
  v_cvt_pk_bf16_f32 v179, v134, v135
  v_mfma_f32_16x16x32_bf16 v[108:111], a[236:239], v[52:55], v[108:111]
  ds_read_b64_tr_b16 a[214:215], v228 offset:13320
  v_mfma_f32_16x16x32_bf16 v[116:119], a[236:239], v[56:59], v[116:119]
  v_exp_f32 v136, v136
  v_mfma_f32_16x16x32_bf16 v[124:127], a[236:239], v[60:63], v[124:127]
  s_waitcnt lgkmcnt(7)
  v_exp_f32 v137, v137
  v_mfma_f32_16x16x32_bf16 v[96:99], a[240:243], v[64:67], v[96:99]
  ds_read_b64_tr_b16 a[216:217], v228 offset:12544
  v_cvt_pk_bf16_f32 v180, v136, v137
  v_mfma_f32_16x16x32_bf16 v[104:107], a[240:243], v[68:71], v[104:107]
  ds_read_b64_tr_b16 a[218:219], v228 offset:13568
  s_add_u32 m0, s57, 0x1010
  v_mfma_f32_16x16x32_bf16 v[112:115], a[240:243], v[72:75], v[112:115]
  buffer_load_dwordx4 v215, s[24:27], s59 offen lds
  v_mfma_f32_16x16x32_bf16 v[120:123], a[240:243], v[76:79], v[120:123]
  s_waitcnt lgkmcnt(8)
  v_exp_f32 v138, v138
  v_mfma_f32_16x16x32_bf16 v[100:103], a[244:247], v[64:67], v[100:103]
  ds_read_b64_tr_b16 a[220:221], v228 offset:12552
  v_mfma_f32_16x16x32_bf16 v[108:111], a[244:247], v[68:71], v[108:111]
  ds_read_b64_tr_b16 a[222:223], v228 offset:13576
  v_mfma_f32_16x16x32_bf16 v[116:119], a[244:247], v[72:75], v[116:119]
  v_exp_f32 v139, v139
  v_mfma_f32_16x16x32_bf16 v[124:127], a[244:247], v[76:79], v[124:127]
  s_waitcnt lgkmcnt(9)
  v_exp_f32 v140, v140
  v_mfma_f32_16x16x32_bf16 v[96:99], a[248:251], v[80:83], v[96:99]
  ds_read_b64_tr_b16 a[224:225], v228 offset:12800
  v_cvt_pk_bf16_f32 v181, v138, v139
  v_mfma_f32_16x16x32_bf16 v[104:107], a[248:251], v[84:87], v[104:107]
  ds_read_b64_tr_b16 a[226:227], v228 offset:13824
  s_add_u32 m0, s57, 0x1410
  v_mfma_f32_16x16x32_bf16 v[112:115], a[248:251], v[88:91], v[112:115]
  buffer_load_dwordx4 v216, s[24:27], s59 offen lds
  v_mfma_f32_16x16x32_bf16 v[120:123], a[248:251], v[92:95], v[120:123]
  s_waitcnt lgkmcnt(10)
  v_exp_f32 v141, v141
  v_mfma_f32_16x16x32_bf16 v[100:103], a[252:255], v[80:83], v[100:103]
  ds_read_b64_tr_b16 a[228:229], v228 offset:12808
  v_cvt_pk_bf16_f32 v182, v140, v141
  v_mfma_f32_16x16x32_bf16 v[108:111], a[252:255], v[84:87], v[108:111]
  ds_read_b64_tr_b16 a[230:231], v228 offset:13832
  v_mfma_f32_16x16x32_bf16 v[116:119], a[252:255], v[88:91], v[116:119]
  v_exp_f32 v142, v142
  v_mfma_f32_16x16x32_bf16 v[124:127], a[252:255], v[92:95], v[124:127]
  s_waitcnt lgkmcnt(10)
  v_exp_f32 v143, v143
  v_mfma_f32_16x16x32_bf16 a[0:3], a[208:211], v[160:163], a[0:3]
  ds_read_b64_tr_b16 a[232:233], v228 offset:13056
  v_cvt_pk_bf16_f32 v183, v142, v143
  v_mfma_f32_16x16x32_bf16 a[8:11], a[208:211], v[164:167], a[8:11]
  ds_read_b64_tr_b16 a[234:235], v228 offset:14080
  s_add_u32 m0, s55, s76
  v_mfma_f32_16x16x32_bf16 a[16:19], a[208:211], v[168:171], a[16:19]
  buffer_load_dwordx4 v217, s[24:27], s59 offen lds
  v_mfma_f32_16x16x32_bf16 a[24:27], a[208:211], v[172:175], a[24:27]
  s_waitcnt lgkmcnt(10)
  v_exp_f32 v144, v144
  v_mfma_f32_16x16x32_bf16 a[4:7], a[212:215], v[160:163], a[4:7]
  ds_read_b64_tr_b16 a[236:237], v228 offset:13064
  v_mfma_f32_16x16x32_bf16 a[12:15], a[212:215], v[164:167], a[12:15]
  ds_read_b64_tr_b16 a[238:239], v228 offset:14088
  v_mfma_f32_16x16x32_bf16 a[20:23], a[212:215], v[168:171], a[20:23]
  v_exp_f32 v145, v145
  v_mfma_f32_16x16x32_bf16 a[28:31], a[212:215], v[172:175], a[28:31]
  s_waitcnt lgkmcnt(10)
  v_exp_f32 v146, v146
  v_mfma_f32_16x16x32_bf16 a[32:35], a[216:219], v[160:163], a[32:35]
  ds_read_b64_tr_b16 a[240:241], v228 offset:14336
  v_cvt_pk_bf16_f32 v184, v144, v145
  v_mfma_f32_16x16x32_bf16 a[40:43], a[216:219], v[164:167], a[40:43]
  ds_read_b64_tr_b16 a[242:243], v228 offset:14848
  s_add_u32 s59, s59, 0x14000
  v_mfma_f32_16x16x32_bf16 a[48:51], a[216:219], v[168:171], a[48:51]
  v_exp_f32 v147, v147
  v_mfma_f32_16x16x32_bf16 a[56:59], a[216:219], v[172:175], a[56:59]
  s_waitcnt lgkmcnt(10)
  v_exp_f32 v148, v148
  v_mfma_f32_16x16x32_bf16 a[36:39], a[220:223], v[160:163], a[36:39]
  ds_read_b64_tr_b16 a[244:245], v228 offset:14344
  v_cvt_pk_bf16_f32 v185, v146, v147
  v_mfma_f32_16x16x32_bf16 a[44:47], a[220:223], v[164:167], a[44:47]
  ds_read_b64_tr_b16 a[246:247], v228 offset:14856
  v_mfma_f32_16x16x32_bf16 a[52:55], a[220:223], v[168:171], a[52:55]
  v_exp_f32 v149, v149
  v_mfma_f32_16x16x32_bf16 a[60:63], a[220:223], v[172:175], a[60:63]
  s_waitcnt lgkmcnt(10)
  v_exp_f32 v150, v150
  v_mfma_f32_16x16x32_bf16 a[64:67], a[224:227], v[160:163], a[64:67]
  ds_read_b64_tr_b16 a[248:249], v228 offset:14592
  v_cvt_pk_bf16_f32 v186, v148, v149
  v_mfma_f32_16x16x32_bf16 a[72:75], a[224:227], v[164:167], a[72:75]
  ds_read_b64_tr_b16 a[250:251], v228 offset:15104
  v_mfma_f32_16x16x32_bf16 a[80:83], a[224:227], v[168:171], a[80:83]
  s_add_u32 s55, s55, 0x6080
  s_cmp_ge_u32 s55, 0x24300
  s_cselect_b32 s55, 0, s55
  v_mfma_f32_16x16x32_bf16 a[88:91], a[224:227], v[172:175], a[88:91]
  s_waitcnt lgkmcnt(10)
  v_exp_f32 v151, v151
  v_mfma_f32_16x16x32_bf16 a[68:71], a[228:231], v[160:163], a[68:71]
  ds_read_b64_tr_b16 a[252:253], v228 offset:14600
  v_cvt_pk_bf16_f32 v187, v150, v151
  v_mfma_f32_16x16x32_bf16 a[76:79], a[228:231], v[164:167], a[76:79]
  s_add_u32 s54, s54, 0x6080
  s_cmp_ge_u32 s54, 0x24300
  s_cselect_b32 s54, 0, s54
  v_mfma_f32_16x16x32_bf16 a[84:87], a[228:231], v[168:171], a[84:87]
  ds_read_b64_tr_b16 a[254:255], v228 offset:15112
  v_mfma_f32_16x16x32_bf16 a[92:95], a[228:231], v[172:175], a[92:95]
  s_waitcnt vmcnt(15)
  s_barrier
  s_waitcnt lgkmcnt(10)
  v_mfma_f32_16x16x32_bf16 a[96:99], a[232:235], v[160:163], a[96:99]
  v_add_u32 v229, s54, v226
  v_add_u32 v228, s54, v225
  v_xor_b32 v230, 64, v229
  v_mfma_f32_16x16x32_bf16 a[104:107], a[232:235], v[164:167], a[104:107]
  ds_read_b128 a[208:211], v229
  v_mfma_f32_16x16x32_bf16 a[112:115], a[232:235], v[168:171], a[112:115]
  v_exp_f32 v152, v152
  v_mfma_f32_16x16x32_bf16 a[120:123], a[232:235], v[172:175], a[120:123]
  s_waitcnt lgkmcnt(9)
  v_exp_f32 v153, v153
  v_mfma_f32_16x16x32_bf16 a[100:103], a[236:239], v[160:163], a[100:103]
  ds_read_b128 a[212:215], v229 offset:512
  v_cvt_pk_bf16_f32 v188, v152, v153
  v_mfma_f32_16x16x32_bf16 a[108:111], a[236:239], v[164:167], a[108:111]
  v_exp_f32 v154, v154
  v_mfma_f32_16x16x32_bf16 a[116:119], a[236:239], v[168:171], a[116:119]
  v_exp_f32 v155, v155
  v_mfma_f32_16x16x32_bf16 a[124:127], a[236:239], v[172:175], a[124:127]
  s_waitcnt lgkmcnt(8)
  v_exp_f32 v156, v156
  v_mfma_f32_16x16x32_bf16 a[128:131], a[240:243], v[160:163], a[128:131]
  ds_read_b128 a[216:219], v230
  v_cvt_pk_bf16_f32 v189, v154, v155
  v_mfma_f32_16x16x32_bf16 a[136:139], a[240:243], v[164:167], a[136:139]
  v_exp_f32 v157, v157
  v_mfma_f32_16x16x32_bf16 a[144:147], a[240:243], v[168:171], a[144:147]
  v_exp_f32 v158, v158
  v_mfma_f32_16x16x32_bf16 a[152:155], a[240:243], v[172:175], a[152:155]
  s_waitcnt lgkmcnt(7)
  v_cvt_pk_bf16_f32 v190, v156, v157
  v_mfma_f32_16x16x32_bf16 a[132:135], a[244:247], v[160:163], a[132:135]
  ds_read_b128 a[220:223], v230 offset:512
  v_mfma_f32_16x16x32_bf16 a[140:143], a[244:247], v[164:167], a[140:143]
  v_exp_f32 v159, v159
  v_mfma_f32_16x16x32_bf16 a[148:151], a[244:247], v[168:171], a[148:151]
  v_cvt_pk_bf16_f32 v191, v158, v159
  v_mfma_f32_16x16x32_bf16 a[156:159], a[244:247], v[172:175], a[156:159]
  s_waitcnt lgkmcnt(6)
  v_mfma_f32_16x16x32_bf16 a[160:163], a[248:251], v[160:163], a[160:163]
  ds_read_b128 a[224:227], v229 offset:4096
  v_mfma_f32_16x16x32_bf16 a[168:171], a[248:251], v[164:167], a[168:171]
  v_mfma_f32_16x16x32_bf16 a[176:179], a[248:251], v[168:171], a[176:179]
  v_mfma_f32_16x16x32_bf16 a[184:187], a[248:251], v[172:175], a[184:187]
  s_waitcnt lgkmcnt(5)
  v_mfma_f32_16x16x32_bf16 a[164:167], a[252:255], v[160:163], a[164:167]
  ds_read_b128 a[228:231], v229 offset:4608
  v_mfma_f32_16x16x32_bf16 a[172:175], a[252:255], v[164:167], a[172:175]
  v_mfma_f32_16x16x32_bf16 a[180:183], a[252:255], v[168:171], a[180:183]
  v_mfma_f32_16x16x32_bf16 a[188:191], a[252:255], v[172:175], a[188:191]
  v_mfma_f32_16x16x32_bf16 a[192:195], v[208:211], v[160:163], a[192:195]
  v_mfma_f32_16x16x32_bf16 a[196:199], v[208:211], v[164:167], a[196:199]
  v_mfma_f32_16x16x32_bf16 a[200:203], v[208:211], v[168:171], a[200:203]
  v_mfma_f32_16x16x32_bf16 a[204:207], v[208:211], v[172:175], a[204:207]
  s_cmp_lg_u32 s66, 0
  s_cbranch_scc1 L_rs9_far
L_rs9:
  s_waitcnt lgkmcnt(5)
  v_mfma_f32_16x16x32_bf16 v[128:131], a[208:211], v[0:3], v[192:195]
  ds_read_b128 a[232:235], v230 offset:4096
  v_max3_f32 v243, v96, v97, v98
  v_mfma_f32_16x16x32_bf16 v[136:139], a[208:211], v[4:7], v[196:199]
  v_max3_f32 v249, v99, v100, v101
  v_max3_f32 v243, v243, v102, v103
  v_mfma_f32_16x16x32_bf16 v[144:147], a[208:211], v[8:11], v[200:203]
  v_max3_f32 v249, v249, v104, v105
  v_max3_f32 v243, v243, v106, v107
  v_mfma_f32_16x16x32_bf16 v[152:155], a[208:211], v[12:15], v[204:207]
  s_waitcnt lgkmcnt(5)
  v_max3_f32 v249, v249, v108, v109
  v_max3_f32 v243, v243, v110, v111
  v_mfma_f32_16x16x32_bf16 v[132:135], a[212:215], v[0:3], v[192:195]
  ds_read_b128 a[236:239], v230 offset:4608
  v_max3_f32 v249, v249, v112, v113
  v_mfma_f32_16x16x32_bf16 v[140:143], a[212:215], v[4:7], v[196:199]
  v_max3_f32 v243, v243, v114, v115
  v_max3_f32 v249, v249, v116, v117
  v_mfma_f32_16x16x32_bf16 v[148:151], a[212:215], v[8:11], v[200:203]
  v_max3_f32 v243, v243, v118, v119
  v_max3_f32 v249, v249, v120, v121
  v_mfma_f32_16x16x32_bf16 v[156:159], a[212:215], v[12:15], v[204:207]
  s_waitcnt lgkmcnt(5)
  v_max3_f32 v243, v243, v122, v123
  v_mfma_f32_16x16x32_bf16 v[128:131], a[216:219], v[16:19], v[128:131]
  ds_read_b128 a[240:243], v229 offset:8192
  v_max3_f32 v249, v249, v124, v125
  v_mfma_f32_16x16x32_bf16 v[136:139], a[216:219], v[20:23], v[136:139]
  v_max3_f32 v243, v243, v126, v127
  v_max_f32 v243, v243, v249
  v_mfma_f32_16x16x32_bf16 v[144:147], a[216:219], v[24:27], v[144:147]
  v_cmp_lt_f32 vcc, s63, v243
  s_cbranch_vccnz L_sk10_far
L_sk10:
  v_mfma_f32_16x16x32_bf16 v[152:155], a[216:219], v[28:31], v[152:155]
  s_waitcnt lgkmcnt(5)
  v_exp_f32 v96, v96
  v_mfma_f32_16x16x32_bf16 v[132:135], a[220:223], v[16:19], v[132:135]
  ds_read_b128 a[244:247], v229 offset:8704
  v_mfma_f32_16x16x32_bf16 v[140:143], a[220:223], v[20:23], v[140:143]
  v_exp_f32 v97, v97
  v_mfma_f32_16x16x32_bf16 v[148:151], a[220:223], v[24:27], v[148:151]
  v_exp_f32 v98, v98
  v_mfma_f32_16x16x32_bf16 v[156:159], a[220:223], v[28:31], v[156:159]
  s_waitcnt lgkmcnt(5)
  v_cvt_pk_bf16_f32 v160, v96, v97
  v_mfma_f32_16x16x32_bf16 v[128:131], a[224:227], v[32:35], v[128:131]
  ds_read_b128 a[248:251], v230 offset:8192
  v_mfma_f32_16x16x32_bf16 v[136:139], a[224:227], v[36:39], v[136:139]
  s_add_u32 s57, s55, s75
  s_add_u32 m0, s57, 0
  v_mfma_f32_16x16x32_bf16 v[144:147], a[224:227], v[40:43], v[144:147]
  buffer_load_dwordx4 v213, s[24:27], s59 offen lds
  v_mfma_f32_16x16x32_bf16 v[152:155], a[224:227], v[44:47], v[152:155]
  s_waitcnt lgkmcnt(5)
  v_exp_f32 v99, v99
  v_mfma_f32_16x16x32_bf16 v[132:135], a[228:231], v[32:35], v[132:135]
  ds_read_b128 a[252:255], v230 offset:8704
  v_cvt_pk_bf16_f32 v161, v98, v99
  v_mfma_f32_16x16x32_bf16 v[140:143], a[228:231], v[36:39], v[140:143]
  v_exp_f32 v100, v100
  v_mfma_f32_16x16x32_bf16 v[148:151], a[228:231], v[40:43], v[148:151]
  v_exp_f32 v101, v101
  v_mfma_f32_16x16x32_bf16 v[156:159], a[228:231], v[44:47], v[156:159]
  s_waitcnt lgkmcnt(5)
  v_exp_f32 v102, v102
  v_mfma_f32_16x16x32_bf16 v[128:131], a[232:235], v[48:51], v[128:131]
  ds_read_b64_tr_b16 a[208:209], v228 offset:12288
  v_cvt_pk_bf16_f32 v162, v100, v101
  v_mfma_f32_16x16x32_bf16 v[136:139], a[232:235], v[52:55], v[136:139]
  ds_read_b64_tr_b16 a[210:211], v228 offset:13312
  s_add_u32 m0, s57, 0x400
  v_mfma_f32_16x16x32_bf16 v[144:147], a[232:235], v[56:59], v[144:147]
  buffer_load_dwordx4 v214, s[24:27], s59 offen lds
  v_mfma_f32_16x16x32_bf16 v[152:155], a[232:235], v[60:63], v[152:155]
  s_waitcnt lgkmcnt(6)
  v_exp_f32 v103, v103
  v_mfma_f32_16x16x32_bf16 v[132:135], a[236:239], v[48:51], v[132:135]
  ds_read_b64_tr_b16 a[212:213], v228 offset:12296
  v_cvt_pk_bf16_f32 v163, v102, v103
  v_mfma_f32_16x16x32_bf16 v[140:143], a[236:239], v[52:55], v[140:143]
  ds_read_b64_tr_b16 a[214:215], v228 offset:13320
  v_mfma_f32_16x16x32_bf16 v[148:151], a[236:239], v[56:59], v[148:151]
  v_exp_f32 v104, v104
  v_mfma_f32_16x16x32_bf16 v[156:159], a[236:239], v[60:63], v[156:159]
  s_waitcnt lgkmcnt(7)
  v_exp_f32 v105, v105
  v_mfma_f32_16x16x32_bf16 v[128:131], a[240:243], v[64:67], v[128:131]
  ds_read_b64_tr_b16 a[216:217], v228 offset:12544
  v_cvt_pk_bf16_f32 v164, v104, v105
  v_mfma_f32_16x16x32_bf16 v[136:139], a[240:243], v[68:71], v[136:139]
  ds_read_b64_tr_b16 a[218:219], v228 offset:13568
  s_add_u32 m0, s57, 0x1010
  v_mfma_f32_16x16x32_bf16 v[144:147], a[240:243], v[72:75], v[144:147]
  buffer_load_dwordx4 v215, s[24:27], s59 offen lds
  v_mfma_f32_16x16x32_bf16 v[152:155], a[240:243], v[76:79], v[152:155]
  s_waitcnt lgkmcnt(8)
  v_exp_f32 v106, v106
  v_mfma_f32_16x16x32_bf16 v[132:135], a[244:247], v[64:67], v[132:135]
  ds_read_b64_tr_b16 a[220:221], v228 offset:12552
  v_mfma_f32_16x16x32_bf16 v[140:143], a[244:247], v[68:71], v[140:143]
  ds_read_b64_tr_b16 a[222:223], v228 offset:13576
  v_mfma_f32_16x16x32_bf16 v[148:151], a[244:247], v[72:75], v[148:151]
  v_exp_f32 v107, v107
  v_mfma_f32_16x16x32_bf16 v[156:159], a[244:247], v[76:79], v[156:159]
  s_waitcnt lgkmcnt(9)
  v_exp_f32 v108, v108
  v_mfma_f32_16x16x32_bf16 v[128:131], a[248:251], v[80:83], v[128:131]
  ds_read_b64_tr_b16 a[224:225], v228 offset:12800
  v_cvt_pk_bf16_f32 v165, v106, v107
  v_mfma_f32_16x16x32_bf16 v[136:139], a[248:251], v[84:87], v[136:139]
  ds_read_b64_tr_b16 a[226:227], v228 offset:13824
  s_add_u32 m0, s57, 0x1410
  v_mfma_f32_16x16x32_bf16 v[144:147], a[248:251], v[88:91], v[144:147]
  buffer_load_dwordx4 v216, s[24:27], s59 offen lds
  v_mfma_f32_16x16x32_bf16 v[152:155], a[248:251], v[92:95], v[152:155]
  s_waitcnt lgkmcnt(10)
  v_exp_f32 v109, v109
  v_mfma_f32_16x16x32_bf16 v[132:135], a[252:255], v[80:83], v[132:135]
  ds_read_b64_tr_b16 a[228:229], v228 offset:12808
  v_cvt_pk_bf16_f32 v166, v108, v109
  v_mfma_f32_16x16x32_bf16 v[140:143], a[252:255], v[84:87], v[140:143]
  ds_read_b64_tr_b16 a[230:231], v228 offset:13832
  v_mfma_f32_16x16x32_bf16 v[148:151], a[252:255], v[88:91], v[148:151]
  v_exp_f32 v110, v110
  v_mfma_f32_16x16x32_bf16 v[156:159], a[252:255], v[92:95], v[156:159]
  s_waitcnt lgkmcnt(10)
  v_exp_f32 v111, v111
  v_mfma_f32_16x16x32_bf16 a[0:3], a[208:211], v[176:179], a[0:3]
  ds_read_b64_tr_b16 a[232:233], v228 offset:13056
  v_cvt_pk_bf16_f32 v167, v110, v111
  v_mfma_f32_16x16x32_bf16 a[8:11], a[208:211], v[180:183], a[8:11]
  ds_read_b64_tr_b16 a[234:235], v228 offset:14080
  s_add_u32 m0, s55, s76
  v_mfma_f32_16x16x32_bf16 a[16:19], a[208:211], v[184:187], a[16:19]
  buffer_load_dwordx4 v217, s[24:27], s59 offen lds
  v_mfma_f32_16x16x32_bf16 a[24:27], a[208:211], v[188:191], a[24:27]
  s_waitcnt lgkmcnt(10)
  v_exp_f32 v112, v112
  v_mfma_f32_16x16x32_bf16 a[4:7], a[212:215], v[176:179], a[4:7]
  ds_read_b64_tr_b16 a[236:237], v228 offset:13064
  v_mfma_f32_16x16x32_bf16 a[12:15], a[212:215], v[180:183], a[12:15]
  ds_read_b64_tr_b16 a[238:239], v228 offset:14088
  v_mfma_f32_16x16x32_bf16 a[20:23], a[212:215], v[184:187], a[20:23]
  v_exp_f32 v113, v113
  v_mfma_f32_16x16x32_bf16 a[28:31], a[212:215], v[188:191], a[28:31]
  s_waitcnt lgkmcnt(10)
  v_exp_f32 v114, v114
  v_mfma_f32_16x16x32_bf16 a[32:35], a[216:219], v[176:179], a[32:35]
  ds_read_b64_tr_b16 a[240:241], v228 offset:14336
  v_cvt_pk_bf16_f32 v168, v112, v113
  v_mfma_f32_16x16x32_bf16 a[40:43], a[216:219], v[180:183], a[40:43]
  ds_read_b64_tr_b16 a[242:243], v228 offset:14848
  s_add_u32 s59, s59, 0x14000
  v_mfma_f32_16x16x32_bf16 a[48:51], a[216:219], v[184:187], a[48:51]
  v_exp_f32 v115, v115
  v_mfma_f32_16x16x32_bf16 a[56:59], a[216:219], v[188:191], a[56:59]
  s_waitcnt lgkmcnt(10)
  v_exp_f32 v116, v116
  v_mfma_f32_16x16x32_bf16 a[36:39], a[220:223], v[176:179], a[36:39]
  ds_read_b64_tr_b16 a[244:245], v228 offset:14344
  v_cvt_pk_bf16_f32 v169, v114, v115
  v_mfma_f32_16x16x32_bf16 a[44:47], a[220:223], v[180:183], a[44:47]
  ds_read_b64_tr_b16 a[246:247], v228 offset:14856
  v_mfma_f32_16x16x32_bf16 a[52:55], a[220:223], v[184:187], a[52:55]
  v_exp_f32 v117, v117
  v_mfma_f32_16x16x32_bf16 a[60:63], a[220:223], v[188:191], a[60:63]
  s_waitcnt lgkmcnt(10)
  v_exp_f32 v118, v118
  v_mfma_f32_16x16x32_bf16 a[64:67], a[224:227], v[176:179], a[64:67]
  ds_read_b64_tr_b16 a[248:249], v228 offset:14592
  v_cvt_pk_bf16_f32 v170, v116, v117
  v_mfma_f32_16x16x32_bf16 a[72:75], a[224:227], v[180:183], a[72:75]
  ds_read_b64_tr_b16 a[250:251], v228 offset:15104
  v_mfma_f32_16x16x32_bf16 a[80:83], a[224:227], v[184:187], a[80:83]
  s_add_u32 s55, s55, 0x6080
  s_cmp_ge_u32 s55, 0x24300
  s_cselect_b32 s55, 0, s55
  v_mfma_f32_16x16x32_bf16 a[88:91], a[224:227], v[188:191], a[88:91]
  s_waitcnt lgkmcnt(10)
  v_exp_f32 v119, v119
  v_mfma_f32_16x16x32_bf16 a[68:71], a[228:231], v[176:179], a[68:71]
  ds_read_b64_tr_b16 a[252:253], v228 offset:14600
  v_cvt_pk_bf16_f32 v171, v118, v119
  v_mfma_f32_16x16x32_bf16 a[76:79], a[228:231], v[180:183], a[76:79]
  s_add_u32 s54, s54, 0x6080
  s_cmp_ge_u32 s54, 0x24300
  s_cselect_b32 s54, 0, s54
  v_mfma_f32_16x16x32_bf16 a[84:87], a[228:231], v[184:187], a[84:87]
  ds_read_b64_tr_b16 a[254:255], v228 offset:15112
  v_mfma_f32_16x16x32_bf16 a[92:95], a[228:231], v[188:191], a[92:95]
  s_waitcnt vmcnt(13)
  s_barrier
  s_waitcnt lgkmcnt(10)
  v_mfma_f32_16x16x32_bf16 a[96:99], a[232:235], v[176:179], a[96:99]
  v_add_u32 v229, s54, v226
  v_add_u32 v228, s54, v225
  v_xor_b32 v230, 64, v229
  v_mfma_f32_16x16x32_bf16 a[104:107], a[232:235], v[180:183], a[104:107]
  ds_read_b64_tr_b16 a[208:209], v228 offset:12288
  v_mfma_f32_16x16x32_bf16 a[112:115], a[232:235], v[184:187], a[112:115]
  ds_read_b64_tr_b16 a[210:211], v228 offset:13312
  v_mfma_f32_16x16x32_bf16 a[120:123], a[232:235], v[188:191], a[120:123]
  s_waitcnt lgkmcnt(10)
  v_exp_f32 v120, v120
  v_mfma_f32_16x16x32_bf16 a[100:103], a[236:239], v[176:179], a[100:103]
  ds_read_b64_tr_b16 a[212:213], v228 offset:12296
  v_mfma_f32_16x16x32_bf16 a[108:111], a[236:239], v[180:183], a[108:111]
  ds_read_b64_tr_b16 a[214:215], v228 offset:13320
  v_mfma_f32_16x16x32_bf16 a[116:119], a[236:239], v[184:187], a[116:119]
  v_exp_f32 v121, v121
  v_mfma_f32_16x16x32_bf16 a[124:127], a[236:239], v[188:191], a[124:127]
  s_waitcnt lgkmcnt(10)
  v_exp_f32 v122, v122
  v_mfma_f32_16x16x32_bf16 a[128:131], a[240:243], v[176:179], a[128:131]
  ds_read_b64_tr_b16 a[216:217], v228 offset:12544
  v_cvt_pk_bf16_f32 v172, v120, v121
  v_mfma_f32_16x16x32_bf16 a[136:139], a[240:243], v[180:183], a[136:139]
  ds_read_b64_tr_b16 a[218:219], v228 offset:13568
  v_mfma_f32_16x16x32_bf16 a[144:147], a[240:243], v[184:187], a[144:147]
  v_exp_f32 v123, v123
  v_mfma_f32_16x16x32_bf16 a[152:155], a[240:243], v[188:191], a[152:155]
  s_waitcnt lgkmcnt(10)
  v_exp_f32 v124, v124
  v_mfma_f32_16x16x32_bf16 a[132:135], a[244:247], v[176:179], a[132:135]
  ds_read_b64_tr_b16 a[220:221], v228 offset:12552
  v_cvt_pk_bf16_f32 v173, v122, v123
  v_mfma_f32_16x16x32_bf16 a[140:143], a[244:247], v[180:183], a[140:143]
  ds_read_b64_tr_b16 a[222:223], v228 offset:13576
  v_mfma_f32_16x16x32_bf16 a[148:151], a[244:247], v[184:187], a[148:151]
  v_exp_f32 v125, v125
  v_mfma_f32_16x16x32_bf16 a[156:159], a[244:247], v[188:191], a[156:159]
  s_waitcnt lgkmcnt(10)
  v_exp_f32 v126, v126
  v_mfma_f32_16x16x32_bf16 a[160:163], a[248:251], v[176:179], a[160:163]
  ds_read_b64_tr_b16 a[224:225], v228 offset:12800
  v_cvt_pk_bf16_f32 v174, v124, v125
  v_mfma_f32_16x16x32_bf16 a[168:171], a[248:251], v[180:183], a[168:171]
  ds_read_b64_tr_b16 a[226:227], v228 offset:13824
  v_mfma_f32_16x16x32_bf16 a[176:179], a[248:251], v[184:187], a[176:179]
  v_exp_f32 v127, v127
  v_mfma_f32_16x16x32_bf16 a[184:187], a[248:251], v[188:191], a[184:187]
  s_waitcnt lgkmcnt(10)
  v_cvt_pk_bf16_f32 v175, v126, v127
  v_mfma_f32_16x16x32_bf16 a[164:167], a[252:255], v[176:179], a[164:167]
  ds_read_b64_tr_b16 a[228:229], v228 offset:12808
  v_mfma_f32_16x16x32_bf16 a[172:175], a[252:255], v[180:183], a[172:175]
  ds_read_b64_tr_b16 a[230:231], v228 offset:13832
  v_mfma_f32_16x16x32_bf16 a[180:183], a[252:255], v[184:187], a[180:183]
  v_mfma_f32_16x16x32_bf16 a[188:191], a[252:255], v[188:191], a[188:191]
  v_mfma_f32_16x16x32_bf16 a[192:195], v[208:211], v[176:179], a[192:195]
  v_mfma_f32_16x16x32_bf16 a[196:199], v[208:211], v[180:183], a[196:199]
  v_mfma_f32_16x16x32_bf16 a[200:203], v[208:211], v[184:187], a[200:203]
  v_mfma_f32_16x16x32_bf16 a[204:207], v[208:211], v[188:191], a[204:207]
  s_cmp_lg_u32 s66, 0
  s_cbranch_scc1 L_rs11_far
L_rs11:
  s_waitcnt lgkmcnt(10)
  v_mfma_f32_16x16x32_bf16 a[0:3], a[208:211], v[160:163], a[0:3]
  ds_read_b64_tr_b16 a[232:233], v228 offset:13056
  v_max3_f32 v243, v128, v129, v130
  v_mfma_f32_16x16x32_bf16 a[8:11], a[208:211], v[164:167], a[8:11]
  ds_read_b64_tr_b16 a[234:235], v228 offset:14080
  v_max3_f32 v249, v131, v132, v133
  v_mfma_f32_16x16x32_bf16 a[16:19], a[208:211], v[168:171], a[16:19]
  s_add_u32 s57, s55, s75
  s_add_u32 m0, s57, 0
  v_max3_f32 v243, v243, v134, v135
  v_mfma_f32_16x16x32_bf16 a[24:27], a[208:211], v[172:175], a[24:27]
  buffer_load_dwordx4 v213, s[24:27], s59 offen lds
  s_waitcnt lgkmcnt(10)
  v_mfma_f32_16x16x32_bf16 a[4:7], a[212:215], v[160:163], a[4:7]
  ds_read_b64_tr_b16 a[236:237], v228 offset:13064
  v_max3_f32 v249, v249, v136, v137
  v_mfma_f32_16x16x32_bf16 a[12:15], a[212:215], v[164:167], a[12:15]
  ds_read_b64_tr_b16 a[238:239], v228 offset:14088
  s_add_u32 m0, s57, 0x400
  v_mfma_f32_16x16x32_bf16 a[20:23], a[212:215], v[168:171], a[20:23]
  buffer_load_dwordx4 v214, s[24:27], s59 offen lds
  v_max3_f32 v243, v243, v138, v139
  v_mfma_f32_16x16x32_bf16 a[28:31], a[212:215], v[172:175], a[28:31]
  s_waitcnt lgkmcnt(10)
  v_max3_f32 v249, v249, v140, v141
  v_max3_f32 v243, v243, v142, v143
  v_mfma_f32_16x16x32_bf16 a[32:35], a[216:219], v[160:163], a[32:35]
  ds_read_b64_tr_b16 a[240:241], v228 offset:14336
  v_max3_f32 v249, v249, v144, v145
  v_mfma_f32_16x16x32_bf16 a[40:43], a[216:219], v[164:167], a[40:43]
  ds_read_b64_tr_b16 a[242:243], v228 offset:14848
  s_add_u32 m0, s57, 0x1010
  v_mfma_f32_16x16x32_bf16 a[48:51], a[216:219], v[168:171], a[48:51]
  buffer_load_dwordx4 v215, s[24:27], s59 offen lds
  v_max3_f32 v243, v243, v146, v147
  v_mfma_f32_16x16x32_bf16 a[56:59], a[216:219], v[172:175], a[56:59]
  s_waitcnt lgkmcnt(10)
  v_max3_f32 v249, v249, v148, v149
  v_max3_f32 v243, v243, v150, v151
  v_mfma_f32_16x16x32_bf16 a[36:39], a[220:223], v[160:163], a[36:39]
  ds_read_b64_tr_b16 a[244:245], v228 offset:14344
  v_max3_f32 v249, v249, v152, v153
  v_mfma_f32_16x16x32_bf16 a[44:47], a[220:223], v[164:167], a[44:47]
  ds_read_b64_tr_b16 a[246:247], v228 offset:14856
  s_add_u32 m0, s57, 0x1410
  v_mfma_f32_16x16x32_bf16 a[52:55], a[220:223], v[168:171], a[52:55]
  buffer_load_dwordx4 v216, s[24:27], s59 offen lds
  v_max3_f32 v243, v243, v154, v155
  v_mfma_f32_16x16x32_bf16 a[60:63], a[220:223], v[172:175], a[60:63]
  s_waitcnt lgkmcnt(10)
  v_max3_f32 v249, v249, v156, v157
  v_max3_f32 v243, v243, v158, v159
  v_mfma_f32_16x16x32_bf16 a[64:67], a[224:227], v[160:163], a[64:67]
  ds_read_b64_tr_b16 a[248:249], v228 offset:14592
  v_max_f32 v243, v243, v249
  v_mfma_f32_16x16x32_bf16 a[72:75], a[224:227], v[164:167], a[72:75]
  ds_read_b64_tr_b16 a[250:251], v228 offset:15104
  s_add_u32 m0, s55, s76
  v_mfma_f32_16x16x32_bf16 a[80:83], a[224:227], v[168:171], a[80:83]
  buffer_load_dwordx4 v217, s[24:27], s59 offen lds
  v_cmp_lt_f32 vcc, s63, v243
  v_mfma_f32_16x16x32_bf16 a[88:91], a[224:227], v[172:175], a[88:91]
  s_cbranch_vccnz L_sk12_far
L_sk12:
  s_waitcnt lgkmcnt(10)
  v_mfma_f32_16x16x32_bf16 a[68:71], a[228:231], v[160:163], a[68:71]
  ds_read_b64_tr_b16 a[252:253], v228 offset:14600
  v_mfma_f32_16x16x32_bf16 a[76:79], a[228:231], v[164:167], a[76:79]
  s_add_u32 s54, s54, 0x6080
  s_cmp_ge_u32 s54, 0x24300
  s_cselect_b32 s54, 0, s54
  v_mfma_f32_16x16x32_bf16 a[84:87], a[228:231], v[168:171], a[84:87]
  ds_read_b64_tr_b16 a[254:255], v228 offset:15112
  s_add_u32 s59, s59, 0x14000
  v_mfma_f32_16x16x32_bf16 a[92:95], a[228:231], v[172:175], a[92:95]
  s_waitcnt vmcnt(15)
  s_barrier
  s_waitcnt lgkmcnt(10)
  v_mfma_f32_16x16x32_bf16 a[96:99], a[232:235], v[160:163], a[96:99]
  v_add_u32 v229, s54, v226
  v_add_u32 v228, s54, v225
  v_xor_b32 v230, 64, v229
  v_mfma_f32_16x16x32_bf16 a[104:107], a[232:235], v[164:167], a[104:107]
  ds_read_b64_tr_b16 a[208:209], v228 offset:12288
  v_mfma_f32_16x16x32_bf16 a[112:115], a[232:235], v[168:171], a[112:115]
  ds_read_b64_tr_b16 a[210:211], v228 offset:13312
  v_mfma_f32_16x16x32_bf16 a[120:123], a[232:235], v[172:175], a[120:123]
  s_add_u32 s55, s55, 0x6080
  s_cmp_ge_u32 s55, 0x24300
  s_cselect_b32 s55, 0, s55
  s_waitcnt lgkmcnt(10)
  v_mfma_f32_16x16x32_bf16 a[100:103], a[236:239], v[160:163], a[100:103]
  ds_read_b64_tr_b16 a[212:213], v228 offset:12296
  v_mfma_f32_16x16x32_bf16 a[108:111], a[236:239], v[164:167], a[108:111]
  ds_read_b64_tr_b16 a[214:215], v228 offset:13320
  v_mfma_f32_16x16x32_bf16 a[116:119], a[236:239], v[168:171], a[116:119]
  v_exp_f32 v128, v128
  v_mfma_f32_16x16x32_bf16 a[124:127], a[236:239], v[172:175], a[124:127]
  s_waitcnt lgkmcnt(10)
  v_exp_f32 v129, v129
  v_mfma_f32_16x16x32_bf16 a[128:131], a[240:243], v[160:163], a[128:131]
  ds_read_b64_tr_b16 a[216:217], v228 offset:12544
  v_cvt_pk_bf16_f32 v176, v128, v129
  v_mfma_f32_16x16x32_bf16 a[136:139], a[240:243], v[164:167], a[136:139]
  ds_read_b64_tr_b16 a[218:219], v228 offset:13568
  v_mfma_f32_16x16x32_bf16 a[144:147], a[240:243], v[168:171], a[144:147]
  v_exp_f32 v130, v130
  v_mfma_f32_16x16x32_bf16 a[152:155], a[240:243], v[172:175], a[152:155]
  s_waitcnt lgkmcnt(10)
  v_exp_f32 v131, v131
  v_mfma_f32_16x16x32_bf16 a[132:135], a[244:247], v[160:163], a[132:135]
  ds_read_b64_tr_b16 a[220:221], v228 offset:12552
  v_cvt_pk_bf16_f32 v177, v130, v131
  v_mfma_f32_16x16x32_bf16 a[140:143], a[244:247], v[164:167], a[140:143]
  ds_read_b64_tr_b16 a[222:223], v228 offset:13576
  v_mfma_f32_16x16x32_bf16 a[148:151], a[244:247], v[168:171], a[148:151]
  v_exp_f32 v132, v132
  v_mfma_f32_16x16x32_bf16 a[156:159], a[244:247], v[172:175], a[156:159]
  s_waitcnt lgkmcnt(10)
  v_exp_f32 v133, v133
  v_mfma_f32_16x16x32_bf16 a[160:163], a[248:251], v[160:163], a[160:163]
  ds_read_b64_tr_b16 a[224:225], v228 offset:12800
  v_cvt_pk_bf16_f32 v178, v132, v133
  v_mfma_f32_16x16x32_bf16 a[168:171], a[248:251], v[164:167], a[168:171]
  ds_read_b64_tr_b16 a[226:227], v228 offset:13824
  v_mfma_f32_16x16x32_bf16 a[176:179], a[248:251], v[168:171], a[176:179]
  v_exp_f32 v134, v134
  v_mfma_f32_16x16x32_bf16 a[184:187], a[248:251], v[172:175], a[184:187]
  s_waitcnt lgkmcnt(10)
  v_exp_f32 v135, v135
  v_mfma_f32_16x16x32_bf16 a[164:167], a[252:255], v[160:163], a[164:167]
  ds_read_b64_tr_b16 a[228:229], v228 offset:12808
  v_cvt_pk_bf16_f32 v179, v134, v135
  v_mfma_f32_16x16x32_bf16 a[172:175], a[252:255], v[164:167], a[172:175]
  ds_read_b64_tr_b16 a[230:231], v228 offset:13832
  v_mfma_f32_16x16x32_bf16 a[180:183], a[252:255], v[168:171], a[180:183]
  v_exp_f32 v136, v136
  v_mfma_f32_16x16x32_bf16 a[188:191], a[252:255], v[172:175], a[188:191]
  v_exp_f32 v137, v137
  v_mfma_f32_16x16x32_bf16 a[192:195], v[208:211], v[160:163], a[192:195]
  v_exp_f32 v138, v138
  v_mfma_f32_16x16x32_bf16 a[196:199], v[208:211], v[164:167], a[196:199]
  v_cvt_pk_bf16_f32 v180, v136, v137
  v_mfma_f32_16x16x32_bf16 a[200:203], v[208:211], v[168:171], a[200:203]
  v_exp_f32 v139, v139
  v_mfma_f32_16x16x32_bf16 a[204:207], v[208:211], v[172:175], a[204:207]
  v_exp_f32 v140, v140
  v_cvt_pk_bf16_f32 v181, v138, v139
  v_exp_f32 v141, v141
  v_exp_f32 v142, v142
  v_cvt_pk_bf16_f32 v182, v140, v141
  v_exp_f32 v143, v143
  v_exp_f32 v144, v144
  v_cvt_pk_bf16_f32 v183, v142, v143
  v_exp_f32 v145, v145
  v_exp_f32 v146, v146
  v_cvt_pk_bf16_f32 v184, v144, v145
  v_exp_f32 v147, v147
  v_exp_f32 v148, v148
  v_cvt_pk_bf16_f32 v185, v146, v147
  v_exp_f32 v149, v149
  v_exp_f32 v150, v150
  v_cvt_pk_bf16_f32 v186, v148, v149
  v_exp_f32 v151, v151
  v_exp_f32 v152, v152
  v_cvt_pk_bf16_f32 v187, v150, v151
  v_exp_f32 v153, v153
  v_exp_f32 v154, v154
  v_cvt_pk_bf16_f32 v188, v152, v153
  v_exp_f32 v155, v155
  v_exp_f32 v156, v156
  v_cvt_pk_bf16_f32 v189, v154, v155
  v_exp_f32 v157, v157
  v_exp_f32 v158, v158
  v_cvt_pk_bf16_f32 v190, v156, v157
  v_exp_f32 v159, v159
  s_nop 0
  v_cvt_pk_bf16_f32 v191, v158, v159
  s_cmp_lg_u32 s66, 0
  s_cbranch_scc1 L_rs13_far
L_rs13:
  s_mov_b32 s26, s98
  v_mfma_f32_16x16x32_bf16 a[192:195], v[208:211], v[176:179], a[192:195]
  v_mfma_f32_16x16x32_bf16 a[196:199], v[208:211], v[180:183], a[196:199]
  s_bfe_u32 s59, s32, 0x40000
  s_mul_i32 s59, s59, 0x14000
  v_mfma_f32_16x16x32_bf16 a[200:203], v[208:211], v[184:187], a[200:203]
  v_mfma_f32_16x16x32_bf16 a[204:207], v[208:211], v[188:191], a[204:207]
  s_waitcnt lgkmcnt(10)
  v_mfma_f32_16x16x32_bf16 a[0:3], a[208:211], v[176:179], a[0:3]
  ds_read_b64_tr_b16 a[232:233], v228 offset:13056
  v_mfma_f32_16x16x32_bf16 a[8:11], a[208:211], v[180:183], a[8:11]
  ds_read_b64_tr_b16 a[234:235], v228 offset:14080
  v_mfma_f32_16x16x32_bf16 a[16:19], a[208:211], v[184:187], a[16:19]
  s_add_u32 s57, s55, s75
  s_add_u32 m0, s57, 0
  v_mfma_f32_16x16x32_bf16 a[24:27], a[208:211], v[188:191], a[24:27]
  buffer_load_dwordx4 v213, s[24:27], s59 offen lds
  s_waitcnt lgkmcnt(10)
  v_mfma_f32_16x16x32_bf16 a[4:7], a[212:215], v[176:179], a[4:7]
  ds_read_b64_tr_b16 a[236:237], v228 offset:13064
  v_mfma_f32_16x16x32_bf16 a[12:15], a[212:215], v[180:183], a[12:15]
  ds_read_b64_tr_b16 a[238:239], v228 offset:14088
  s_add_u32 m0, s57, 0x400
  v_mfma_f32_16x16x32_bf16 a[20:23], a[212:215], v[184:187], a[20:23]
  buffer_load_dwordx4 v214, s[24:27], s59 offen lds
  v_accvgpr_read_b32 v239, a192
  v_mfma_f32_16x16x32_bf16 a[28:31], a[212:215], v[188:191], a[28:31]
  s_waitcnt lgkmcnt(10)
  v_accvgpr_read_b32 v240, a196
  v_accvgpr_read_b32 v241, a200
  v_mfma_f32_16x16x32_bf16 a[32:35], a[216:219], v[176:179], a[32:35]
  ds_read_b64_tr_b16 a[240:241], v228 offset:14336
  v_accvgpr_read_b32 v242, a204
  v_mfma_f32_16x16x32_bf16 a[40:43], a[216:219], v[180:183], a[40:43]
  ds_read_b64_tr_b16 a[242:243], v228 offset:14848
  s_add_u32 m0, s57, 0x1010
  v_mfma_f32_16x16x32_bf16 a[48:51], a[216:219], v[184:187], a[48:51]
  buffer_load_dwordx4 v215, s[24:27], s59 offen lds
  v_mfma_f32_16x16x32_bf16 a[56:59], a[216:219], v[188:191], a[56:59]
  s_waitcnt lgkmcnt(10)
  v_rcp_f32 v239, v239
  v_mfma_f32_16x16x32_bf16 a[36:39], a[220:223], v[176:179], a[36:39]
  ds_read_b64_tr_b16 a[244:245], v228 offset:14344
  v_mfma_f32_16x16x32_bf16 a[44:47], a[220:223], v[180:183], a[44:47]
  ds_read_b64_tr_b16 a[246:247], v228 offset:14856
  s_add_u32 m0, s57, 0x1410
  v_mfma_f32_16x16x32_bf16 a[52:55], a[220:223], v[184:187], a[52:55]
  buffer_load_dwordx4 v216, s[24:27], s59 offen lds
  v_accvgpr_read_b32 v192, a0
  v_mfma_f32_16x16x32_bf16 a[60:63], a[220:223], v[188:191], a[60:63]
  s_waitcnt lgkmcnt(10)
  v_rcp_f32 v240, v240
  v_mfma_f32_16x16x32_bf16 a[64:67], a[224:227], v[176:179], a[64:67]
  ds_read_b64_tr_b16 a[248:249], v228 offset:14592
  v_accvgpr_read_b32 v193, a1
  v_mfma_f32_16x16x32_bf16 a[72:75], a[224:227], v[180:183], a[72:75]
  ds_read_b64_tr_b16 a[250:251], v228 offset:15104
  s_add_u32 m0, s55, s76
  v_mfma_f32_16x16x32_bf16 a[80:83], a[224:227], v[184:187], a[80:83]
  buffer_load_dwordx4 v217, s[24:27], s59 offen lds
  v_accvgpr_read_b32 v194, a2
  v_mfma_f32_16x16x32_bf16 a[88:91], a[224:227], v[188:191], a[88:91]
  s_waitcnt lgkmcnt(10)
  v_rcp_f32 v241, v241
  v_mfma_f32_16x16x32_bf16 a[68:71], a[228:231], v[176:179], a[68:71]
  ds_read_b64_tr_b16 a[252:253], v228 offset:14600
  v_accvgpr_read_b32 v195, a3
  v_mfma_f32_16x16x32_bf16 a[76:79], a[228:231], v[180:183], a[76:79]
  s_add_u32 s54, s54, 0x6080
  s_cmp_ge_u32 s54, 0x24300
  s_cselect_b32 s54, 0, s54
  v_mfma_f32_16x16x32_bf16 a[84:87], a[228:231], v[184:187], a[84:87]
  ds_read_b64_tr_b16 a[254:255], v228 offset:15112
  v_accvgpr_read_b32 v196, a4
  v_mfma_f32_16x16x32_bf16 a[92:95], a[228:231], v[188:191], a[92:95]
  s_add_u32 s55, s55, 0x6080
  s_cmp_ge_u32 s55, 0x24300
  s_cselect_b32 s55, 0, s55
  s_waitcnt lgkmcnt(10)
  v_mfma_f32_16x16x32_bf16 a[96:99], a[232:235], v[176:179], a[96:99]
  s_waitcnt vmcnt(15)
  s_barrier
  v_add_u32 v228, s54, v218
  v_add_u32 v229, s54, v219
  v_mfma_f32_16x16x32_bf16 a[104:107], a[232:235], v[180:183], a[104:107]
  ds_read_b64_tr_b16 a[208:209], v228
  v_accvgpr_read_b32 v197, a5
  v_mfma_f32_16x16x32_bf16 a[112:115], a[232:235], v[184:187], a[112:115]
  ds_read_b64_tr_b16 a[210:211], v228 offset:1024
  v_accvgpr_read_b32 v198, a6
  v_mfma_f32_16x16x32_bf16 a[120:123], a[232:235], v[188:191], a[120:123]
  s_waitcnt lgkmcnt(10)
  v_rcp_f32 v242, v242
  v_mfma_f32_16x16x32_bf16 a[100:103], a[236:239], v[176:179], a[100:103]
  ds_read_b64_tr_b16 a[212:213], v228 offset:8
  v_accvgpr_read_b32 v199, a7
  v_mfma_f32_16x16x32_bf16 a[108:111], a[236:239], v[180:183], a[108:111]
  ds_read_b64_tr_b16 a[214:215], v228 offset:1032
  v_mul_f32 v192, v192, v239
  v_mfma_f32_16x16x32_bf16 a[116:119], a[236:239], v[184:187], a[116:119]
  v_mul_f32 v193, v193, v239
  v_mul_f32 v194, v194, v239
  v_mfma_f32_16x16x32_bf16 a[124:127], a[236:239], v[188:191], a[124:127]
  s_waitcnt lgkmcnt(10)
  v_mul_f32 v195, v195, v239
  v_mul_f32 v196, v196, v239
  v_mfma_f32_16x16x32_bf16 a[128:131], a[240:243], v[176:179], a[128:131]
  ds_read_b64_tr_b16 a[216:217], v228 offset:256
  v_mul_f32 v197, v197, v239
  v_mfma_f32_16x16x32_bf16 a[136:139], a[240:243], v[180:183], a[136:139]
  ds_read_b64_tr_b16 a[218:219], v228 offset:1280
  v_mul_f32 v198, v198, v239
  v_mfma_f32_16x16x32_bf16 a[144:147], a[240:243], v[184:187], a[144:147]
  v_mul_f32 v199, v199, v239
  v_cvt_pk_bf16_f32 v160, v192, v193
  v_mfma_f32_16x16x32_bf16 a[152:155], a[240:243], v[188:191], a[152:155]
  s_waitcnt lgkmcnt(10)
  v_cvt_pk_bf16_f32 v161, v194, v195
  v_cvt_pk_bf16_f32 v162, v196, v197
  v_mfma_f32_16x16x32_bf16 a[132:135], a[244:247], v[176:179], a[132:135]
  ds_read_b64_tr_b16 a[220:221], v228 offset:264
  v_cvt_pk_bf16_f32 v163, v198, v199
  v_mfma_f32_16x16x32_bf16 a[140:143], a[244:247], v[180:183], a[140:143]
  ds_read_b64_tr_b16 a[222:223], v228 offset:1288
  v_accvgpr_read_b32 v200, a8
  v_mfma_f32_16x16x32_bf16 a[148:151], a[244:247], v[184:187], a[148:151]
  buffer_store_dwordx4 v[160:163], v235, s[20:23], s77 offen sc1
  v_accvgpr_read_b32 v201, a9
  v_mfma_f32_16x16x32_bf16 a[156:159], a[244:247], v[188:191], a[156:159]
  s_waitcnt lgkmcnt(10)
  v_accvgpr_read_b32 v202, a10
  v_accvgpr_read_b32 v203, a11
  v_mfma_f32_16x16x32_bf16 a[160:163], a[248:251], v[176:179], a[160:163]
  ds_read_b64_tr_b16 a[224:225], v228 offset:512
  v_accvgpr_read_b32 v204, a12
  v_mfma_f32_16x16x32_bf16 a[168:171], a[248:251], v[180:183], a[168:171]
  ds_read_b64_tr_b16 a[226:227], v228 offset:1536
  v_accvgpr_read_b32 v205, a13
  v_mfma_f32_16x16x32_bf16 a[176:179], a[248:251], v[184:187], a[176:179]
  v_accvgpr_read_b32 v206, a14
  v_accvgpr_read_b32 v207, a15
  v_mfma_f32_16x16x32_bf16 a[184:187], a[248:251], v[188:191], a[184:187]
  s_waitcnt lgkmcnt(10)
  v_mul_f32 v200, v200, v240
  v_mul_f32 v201, v201, v240
  v_mfma_f32_16x16x32_bf16 a[164:167], a[252:255], v[176:179], a[164:167]
  ds_read_b64_tr_b16 a[228:229], v228 offset:520
  v_mul_f32 v202, v202, v240
  v_mfma_f32_16x16x32_bf16 a[172:175], a[252:255], v[180:183], a[172:175]
  ds_read_b64_tr_b16 a[230:231], v228 offset:1544
  v_mul_f32 v203, v203, v240
  v_mfma_f32_16x16x32_bf16 a[180:183], a[252:255], v[184:187], a[180:183]
  v_mul_f32 v204, v204, v240
  v_mul_f32 v205, v205, v240
  v_mfma_f32_16x16x32_bf16 a[188:191], a[252:255], v[188:191], a[188:191]
  v_mul_f32 v206, v206, v240
  v_mul_f32 v207, v207, v240
  v_cvt_pk_bf16_f32 v164, v200, v201
  v_cvt_pk_bf16_f32 v165, v202, v203
  v_cvt_pk_bf16_f32 v166, v204, v205
  v_cvt_pk_bf16_f32 v167, v206, v207
  buffer_store_dwordx4 v[164:167], v236, s[20:23], s77 offen sc1
  v_accvgpr_read_b32 v192, a16
  v_accvgpr_read_b32 v193, a17
  v_accvgpr_read_b32 v194, a18
  v_accvgpr_read_b32 v195, a19
  v_accvgpr_read_b32 v196, a20
  v_accvgpr_read_b32 v197, a21
  v_accvgpr_read_b32 v198, a22
  v_accvgpr_read_b32 v199, a23
  v_mul_f32 v192, v192, v241
  v_mul_f32 v193, v193, v241
  v_mul_f32 v194, v194, v241
  v_mul_f32 v195, v195, v241
  v_mul_f32 v196, v196, v241
  v_mul_f32 v197, v197, v241
  v_mul_f32 v198, v198, v241
  v_mul_f32 v199, v199, v241
  v_cvt_pk_bf16_f32 v168, v192, v193
  v_cvt_pk_bf16_f32 v169, v194, v195
  v_cvt_pk_bf16_f32 v170, v196, v197
  v_cvt_pk_bf16_f32 v171, v198, v199
  buffer_store_dwordx4 v[168:171], v237, s[20:23], s77 offen sc1
  v_accvgpr_read_b32 v200, a24
  v_accvgpr_read_b32 v201, a25
  v_accvgpr_read_b32 v202, a26
  v_accvgpr_read_b32 v203, a27
  v_accvgpr_read_b32 v204, a28
  v_accvgpr_read_b32 v205, a29
  v_accvgpr_read_b32 v206, a30
  v_accvgpr_read_b32 v207, a31
  v_mul_f32 v200, v200, v242
  v_mul_f32 v201, v201, v242
  v_mul_f32 v202, v202, v242
  v_mul_f32 v203, v203, v242
  v_mul_f32 v204, v204, v242
  v_mul_f32 v205, v205, v242
  v_mul_f32 v206, v206, v242
  v_mul_f32 v207, v207, v242
  v_cvt_pk_bf16_f32 v172, v200, v201
  v_cvt_pk_bf16_f32 v173, v202, v203
  v_cvt_pk_bf16_f32 v174, v204, v205
  v_cvt_pk_bf16_f32 v175, v206, v207
  buffer_store_dwordx4 v[172:175], v238, s[20:23], s77 offen sc1
  s_waitcnt lgkmcnt(10)
  v_mfma_f32_16x16x32_bf16 v[0:3], a[208:211], v[160:163], 0
  ds_read_b64_tr_b16 a[232:233], v228 offset:768
  v_accvgpr_read_b32 v192, a32
  v_mfma_f32_16x16x32_bf16 v[8:11], a[208:211], v[164:167], 0
  ds_read_b64_tr_b16 a[234:235], v228 offset:1792
  v_accvgpr_read_b32 v193, a33
  v_mfma_f32_16x16x32_bf16 v[16:19], a[208:211], v[168:171], 0
  v_accvgpr_read_b32 v194, a34
  v_accvgpr_read_b32 v195, a35
  v_mfma_f32_16x16x32_bf16 v[24:27], a[208:211], v[172:175], 0
  s_waitcnt lgkmcnt(10)
  v_accvgpr_read_b32 v196, a36
  v_accvgpr_read_b32 v197, a37
  v_mfma_f32_16x16x32_bf16 v[4:7], a[212:215], v[160:163], 0
  ds_read_b64_tr_b16 a[236:237], v228 offset:776
  v_accvgpr_read_b32 v198, a38
  v_mfma_f32_16x16x32_bf16 v[12:15], a[212:215], v[164:167], 0
  ds_read_b64_tr_b16 a[238:239], v228 offset:1800
  v_accvgpr_read_b32 v199, a39
  v_mfma_f32_16x16x32_bf16 v[20:23], a[212:215], v[168:171], 0
  v_mul_f32 v192, v192, v239
  v_mul_f32 v193, v193, v239
  v_mfma_f32_16x16x32_bf16 v[28:31], a[212:215], v[172:175], 0
  s_waitcnt lgkmcnt(10)
  v_mul_f32 v194, v194, v239
  v_mul_f32 v195, v195, v239
  v_mfma_f32_16x16x32_bf16 v[32:35], a[216:219], v[160:163], 0
  ds_read_b64_tr_b16 a[240:241], v229 offset:8224
  v_mul_f32 v196, v196, v239
  v_mfma_f32_16x16x32_bf16 v[40:43], a[216:219], v[164:167], 0
  ds_read_b64_tr_b16 a[242:243], v229 offset:8480
  v_mul_f32 v197, v197, v239
  v_mfma_f32_16x16x32_bf16 v[48:51], a[216:219], v[168:171], 0
  v_mul_f32 v198, v198, v239
  v_mul_f32 v199, v199, v239
  v_mfma_f32_16x16x32_bf16 v[56:59], a[216:219], v[172:175], 0
  s_waitcnt lgkmcnt(10)
  v_cvt_pk_bf16_f32 v176, v192, v193
  v_cvt_pk_bf16_f32 v177, v194, v195
  v_mfma_f32_16x16x32_bf16 v[36:39], a[220:223], v[160:163], 0
  ds_read_b64_tr_b16 a[244:245], v229 offset:8232
  v_cvt_pk_bf16_f32 v178, v196, v197
  v_mfma_f32_16x16x32_bf16 v[44:47], a[220:223], v[164:167], 0
  ds_read_b64_tr_b16 a[246:247], v229 offset:8488
  v_cvt_pk_bf16_f32 v179, v198, v199
  v_mfma_f32_16x16x32_bf16 v[52:55], a[220:223], v[168:171], 0
  buffer_store_dwordx4 v[176:179], v235, s[20:23], s77 offen offset:1024 sc1
  v_accvgpr_read_b32 v200, a40
  v_mfma_f32_16x16x32_bf16 v[60:63], a[220:223], v[172:175], 0
  s_waitcnt lgkmcnt(10)
  v_accvgpr_read_b32 v201, a41
  v_accvgpr_read_b32 v202, a42
  v_mfma_f32_16x16x32_bf16 v[64:67], a[224:227], v[160:163], 0
  ds_read_b64_tr_b16 a[208:209], v228 offset:10288
  v_accvgpr_read_b32 v203, a43
  v_mfma_f32_16x16x32_bf16 v[72:75], a[224:227], v[164:167], 0
  ds_read_b64_tr_b16 a[210:211], v228 offset:11312
  v_accvgpr_read_b32 v204, a44
  v_mfma_f32_16x16x32_bf16 v[80:83], a[224:227], v[168:171], 0
  s_bfe_u32 s59, s32, 0x40004
  s_mul_i32 s59, s59, 0x14000
  v_accvgpr_read_b32 v205, a45
  v_mfma_f32_16x16x32_bf16 v[88:91], a[224:227], v[172:175], 0
  s_waitcnt lgkmcnt(10)
  v_accvgpr_read_b32 v206, a46
  v_accvgpr_read_b32 v207, a47
  v_mfma_f32_16x16x32_bf16 v[68:71], a[228:231], v[160:163], 0
  ds_read_b64_tr_b16 a[212:213], v228 offset:10296
  v_mul_f32 v200, v200, v240
  v_mfma_f32_16x16x32_bf16 v[76:79], a[228:231], v[164:167], 0
  ds_read_b64_tr_b16 a[214:215], v228 offset:11320
  v_mul_f32 v201, v201, v240
  v_mfma_f32_16x16x32_bf16 v[84:87], a[228:231], v[168:171], 0
  s_add_u32 s57, s55, s75
  s_add_u32 m0, s57, 0
  v_mul_f32 v202, v202, v240
  v_mfma_f32_16x16x32_bf16 v[92:95], a[228:231], v[172:175], 0
  buffer_load_dwordx4 v213, s[24:27], s59 offen lds
  s_waitcnt lgkmcnt(10)
  v_mfma_f32_16x16x32_bf16 v[96:99], a[232:235], v[160:163], 0
  ds_read_b64_tr_b16 a[216:217], v228 offset:10544
  v_mul_f32 v203, v203, v240
  v_mfma_f32_16x16x32_bf16 v[104:107], a[232:235], v[164:167], 0
  ds_read_b64_tr_b16 a[218:219], v228 offset:11568
  s_add_u32 m0, s57, 0x400
  v_mfma_f32_16x16x32_bf16 v[112:115], a[232:235], v[168:171], 0
  buffer_load_dwordx4 v214, s[24:27], s59 offen lds
  v_mul_f32 v204, v204, v240
  v_mfma_f32_16x16x32_bf16 v[120:123], a[232:235], v[172:175], 0
  s_waitcnt lgkmcnt(10)
  v_mul_f32 v205, v205, v240
  v_mul_f32 v206, v206, v240
  v_mfma_f32_16x16x32_bf16 v[100:103], a[236:239], v[160:163], 0
  ds_read_b64_tr_b16 a[220:221], v228 offset:10552
  v_mul_f32 v207, v207, v240
  v_mfma_f32_16x16x32_bf16 v[108:111], a[236:239], v[164:167], 0
  ds_read_b64_tr_b16 a[222:223], v228 offset:11576
  s_add_u32 m0, s57, 0x1010
  v_mfma_f32_16x16x32_bf16 v[116:119], a[236:239], v[168:171], 0
  buffer_load_dwordx4 v215, s[24:27], s59 offen lds
  v_cvt_pk_bf16_f32 v180, v200, v201
  v_mfma_f32_16x16x32_bf16 v[124:127], a[236:239], v[172:175], 0
  s_waitcnt lgkmcnt(10)
  v_cvt_pk_bf16_f32 v181, v202, v203
  v_cvt_pk_bf16_f32 v182, v204, v205
  v_mfma_f32_16x16x32_bf16 v[128:131], a[240:243], v[160:163], 0
  ds_read_b64_tr_b16 a[224:225], v228 offset:10800
  v_cvt_pk_bf16_f32 v183, v206, v207
  v_mfma_f32_16x16x32_bf16 v[136:139], a[240:243], v[164:167], 0
  ds_read_b64_tr_b16 a[226:227], v228 offset:11824
  s_add_u32 m0, s57, 0x1410
  v_mfma_f32_16x16x32_bf16 v[144:147], a[240:243], v[168:171], 0
  buffer_load_dwordx4 v216, s[24:27], s59 offen lds
  v_accvgpr_read_b32 v192, a48
  v_mfma_f32_16x16x32_bf16 v[152:155], a[240:243], v[172:175], 0
  buffer_store_dwordx4 v[180:183], v236, s[20:23], s77 offen offset:1024 sc1
  s_waitcnt lgkmcnt(10)
  v_mfma_f32_16x16x32_bf16 v[132:135], a[244:247], v[160:163], 0
  ds_read_b64_tr_b16 a[228:229], v228 offset:10808
  v_accvgpr_read_b32 v193, a49
  v_mfma_f32_16x16x32_bf16 v[140:143], a[244:247], v[164:167], 0
  ds_read_b64_tr_b16 a[230:231], v228 offset:11832
  s_add_u32 m0, s55, s76
  v_mfma_f32_16x16x32_bf16 v[148:151], a[244:247], v[168:171], 0
  buffer_load_dwordx4 v217, s[24:27], s59 offen lds
  v_accvgpr_read_b32 v194, a50
  v_mfma_f32_16x16x32_bf16 v[156:159], a[244:247], v[172:175], 0
  v_accvgpr_read_b32 v195, a51
  v_accvgpr_read_b32 v196, a52
  v_accvgpr_read_b32 v197, a53
  v_accvgpr_read_b32 v198, a54
  v_accvgpr_read_b32 v199, a55
  v_mul_f32 v192, v192, v241
  v_mul_f32 v193, v193, v241
  v_mul_f32 v194, v194, v241
  v_mul_f32 v195, v195, v241
  v_mul_f32 v196, v196, v241
  v_mul_f32 v197, v197, v241
  v_mul_f32 v198, v198, v241
  v_mul_f32 v199, v199, v241
  v_cvt_pk_bf16_f32 v184, v192, v193
  v_cvt_pk_bf16_f32 v185, v194, v195
  v_cvt_pk_bf16_f32 v186, v196, v197
  v_cvt_pk_bf16_f32 v187, v198, v199
  buffer_store_dwordx4 v[184:187], v237, s[20:23], s77 offen offset:1024 sc1
  v_accvgpr_read_b32 v200, a56
  v_accvgpr_read_b32 v201, a57
  v_accvgpr_read_b32 v202, a58
  v_accvgpr_read_b32 v203, a59
  v_accvgpr_read_b32 v204, a60
  v_accvgpr_read_b32 v205, a61
  v_accvgpr_read_b32 v206, a62
  v_accvgpr_read_b32 v207, a63
  v_mul_f32 v200, v200, v242
  v_mul_f32 v201, v201, v242
  v_mul_f32 v202, v202, v242
  v_mul_f32 v203, v203, v242
  v_mul_f32 v204, v204, v242
  v_mul_f32 v205, v205, v242
  v_mul_f32 v206, v206, v242
  v_mul_f32 v207, v207, v242
  v_cvt_pk_bf16_f32 v188, v200, v201
  v_cvt_pk_bf16_f32 v189, v202, v203
  v_cvt_pk_bf16_f32 v190, v204, v205
  v_cvt_pk_bf16_f32 v191, v206, v207
  buffer_store_dwordx4 v[188:191], v238, s[20:23], s77 offen offset:1024 sc1
  s_waitcnt lgkmcnt(10)
  v_mfma_f32_16x16x32_bf16 v[0:3], a[208:211], v[176:179], v[0:3]
  ds_read_b64_tr_b16 a[232:233], v228 offset:11056
  v_accvgpr_read_b32 v192, a64
  v_mfma_f32_16x16x32_bf16 v[8:11], a[208:211], v[180:183], v[8:11]
  ds_read_b64_tr_b16 a[234:235], v228 offset:12080
  v_accvgpr_read_b32 v193, a65
  v_mfma_f32_16x16x32_bf16 v[16:19], a[208:211], v[184:187], v[16:19]
  s_add_u32 s55, s55, 0x6080
  s_cmp_ge_u32 s55, 0x24300
  s_cselect_b32 s55, 0, s55
  v_mfma_f32_16x16x32_bf16 v[24:27], a[208:211], v[188:191], v[24:27]
  s_waitcnt lgkmcnt(10)
  v_accvgpr_read_b32 v194, a66
  v_accvgpr_read_b32 v195, a67
  v_mfma_f32_16x16x32_bf16 v[4:7], a[212:215], v[176:179], v[4:7]
  ds_read_b64_tr_b16 a[236:237], v228 offset:11064
  v_accvgpr_read_b32 v196, a68
  v_mfma_f32_16x16x32_bf16 v[12:15], a[212:215], v[180:183], v[12:15]
  ds_read_b64_tr_b16 a[238:239], v228 offset:12088
  v_accvgpr_read_b32 v197, a69
  v_mfma_f32_16x16x32_bf16 v[20:23], a[212:215], v[184:187], v[20:23]
  v_accvgpr_read_b32 v198, a70
  v_accvgpr_read_b32 v199, a71
  v_mfma_f32_16x16x32_bf16 v[28:31], a[212:215], v[188:191], v[28:31]
  s_waitcnt lgkmcnt(10)
  v_mul_f32 v192, v192, v239
  v_mul_f32 v193, v193, v239
  v_mfma_f32_16x16x32_bf16 v[32:35], a[216:219], v[176:179], v[32:35]
  ds_read_b64_tr_b16 a[240:241], v229 offset:18512
  v_mul_f32 v194, v194, v239
  v_mfma_f32_16x16x32_bf16 v[40:43], a[216:219], v[180:183], v[40:43]
  ds_read_b64_tr_b16 a[242:243], v229 offset:18768
  v_mul_f32 v195, v195, v239
  v_mfma_f32_16x16x32_bf16 v[48:51], a[216:219], v[184:187], v[48:51]
  v_mul_f32 v196, v196, v239
  v_mul_f32 v197, v197, v239
  v_mfma_f32_16x16x32_bf16 v[56:59], a[216:219], v[188:191], v[56:59]
  s_waitcnt lgkmcnt(10)
  v_mul_f32 v198, v198, v239
  v_mul_f32 v199, v199, v239
  v_mfma_f32_16x16x32_bf16 v[36:39], a[220:223], v[176:179], v[36:39]
  ds_read_b64_tr_b16 a[244:245], v229 offset:18520
  v_cvt_pk_bf16_f32 v160, v192, v193
  v_mfma_f32_16x16x32_bf16 v[44:47], a[220:223], v[180:183], v[44:47]
  s_add_u32 s54, s54, 0x6080
  s_cmp_ge_u32 s54, 0x24300
  s_cselect_b32 s54, 0, s54
  v_mfma_f32_16x16x32_bf16 v[52:55], a[220:223], v[184:187], v[52:55]
  ds_read_b64_tr_b16 a[246:247], v229 offset:18776
  v_cvt_pk_bf16_f32 v161, v194, v195
  v_mfma_f32_16x16x32_bf16 v[60:63], a[220:223], v[188:191], v[60:63]
  s_waitcnt vmcnt(23)
  s_barrier
  s_waitcnt lgkmcnt(10)
  v_mfma_f32_16x16x32_bf16 v[64:67], a[224:227], v[176:179], v[64:67]
  v_add_u32 v228, s54, v218
  v_add_u32 v229, s54, v219
  v_mfma_f32_16x16x32_bf16 v[72:75], a[224:227], v[180:183], v[72:75]
  ds_read_b64_tr_b16 a[208:209], v228
  v_cvt_pk_bf16_f32 v162, v196, v197
  v_mfma_f32_16x16x32_bf16 v[80:83], a[224:227], v[184:187], v[80:83]
  ds_read_b64_tr_b16 a[210:211], v228 offset:1024
  v_cvt_pk_bf16_f32 v163, v198, v199
  v_mfma_f32_16x16x32_bf16 v[88:91], a[224:227], v[188:191], v[88:91]
  buffer_store_dwordx4 v[160:163], v235, s[20:23], s77 offen offset:2048 sc1
  s_waitcnt lgkmcnt(10)
  v_mfma_f32_16x16x32_bf16 v[68:71], a[228:231], v[176:179], v[68:71]
  ds_read_b64_tr_b16 a[212:213], v228 offset:8
  v_accvgpr_read_b32 v200, a72
  v_mfma_f32_16x16x32_bf16 v[76:79], a[228:231], v[180:183], v[76:79]
  ds_read_b64_tr_b16 a[214:215], v228 offset:1032
  v_accvgpr_read_b32 v201, a73
  v_mfma_f32_16x16x32_bf16 v[84:87], a[228:231], v[184:187], v[84:87]
  v_accvgpr_read_b32 v202, a74
  v_accvgpr_read_b32 v203, a75
  v_mfma_f32_16x16x32_bf16 v[92:95], a[228:231], v[188:191], v[92:95]
  s_waitcnt lgkmcnt(10)
  v_accvgpr_read_b32 v204, a76
  v_accvgpr_read_b32 v205, a77
  v_mfma_f32_16x16x32_bf16 v[96:99], a[232:235], v[176:179], v[96:99]
  ds_read_b64_tr_b16 a[216:217], v228 offset:256
  v_accvgpr_read_b32 v206, a78
  v_mfma_f32_16x16x32_bf16 v[104:107], a[232:235], v[180:183], v[104:107]
  ds_read_b64_tr_b16 a[218:219], v228 offset:1280
  v_accvgpr_read_b32 v207, a79
  v_mfma_f32_16x16x32_bf16 v[112:115], a[232:235], v[184:187], v[112:115]
  v_mul_f32 v200, v200, v240
  v_mul_f32 v201, v201, v240
  v_mfma_f32_16x16x32_bf16 v[120:123], a[232:235], v[188:191], v[120:123]
  s_waitcnt lgkmcnt(10)
  v_mul_f32 v202, v202, v240
  v_mul_f32 v203, v203, v240
  v_mfma_f32_16x16x32_bf16 v[100:103], a[236:239], v[176:179], v[100:103]
  ds_read_b64_tr_b16 a[220:221], v228 offset:264
  v_mul_f32 v204, v204, v240
  v_mfma_f32_16x16x32_bf16 v[108:111], a[236:239], v[180:183], v[108:111]
  ds_read_b64_tr_b16 a[222:223], v228 offset:1288
  v_mul_f32 v205, v205, v240
  v_mfma_f32_16x16x32_bf16 v[116:119], a[236:239], v[184:187], v[116:119]
  v_mul_f32 v206, v206, v240
  v_mul_f32 v207, v207, v240
  v_mfma_f32_16x16x32_bf16 v[124:127], a[236:239], v[188:191], v[124:127]
  s_waitcnt lgkmcnt(10)
  v_cvt_pk_bf16_f32 v164, v200, v201
  v_cvt_pk_bf16_f32 v165, v202, v203
  v_mfma_f32_16x16x32_bf16 v[128:131], a[240:243], v[176:179], v[128:131]
  ds_read_b64_tr_b16 a[224:225], v228 offset:512
  v_cvt_pk_bf16_f32 v166, v204, v205
  v_mfma_f32_16x16x32_bf16 v[136:139], a[240:243], v[180:183], v[136:139]
  ds_read_b64_tr_b16 a[226:227], v228 offset:1536
  v_cvt_pk_bf16_f32 v167, v206, v207
  v_mfma_f32_16x16x32_bf16 v[144:147], a[240:243], v[184:187], v[144:147]
  buffer_store_dwordx4 v[164:167], v236, s[20:23], s77 offen offset:2048 sc1
  v_accvgpr_read_b32 v192, a80
  v_mfma_f32_16x16x32_bf16 v[152:155], a[240:243], v[188:191], v[152:155]
  s_waitcnt lgkmcnt(10)
  v_accvgpr_read_b32 v193, a81
  v_accvgpr_read_b32 v194, a82
  v_mfma_f32_16x16x32_bf16 v[132:135], a[244:247], v[176:179], v[132:135]
  ds_read_b64_tr_b16 a[228:229], v228 offset:520
  v_accvgpr_read_b32 v195, a83
  v_mfma_f32_16x16x32_bf16 v[140:143], a[244:247], v[180:183], v[140:143]
  ds_read_b64_tr_b16 a[230:231], v228 offset:1544
  v_accvgpr_read_b32 v196, a84
  v_mfma_f32_16x16x32_bf16 v[148:151], a[244:247], v[184:187], v[148:151]
  v_accvgpr_read_b32 v197, a85
  v_accvgpr_read_b32 v198, a86
  v_mfma_f32_16x16x32_bf16 v[156:159], a[244:247], v[188:191], v[156:159]
  v_accvgpr_read_b32 v199, a87
  v_mul_f32 v192, v192, v241
  v_mul_f32 v193, v193, v241
  v_mul_f32 v194, v194, v241
  v_mul_f32 v195, v195, v241
  v_mul_f32 v196, v196, v241
  v_mul_f32 v197, v197, v241
  v_mul_f32 v198, v198, v241
  v_mul_f32 v199, v199, v241
  v_cvt_pk_bf16_f32 v168, v192, v193
  v_cvt_pk_bf16_f32 v169, v194, v195
  v_cvt_pk_bf16_f32 v170, v196, v197
  v_cvt_pk_bf16_f32 v171, v198, v199
  buffer_store_dwordx4 v[168:171], v237, s[20:23], s77 offen offset:2048 sc1
  v_accvgpr_read_b32 v200, a88
  v_accvgpr_read_b32 v201, a89
  v_accvgpr_read_b32 v202, a90
  v_accvgpr_read_b32 v203, a91
  v_accvgpr_read_b32 v204, a92
  v_accvgpr_read_b32 v205, a93
  v_accvgpr_read_b32 v206, a94
  v_accvgpr_read_b32 v207, a95
  v_mul_f32 v200, v200, v242
  v_mul_f32 v201, v201, v242
  v_mul_f32 v202, v202, v242
  v_mul_f32 v203, v203, v242
  v_mul_f32 v204, v204, v242
  v_mul_f32 v205, v205, v242
  v_mul_f32 v206, v206, v242
  v_mul_f32 v207, v207, v242
  v_cvt_pk_bf16_f32 v172, v200, v201
  v_cvt_pk_bf16_f32 v173, v202, v203
  v_cvt_pk_bf16_f32 v174, v204, v205
  v_cvt_pk_bf16_f32 v175, v206, v207
  buffer_store_dwordx4 v[172:175], v238, s[20:23], s77 offen offset:2048 sc1
  s_waitcnt lgkmcnt(10)
  v_mfma_f32_16x16x32_bf16 v[0:3], a[208:211], v[160:163], v[0:3]
  ds_read_b64_tr_b16 a[232:233], v228 offset:768
  v_accvgpr_read_b32 v192, a96
  v_mfma_f32_16x16x32_bf16 v[8:11], a[208:211], v[164:167], v[8:11]
  ds_read_b64_tr_b16 a[234:235], v228 offset:1792
  v_accvgpr_read_b32 v193, a97
  v_mfma_f32_16x16x32_bf16 v[16:19], a[208:211], v[168:171], v[16:19]
  s_waitcnt vmcnt(4)
  v_mov_b32 v248, 1
  v_accvgpr_read_b32 v194, a98
  v_mfma_f32_16x16x32_bf16 v[24:27], a[208:211], v[172:175], v[24:27]
  buffer_store_dword v248, v250, s[20:23], s81 offen sc1
  s_waitcnt lgkmcnt(10)
  v_mfma_f32_16x16x32_bf16 v[4:7], a[212:215], v[160:163], v[4:7]
  ds_read_b64_tr_b16 a[236:237], v228 offset:776
  v_accvgpr_read_b32 v195, a99
  v_mfma_f32_16x16x32_bf16 v[12:15], a[212:215], v[164:167], v[12:15]
  ds_read_b64_tr_b16 a[238:239], v228 offset:1800
  v_accvgpr_read_b32 v196, a100
  v_mfma_f32_16x16x32_bf16 v[20:23], a[212:215], v[168:171], v[20:23]
  v_accvgpr_read_b32 v197, a101
  v_accvgpr_read_b32 v198, a102
  v_mfma_f32_16x16x32_bf16 v[28:31], a[212:215], v[172:175], v[28:31]
  s_waitcnt lgkmcnt(10)
  v_accvgpr_read_b32 v199, a103
  v_mul_f32 v192, v192, v239
  v_mfma_f32_16x16x32_bf16 v[32:35], a[216:219], v[160:163], v[32:35]
  ds_read_b64_tr_b16 a[240:241], v229 offset:8224
  v_mul_f32 v193, v193, v239
  v_mfma_f32_16x16x32_bf16 v[40:43], a[216:219], v[164:167], v[40:43]
  ds_read_b64_tr_b16 a[242:243], v229 offset:8480
  v_mul_f32 v194, v194, v239
  v_mfma_f32_16x16x32_bf16 v[48:51], a[216:219], v[168:171], v[48:51]
  v_mul_f32 v195, v195, v239
  v_mul_f32 v196, v196, v239
  v_mfma_f32_16x16x32_bf16 v[56:59], a[216:219], v[172:175], v[56:59]
  s_waitcnt lgkmcnt(10)
  v_mul_f32 v197, v197, v239
  v_mul_f32 v198, v198, v239
  v_mfma_f32_16x16x32_bf16 v[36:39], a[220:223], v[160:163], v[36:39]
  ds_read_b64_tr_b16 a[244:245], v229 offset:8232
  v_mul_f32 v199, v199, v239
  v_mfma_f32_16x16x32_bf16 v[44:47], a[220:223], v[164:167], v[44:47]
  ds_read_b64_tr_b16 a[246:247], v229 offset:8488
  v_cvt_pk_bf16_f32 v176, v192, v193
  v_mfma_f32_16x16x32_bf16 v[52:55], a[220:223], v[168:171], v[52:55]
  v_cvt_pk_bf16_f32 v177, v194, v195
  v_cvt_pk_bf16_f32 v178, v196, v197
  v_mfma_f32_16x16x32_bf16 v[60:63], a[220:223], v[172:175], v[60:63]
  s_waitcnt lgkmcnt(10)
  v_cvt_pk_bf16_f32 v179, v198, v199
  v_accvgpr_read_b32 v200, a104
  v_mfma_f32_16x16x32_bf16 v[64:67], a[224:227], v[160:163], v[64:67]
  ds_read_b64_tr_b16 a[208:209], v228 offset:10288
  v_accvgpr_read_b32 v201, a105
  v_mfma_f32_16x16x32_bf16 v[72:75], a[224:227], v[164:167], v[72:75]
  ds_read_b64_tr_b16 a[210:211], v228 offset:11312
  v_accvgpr_read_b32 v202, a106
  v_mfma_f32_16x16x32_bf16 v[80:83], a[224:227], v[168:171], v[80:83]
  s_bfe_u32 s59, s32, 0x40008
  s_mul_i32 s59, s59, 0x14000
  v_accvgpr_read_b32 v203, a107
  v_mfma_f32_16x16x32_bf16 v[88:91], a[224:227], v[172:175], v[88:91]
  buffer_store_dwordx4 v[176:179], v235, s[20:23], s77 offen offset:3072 sc1
  s_waitcnt lgkmcnt(10)
  v_mfma_f32_16x16x32_bf16 v[68:71], a[228:231], v[160:163], v[68:71]
  ds_read_b64_tr_b16 a[212:213], v228 offset:10296
  v_accvgpr_read_b32 v204, a108
  v_mfma_f32_16x16x32_bf16 v[76:79], a[228:231], v[164:167], v[76:79]
  ds_read_b64_tr_b16 a[214:215], v228 offset:11320
  v_accvgpr_read_b32 v205, a109
  v_mfma_f32_16x16x32_bf16 v[84:87], a[228:231], v[168:171], v[84:87]
  s_add_u32 s57, s55, s75
  s_add_u32 m0, s57, 0
  v_accvgpr_read_b32 v206, a110
  v_mfma_f32_16x16x32_bf16 v[92:95], a[228:231], v[172:175], v[92:95]
  buffer_load_dwordx4 v213, s[24:27], s59 offen lds
  s_waitcnt lgkmcnt(10)
  v_mfma_f32_16x16x32_bf16 v[96:99], a[232:235], v[160:163], v[96:99]
  ds_read_b64_tr_b16 a[216:217], v228 offset:10544
  v_accvgpr_read_b32 v207, a111
  v_mfma_f32_16x16x32_bf16 v[104:107], a[232:235], v[164:167], v[104:107]
  ds_read_b64_tr_b16 a[218:219], v228 offset:11568
  s_add_u32 m0, s57, 0x400
  v_mfma_f32_16x16x32_bf16 v[112:115], a[232:235], v[168:171], v[112:115]
  buffer_load_dwordx4 v214, s[24:27], s59 offen lds
  v_mul_f32 v200, v200, v240
  v_mfma_f32_16x16x32_bf16 v[120:123], a[232:235], v[172:175], v[120:123]
  s_waitcnt lgkmcnt(10)
  v_mul_f32 v201, v201, v240
  v_mul_f32 v202, v202, v240
  v_mfma_f32_16x16x32_bf16 v[100:103], a[236:239], v[160:163], v[100:103]
  ds_read_b64_tr_b16 a[220:221], v228 offset:10552
  v_mul_f32 v203, v203, v240
  v_mfma_f32_16x16x32_bf16 v[108:111], a[236:239], v[164:167], v[108:111]
  ds_read_b64_tr_b16 a[222:223], v228 offset:11576
  s_add_u32 m0, s57, 0x1010
  v_mfma_f32_16x16x32_bf16 v[116:119], a[236:239], v[168:171], v[116:119]
  buffer_load_dwordx4 v215, s[24:27], s59 offen lds
  v_mul_f32 v204, v204, v240
  v_mfma_f32_16x16x32_bf16 v[124:127], a[236:239], v[172:175], v[124:127]
  s_waitcnt lgkmcnt(10)
  v_mul_f32 v205, v205, v240
  v_mul_f32 v206, v206, v240
  v_mfma_f32_16x16x32_bf16 v[128:131], a[240:243], v[160:163], v[128:131]
  ds_read_b64_tr_b16 a[224:225], v228 offset:10800
  v_mul_f32 v207, v207, v240
  v_mfma_f32_16x16x32_bf16 v[136:139], a[240:243], v[164:167], v[136:139]
  ds_read_b64_tr_b16 a[226:227], v228 offset:11824
  s_add_u32 m0, s57, 0x1410
  v_mfma_f32_16x16x32_bf16 v[144:147], a[240:243], v[168:171], v[144:147]
  buffer_load_dwordx4 v216, s[24:27], s59 offen lds
  v_cvt_pk_bf16_f32 v180, v200, v201
  v_mfma_f32_16x16x32_bf16 v[152:155], a[240:243], v[172:175], v[152:155]
  s_waitcnt lgkmcnt(10)
  v_cvt_pk_bf16_f32 v181, v202, v203
  v_cvt_pk_bf16_f32 v182, v204, v205
  v_mfma_f32_16x16x32_bf16 v[132:135], a[244:247], v[160:163], v[132:135]
  ds_read_b64_tr_b16 a[228:229], v228 offset:10808
  v_cvt_pk_bf16_f32 v183, v206, v207
  v_mfma_f32_16x16x32_bf16 v[140:143], a[244:247], v[164:167], v[140:143]
  ds_read_b64_tr_b16 a[230:231], v228 offset:11832
  s_add_u32 m0, s55, s76
  v_mfma_f32_16x16x32_bf16 v[148:151], a[244:247], v[168:171], v[148:151]
  buffer_load_dwordx4 v217, s[24:27], s59 offen lds
  v_accvgpr_read_b32 v192, a112
  v_mfma_f32_16x16x32_bf16 v[156:159], a[244:247], v[172:175], v[156:159]
  buffer_store_dwordx4 v[180:183], v236, s[20:23], s77 offen offset:3072 sc1
  v_accvgpr_read_b32 v193, a113
  v_accvgpr_read_b32 v194, a114
  v_accvgpr_read_b32 v195, a115
  v_accvgpr_read_b32 v196, a116
  v_accvgpr_read_b32 v197, a117
  v_accvgpr_read_b32 v198, a118
  v_accvgpr_read_b32 v199, a119
  v_mul_f32 v192, v192, v241
  v_mul_f32 v193, v193, v241
  v_mul_f32 v194, v194, v241
  v_mul_f32 v195, v195, v241
  v_mul_f32 v196, v196, v241
  v_mul_f32 v197, v197, v241
  v_mul_f32 v198, v198, v241
  v_mul_f32 v199, v199, v241
  v_cvt_pk_bf16_f32 v184, v192, v193
  v_cvt_pk_bf16_f32 v185, v194, v195
  v_cvt_pk_bf16_f32 v186, v196, v197
  v_cvt_pk_bf16_f32 v187, v198, v199
  buffer_store_dwordx4 v[184:187], v237, s[20:23], s77 offen offset:3072 sc1
  v_accvgpr_read_b32 v200, a120
  v_accvgpr_read_b32 v201, a121
  v_accvgpr_read_b32 v202, a122
  v_accvgpr_read_b32 v203, a123
  v_accvgpr_read_b32 v204, a124
  v_accvgpr_read_b32 v205, a125
  v_accvgpr_read_b32 v206, a126
  v_accvgpr_read_b32 v207, a127
  v_mul_f32 v200, v200, v242
  v_mul_f32 v201, v201, v242
  v_mul_f32 v202, v202, v242
  v_mul_f32 v203, v203, v242
  v_mul_f32 v204, v204, v242
  v_mul_f32 v205, v205, v242
  v_mul_f32 v206, v206, v242
  v_mul_f32 v207, v207, v242
  v_cvt_pk_bf16_f32 v188, v200, v201
  v_cvt_pk_bf16_f32 v189, v202, v203
  v_cvt_pk_bf16_f32 v190, v204, v205
  v_cvt_pk_bf16_f32 v191, v206, v207
  buffer_store_dwordx4 v[188:191], v238, s[20:23], s77 offen offset:3072 sc1
  s_waitcnt lgkmcnt(10)
  v_mfma_f32_16x16x32_bf16 v[0:3], a[208:211], v[176:179], v[0:3]
  ds_read_b64_tr_b16 a[232:233], v228 offset:11056
  v_accvgpr_read_b32 v192, a128
  v_mfma_f32_16x16x32_bf16 v[8:11], a[208:211], v[180:183], v[8:11]
  ds_read_b64_tr_b16 a[234:235], v228 offset:12080
  v_accvgpr_read_b32 v193, a129
  v_mfma_f32_16x16x32_bf16 v[16:19], a[208:211], v[184:187], v[16:19]
  s_add_u32 s55, s55, 0x6080
  s_cmp_ge_u32 s55, 0x24300
  s_cselect_b32 s55, 0, s55
  v_mfma_f32_16x16x32_bf16 v[24:27], a[208:211], v[188:191], v[24:27]
  s_waitcnt lgkmcnt(10)
  v_accvgpr_read_b32 v194, a130
  v_accvgpr_read_b32 v195, a131
  v_mfma_f32_16x16x32_bf16 v[4:7], a[212:215], v[176:179], v[4:7]
  ds_read_b64_tr_b16 a[236:237], v228 offset:11064
  v_accvgpr_read_b32 v196, a132
  v_mfma_f32_16x16x32_bf16 v[12:15], a[212:215], v[180:183], v[12:15]
  ds_read_b64_tr_b16 a[238:239], v228 offset:12088
  v_accvgpr_read_b32 v197, a133
  v_mfma_f32_16x16x32_bf16 v[20:23], a[212:215], v[184:187], v[20:23]
  v_accvgpr_read_b32 v198, a134
  v_accvgpr_read_b32 v199, a135
  v_mfma_f32_16x16x32_bf16 v[28:31], a[212:215], v[188:191], v[28:31]
  s_waitcnt lgkmcnt(10)
  v_mul_f32 v192, v192, v239
  v_mul_f32 v193, v193, v239
  v_mfma_f32_16x16x32_bf16 v[32:35], a[216:219], v[176:179], v[32:35]
  ds_read_b64_tr_b16 a[240:241], v229 offset:18512
  v_mul_f32 v194, v194, v239
  v_mfma_f32_16x16x32_bf16 v[40:43], a[216:219], v[180:183], v[40:43]
  ds_read_b64_tr_b16 a[242:243], v229 offset:18768
  v_mul_f32 v195, v195, v239
  v_mfma_f32_16x16x32_bf16 v[48:51], a[216:219], v[184:187], v[48:51]
  v_mul_f32 v196, v196, v239
  v_mul_f32 v197, v197, v239
  v_mfma_f32_16x16x32_bf16 v[56:59], a[216:219], v[188:191], v[56:59]
  s_waitcnt lgkmcnt(10)
  v_mul_f32 v198, v198, v239
  v_mul_f32 v199, v199, v239
  v_mfma_f32_16x16x32_bf16 v[36:39], a[220:223], v[176:179], v[36:39]
  ds_read_b64_tr_b16 a[244:245], v229 offset:18520
  v_cvt_pk_bf16_f32 v160, v192, v193
  v_mfma_f32_16x16x32_bf16 v[44:47], a[220:223], v[180:183], v[44:47]
  s_add_u32 s54, s54, 0x6080
  s_cmp_ge_u32 s54, 0x24300
  s_cselect_b32 s54, 0, s54
  v_mfma_f32_16x16x32_bf16 v[52:55], a[220:223], v[184:187], v[52:55]
  ds_read_b64_tr_b16 a[246:247], v229 offset:18776
  v_cvt_pk_bf16_f32 v161, v194, v195
  v_mfma_f32_16x16x32_bf16 v[60:63], a[220:223], v[188:191], v[60:63]
  s_barrier
  s_waitcnt lgkmcnt(10)
  v_mfma_f32_16x16x32_bf16 v[64:67], a[224:227], v[176:179], v[64:67]
  v_add_u32 v228, s54, v218
  v_add_u32 v229, s54, v219
  v_mfma_f32_16x16x32_bf16 v[72:75], a[224:227], v[180:183], v[72:75]
  ds_read_b64_tr_b16 a[208:209], v228
  v_cvt_pk_bf16_f32 v162, v196, v197
  v_mfma_f32_16x16x32_bf16 v[80:83], a[224:227], v[184:187], v[80:83]
  ds_read_b64_tr_b16 a[210:211], v228 offset:1024
  v_cvt_pk_bf16_f32 v163, v198, v199
  v_mfma_f32_16x16x32_bf16 v[88:91], a[224:227], v[188:191], v[88:91]
  buffer_store_dwordx4 v[160:163], v235, s[20:23], s78 offen sc1
  s_waitcnt lgkmcnt(10)
  v_mfma_f32_16x16x32_bf16 v[68:71], a[228:231], v[176:179], v[68:71]
  ds_read_b64_tr_b16 a[212:213], v228 offset:8
  v_accvgpr_read_b32 v200, a136
  v_mfma_f32_16x16x32_bf16 v[76:79], a[228:231], v[180:183], v[76:79]
  ds_read_b64_tr_b16 a[214:215], v228 offset:1032
  v_accvgpr_read_b32 v201, a137
  v_mfma_f32_16x16x32_bf16 v[84:87], a[228:231], v[184:187], v[84:87]
  v_accvgpr_read_b32 v202, a138
  v_accvgpr_read_b32 v203, a139
  v_mfma_f32_16x16x32_bf16 v[92:95], a[228:231], v[188:191], v[92:95]
  s_waitcnt lgkmcnt(10)
  v_accvgpr_read_b32 v204, a140
  v_accvgpr_read_b32 v205, a141
  v_mfma_f32_16x16x32_bf16 v[96:99], a[232:235], v[176:179], v[96:99]
  ds_read_b64_tr_b16 a[216:217], v228 offset:256
  v_accvgpr_read_b32 v206, a142
  v_mfma_f32_16x16x32_bf16 v[104:107], a[232:235], v[180:183], v[104:107]
  ds_read_b64_tr_b16 a[218:219], v228 offset:1280
  v_accvgpr_read_b32 v207, a143
  v_mfma_f32_16x16x32_bf16 v[112:115], a[232:235], v[184:187], v[112:115]
  v_mul_f32 v200, v200, v240
  v_mul_f32 v201, v201, v240
  v_mfma_f32_16x16x32_bf16 v[120:123], a[232:235], v[188:191], v[120:123]
  s_waitcnt lgkmcnt(10)
  v_mul_f32 v202, v202, v240
  v_mul_f32 v203, v203, v240
  v_mfma_f32_16x16x32_bf16 v[100:103], a[236:239], v[176:179], v[100:103]
  ds_read_b64_tr_b16 a[220:221], v228 offset:264
  v_mul_f32 v204, v204, v240
  v_mfma_f32_16x16x32_bf16 v[108:111], a[236:239], v[180:183], v[108:111]
  ds_read_b64_tr_b16 a[222:223], v228 offset:1288
  v_mul_f32 v205, v205, v240
  v_mfma_f32_16x16x32_bf16 v[116:119], a[236:239], v[184:187], v[116:119]
  v_mul_f32 v206, v206, v240
  v_mul_f32 v207, v207, v240
  v_mfma_f32_16x16x32_bf16 v[124:127], a[236:239], v[188:191], v[124:127]
  s_waitcnt lgkmcnt(10)
  v_cvt_pk_bf16_f32 v164, v200, v201
  v_cvt_pk_bf16_f32 v165, v202, v203
  v_mfma_f32_16x16x32_bf16 v[128:131], a[240:243], v[176:179], v[128:131]
  ds_read_b64_tr_b16 a[224:225], v228 offset:512
  v_cvt_pk_bf16_f32 v166, v204, v205
  v_mfma_f32_16x16x32_bf16 v[136:139], a[240:243], v[180:183], v[136:139]
  ds_read_b64_tr_b16 a[226:227], v228 offset:1536
  v_cvt_pk_bf16_f32 v167, v206, v207
  v_mfma_f32_16x16x32_bf16 v[144:147], a[240:243], v[184:187], v[144:147]
  buffer_store_dwordx4 v[164:167], v236, s[20:23], s78 offen sc1
  v_accvgpr_read_b32 v192, a144
  v_mfma_f32_16x16x32_bf16 v[152:155], a[240:243], v[188:191], v[152:155]
  s_waitcnt lgkmcnt(10)
  v_accvgpr_read_b32 v193, a145
  v_accvgpr_read_b32 v194, a146
  v_mfma_f32_16x16x32_bf16 v[132:135], a[244:247], v[176:179], v[132:135]
  ds_read_b64_tr_b16 a[228:229], v228 offset:520
  v_accvgpr_read_b32 v195, a147
  v_mfma_f32_16x16x32_bf16 v[140:143], a[244:247], v[180:183], v[140:143]
  ds_read_b64_tr_b16 a[230:231], v228 offset:1544
  v_accvgpr_read_b32 v196, a148
  v_mfma_f32_16x16x32_bf16 v[148:151], a[244:247], v[184:187], v[148:151]
  v_accvgpr_read_b32 v197, a149
  v_accvgpr_read_b32 v198, a150
  v_mfma_f32_16x16x32_bf16 v[156:159], a[244:247], v[188:191], v[156:159]
  v_accvgpr_read_b32 v199, a151
  v_mul_f32 v192, v192, v241
  v_mul_f32 v193, v193, v241
  v_mul_f32 v194, v194, v241
  v_mul_f32 v195, v195, v241
  v_mul_f32 v196, v196, v241
  v_mul_f32 v197, v197, v241
  v_mul_f32 v198, v198, v241
  v_mul_f32 v199, v199, v241
  v_cvt_pk_bf16_f32 v168, v192, v193
  v_cvt_pk_bf16_f32 v169, v194, v195
  v_cvt_pk_bf16_f32 v170, v196, v197
  v_cvt_pk_bf16_f32 v171, v198, v199
  buffer_store_dwordx4 v[168:171], v237, s[20:23], s78 offen sc1
  v_accvgpr_read_b32 v200, a152
  v_accvgpr_read_b32 v201, a153
  v_accvgpr_read_b32 v202, a154
  v_accvgpr_read_b32 v203, a155
  v_accvgpr_read_b32 v204, a156
  v_accvgpr_read_b32 v205, a157
  v_accvgpr_read_b32 v206, a158
  v_accvgpr_read_b32 v207, a159
  v_mul_f32 v200, v200, v242
  v_mul_f32 v201, v201, v242
  v_mul_f32 v202, v202, v242
  v_mul_f32 v203, v203, v242
  v_mul_f32 v204, v204, v242
  v_mul_f32 v205, v205, v242
  v_mul_f32 v206, v206, v242
  v_mul_f32 v207, v207, v242
  v_cvt_pk_bf16_f32 v172, v200, v201
  v_cvt_pk_bf16_f32 v173, v202, v203
  v_cvt_pk_bf16_f32 v174, v204, v205
  v_cvt_pk_bf16_f32 v175, v206, v207
  buffer_store_dwordx4 v[172:175], v238, s[20:23], s78 offen sc1
  s_waitcnt lgkmcnt(10)
  v_mfma_f32_16x16x32_bf16 v[0:3], a[208:211], v[160:163], v[0:3]
  ds_read_b64_tr_b16 a[232:233], v228 offset:768
  v_accvgpr_read_b32 v192, a160
  v_mfma_f32_16x16x32_bf16 v[8:11], a[208:211], v[164:167], v[8:11]
  ds_read_b64_tr_b16 a[234:235], v228 offset:1792
  v_accvgpr_read_b32 v193, a161
  v_mfma_f32_16x16x32_bf16 v[16:19], a[208:211], v[168:171], v[16:19]
  s_waitcnt vmcnt(4)
  v_mov_b32 v248, 2
  v_accvgpr_read_b32 v194, a162
  v_mfma_f32_16x16x32_bf16 v[24:27], a[208:211], v[172:175], v[24:27]
  buffer_store_dword v248, v250, s[20:23], s81 offen sc1
  s_waitcnt lgkmcnt(10)
  v_mfma_f32_16x16x32_bf16 v[4:7], a[212:215], v[160:163], v[4:7]
  ds_read_b64_tr_b16 a[236:237], v228 offset:776
  v_accvgpr_read_b32 v195, a163
  v_mfma_f32_16x16x32_bf16 v[12:15], a[212:215], v[164:167], v[12:15]
  ds_read_b64_tr_b16 a[238:239], v228 offset:1800
  v_accvgpr_read_b32 v196, a164
  v_mfma_f32_16x16x32_bf16 v[20:23], a[212:215], v[168:171], v[20:23]
  v_accvgpr_read_b32 v197, a165
  v_accvgpr_read_b32 v198, a166
  v_mfma_f32_16x16x32_bf16 v[28:31], a[212:215], v[172:175], v[28:31]
  s_waitcnt lgkmcnt(10)
  v_accvgpr_read_b32 v199, a167
  v_mul_f32 v192, v192, v239
  v_mfma_f32_16x16x32_bf16 v[32:35], a[216:219], v[160:163], v[32:35]
  ds_read_b64_tr_b16 a[240:241], v229 offset:8224
  v_mul_f32 v193, v193, v239
  v_mfma_f32_16x16x32_bf16 v[40:43], a[216:219], v[164:167], v[40:43]
  ds_read_b64_tr_b16 a[242:243], v229 offset:8480
  v_mul_f32 v194, v194, v239
  v_mfma_f32_16x16x32_bf16 v[48:51], a[216:219], v[168:171], v[48:51]
  v_mul_f32 v195, v195, v239
  v_mul_f32 v196, v196, v239
  v_mfma_f32_16x16x32_bf16 v[56:59], a[216:219], v[172:175], v[56:59]
  s_waitcnt lgkmcnt(10)
  v_mul_f32 v197, v197, v239
  v_mul_f32 v198, v198, v239
  v_mfma_f32_16x16x32_bf16 v[36:39], a[220:223], v[160:163], v[36:39]
  ds_read_b64_tr_b16 a[244:245], v229 offset:8232
  v_mul_f32 v199, v199, v239
  v_mfma_f32_16x16x32_bf16 v[44:47], a[220:223], v[164:167], v[44:47]
  ds_read_b64_tr_b16 a[246:247], v229 offset:8488
  v_cvt_pk_bf16_f32 v176, v192, v193
  v_mfma_f32_16x16x32_bf16 v[52:55], a[220:223], v[168:171], v[52:55]
  v_cvt_pk_bf16_f32 v177, v194, v195
  v_cvt_pk_bf16_f32 v178, v196, v197
  v_mfma_f32_16x16x32_bf16 v[60:63], a[220:223], v[172:175], v[60:63]
  buffer_load_dword v220, v221, s[20:23], s83 offen sc1
  s_waitcnt lgkmcnt(10)
  v_mfma_f32_16x16x32_bf16 v[64:67], a[224:227], v[160:163], v[64:67]
  ds_read_b64_tr_b16 a[208:209], v228 offset:10288
  v_cvt_pk_bf16_f32 v179, v198, v199
  v_mfma_f32_16x16x32_bf16 v[72:75], a[224:227], v[164:167], v[72:75]
  ds_read_b64_tr_b16 a[210:211], v228 offset:11312
  v_accvgpr_read_b32 v200, a168
  v_mfma_f32_16x16x32_bf16 v[80:83], a[224:227], v[168:171], v[80:83]
  s_bfe_u32 s59, s32, 0x4000c
  s_mul_i32 s59, s59, 0x14000
  v_accvgpr_read_b32 v201, a169
  v_mfma_f32_16x16x32_bf16 v[88:91], a[224:227], v[172:175], v[88:91]
  buffer_store_dwordx4 v[176:179], v235, s[20:23], s78 offen offset:1024 sc1
  s_waitcnt lgkmcnt(10)
  v_mfma_f32_16x16x32_bf16 v[68:71], a[228:231], v[160:163], v[68:71]
  ds_read_b64_tr_b16 a[212:213], v228 offset:10296
  v_accvgpr_read_b32 v202, a170
  v_mfma_f32_16x16x32_bf16 v[76:79], a[228:231], v[164:167], v[76:79]
  ds_read_b64_tr_b16 a[214:215], v228 offset:11320
  v_accvgpr_read_b32 v203, a171
  v_mfma_f32_16x16x32_bf16 v[84:87], a[228:231], v[168:171], v[84:87]
  s_add_u32 s57, s55, s75
  s_add_u32 m0, s57, 0
  v_accvgpr_read_b32 v204, a172
  v_mfma_f32_16x16x32_bf16 v[92:95], a[228:231], v[172:175], v[92:95]
  buffer_load_dwordx4 v213, s[24:27], s59 offen lds
  s_waitcnt lgkmcnt(10)
  v_mfma_f32_16x16x32_bf16 v[96:99], a[232:235], v[160:163], v[96:99]
  ds_read_b64_tr_b16 a[216:217], v228 offset:10544
  v_accvgpr_read_b32 v205, a173
  v_mfma_f32_16x16x32_bf16 v[104:107], a[232:235], v[164:167], v[104:107]
  ds_read_b64_tr_b16 a[218:219], v228 offset:11568
  s_add_u32 m0, s57, 0x400
  v_mfma_f32_16x16x32_bf16 v[112:115], a[232:235], v[168:171], v[112:115]
  buffer_load_dwordx4 v214, s[24:27], s59 offen lds
  s_bfe_u32 s58, s32, 0x40000
  v_mfma_f32_16x16x32_bf16 v[120:123], a[232:235], v[172:175], v[120:123]
  s_lshl_b32 s58, s58, 11
  s_add_u32 s58, s58, s97
  s_waitcnt lgkmcnt(10)
  v_mfma_f32_16x16x32_bf16 v[100:103], a[236:239], v[160:163], v[100:103]
  ds_read_b64_tr_b16 a[220:221], v228 offset:10552
  s_bfe_u32 s84, s34, 0x20000
  v_mfma_f32_16x16x32_bf16 v[108:111], a[236:239], v[164:167], v[108:111]
  s_waitcnt vmcnt(3)
  v_cmp_gt_u32 vcc, s84, v220
  s_cbranch_vccnz L_chk0_far
L_chk0:
  v_accvgpr_read_b32 v206, a174
  v_mfma_f32_16x16x32_bf16 v[116:119], a[236:239], v[168:171], v[116:119]
  ds_read_b64_tr_b16 a[222:223], v228 offset:11576
  s_add_u32 m0, s57, 0x1010
  v_mfma_f32_16x16x32_bf16 v[124:127], a[236:239], v[172:175], v[124:127]
  buffer_load_dwordx4 a[0:3], v231, s[20:23], s58 offen sc1
  s_waitcnt lgkmcnt(10)
  v_mfma_f32_16x16x32_bf16 v[128:131], a[240:243], v[160:163], v[128:131]
  buffer_load_dwordx4 v215, s[24:27], s59 offen lds
  v_accvgpr_read_b32 v207, a175
  v_mfma_f32_16x16x32_bf16 v[136:139], a[240:243], v[164:167], v[136:139]
  ds_read_b64_tr_b16 a[224:225], v228 offset:10800
  v_mul_f32 v200, v200, v240
  v_mfma_f32_16x16x32_bf16 v[144:147], a[240:243], v[168:171], v[144:147]
  buffer_load_dwordx4 a[4:7], v232, s[20:23], s58 offen sc1
  v_mul_f32 v201, v201, v240
  v_mfma_f32_16x16x32_bf16 v[152:155], a[240:243], v[172:175], v[152:155]
  ds_read_b64_tr_b16 a[226:227], v228 offset:11824
  s_add_u32 m0, s57, 0x1410
  s_waitcnt lgkmcnt(10)
  v_mfma_f32_16x16x32_bf16 v[132:135], a[244:247], v[160:163], v[132:135]
  buffer_load_dwordx4 a[8:11], v233, s[20:23], s58 offen sc1
  buffer_load_dwordx4 v216, s[24:27], s59 offen lds
  v_mfma_f32_16x16x32_bf16 v[140:143], a[244:247], v[164:167], v[140:143]
  ds_read_b64_tr_b16 a[228:229], v228 offset:10808
  v_mul_f32 v202, v202, v240
  v_mfma_f32_16x16x32_bf16 v[148:151], a[244:247], v[168:171], v[148:151]
  buffer_load_dwordx4 a[12:15], v234, s[20:23], s58 offen sc1
  v_mul_f32 v203, v203, v240
  v_mfma_f32_16x16x32_bf16 v[156:159], a[244:247], v[172:175], v[156:159]
  ds_read_b64_tr_b16 a[230:231], v228 offset:11832
  s_add_u32 m0, s55, s76
  buffer_load_dwordx4 a[16:19], v231, s[20:23], s58 offen offset:1024 sc1
  buffer_load_dwordx4 v217, s[24:27], s59 offen lds
  v_mul_f32 v204, v204, v240
  v_mul_f32 v205, v205, v240
  v_mul_f32 v206, v206, v240
  v_mul_f32 v207, v207, v240
  v_cvt_pk_bf16_f32 v180, v200, v201
  v_cvt_pk_bf16_f32 v181, v202, v203
  v_cvt_pk_bf16_f32 v182, v204, v205
  v_cvt_pk_bf16_f32 v183, v206, v207
  buffer_store_dwordx4 v[180:183], v236, s[20:23], s78 offen offset:1024 sc1
  v_accvgpr_read_b32 v192, a176
  v_accvgpr_read_b32 v193, a177
  v_accvgpr_read_b32 v194, a178
  v_accvgpr_read_b32 v195, a179
  v_accvgpr_read_b32 v196, a180
  v_accvgpr_read_b32 v197, a181
  v_accvgpr_read_b32 v198, a182
  v_accvgpr_read_b32 v199, a183
  v_mul_f32 v192, v192, v241
  v_mul_f32 v193, v193, v241
  v_mul_f32 v194, v194, v241
  v_mul_f32 v195, v195, v241
  v_mul_f32 v196, v196, v241
  v_mul_f32 v197, v197, v241
  v_mul_f32 v198, v198, v241
  v_mul_f32 v199, v199, v241
  v_cvt_pk_bf16_f32 v184, v192, v193
  v_cvt_pk_bf16_f32 v185, v194, v195
  v_cvt_pk_bf16_f32 v186, v196, v197
  v_cvt_pk_bf16_f32 v187, v198, v199
  buffer_store_dwordx4 v[184:187], v237, s[20:23], s78 offen offset:1024 sc1
  v_accvgpr_read_b32 v200, a184
  v_accvgpr_read_b32 v201, a185
  v_accvgpr_read_b32 v202, a186
  v_accvgpr_read_b32 v203, a187
  v_accvgpr_read_b32 v204, a188
  v_accvgpr_read_b32 v205, a189
  v_accvgpr_read_b32 v206, a190
  v_accvgpr_read_b32 v207, a191
  v_mul_f32 v200, v200, v242
  v_mul_f32 v201, v201, v242
  v_mul_f32 v202, v202, v242
  v_mul_f32 v203, v203, v242
  v_mul_f32 v204, v204, v242
  v_mul_f32 v205, v205, v242
  v_mul_f32 v206, v206, v242
  v_mul_f32 v207, v207, v242
  v_cvt_pk_bf16_f32 v188, v200, v201
  v_cvt_pk_bf16_f32 v189, v202, v203
  v_cvt_pk_bf16_f32 v190, v204, v205
  v_cvt_pk_bf16_f32 v191, v206, v207
  buffer_store_dwordx4 v[188:191], v238, s[20:23], s78 offen offset:1024 sc1
  s_waitcnt lgkmcnt(10)
  v_mfma_f32_16x16x32_bf16 v[0:3], a[208:211], v[176:179], v[0:3]
  ds_read_b64_tr_b16 a[232:233], v228 offset:11056
  v_mfma_f32_16x16x32_bf16 v[8:11], a[208:211], v[180:183], v[8:11]
  buffer_load_dwordx4 a[20:23], v232, s[20:23], s58 offen offset:1024 sc1
  v_mfma_f32_16x16x32_bf16 v[16:19], a[208:211], v[184:187], v[16:19]
  ds_read_b64_tr_b16 a[234:235], v228 offset:12080
  v_mfma_f32_16x16x32_bf16 v[24:27], a[208:211], v[188:191], v[24:27]
  s_add_u32 s55, s55, 0x6080
  s_cmp_ge_u32 s55, 0x24300
  s_cselect_b32 s55, 0, s55
  s_waitcnt lgkmcnt(10)
  v_mfma_f32_16x16x32_bf16 v[4:7], a[212:215], v[176:179], v[4:7]
  buffer_load_dwordx4 a[24:27], v233, s[20:23], s58 offen offset:1024 sc1
  v_mfma_f32_16x16x32_bf16 v[12:15], a[212:215], v[180:183], v[12:15]
  ds_read_b64_tr_b16 a[236:237], v228 offset:11064
  v_mfma_f32_16x16x32_bf16 v[20:23], a[212:215], v[184:187], v[20:23]
  buffer_load_dwordx4 a[28:31], v234, s[20:23], s58 offen offset:1024 sc1
  s_bfe_u32 s58, s32, 0x40004
  s_lshl_b32 s58, s58, 11
  s_add_u32 s58, s58, s97
  s_bfe_u32 s84, s34, 0x20002
  v_mfma_f32_16x16x32_bf16 v[28:31], a[212:215], v[188:191], v[28:31]
  v_cmp_gt_u32 vcc, s84, v220
  s_cbranch_vccnz L_chk2_far
L_chk2:
  ds_read_b64_tr_b16 a[238:239], v228 offset:12088
  s_waitcnt lgkmcnt(10)
  v_mfma_f32_16x16x32_bf16 v[32:35], a[216:219], v[176:179], v[32:35]
  buffer_load_dwordx4 a[32:35], v231, s[20:23], s58 offen sc1
  v_mfma_f32_16x16x32_bf16 v[40:43], a[216:219], v[180:183], v[40:43]
  ds_read_b64_tr_b16 a[240:241], v229 offset:18512
  v_mfma_f32_16x16x32_bf16 v[48:51], a[216:219], v[184:187], v[48:51]
  buffer_load_dwordx4 a[36:39], v232, s[20:23], s58 offen sc1
  v_mfma_f32_16x16x32_bf16 v[56:59], a[216:219], v[188:191], v[56:59]
  ds_read_b64_tr_b16 a[242:243], v229 offset:18768
  s_waitcnt lgkmcnt(10)
  v_mfma_f32_16x16x32_bf16 v[36:39], a[220:223], v[176:179], v[36:39]
  buffer_load_dwordx4 a[40:43], v233, s[20:23], s58 offen sc1
  v_mfma_f32_16x16x32_bf16 v[44:47], a[220:223], v[180:183], v[44:47]
  ds_read_b64_tr_b16 a[244:245], v229 offset:18520
  v_mfma_f32_16x16x32_bf16 v[52:55], a[220:223], v[184:187], v[52:55]
  buffer_load_dwordx4 a[44:47], v234, s[20:23], s58 offen sc1
  s_add_u32 s54, s54, 0x6080
  s_cmp_ge_u32 s54, 0x24300
  s_cselect_b32 s54, 0, s54
  v_mfma_f32_16x16x32_bf16 v[60:63], a[220:223], v[188:191], v[60:63]
  ds_read_b64_tr_b16 a[246:247], v229 offset:18776
  s_waitcnt lgkmcnt(10)
  v_mfma_f32_16x16x32_bf16 v[64:67], a[224:227], v[176:179], v[64:67]
  s_barrier
  buffer_load_dwordx4 a[48:51], v231, s[20:23], s58 offen offset:1024 sc1
  v_add_u32 v228, s54, v218
  v_add_u32 v229, s54, v219
  v_mfma_f32_16x16x32_bf16 v[72:75], a[224:227], v[180:183], v[72:75]
  ds_read_b64_tr_b16 a[208:209], v228
  v_mfma_f32_16x16x32_bf16 v[80:83], a[224:227], v[184:187], v[80:83]
  buffer_load_dwordx4 a[52:55], v232, s[20:23], s58 offen offset:1024 sc1
  v_mfma_f32_16x16x32_bf16 v[88:91], a[224:227], v[188:191], v[88:91]
  ds_read_b64_tr_b16 a[210:211], v228 offset:1024
  s_waitcnt lgkmcnt(10)
  v_mfma_f32_16x16x32_bf16 v[68:71], a[228:231], v[176:179], v[68:71]
  buffer_load_dwordx4 a[56:59], v233, s[20:23], s58 offen offset:1024 sc1
  v_mfma_f32_16x16x32_bf16 v[76:79], a[228:231], v[180:183], v[76:79]
  ds_read_b64_tr_b16 a[212:213], v228 offset:8
  v_mfma_f32_16x16x32_bf16 v[84:87], a[228:231], v[184:187], v[84:87]
  buffer_load_dwordx4 a[60:63], v234, s[20:23], s58 offen offset:1024 sc1
  s_bfe_u32 s58, s32, 0x40008
  s_lshl_b32 s58, s58, 11
  s_add_u32 s58, s58, s97
  s_bfe_u32 s84, s34, 0x20004
  v_mfma_f32_16x16x32_bf16 v[92:95], a[228:231], v[188:191], v[92:95]
  v_cmp_gt_u32 vcc, s84, v220
  s_cbranch_vccnz L_chk4_far
L_chk4:
  ds_read_b64_tr_b16 a[214:215], v228 offset:1032
  s_waitcnt lgkmcnt(10)
  v_mfma_f32_16x16x32_bf16 v[96:99], a[232:235], v[176:179], v[96:99]
  buffer_load_dwordx4 a[64:67], v231, s[20:23], s58 offen sc1
  v_mfma_f32_16x16x32_bf16 v[104:107], a[232:235], v[180:183], v[104:107]
  ds_read_b64_tr_b16 a[216:217], v228 offset:256
  v_mfma_f32_16x16x32_bf16 v[112:115], a[232:235], v[184:187], v[112:115]
  buffer_load_dwordx4 a[68:71], v232, s[20:23], s58 offen sc1
  v_mfma_f32_16x16x32_bf16 v[120:123], a[232:235], v[188:191], v[120:123]
  ds_read_b64_tr_b16 a[218:219], v228 offset:1280
  s_waitcnt lgkmcnt(10)
  v_mfma_f32_16x16x32_bf16 v[100:103], a[236:239], v[176:179], v[100:103]
  buffer_load_dwordx4 a[72:75], v233, s[20:23], s58 offen sc1
  v_mfma_f32_16x16x32_bf16 v[108:111], a[236:239], v[180:183], v[108:111]
  ds_read_b64_tr_b16 a[220:221], v228 offset:264
  v_mfma_f32_16x16x32_bf16 v[116:119], a[236:239], v[184:187], v[116:119]
  buffer_load_dwordx4 a[76:79], v234, s[20:23], s58 offen sc1
  v_mfma_f32_16x16x32_bf16 v[124:127], a[236:239], v[188:191], v[124:127]
  ds_read_b64_tr_b16 a[222:223], v228 offset:1288
  s_waitcnt lgkmcnt(10)
  v_mfma_f32_16x16x32_bf16 v[128:131], a[240:243], v[176:179], v[128:131]
  buffer_load_dwordx4 a[80:83], v231, s[20:23], s58 offen offset:1024 sc1
  v_mfma_f32_16x16x32_bf16 v[136:139], a[240:243], v[180:183], v[136:139]
  ds_read_b64_tr_b16 a[224:225], v228 offset:512
  v_mfma_f32_16x16x32_bf16 v[144:147], a[240:243], v[184:187], v[144:147]
  buffer_load_dwordx4 a[84:87], v232, s[20:23], s58 offen offset:1024 sc1
  v_mfma_f32_16x16x32_bf16 v[152:155], a[240:243], v[188:191], v[152:155]
  ds_read_b64_tr_b16 a[226:227], v228 offset:1536
  s_waitcnt lgkmcnt(10)
  v_mfma_f32_16x16x32_bf16 v[132:135], a[244:247], v[176:179], v[132:135]
  buffer_load_dwordx4 a[88:91], v233, s[20:23], s58 offen offset:1024 sc1
  v_mfma_f32_16x16x32_bf16 v[140:143], a[244:247], v[180:183], v[140:143]
  ds_read_b64_tr_b16 a[228:229], v228 offset:520
  v_mfma_f32_16x16x32_bf16 v[148:151], a[244:247], v[184:187], v[148:151]
  buffer_load_dwordx4 a[92:95], v234, s[20:23], s58 offen offset:1024 sc1
  v_mfma_f32_16x16x32_bf16 v[156:159], a[244:247], v[188:191], v[156:159]
  ds_read_b64_tr_b16 a[230:231], v228 offset:1544
  s_waitcnt vmcnt(24) lgkmcnt(10)
  v_mfma_f32_16x16x32_bf16 v[0:3], a[208:211], a[0:3], v[0:3]
  ds_read_b64_tr_b16 a[232:233], v228 offset:768
  v_mfma_f32_16x16x32_bf16 v[8:11], a[208:211], a[4:7], v[8:11]
  ds_read_b64_tr_b16 a[234:235], v228 offset:1792
  v_mfma_f32_16x16x32_bf16 v[16:19], a[208:211], a[8:11], v[16:19]
  s_waitcnt vmcnt(19)
  s_bfe_u32 s59, s32, 0x40010
  v_mov_b32 v248, 3
  v_mfma_f32_16x16x32_bf16 v[24:27], a[208:211], a[12:15], v[24:27]
  buffer_store_dword v248, v250, s[20:23], s81 offen sc1
  s_waitcnt lgkmcnt(10)
  v_mfma_f32_16x16x32_bf16 v[4:7], a[212:215], a[0:3], v[4:7]
  ds_read_b64_tr_b16 a[236:237], v228 offset:776
  s_mul_i32 s59, s59, 0x14000
  v_mfma_f32_16x16x32_bf16 v[12:15], a[212:215], a[4:7], v[12:15]
  s_add_u32 s57, s55, s75
  s_add_u32 m0, s57, 0
  v_mfma_f32_16x16x32_bf16 v[20:23], a[212:215], a[8:11], v[20:23]
  ds_read_b64_tr_b16 a[238:239], v228 offset:1800
  s_bfe_u32 s58, s32, 0x4000c
  v_mfma_f32_16x16x32_bf16 v[28:31], a[212:215], a[12:15], v[28:31]
  buffer_load_dwordx4 v213, s[24:27], s59 offen lds
  s_waitcnt lgkmcnt(10)
  v_mfma_f32_16x16x32_bf16 v[32:35], a[216:219], a[0:3], v[32:35]
  s_lshl_b32 s58, s58, 11
  s_add_u32 s58, s58, s97
  v_mfma_f32_16x16x32_bf16 v[40:43], a[216:219], a[4:7], v[40:43]
  ds_read_b64_tr_b16 a[240:241], v229 offset:8224
  s_bfe_u32 s84, s34, 0x20006
  v_mfma_f32_16x16x32_bf16 v[48:51], a[216:219], a[8:11], v[48:51]
  v_cmp_gt_u32 vcc, s84, v220
  s_cbranch_vccnz L_chk6_far
L_chk6:
  v_mfma_f32_16x16x32_bf16 v[56:59], a[216:219], a[12:15], v[56:59]
  ds_read_b64_tr_b16 a[242:243], v229 offset:8480
  s_waitcnt lgkmcnt(10)
  v_mfma_f32_16x16x32_bf16 v[36:39], a[220:223], a[0:3], v[36:39]
  buffer_load_dwordx4 a[96:99], v231, s[20:23], s58 offen sc1
  v_mfma_f32_16x16x32_bf16 v[44:47], a[220:223], a[4:7], v[44:47]
  ds_read_b64_tr_b16 a[244:245], v229 offset:8232
  s_add_u32 m0, s57, 0x400
  v_mfma_f32_16x16x32_bf16 v[52:55], a[220:223], a[8:11], v[52:55]
  ds_read_b64_tr_b16 a[246:247], v229 offset:8488
  v_mfma_f32_16x16x32_bf16 v[60:63], a[220:223], a[12:15], v[60:63]
  buffer_load_dwordx4 v214, s[24:27], s59 offen lds
  s_waitcnt lgkmcnt(10)
  v_mfma_f32_16x16x32_bf16 v[64:67], a[224:227], a[0:3], v[64:67]
  ds_read_b64_tr_b16 a[208:209], v228 offset:10288
  v_mfma_f32_16x16x32_bf16 v[72:75], a[224:227], a[4:7], v[72:75]
  ds_read_b64_tr_b16 a[210:211], v228 offset:11312
  v_mfma_f32_16x16x32_bf16 v[80:83], a[224:227], a[8:11], v[80:83]
  buffer_load_dwordx4 a[100:103], v232, s[20:23], s58 offen sc1
  v_mfma_f32_16x16x32_bf16 v[88:91], a[224:227], a[12:15], v[88:91]
  s_waitcnt lgkmcnt(10)
  v_mfma_f32_16x16x32_bf16 v[68:71], a[228:231], a[0:3], v[68:71]
  ds_read_b64_tr_b16 a[212:213], v228 offset:10296
  v_mfma_f32_16x16x32_bf16 v[76:79], a[228:231], a[4:7], v[76:79]
  ds_read_b64_tr_b16 a[214:215], v228 offset:11320
  s_add_u32 m0, s57, 0x1010
  v_mfma_f32_16x16x32_bf16 v[84:87], a[228:231], a[8:11], v[84:87]
  buffer_load_dwordx4 v215, s[24:27], s59 offen lds
  v_mfma_f32_16x16x32_bf16 v[92:95], a[228:231], a[12:15], v[92:95]
  s_waitcnt lgkmcnt(10)
  v_mfma_f32_16x16x32_bf16 v[96:99], a[232:235], a[0:3], v[96:99]
  ds_read_b64_tr_b16 a[216:217], v228 offset:10544
  v_mfma_f32_16x16x32_bf16 v[104:107], a[232:235], a[4:7], v[104:107]
  ds_read_b64_tr_b16 a[218:219], v228 offset:11568
  v_mfma_f32_16x16x32_bf16 v[112:115], a[232:235], a[8:11], v[112:115]
  v_mfma_f32_16x16x32_bf16 v[120:123], a[232:235], a[12:15], v[120:123]
  buffer_load_dwordx4 a[104:107], v233, s[20:23], s58 offen sc1
  s_waitcnt lgkmcnt(10)
  v_mfma_f32_16x16x32_bf16 v[100:103], a[236:239], a[0:3], v[100:103]
  ds_read_b64_tr_b16 a[220:221], v228 offset:10552
  v_mfma_f32_16x16x32_bf16 v[108:111], a[236:239], a[4:7], v[108:111]
  ds_read_b64_tr_b16 a[222:223], v228 offset:11576
  s_add_u32 m0, s57, 0x1410
  v_mfma_f32_16x16x32_bf16 v[116:119], a[236:239], a[8:11], v[116:119]
  buffer_load_dwordx4 v216, s[24:27], s59 offen lds
  v_mfma_f32_16x16x32_bf16 v[124:127], a[236:239], a[12:15], v[124:127]
  s_waitcnt lgkmcnt(10)
  v_mfma_f32_16x16x32_bf16 v[128:131], a[240:243], a[0:3], v[128:131]
  ds_read_b64_tr_b16 a[224:225], v228 offset:10800
  v_mfma_f32_16x16x32_bf16 v[136:139], a[240:243], a[4:7], v[136:139]
  ds_read_b64_tr_b16 a[226:227], v228 offset:11824
  v_mfma_f32_16x16x32_bf16 v[144:147], a[240:243], a[8:11], v[144:147]
  v_mfma_f32_16x16x32_bf16 v[152:155], a[240:243], a[12:15], v[152:155]
  buffer_load_dwordx4 a[108:111], v234, s[20:23], s58 offen sc1
  s_waitcnt lgkmcnt(10)
  v_mfma_f32_16x16x32_bf16 v[132:135], a[244:247], a[0:3], v[132:135]
  ds_read_b64_tr_b16 a[228:229], v228 offset:10808
  v_mfma_f32_16x16x32_bf16 v[140:143], a[244:247], a[4:7], v[140:143]
  ds_read_b64_tr_b16 a[230:231], v228 offset:11832
  s_add_u32 m0, s55, s76
  v_mfma_f32_16x16x32_bf16 v[148:151], a[244:247], a[8:11], v[148:151]
  buffer_load_dwordx4 v217, s[24:27], s59 offen lds
  v_mfma_f32_16x16x32_bf16 v[156:159], a[244:247], a[12:15], v[156:159]
  s_waitcnt vmcnt(26) lgkmcnt(10)
  v_mfma_f32_16x16x32_bf16 v[0:3], a[208:211], a[16:19], v[0:3]
  ds_read_b64_tr_b16 a[232:233], v228 offset:11056
  v_mfma_f32_16x16x32_bf16 v[8:11], a[208:211], a[20:23], v[8:11]
  s_add_u32 s55, s55, 0x6080
  s_cmp_ge_u32 s55, 0x24300
  s_cselect_b32 s55, 0, s55
  v_mfma_f32_16x16x32_bf16 v[16:19], a[208:211], a[24:27], v[16:19]
  ds_read_b64_tr_b16 a[234:235], v228 offset:12080
  v_mfma_f32_16x16x32_bf16 v[24:27], a[208:211], a[28:31], v[24:27]
  s_waitcnt lgkmcnt(10)
  v_mfma_f32_16x16x32_bf16 v[4:7], a[212:215], a[16:19], v[4:7]
  ds_read_b64_tr_b16 a[236:237], v228 offset:11064
  v_mfma_f32_16x16x32_bf16 v[12:15], a[212:215], a[20:23], v[12:15]
  buffer_load_dwordx4 a[112:115], v231, s[20:23], s58 offen offset:1024 sc1
  v_mfma_f32_16x16x32_bf16 v[20:23], a[212:215], a[24:27], v[20:23]
  ds_read_b64_tr_b16 a[238:239], v228 offset:12088
  v_mfma_f32_16x16x32_bf16 v[28:31], a[212:215], a[28:31], v[28:31]
  s_waitcnt lgkmcnt(10)
  v_mfma_f32_16x16x32_bf16 v[32:35], a[216:219], a[16:19], v[32:35]
  ds_read_b64_tr_b16 a[240:241], v229 offset:18512
  v_mfma_f32_16x16x32_bf16 v[40:43], a[216:219], a[20:23], v[40:43]
  ds_read_b64_tr_b16 a[242:243], v229 offset:18768
  v_mfma_f32_16x16x32_bf16 v[48:51], a[216:219], a[24:27], v[48:51]
  v_mfma_f32_16x16x32_bf16 v[56:59], a[216:219], a[28:31], v[56:59]
  s_waitcnt lgkmcnt(10)
  v_mfma_f32_16x16x32_bf16 v[36:39], a[220:223], a[16:19], v[36:39]
  ds_read_b64_tr_b16 a[244:245], v229 offset:18520
  v_mfma_f32_16x16x32_bf16 v[44:47], a[220:223], a[20:23], v[44:47]
  s_add_u32 s54, s54, 0x6080
  s_cmp_ge_u32 s54, 0x24300
  s_cselect_b32 s54, 0, s54
  v_mfma_f32_16x16x32_bf16 v[52:55], a[220:223], a[24:27], v[52:55]
  buffer_load_dwordx4 a[116:119], v232, s[20:23], s58 offen offset:1024 sc1
  v_mfma_f32_16x16x32_bf16 v[60:63], a[220:223], a[28:31], v[60:63]
  ds_read_b64_tr_b16 a[246:247], v229 offset:18776
  s_waitcnt lgkmcnt(10)
  v_mfma_f32_16x16x32_bf16 v[64:67], a[224:227], a[16:19], v[64:67]
  s_barrier
  v_add_u32 v228, s54, v218
  v_add_u32 v229, s54, v219
  v_mfma_f32_16x16x32_bf16 v[72:75], a[224:227], a[20:23], v[72:75]
  ds_read_b64_tr_b16 a[208:209], v228
  v_mfma_f32_16x16x32_bf16 v[80:83], a[224:227], a[24:27], v[80:83]
  ds_read_b64_tr_b16 a[210:211], v228 offset:1024
  v_mfma_f32_16x16x32_bf16 v[88:91], a[224:227], a[28:31], v[88:91]
  s_waitcnt lgkmcnt(10)
  v_mfma_f32_16x16x32_bf16 v[68:71], a[228:231], a[16:19], v[68:71]
  ds_read_b64_tr_b16 a[212:213], v228 offset:8
  v_mfma_f32_16x16x32_bf16 v[76:79], a[228:231], a[20:23], v[76:79]
  buffer_load_dword v220, v221, s[20:23], s83 offen sc1
  v_mfma_f32_16x16x32_bf16 v[84:87], a[228:231], a[24:27], v[84:87]
  ds_read_b64_tr_b16 a[214:215], v228 offset:1032
  v_mfma_f32_16x16x32_bf16 v[92:95], a[228:231], a[28:31], v[92:95]
  buffer_load_dwordx4 a[120:123], v233, s[20:23], s58 offen offset:1024 sc1
  s_waitcnt lgkmcnt(10)
  v_mfma_f32_16x16x32_bf16 v[96:99], a[232:235], a[16:19], v[96:99]
  ds_read_b64_tr_b16 a[216:217], v228 offset:256
  v_mfma_f32_16x16x32_bf16 v[104:107], a[232:235], a[20:23], v[104:107]
  ds_read_b64_tr_b16 a[218:219], v228 offset:1280
  v_mfma_f32_16x16x32_bf16 v[112:115], a[232:235], a[24:27], v[112:115]
  v_mfma_f32_16x16x32_bf16 v[120:123], a[232:235], a[28:31], v[120:123]
  s_waitcnt lgkmcnt(10)
  v_mfma_f32_16x16x32_bf16 v[100:103], a[236:239], a[16:19], v[100:103]
  ds_read_b64_tr_b16 a[220:221], v228 offset:264
  v_mfma_f32_16x16x32_bf16 v[108:111], a[236:239], a[20:23], v[108:111]
  ds_read_b64_tr_b16 a[222:223], v228 offset:1288
  v_mfma_f32_16x16x32_bf16 v[116:119], a[236:239], a[24:27], v[116:119]
  buffer_load_dwordx4 a[124:127], v234, s[20:23], s58 offen offset:1024 sc1
  v_mfma_f32_16x16x32_bf16 v[124:127], a[236:239], a[28:31], v[124:127]
  s_waitcnt lgkmcnt(10)
  v_mfma_f32_16x16x32_bf16 v[128:131], a[240:243], a[16:19], v[128:131]
  ds_read_b64_tr_b16 a[224:225], v228 offset:512
  v_mfma_f32_16x16x32_bf16 v[136:139], a[240:243], a[20:23], v[136:139]
  ds_read_b64_tr_b16 a[226:227], v228 offset:1536
  v_mfma_f32_16x16x32_bf16 v[144:147], a[240:243], a[24:27], v[144:147]
  v_mfma_f32_16x16x32_bf16 v[152:155], a[240:243], a[28:31], v[152:155]
  s_waitcnt lgkmcnt(10)
  v_mfma_f32_16x16x32_bf16 v[132:135], a[244:247], a[16:19], v[132:135]
  ds_read_b64_tr_b16 a[228:229], v228 offset:520
  v_mfma_f32_16x16x32_bf16 v[140:143], a[244:247], a[20:23], v[140:143]
  ds_read_b64_tr_b16 a[230:231], v228 offset:1544
  v_mfma_f32_16x16x32_bf16 v[148:151], a[244:247], a[24:27], v[148:151]
  v_mfma_f32_16x16x32_bf16 v[156:159], a[244:247], a[28:31], v[156:159]
  s_waitcnt vmcnt(27) lgkmcnt(10)
  v_mfma_f32_16x16x32_bf16 v[0:3], a[208:211], a[32:35], v[0:3]
  ds_read_b64_tr_b16 a[232:233], v228 offset:768
  v_mfma_f32_16x16x32_bf16 v[8:11], a[208:211], a[36:39], v[8:11]
  ds_read_b64_tr_b16 a[234:235], v228 offset:1792
  v_mfma_f32_16x16x32_bf16 v[16:19], a[208:211], a[40:43], v[16:19]
  s_bfe_u32 s59, s32, 0x40014
  v_mfma_f32_16x16x32_bf16 v[24:27], a[208:211], a[44:47], v[24:27]
  s_mul_i32 s59, s59, 0x14000
  s_waitcnt lgkmcnt(10)
  v_mfma_f32_16x16x32_bf16 v[4:7], a[212:215], a[32:35], v[4:7]
  ds_read_b64_tr_b16 a[236:237], v228 offset:776
  s_add_u32 s57, s55, s75
  v_mfma_f32_16x16x32_bf16 v[12:15], a[212:215], a[36:39], v[12:15]
  ds_read_b64_tr_b16 a[238:239], v228 offset:1800
  s_add_u32 m0, s57, 0
  v_mfma_f32_16x16x32_bf16 v[20:23], a[212:215], a[40:43], v[20:23]
  buffer_load_dwordx4 v213, s[24:27], s59 offen lds
  s_bfe_u32 s58, s32, 0x40010
  v_mfma_f32_16x16x32_bf16 v[28:31], a[212:215], a[44:47], v[28:31]
  s_lshl_b32 s58, s58, 11
  s_add_u32 s58, s58, s97
  s_waitcnt lgkmcnt(10)
  v_mfma_f32_16x16x32_bf16 v[32:35], a[216:219], a[32:35], v[32:35]
  ds_read_b64_tr_b16 a[240:241], v229 offset:8224
  s_bfe_u32 s84, s34, 0x20008
  v_mfma_f32_16x16x32_bf16 v[40:43], a[216:219], a[36:39], v[40:43]
  s_waitcnt vmcnt(3)
  v_cmp_gt_u32 vcc, s84, v220
  s_cbranch_vccnz L_chk8_far
L_chk8:
  v_mfma_f32_16x16x32_bf16 v[48:51], a[216:219], a[40:43], v[48:51]
  ds_read_b64_tr_b16 a[242:243], v229 offset:8480
  v_mfma_f32_16x16x32_bf16 v[56:59], a[216:219], a[44:47], v[56:59]
  buffer_load_dwordx4 a[128:131], v231, s[20:23], s58 offen sc1
  s_waitcnt lgkmcnt(10)
  v_mfma_f32_16x16x32_bf16 v[36:39], a[220:223], a[32:35], v[36:39]
  ds_read_b64_tr_b16 a[244:245], v229 offset:8232
  v_mfma_f32_16x16x32_bf16 v[44:47], a[220:223], a[36:39], v[44:47]
  ds_read_b64_tr_b16 a[246:247], v229 offset:8488
  s_add_u32 m0, s57, 0x400
  v_mfma_f32_16x16x32_bf16 v[52:55], a[220:223], a[40:43], v[52:55]
  buffer_load_dwordx4 v214, s[24:27], s59 offen lds
  v_mfma_f32_16x16x32_bf16 v[60:63], a[220:223], a[44:47], v[60:63]
  s_waitcnt lgkmcnt(10)
  v_mfma_f32_16x16x32_bf16 v[64:67], a[224:227], a[32:35], v[64:67]
  ds_read_b64_tr_b16 a[208:209], v228 offset:10288
  v_mfma_f32_16x16x32_bf16 v[72:75], a[224:227], a[36:39], v[72:75]
  ds_read_b64_tr_b16 a[210:211], v228 offset:11312
  v_mfma_f32_16x16x32_bf16 v[80:83], a[224:227], a[40:43], v[80:83]
  buffer_load_dwordx4 a[132:135], v232, s[20:23], s58 offen sc1
  v_mfma_f32_16x16x32_bf16 v[88:91], a[224:227], a[44:47], v[88:91]
  s_waitcnt lgkmcnt(10)
  v_mfma_f32_16x16x32_bf16 v[68:71], a[228:231], a[32:35], v[68:71]
  ds_read_b64_tr_b16 a[212:213], v228 offset:10296
  v_mfma_f32_16x16x32_bf16 v[76:79], a[228:231], a[36:39], v[76:79]
  ds_read_b64_tr_b16 a[214:215], v228 offset:11320
  s_add_u32 m0, s57, 0x1010
  v_mfma_f32_16x16x32_bf16 v[84:87], a[228:231], a[40:43], v[84:87]
  buffer_load_dwordx4 v215, s[24:27], s59 offen lds
  v_mfma_f32_16x16x32_bf16 v[92:95], a[228:231], a[44:47], v[92:95]
  s_waitcnt lgkmcnt(10)
  v_mfma_f32_16x16x32_bf16 v[96:99], a[232:235], a[32:35], v[96:99]
  ds_read_b64_tr_b16 a[216:217], v228 offset:10544
  v_mfma_f32_16x16x32_bf16 v[104:107], a[232:235], a[36:39], v[104:107]
  ds_read_b64_tr_b16 a[218:219], v228 offset:11568
  v_mfma_f32_16x16x32_bf16 v[112:115], a[232:235], a[40:43], v[112:115]
  v_mfma_f32_16x16x32_bf16 v[120:123], a[232:235], a[44:47], v[120:123]
  buffer_load_dwordx4 a[136:139], v233, s[20:23], s58 offen sc1
  s_waitcnt lgkmcnt(10)
  v_mfma_f32_16x16x32_bf16 v[100:103], a[236:239], a[32:35], v[100:103]
  ds_read_b64_tr_b16 a[220:221], v228 offset:10552
  v_mfma_f32_16x16x32_bf16 v[108:111], a[236:239], a[36:39], v[108:111]
  ds_read_b64_tr_b16 a[222:223], v228 offset:11576
  s_add_u32 m0, s57, 0x1410
  v_mfma_f32_16x16x32_bf16 v[116:119], a[236:239], a[40:43], v[116:119]
  buffer_load_dwordx4 v216, s[24:27], s59 offen lds
  v_mfma_f32_16x16x32_bf16 v[124:127], a[236:239], a[44:47], v[124:127]
  s_waitcnt lgkmcnt(10)
  v_mfma_f32_16x16x32_bf16 v[128:131], a[240:243], a[32:35], v[128:131]
  ds_read_b64_tr_b16 a[224:225], v228 offset:10800
  v_mfma_f32_16x16x32_bf16 v[136:139], a[240:243], a[36:39], v[136:139]
  ds_read_b64_tr_b16 a[226:227], v228 offset:11824
  v_mfma_f32_16x16x32_bf16 v[144:147], a[240:243], a[40:43], v[144:147]
  v_mfma_f32_16x16x32_bf16 v[152:155], a[240:243], a[44:47], v[152:155]
  buffer_load_dwordx4 a[140:143], v234, s[20:23], s58 offen sc1
  s_waitcnt lgkmcnt(10)
  v_mfma_f32_16x16x32_bf16 v[132:135], a[244:247], a[32:35], v[132:135]
  ds_read_b64_tr_b16 a[228:229], v228 offset:10808
  v_mfma_f32_16x16x32_bf16 v[140:143], a[244:247], a[36:39], v[140:143]
  ds_read_b64_tr_b16 a[230:231], v228 offset:11832
  s_add_u32 m0, s55, s76
  v_mfma_f32_16x16x32_bf16 v[148:151], a[244:247], a[40:43], v[148:151]
  buffer_load_dwordx4 v217, s[24:27], s59 offen lds
  v_mfma_f32_16x16x32_bf16 v[156:159], a[244:247], a[44:47], v[156:159]
  s_waitcnt lgkmcnt(10)
  v_mfma_f32_16x16x32_bf16 v[0:3], a[208:211], a[48:51], v[0:3]
  ds_read_b64_tr_b16 a[232:233], v228 offset:11056
  v_mfma_f32_16x16x32_bf16 v[8:11], a[208:211], a[52:55], v[8:11]
  s_add_u32 s55, s55, 0x6080
  s_cmp_ge_u32 s55, 0x24300
  s_cselect_b32 s55, 0, s55
  v_mfma_f32_16x16x32_bf16 v[16:19], a[208:211], a[56:59], v[16:19]
  ds_read_b64_tr_b16 a[234:235], v228 offset:12080
  v_mfma_f32_16x16x32_bf16 v[24:27], a[208:211], a[60:63], v[24:27]
  s_waitcnt lgkmcnt(10)
  v_mfma_f32_16x16x32_bf16 v[4:7], a[212:215], a[48:51], v[4:7]
  ds_read_b64_tr_b16 a[236:237], v228 offset:11064
  v_mfma_f32_16x16x32_bf16 v[12:15], a[212:215], a[52:55], v[12:15]
  buffer_load_dwordx4 a[144:147], v231, s[20:23], s58 offen offset:1024 sc1
  v_mfma_f32_16x16x32_bf16 v[20:23], a[212:215], a[56:59], v[20:23]
  ds_read_b64_tr_b16 a[238:239], v228 offset:12088
  v_mfma_f32_16x16x32_bf16 v[28:31], a[212:215], a[60:63], v[28:31]
  s_waitcnt lgkmcnt(10)
  v_mfma_f32_16x16x32_bf16 v[32:35], a[216:219], a[48:51], v[32:35]
  ds_read_b64_tr_b16 a[240:241], v229 offset:18512
  v_mfma_f32_16x16x32_bf16 v[40:43], a[216:219], a[52:55], v[40:43]
  ds_read_b64_tr_b16 a[242:243], v229 offset:18768
  v_mfma_f32_16x16x32_bf16 v[48:51], a[216:219], a[56:59], v[48:51]
  v_mfma_f32_16x16x32_bf16 v[56:59], a[216:219], a[60:63], v[56:59]
  s_waitcnt lgkmcnt(10)
  v_mfma_f32_16x16x32_bf16 v[36:39], a[220:223], a[48:51], v[36:39]
  ds_read_b64_tr_b16 a[244:245], v229 offset:18520
  v_mfma_f32_16x16x32_bf16 v[44:47], a[220:223], a[52:55], v[44:47]
  s_add_u32 s54, s54, 0x6080
  s_cmp_ge_u32 s54, 0x24300
  s_cselect_b32 s54, 0, s54
  v_mfma_f32_16x16x32_bf16 v[52:55], a[220:223], a[56:59], v[52:55]
  buffer_load_dwordx4 a[148:151], v232, s[20:23], s58 offen offset:1024 sc1
  v_mfma_f32_16x16x32_bf16 v[60:63], a[220:223], a[60:63], v[60:63]
  ds_read_b64_tr_b16 a[246:247], v229 offset:18776
  s_waitcnt lgkmcnt(10)
  v_mfma_f32_16x16x32_bf16 v[64:67], a[224:227], a[48:51], v[64:67]
  s_barrier
  v_add_u32 v228, s54, v218
  v_add_u32 v229, s54, v219
  v_mfma_f32_16x16x32_bf16 v[72:75], a[224:227], a[52:55], v[72:75]
  ds_read_b64_tr_b16 a[208:209], v228
  v_mfma_f32_16x16x32_bf16 v[80:83], a[224:227], a[56:59], v[80:83]
  ds_read_b64_tr_b16 a[210:211], v228 offset:1024
  v_mfma_f32_16x16x32_bf16 v[88:91], a[224:227], a[60:63], v[88:91]
  s_waitcnt lgkmcnt(10)
  v_mfma_f32_16x16x32_bf16 v[68:71], a[228:231], a[48:51], v[68:71]
  ds_read_b64_tr_b16 a[212:213], v228 offset:8
  v_mfma_f32_16x16x32_bf16 v[76:79], a[228:231], a[52:55], v[76:79]
  buffer_load_dword v220, v221, s[20:23], s83 offen sc1
  v_mfma_f32_16x16x32_bf16 v[84:87], a[228:231], a[56:59], v[84:87]
  ds_read_b64_tr_b16 a[214:215], v228 offset:1032
  v_mfma_f32_16x16x32_bf16 v[92:95], a[228:231], a[60:63], v[92:95]
  buffer_load_dwordx4 a[152:155], v233, s[20:23], s58 offen offset:1024 sc1
  s_waitcnt lgkmcnt(10)
  v_mfma_f32_16x16x32_bf16 v[96:99], a[232:235], a[48:51], v[96:99]
  ds_read_b64_tr_b16 a[216:217], v228 offset:256
  v_mfma_f32_16x16x32_bf16 v[104:107], a[232:235], a[52:55], v[104:107]
  ds_read_b64_tr_b16 a[218:219], v228 offset:1280
  v_mfma_f32_16x16x32_bf16 v[112:115], a[232:235], a[56:59], v[112:115]
  v_mfma_f32_16x16x32_bf16 v[120:123], a[232:235], a[60:63], v[120:123]
  s_waitcnt lgkmcnt(10)
  v_mfma_f32_16x16x32_bf16 v[100:103], a[236:239], a[48:51], v[100:103]
  ds_read_b64_tr_b16 a[220:221], v228 offset:264
  v_mfma_f32_16x16x32_bf16 v[108:111], a[236:239], a[52:55], v[108:111]
  ds_read_b64_tr_b16 a[222:223], v228 offset:1288
  v_mfma_f32_16x16x32_bf16 v[116:119], a[236:239], a[56:59], v[116:119]
  buffer_load_dwordx4 a[156:159], v234, s[20:23], s58 offen offset:1024 sc1
  v_mfma_f32_16x16x32_bf16 v[124:127], a[236:239], a[60:63], v[124:127]
  s_waitcnt lgkmcnt(10)
  v_mfma_f32_16x16x32_bf16 v[128:131], a[240:243], a[48:51], v[128:131]
  ds_read_b64_tr_b16 a[224:225], v228 offset:512
  v_mfma_f32_16x16x32_bf16 v[136:139], a[240:243], a[52:55], v[136:139]
  ds_read_b64_tr_b16 a[226:227], v228 offset:1536
  v_mfma_f32_16x16x32_bf16 v[144:147], a[240:243], a[56:59], v[144:147]
  v_mfma_f32_16x16x32_bf16 v[152:155], a[240:243], a[60:63], v[152:155]
  s_waitcnt lgkmcnt(10)
  v_mfma_f32_16x16x32_bf16 v[132:135], a[244:247], a[48:51], v[132:135]
  ds_read_b64_tr_b16 a[228:229], v228 offset:520
  v_mfma_f32_16x16x32_bf16 v[140:143], a[244:247], a[52:55], v[140:143]
  ds_read_b64_tr_b16 a[230:231], v228 offset:1544
  v_mfma_f32_16x16x32_bf16 v[148:151], a[244:247], a[56:59], v[148:151]
  v_mfma_f32_16x16x32_bf16 v[156:159], a[244:247], a[60:63], v[156:159]
  s_waitcnt lgkmcnt(10)
  v_mfma_f32_16x16x32_bf16 v[0:3], a[208:211], a[64:67], v[0:3]
  ds_read_b64_tr_b16 a[232:233], v228 offset:768
  v_mfma_f32_16x16x32_bf16 v[8:11], a[208:211], a[68:71], v[8:11]
  ds_read_b64_tr_b16 a[234:235], v228 offset:1792
  v_mfma_f32_16x16x32_bf16 v[16:19], a[208:211], a[72:75], v[16:19]
  s_bfe_u32 s59, s32, 0x40018
  v_mfma_f32_16x16x32_bf16 v[24:27], a[208:211], a[76:79], v[24:27]
  s_mul_i32 s59, s59, 0x14000
  s_waitcnt lgkmcnt(10)
  v_mfma_f32_16x16x32_bf16 v[4:7], a[212:215], a[64:67], v[4:7]
  ds_read_b64_tr_b16 a[236:237], v228 offset:776
  s_add_u32 s57, s55, s75
  v_mfma_f32_16x16x32_bf16 v[12:15], a[212:215], a[68:71], v[12:15]
  ds_read_b64_tr_b16 a[238:239], v228 offset:1800
  s_add_u32 m0, s57, 0
  v_mfma_f32_16x16x32_bf16 v[20:23], a[212:215], a[72:75], v[20:23]
  buffer_load_dwordx4 v213, s[24:27], s59 offen lds
  s_bfe_u32 s58, s32, 0x40014
  v_mfma_f32_16x16x32_bf16 v[28:31], a[212:215], a[76:79], v[28:31]
  s_lshl_b32 s58, s58, 11
  s_add_u32 s58, s58, s97
  s_waitcnt lgkmcnt(10)
  v_mfma_f32_16x16x32_bf16 v[32:35], a[216:219], a[64:67], v[32:35]
  ds_read_b64_tr_b16 a[240:241], v229 offset:8224
  s_bfe_u32 s84, s34, 0x2000a
  v_mfma_f32_16x16x32_bf16 v[40:43], a[216:219], a[68:71], v[40:43]
  s_waitcnt vmcnt(3)
  v_cmp_gt_u32 vcc, s84, v220
  s_cbranch_vccnz L_chk10_far
L_chk10:
  v_mfma_f32_16x16x32_bf16 v[48:51], a[216:219], a[72:75], v[48:51]
  ds_read_b64_tr_b16 a[242:243], v229 offset:8480
  v_mfma_f32_16x16x32_bf16 v[56:59], a[216:219], a[76:79], v[56:59]
  buffer_load_dwordx4 a[160:163], v231, s[20:23], s58 offen sc1
  s_waitcnt lgkmcnt(10)
  v_mfma_f32_16x16x32_bf16 v[36:39], a[220:223], a[64:67], v[36:39]
  ds_read_b64_tr_b16 a[244:245], v229 offset:8232
  v_mfma_f32_16x16x32_bf16 v[44:47], a[220:223], a[68:71], v[44:47]
  ds_read_b64_tr_b16 a[246:247], v229 offset:8488
  s_add_u32 m0, s57, 0x400
  v_mfma_f32_16x16x32_bf16 v[52:55], a[220:223], a[72:75], v[52:55]
  buffer_load_dwordx4 v214, s[24:27], s59 offen lds
  v_mfma_f32_16x16x32_bf16 v[60:63], a[220:223], a[76:79], v[60:63]
  s_waitcnt lgkmcnt(10)
  v_mfma_f32_16x16x32_bf16 v[64:67], a[224:227], a[64:67], v[64:67]
  ds_read_b64_tr_b16 a[208:209], v228 offset:10288
  v_mfma_f32_16x16x32_bf16 v[72:75], a[224:227], a[68:71], v[72:75]
  ds_read_b64_tr_b16 a[210:211], v228 offset:11312
  v_mfma_f32_16x16x32_bf16 v[80:83], a[224:227], a[72:75], v[80:83]
  buffer_load_dwordx4 a[164:167], v232, s[20:23], s58 offen sc1
  v_mfma_f32_16x16x32_bf16 v[88:91], a[224:227], a[76:79], v[88:91]
  s_waitcnt lgkmcnt(10)
  v_mfma_f32_16x16x32_bf16 v[68:71], a[228:231], a[64:67], v[68:71]
  ds_read_b64_tr_b16 a[212:213], v228 offset:10296
  v_mfma_f32_16x16x32_bf16 v[76:79], a[228:231], a[68:71], v[76:79]
  ds_read_b64_tr_b16 a[214:215], v228 offset:11320
  s_add_u32 m0, s57, 0x1010
  v_mfma_f32_16x16x32_bf16 v[84:87], a[228:231], a[72:75], v[84:87]
  buffer_load_dwordx4 v215, s[24:27], s59 offen lds
  v_mfma_f32_16x16x32_bf16 v[92:95], a[228:231], a[76:79], v[92:95]
  s_waitcnt lgkmcnt(10)
  v_mfma_f32_16x16x32_bf16 v[96:99], a[232:235], a[64:67], v[96:99]
  ds_read_b64_tr_b16 a[216:217], v228 offset:10544
  v_mfma_f32_16x16x32_bf16 v[104:107], a[232:235], a[68:71], v[104:107]
  ds_read_b64_tr_b16 a[218:219], v228 offset:11568
  v_mfma_f32_16x16x32_bf16 v[112:115], a[232:235], a[72:75], v[112:115]
  v_mfma_f32_16x16x32_bf16 v[120:123], a[232:235], a[76:79], v[120:123]
  buffer_load_dwordx4 a[168:171], v233, s[20:23], s58 offen sc1
  s_waitcnt lgkmcnt(10)
  v_mfma_f32_16x16x32_bf16 v[100:103], a[236:239], a[64:67], v[100:103]
  ds_read_b64_tr_b16 a[220:221], v228 offset:10552
  v_mfma_f32_16x16x32_bf16 v[108:111], a[236:239], a[68:71], v[108:111]
  ds_read_b64_tr_b16 a[222:223], v228 offset:11576
  s_add_u32 m0, s57, 0x1410
  v_mfma_f32_16x16x32_bf16 v[116:119], a[236:239], a[72:75], v[116:119]
  buffer_load_dwordx4 v216, s[24:27], s59 offen lds
  v_mfma_f32_16x16x32_bf16 v[124:127], a[236:239], a[76:79], v[124:127]
  s_waitcnt lgkmcnt(10)
  v_mfma_f32_16x16x32_bf16 v[128:131], a[240:243], a[64:67], v[128:131]
  ds_read_b64_tr_b16 a[224:225], v228 offset:10800
  v_mfma_f32_16x16x32_bf16 v[136:139], a[240:243], a[68:71], v[136:139]
  ds_read_b64_tr_b16 a[226:227], v228 offset:11824
  v_mfma_f32_16x16x32_bf16 v[144:147], a[240:243], a[72:75], v[144:147]
  v_mfma_f32_16x16x32_bf16 v[152:155], a[240:243], a[76:79], v[152:155]
  buffer_load_dwordx4 a[172:175], v234, s[20:23], s58 offen sc1
  s_waitcnt lgkmcnt(10)
  v_mfma_f32_16x16x32_bf16 v[132:135], a[244:247], a[64:67], v[132:135]
  ds_read_b64_tr_b16 a[228:229], v228 offset:10808
  v_mfma_f32_16x16x32_bf16 v[140:143], a[244:247], a[68:71], v[140:143]
  ds_read_b64_tr_b16 a[230:231], v228 offset:11832
  s_add_u32 m0, s55, s76
  v_mfma_f32_16x16x32_bf16 v[148:151], a[244:247], a[72:75], v[148:151]
  buffer_load_dwordx4 v217, s[24:27], s59 offen lds
  v_mfma_f32_16x16x32_bf16 v[156:159], a[244:247], a[76:79], v[156:159]
  s_waitcnt lgkmcnt(10)
  v_mfma_f32_16x16x32_bf16 v[0:3], a[208:211], a[80:83], v[0:3]
  ds_read_b64_tr_b16 a[232:233], v228 offset:11056
  v_mfma_f32_16x16x32_bf16 v[8:11], a[208:211], a[84:87], v[8:11]
  s_add_u32 s55, s55, 0x6080
  s_cmp_ge_u32 s55, 0x24300
  s_cselect_b32 s55, 0, s55
  v_mfma_f32_16x16x32_bf16 v[16:19], a[208:211], a[88:91], v[16:19]
  ds_read_b64_tr_b16 a[234:235], v228 offset:12080
  v_mfma_f32_16x16x32_bf16 v[24:27], a[208:211], a[92:95], v[24:27]
  s_waitcnt lgkmcnt(10)
  v_mfma_f32_16x16x32_bf16 v[4:7], a[212:215], a[80:83], v[4:7]
  ds_read_b64_tr_b16 a[236:237], v228 offset:11064
  v_mfma_f32_16x16x32_bf16 v[12:15], a[212:215], a[84:87], v[12:15]
  buffer_load_dwordx4 a[176:179], v231, s[20:23], s58 offen offset:1024 sc1
  v_mfma_f32_16x16x32_bf16 v[20:23], a[212:215], a[88:91], v[20:23]
  ds_read_b64_tr_b16 a[238:239], v228 offset:12088
  v_mfma_f32_16x16x32_bf16 v[28:31], a[212:215], a[92:95], v[28:31]
  s_waitcnt lgkmcnt(10)
  v_mfma_f32_16x16x32_bf16 v[32:35], a[216:219], a[80:83], v[32:35]
  ds_read_b64_tr_b16 a[240:241], v229 offset:18512
  v_mfma_f32_16x16x32_bf16 v[40:43], a[216:219], a[84:87], v[40:43]
  ds_read_b64_tr_b16 a[242:243], v229 offset:18768
  v_mfma_f32_16x16x32_bf16 v[48:51], a[216:219], a[88:91], v[48:51]
  v_mfma_f32_16x16x32_bf16 v[56:59], a[216:219], a[92:95], v[56:59]
  s_waitcnt lgkmcnt(10)
  v_mfma_f32_16x16x32_bf16 v[36:39], a[220:223], a[80:83], v[36:39]
  ds_read_b64_tr_b16 a[244:245], v229 offset:18520
  v_mfma_f32_16x16x32_bf16 v[44:47], a[220:223], a[84:87], v[44:47]
  s_add_u32 s54, s54, 0x6080
  s_cmp_ge_u32 s54, 0x24300
  s_cselect_b32 s54, 0, s54
  v_mfma_f32_16x16x32_bf16 v[52:55], a[220:223], a[88:91], v[52:55]
  buffer_load_dwordx4 a[180:183], v232, s[20:23], s58 offen offset:1024 sc1
  v_mfma_f32_16x16x32_bf16 v[60:63], a[220:223], a[92:95], v[60:63]
  ds_read_b64_tr_b16 a[246:247], v229 offset:18776
  s_waitcnt lgkmcnt(10)
  v_mfma_f32_16x16x32_bf16 v[64:67], a[224:227], a[80:83], v[64:67]
  s_barrier
  v_add_u32 v228, s54, v218
  v_add_u32 v229, s54, v219
  v_mfma_f32_16x16x32_bf16 v[72:75], a[224:227], a[84:87], v[72:75]
  ds_read_b64_tr_b16 a[208:209], v228
  v_mfma_f32_16x16x32_bf16 v[80:83], a[224:227], a[88:91], v[80:83]
  ds_read_b64_tr_b16 a[210:211], v228 offset:1024
  v_mfma_f32_16x16x32_bf16 v[88:91], a[224:227], a[92:95], v[88:91]
  s_waitcnt lgkmcnt(10)
  v_mfma_f32_16x16x32_bf16 v[68:71], a[228:231], a[80:83], v[68:71]
  ds_read_b64_tr_b16 a[212:213], v228 offset:8
  v_mfma_f32_16x16x32_bf16 v[76:79], a[228:231], a[84:87], v[76:79]
  buffer_load_dword v220, v221, s[20:23], s83 offen sc1
  v_mfma_f32_16x16x32_bf16 v[84:87], a[228:231], a[88:91], v[84:87]
  ds_read_b64_tr_b16 a[214:215], v228 offset:1032
  v_mfma_f32_16x16x32_bf16 v[92:95], a[228:231], a[92:95], v[92:95]
  buffer_load_dwordx4 a[184:187], v233, s[20:23], s58 offen offset:1024 sc1
  s_waitcnt lgkmcnt(10)
  v_mfma_f32_16x16x32_bf16 v[96:99], a[232:235], a[80:83], v[96:99]
  ds_read_b64_tr_b16 a[216:217], v228 offset:256
  v_mfma_f32_16x16x32_bf16 v[104:107], a[232:235], a[84:87], v[104:107]
  ds_read_b64_tr_b16 a[218:219], v228 offset:1280
  v_mfma_f32_16x16x32_bf16 v[112:115], a[232:235], a[88:91], v[112:115]
  v_mfma_f32_16x16x32_bf16 v[120:123], a[232:235], a[92:95], v[120:123]
  s_waitcnt lgkmcnt(10)
  v_mfma_f32_16x16x32_bf16 v[100:103], a[236:239], a[80:83], v[100:103]
  ds_read_b64_tr_b16 a[220:221], v228 offset:264
  v_mfma_f32_16x16x32_bf16 v[108:111], a[236:239], a[84:87], v[108:111]
  ds_read_b64_tr_b16 a[222:223], v228 offset:1288
  v_mfma_f32_16x16x32_bf16 v[116:119], a[236:239], a[88:91], v[116:119]
  buffer_load_dwordx4 a[188:191], v234, s[20:23], s58 offen offset:1024 sc1
  v_mfma_f32_16x16x32_bf16 v[124:127], a[236:239], a[92:95], v[124:127]
  s_waitcnt lgkmcnt(10)
  v_mfma_f32_16x16x32_bf16 v[128:131], a[240:243], a[80:83], v[128:131]
  ds_read_b64_tr_b16 a[224:225], v228 offset:512
  v_mfma_f32_16x16x32_bf16 v[136:139], a[240:243], a[84:87], v[136:139]
  ds_read_b64_tr_b16 a[226:227], v228 offset:1536
  v_mfma_f32_16x16x32_bf16 v[144:147], a[240:243], a[88:91], v[144:147]
  v_mfma_f32_16x16x32_bf16 v[152:155], a[240:243], a[92:95], v[152:155]
  s_waitcnt lgkmcnt(10)
  v_mfma_f32_16x16x32_bf16 v[132:135], a[244:247], a[80:83], v[132:135]
  ds_read_b64_tr_b16 a[228:229], v228 offset:520
  v_mfma_f32_16x16x32_bf16 v[140:143], a[244:247], a[84:87], v[140:143]
  ds_read_b64_tr_b16 a[230:231], v228 offset:1544
  v_mfma_f32_16x16x32_bf16 v[148:151], a[244:247], a[88:91], v[148:151]
  v_mfma_f32_16x16x32_bf16 v[156:159], a[244:247], a[92:95], v[156:159]
  s_waitcnt lgkmcnt(10)
  v_mfma_f32_16x16x32_bf16 v[0:3], a[208:211], a[96:99], v[0:3]
  ds_read_b64_tr_b16 a[232:233], v228 offset:768
  v_mfma_f32_16x16x32_bf16 v[8:11], a[208:211], a[100:103], v[8:11]
  ds_read_b64_tr_b16 a[234:235], v228 offset:1792
  v_mfma_f32_16x16x32_bf16 v[16:19], a[208:211], a[104:107], v[16:19]
  s_bfe_u32 s59, s32, 0x4001c
  v_mfma_f32_16x16x32_bf16 v[24:27], a[208:211], a[108:111], v[24:27]
  s_mul_i32 s59, s59, 0x14000
  s_waitcnt lgkmcnt(10)
  v_mfma_f32_16x16x32_bf16 v[4:7], a[212:215], a[96:99], v[4:7]
  ds_read_b64_tr_b16 a[236:237], v228 offset:776
  s_add_u32 s57, s55, s75
  v_mfma_f32_16x16x32_bf16 v[12:15], a[212:215], a[100:103], v[12:15]
  ds_read_b64_tr_b16 a[238:239], v228 offset:1800
  s_add_u32 m0, s57, 0
  v_mfma_f32_16x16x32_bf16 v[20:23], a[212:215], a[104:107], v[20:23]
  buffer_load_dwordx4 v213, s[24:27], s59 offen lds
  s_bfe_u32 s58, s32, 0x40018
  v_mfma_f32_16x16x32_bf16 v[28:31], a[212:215], a[108:111], v[28:31]
  s_lshl_b32 s58, s58, 11
  s_add_u32 s58, s58, s97
  s_waitcnt lgkmcnt(10)
  v_mfma_f32_16x16x32_bf16 v[32:35], a[216:219], a[96:99], v[32:35]
  ds_read_b64_tr_b16 a[240:241], v229 offset:8224
  s_bfe_u32 s84, s34, 0x2000c
  v_mfma_f32_16x16x32_bf16 v[40:43], a[216:219], a[100:103], v[40:43]
  s_waitcnt vmcnt(3)
  v_cmp_gt_u32 vcc, s84, v220
  s_cbranch_vccnz L_chk12_far
L_chk12:
  v_mfma_f32_16x16x32_bf16 v[48:51], a[216:219], a[104:107], v[48:51]
  ds_read_b64_tr_b16 a[242:243], v229 offset:8480
  v_mfma_f32_16x16x32_bf16 v[56:59], a[216:219], a[108:111], v[56:59]
  buffer_load_dwordx4 a[0:3], v231, s[20:23], s58 offen sc1
  s_waitcnt lgkmcnt(10)
  v_mfma_f32_16x16x32_bf16 v[36:39], a[220:223], a[96:99], v[36:39]
  ds_read_b64_tr_b16 a[244:245], v229 offset:8232
  v_mfma_f32_16x16x32_bf16 v[44:47], a[220:223], a[100:103], v[44:47]
  ds_read_b64_tr_b16 a[246:247], v229 offset:8488
  s_add_u32 m0, s57, 0x400
  v_mfma_f32_16x16x32_bf16 v[52:55], a[220:223], a[104:107], v[52:55]
  buffer_load_dwordx4 v214, s[24:27], s59 offen lds
  v_mfma_f32_16x16x32_bf16 v[60:63], a[220:223], a[108:111], v[60:63]
  s_waitcnt lgkmcnt(10)
  v_mfma_f32_16x16x32_bf16 v[64:67], a[224:227], a[96:99], v[64:67]
  ds_read_b64_tr_b16 a[208:209], v228 offset:10288
  v_mfma_f32_16x16x32_bf16 v[72:75], a[224:227], a[100:103], v[72:75]
  ds_read_b64_tr_b16 a[210:211], v228 offset:11312
  v_mfma_f32_16x16x32_bf16 v[80:83], a[224:227], a[104:107], v[80:83]
  buffer_load_dwordx4 a[4:7], v232, s[20:23], s58 offen sc1
  v_mfma_f32_16x16x32_bf16 v[88:91], a[224:227], a[108:111], v[88:91]
  s_waitcnt lgkmcnt(10)
  v_mfma_f32_16x16x32_bf16 v[68:71], a[228:231], a[96:99], v[68:71]
  ds_read_b64_tr_b16 a[212:213], v228 offset:10296
  v_mfma_f32_16x16x32_bf16 v[76:79], a[228:231], a[100:103], v[76:79]
  ds_read_b64_tr_b16 a[214:215], v228 offset:11320
  s_add_u32 m0, s57, 0x1010
  v_mfma_f32_16x16x32_bf16 v[84:87], a[228:231], a[104:107], v[84:87]
  buffer_load_dwordx4 v215, s[24:27], s59 offen lds
  v_mfma_f32_16x16x32_bf16 v[92:95], a[228:231], a[108:111], v[92:95]
  s_waitcnt lgkmcnt(10)
  v_mfma_f32_16x16x32_bf16 v[96:99], a[232:235], a[96:99], v[96:99]
  ds_read_b64_tr_b16 a[216:217], v228 offset:10544
  v_mfma_f32_16x16x32_bf16 v[104:107], a[232:235], a[100:103], v[104:107]
  ds_read_b64_tr_b16 a[218:219], v228 offset:11568
  v_mfma_f32_16x16x32_bf16 v[112:115], a[232:235], a[104:107], v[112:115]
  v_mfma_f32_16x16x32_bf16 v[120:123], a[232:235], a[108:111], v[120:123]
  buffer_load_dwordx4 a[8:11], v233, s[20:23], s58 offen sc1
  s_waitcnt lgkmcnt(10)
  v_mfma_f32_16x16x32_bf16 v[100:103], a[236:239], a[96:99], v[100:103]
  ds_read_b64_tr_b16 a[220:221], v228 offset:10552
  v_mfma_f32_16x16x32_bf16 v[108:111], a[236:239], a[100:103], v[108:111]
  ds_read_b64_tr_b16 a[222:223], v228 offset:11576
  s_add_u32 m0, s57, 0x1410
  v_mfma_f32_16x16x32_bf16 v[116:119], a[236:239], a[104:107], v[116:119]
  buffer_load_dwordx4 v216, s[24:27], s59 offen lds
  v_mfma_f32_16x16x32_bf16 v[124:127], a[236:239], a[108:111], v[124:127]
  s_waitcnt lgkmcnt(10)
  v_mfma_f32_16x16x32_bf16 v[128:131], a[240:243], a[96:99], v[128:131]
  ds_read_b64_tr_b16 a[224:225], v228 offset:10800
  v_mfma_f32_16x16x32_bf16 v[136:139], a[240:243], a[100:103], v[136:139]
  ds_read_b64_tr_b16 a[226:227], v228 offset:11824
  v_mfma_f32_16x16x32_bf16 v[144:147], a[240:243], a[104:107], v[144:147]
  v_mfma_f32_16x16x32_bf16 v[152:155], a[240:243], a[108:111], v[152:155]
  buffer_load_dwordx4 a[12:15], v234, s[20:23], s58 offen sc1
  s_waitcnt lgkmcnt(10)
  v_mfma_f32_16x16x32_bf16 v[132:135], a[244:247], a[96:99], v[132:135]
  ds_read_b64_tr_b16 a[228:229], v228 offset:10808
  v_mfma_f32_16x16x32_bf16 v[140:143], a[244:247], a[100:103], v[140:143]
  ds_read_b64_tr_b16 a[230:231], v228 offset:11832
  s_add_u32 m0, s55, s76
  v_mfma_f32_16x16x32_bf16 v[148:151], a[244:247], a[104:107], v[148:151]
  buffer_load_dwordx4 v217, s[24:27], s59 offen lds
  v_mfma_f32_16x16x32_bf16 v[156:159], a[244:247], a[108:111], v[156:159]
  s_waitcnt lgkmcnt(10)
  v_mfma_f32_16x16x32_bf16 v[0:3], a[208:211], a[112:115], v[0:3]
  ds_read_b64_tr_b16 a[232:233], v228 offset:11056
  v_mfma_f32_16x16x32_bf16 v[8:11], a[208:211], a[116:119], v[8:11]
  s_add_u32 s55, s55, 0x6080
  s_cmp_ge_u32 s55, 0x24300
  s_cselect_b32 s55, 0, s55
  v_mfma_f32_16x16x32_bf16 v[16:19], a[208:211], a[120:123], v[16:19]
  ds_read_b64_tr_b16 a[234:235], v228 offset:12080
  v_mfma_f32_16x16x32_bf16 v[24:27], a[208:211], a[124:127], v[24:27]
  s_waitcnt lgkmcnt(10)
  v_mfma_f32_16x16x32_bf16 v[4:7], a[212:215], a[112:115], v[4:7]
  ds_read_b64_tr_b16 a[236:237], v228 offset:11064
  v_mfma_f32_16x16x32_bf16 v[12:15], a[212:215], a[116:119], v[12:15]
  buffer_load_dwordx4 a[16:19], v231, s[20:23], s58 offen offset:1024 sc1
  v_mfma_f32_16x16x32_bf16 v[20:23], a[212:215], a[120:123], v[20:23]
  ds_read_b64_tr_b16 a[238:239], v228 offset:12088
  v_mfma_f32_16x16x32_bf16 v[28:31], a[212:215], a[124:127], v[28:31]
  s_waitcnt lgkmcnt(10)
  v_mfma_f32_16x16x32_bf16 v[32:35], a[216:219], a[112:115], v[32:35]
  ds_read_b64_tr_b16 a[240:241], v229 offset:18512
  v_mfma_f32_16x16x32_bf16 v[40:43], a[216:219], a[116:119], v[40:43]
  ds_read_b64_tr_b16 a[242:243], v229 offset:18768
  v_mfma_f32_16x16x32_bf16 v[48:51], a[216:219], a[120:123], v[48:51]
  v_mfma_f32_16x16x32_bf16 v[56:59], a[216:219], a[124:127], v[56:59]
  s_waitcnt lgkmcnt(10)
  v_mfma_f32_16x16x32_bf16 v[36:39], a[220:223], a[112:115], v[36:39]
  ds_read_b64_tr_b16 a[244:245], v229 offset:18520
  v_mfma_f32_16x16x32_bf16 v[44:47], a[220:223], a[116:119], v[44:47]
  s_add_u32 s54, s54, 0x6080
  s_cmp_ge_u32 s54, 0x24300
  s_cselect_b32 s54, 0, s54
  v_mfma_f32_16x16x32_bf16 v[52:55], a[220:223], a[120:123], v[52:55]
  buffer_load_dwordx4 a[20:23], v232, s[20:23], s58 offen offset:1024 sc1
  v_mfma_f32_16x16x32_bf16 v[60:63], a[220:223], a[124:127], v[60:63]
  ds_read_b64_tr_b16 a[246:247], v229 offset:18776
  s_waitcnt lgkmcnt(10)
  v_mfma_f32_16x16x32_bf16 v[64:67], a[224:227], a[112:115], v[64:67]
  s_barrier
  v_add_u32 v228, s54, v218
  v_add_u32 v229, s54, v219
  v_mfma_f32_16x16x32_bf16 v[72:75], a[224:227], a[116:119], v[72:75]
  ds_read_b64_tr_b16 a[208:209], v228
  v_mfma_f32_16x16x32_bf16 v[80:83], a[224:227], a[120:123], v[80:83]
  ds_read_b64_tr_b16 a[210:211], v228 offset:1024
  v_mfma_f32_16x16x32_bf16 v[88:91], a[224:227], a[124:127], v[88:91]
  s_waitcnt lgkmcnt(10)
  v_mfma_f32_16x16x32_bf16 v[68:71], a[228:231], a[112:115], v[68:71]
  ds_read_b64_tr_b16 a[212:213], v228 offset:8
  v_mfma_f32_16x16x32_bf16 v[76:79], a[228:231], a[116:119], v[76:79]
  buffer_load_dword v220, v221, s[20:23], s83 offen sc1
  v_mfma_f32_16x16x32_bf16 v[84:87], a[228:231], a[120:123], v[84:87]
  ds_read_b64_tr_b16 a[214:215], v228 offset:1032
  v_mfma_f32_16x16x32_bf16 v[92:95], a[228:231], a[124:127], v[92:95]
  buffer_load_dwordx4 a[24:27], v233, s[20:23], s58 offen offset:1024 sc1
  s_waitcnt lgkmcnt(10)
  v_mfma_f32_16x16x32_bf16 v[96:99], a[232:235], a[112:115], v[96:99]
  ds_read_b64_tr_b16 a[216:217], v228 offset:256
  v_mfma_f32_16x16x32_bf16 v[104:107], a[232:235], a[116:119], v[104:107]
  ds_read_b64_tr_b16 a[218:219], v228 offset:1280
  v_mfma_f32_16x16x32_bf16 v[112:115], a[232:235], a[120:123], v[112:115]
  v_mfma_f32_16x16x32_bf16 v[120:123], a[232:235], a[124:127], v[120:123]
  s_waitcnt lgkmcnt(10)
  v_mfma_f32_16x16x32_bf16 v[100:103], a[236:239], a[112:115], v[100:103]
  ds_read_b64_tr_b16 a[220:221], v228 offset:264
  v_mfma_f32_16x16x32_bf16 v[108:111], a[236:239], a[116:119], v[108:111]
  ds_read_b64_tr_b16 a[222:223], v228 offset:1288
  v_mfma_f32_16x16x32_bf16 v[116:119], a[236:239], a[120:123], v[116:119]
  buffer_load_dwordx4 a[28:31], v234, s[20:23], s58 offen offset:1024 sc1
  v_mfma_f32_16x16x32_bf16 v[124:127], a[236:239], a[124:127], v[124:127]
  s_waitcnt lgkmcnt(10)
  v_mfma_f32_16x16x32_bf16 v[128:131], a[240:243], a[112:115], v[128:131]
  ds_read_b64_tr_b16 a[224:225], v228 offset:512
  v_mfma_f32_16x16x32_bf16 v[136:139], a[240:243], a[116:119], v[136:139]
  ds_read_b64_tr_b16 a[226:227], v228 offset:1536
  v_mfma_f32_16x16x32_bf16 v[144:147], a[240:243], a[120:123], v[144:147]
  v_mfma_f32_16x16x32_bf16 v[152:155], a[240:243], a[124:127], v[152:155]
  s_waitcnt lgkmcnt(10)
  v_mfma_f32_16x16x32_bf16 v[132:135], a[244:247], a[112:115], v[132:135]
  ds_read_b64_tr_b16 a[228:229], v228 offset:520
  v_mfma_f32_16x16x32_bf16 v[140:143], a[244:247], a[116:119], v[140:143]
  ds_read_b64_tr_b16 a[230:231], v228 offset:1544
  v_mfma_f32_16x16x32_bf16 v[148:151], a[244:247], a[120:123], v[148:151]
  v_mfma_f32_16x16x32_bf16 v[156:159], a[244:247], a[124:127], v[156:159]
  s_waitcnt lgkmcnt(10)
  v_mfma_f32_16x16x32_bf16 v[0:3], a[208:211], a[128:131], v[0:3]
  ds_read_b64_tr_b16 a[232:233], v228 offset:768
  v_mfma_f32_16x16x32_bf16 v[8:11], a[208:211], a[132:135], v[8:11]
  ds_read_b64_tr_b16 a[234:235], v228 offset:1792
  v_mfma_f32_16x16x32_bf16 v[16:19], a[208:211], a[136:139], v[16:19]
  s_bfe_u32 s59, s33, 0x40000
  v_mfma_f32_16x16x32_bf16 v[24:27], a[208:211], a[140:143], v[24:27]
  s_mul_i32 s59, s59, 0x14000
  s_waitcnt lgkmcnt(10)
  v_mfma_f32_16x16x32_bf16 v[4:7], a[212:215], a[128:131], v[4:7]
  ds_read_b64_tr_b16 a[236:237], v228 offset:776
  s_add_u32 s57, s55, s75
  v_mfma_f32_16x16x32_bf16 v[12:15], a[212:215], a[132:135], v[12:15]
  ds_read_b64_tr_b16 a[238:239], v228 offset:1800
  s_add_u32 m0, s57, 0
  v_mfma_f32_16x16x32_bf16 v[20:23], a[212:215], a[136:139], v[20:23]
  buffer_load_dwordx4 v213, s[24:27], s59 offen lds
  s_bfe_u32 s58, s32, 0x4001c
  v_mfma_f32_16x16x32_bf16 v[28:31], a[212:215], a[140:143], v[28:31]
  s_lshl_b32 s58, s58, 11
  s_add_u32 s58, s58, s97
  s_waitcnt lgkmcnt(10)
  v_mfma_f32_16x16x32_bf16 v[32:35], a[216:219], a[128:131], v[32:35]
  ds_read_b64_tr_b16 a[240:241], v229 offset:8224
  s_bfe_u32 s84, s34, 0x2000e
  v_mfma_f32_16x16x32_bf16 v[40:43], a[216:219], a[132:135], v[40:43]
  s_waitcnt vmcnt(3)
  v_cmp_gt_u32 vcc, s84, v220
  s_cbranch_vccnz L_chk14_far
L_chk14:
  v_mfma_f32_16x16x32_bf16 v[48:51], a[216:219], a[136:139], v[48:51]
  ds_read_b64_tr_b16 a[242:243], v229 offset:8480
  v_mfma_f32_16x16x32_bf16 v[56:59], a[216:219], a[140:143], v[56:59]
  buffer_load_dwordx4 a[32:35], v231, s[20:23], s58 offen sc1
  s_waitcnt lgkmcnt(10)
  v_mfma_f32_16x16x32_bf16 v[36:39], a[220:223], a[128:131], v[36:39]
  ds_read_b64_tr_b16 a[244:245], v229 offset:8232
  v_mfma_f32_16x16x32_bf16 v[44:47], a[220:223], a[132:135], v[44:47]
  ds_read_b64_tr_b16 a[246:247], v229 offset:8488
  s_add_u32 m0, s57, 0x400
  v_mfma_f32_16x16x32_bf16 v[52:55], a[220:223], a[136:139], v[52:55]
  buffer_load_dwordx4 v214, s[24:27], s59 offen lds
  v_mfma_f32_16x16x32_bf16 v[60:63], a[220:223], a[140:143], v[60:63]
  s_waitcnt lgkmcnt(10)
  v_mfma_f32_16x16x32_bf16 v[64:67], a[224:227], a[128:131], v[64:67]
  ds_read_b64_tr_b16 a[208:209], v228 offset:10288
  v_mfma_f32_16x16x32_bf16 v[72:75], a[224:227], a[132:135], v[72:75]
  ds_read_b64_tr_b16 a[210:211], v228 offset:11312
  v_mfma_f32_16x16x32_bf16 v[80:83], a[224:227], a[136:139], v[80:83]
  buffer_load_dwordx4 a[36:39], v232, s[20:23], s58 offen sc1
  v_mfma_f32_16x16x32_bf16 v[88:91], a[224:227], a[140:143], v[88:91]
  s_waitcnt lgkmcnt(10)
  v_mfma_f32_16x16x32_bf16 v[68:71], a[228:231], a[128:131], v[68:71]
  ds_read_b64_tr_b16 a[212:213], v228 offset:10296
  v_mfma_f32_16x16x32_bf16 v[76:79], a[228:231], a[132:135], v[76:79]
  ds_read_b64_tr_b16 a[214:215], v228 offset:11320
  s_add_u32 m0, s57, 0x1010
  v_mfma_f32_16x16x32_bf16 v[84:87], a[228:231], a[136:139], v[84:87]
  buffer_load_dwordx4 v215, s[24:27], s59 offen lds
  v_mfma_f32_16x16x32_bf16 v[92:95], a[228:231], a[140:143], v[92:95]
  s_waitcnt lgkmcnt(10)
  v_mfma_f32_16x16x32_bf16 v[96:99], a[232:235], a[128:131], v[96:99]
  ds_read_b64_tr_b16 a[216:217], v228 offset:10544
  v_mfma_f32_16x16x32_bf16 v[104:107], a[232:235], a[132:135], v[104:107]
  ds_read_b64_tr_b16 a[218:219], v228 offset:11568
  v_mfma_f32_16x16x32_bf16 v[112:115], a[232:235], a[136:139], v[112:115]
  v_mfma_f32_16x16x32_bf16 v[120:123], a[232:235], a[140:143], v[120:123]
  buffer_load_dwordx4 a[40:43], v233, s[20:23], s58 offen sc1
  s_waitcnt lgkmcnt(10)
  v_mfma_f32_16x16x32_bf16 v[100:103], a[236:239], a[128:131], v[100:103]
  ds_read_b64_tr_b16 a[220:221], v228 offset:10552
  v_mfma_f32_16x16x32_bf16 v[108:111], a[236:239], a[132:135], v[108:111]
  ds_read_b64_tr_b16 a[222:223], v228 offset:11576
  s_add_u32 m0, s57, 0x1410
  v_mfma_f32_16x16x32_bf16 v[116:119], a[236:239], a[136:139], v[116:119]
  buffer_load_dwordx4 v216, s[24:27], s59 offen lds
  v_mfma_f32_16x16x32_bf16 v[124:127], a[236:239], a[140:143], v[124:127]
  s_waitcnt lgkmcnt(10)
  v_mfma_f32_16x16x32_bf16 v[128:131], a[240:243], a[128:131], v[128:131]
  ds_read_b64_tr_b16 a[224:225], v228 offset:10800
  v_mfma_f32_16x16x32_bf16 v[136:139], a[240:243], a[132:135], v[136:139]
  ds_read_b64_tr_b16 a[226:227], v228 offset:11824
  v_mfma_f32_16x16x32_bf16 v[144:147], a[240:243], a[136:139], v[144:147]
  v_mfma_f32_16x16x32_bf16 v[152:155], a[240:243], a[140:143], v[152:155]
  buffer_load_dwordx4 a[44:47], v234, s[20:23], s58 offen sc1
  s_waitcnt lgkmcnt(10)
  v_mfma_f32_16x16x32_bf16 v[132:135], a[244:247], a[128:131], v[132:135]
  ds_read_b64_tr_b16 a[228:229], v228 offset:10808
  v_mfma_f32_16x16x32_bf16 v[140:143], a[244:247], a[132:135], v[140:143]
  ds_read_b64_tr_b16 a[230:231], v228 offset:11832
  s_add_u32 m0, s55, s76
  v_mfma_f32_16x16x32_bf16 v[148:151], a[244:247], a[136:139], v[148:151]
  buffer_load_dwordx4 v217, s[24:27], s59 offen lds
  v_mfma_f32_16x16x32_bf16 v[156:159], a[244:247], a[140:143], v[156:159]
  s_waitcnt lgkmcnt(10)
  v_mfma_f32_16x16x32_bf16 v[0:3], a[208:211], a[144:147], v[0:3]
  ds_read_b64_tr_b16 a[232:233], v228 offset:11056
  v_mfma_f32_16x16x32_bf16 v[8:11], a[208:211], a[148:151], v[8:11]
  s_add_u32 s55, s55, 0x6080
  s_cmp_ge_u32 s55, 0x24300
  s_cselect_b32 s55, 0, s55
  v_mfma_f32_16x16x32_bf16 v[16:19], a[208:211], a[152:155], v[16:19]
  ds_read_b64_tr_b16 a[234:235], v228 offset:12080
  v_mfma_f32_16x16x32_bf16 v[24:27], a[208:211], a[156:159], v[24:27]
  s_waitcnt lgkmcnt(10)
  v_mfma_f32_16x16x32_bf16 v[4:7], a[212:215], a[144:147], v[4:7]
  ds_read_b64_tr_b16 a[236:237], v228 offset:11064
  v_mfma_f32_16x16x32_bf16 v[12:15], a[212:215], a[148:151], v[12:15]
  buffer_load_dwordx4 a[48:51], v231, s[20:23], s58 offen offset:1024 sc1
  v_mfma_f32_16x16x32_bf16 v[20:23], a[212:215], a[152:155], v[20:23]
  ds_read_b64_tr_b16 a[238:239], v228 offset:12088
  v_mfma_f32_16x16x32_bf16 v[28:31], a[212:215], a[156:159], v[28:31]
  s_waitcnt lgkmcnt(10)
  v_mfma_f32_16x16x32_bf16 v[32:35], a[216:219], a[144:147], v[32:35]
  ds_read_b64_tr_b16 a[240:241], v229 offset:18512
  v_mfma_f32_16x16x32_bf16 v[40:43], a[216:219], a[148:151], v[40:43]
  ds_read_b64_tr_b16 a[242:243], v229 offset:18768
  v_mfma_f32_16x16x32_bf16 v[48:51], a[216:219], a[152:155], v[48:51]
  v_mfma_f32_16x16x32_bf16 v[56:59], a[216:219], a[156:159], v[56:59]
  s_waitcnt lgkmcnt(10)
  v_mfma_f32_16x16x32_bf16 v[36:39], a[220:223], a[144:147], v[36:39]
  ds_read_b64_tr_b16 a[244:245], v229 offset:18520
  v_mfma_f32_16x16x32_bf16 v[44:47], a[220:223], a[148:151], v[44:47]
  s_add_u32 s54, s54, 0x6080
  s_cmp_ge_u32 s54, 0x24300
  s_cselect_b32 s54, 0, s54
  v_mfma_f32_16x16x32_bf16 v[52:55], a[220:223], a[152:155], v[52:55]
  buffer_load_dwordx4 a[52:55], v232, s[20:23], s58 offen offset:1024 sc1
  v_mfma_f32_16x16x32_bf16 v[60:63], a[220:223], a[156:159], v[60:63]
  ds_read_b64_tr_b16 a[246:247], v229 offset:18776
  s_waitcnt lgkmcnt(10)
  v_mfma_f32_16x16x32_bf16 v[64:67], a[224:227], a[144:147], v[64:67]
  s_barrier
  v_add_u32 v228, s54, v218
  v_add_u32 v229, s54, v219
  v_mfma_f32_16x16x32_bf16 v[72:75], a[224:227], a[148:151], v[72:75]
  ds_read_b64_tr_b16 a[208:209], v228
  v_mfma_f32_16x16x32_bf16 v[80:83], a[224:227], a[152:155], v[80:83]
  ds_read_b64_tr_b16 a[210:211], v228 offset:1024
  v_mfma_f32_16x16x32_bf16 v[88:91], a[224:227], a[156:159], v[88:91]
  s_waitcnt lgkmcnt(10)
  v_mfma_f32_16x16x32_bf16 v[68:71], a[228:231], a[144:147], v[68:71]
  ds_read_b64_tr_b16 a[212:213], v228 offset:8
  v_mfma_f32_16x16x32_bf16 v[76:79], a[228:231], a[148:151], v[76:79]
  buffer_load_dword v220, v221, s[20:23], s83 offen sc1
  v_mfma_f32_16x16x32_bf16 v[84:87], a[228:231], a[152:155], v[84:87]
  ds_read_b64_tr_b16 a[214:215], v228 offset:1032
  v_mfma_f32_16x16x32_bf16 v[92:95], a[228:231], a[156:159], v[92:95]
  buffer_load_dwordx4 a[56:59], v233, s[20:23], s58 offen offset:1024 sc1
  s_waitcnt lgkmcnt(10)
  v_mfma_f32_16x16x32_bf16 v[96:99], a[232:235], a[144:147], v[96:99]
  ds_read_b64_tr_b16 a[216:217], v228 offset:256
  v_mfma_f32_16x16x32_bf16 v[104:107], a[232:235], a[148:151], v[104:107]
  ds_read_b64_tr_b16 a[218:219], v228 offset:1280
  v_mfma_f32_16x16x32_bf16 v[112:115], a[232:235], a[152:155], v[112:115]
  v_mfma_f32_16x16x32_bf16 v[120:123], a[232:235], a[156:159], v[120:123]
  s_waitcnt lgkmcnt(10)
  v_mfma_f32_16x16x32_bf16 v[100:103], a[236:239], a[144:147], v[100:103]
  ds_read_b64_tr_b16 a[220:221], v228 offset:264
  v_mfma_f32_16x16x32_bf16 v[108:111], a[236:239], a[148:151], v[108:111]
  ds_read_b64_tr_b16 a[222:223], v228 offset:1288
  v_mfma_f32_16x16x32_bf16 v[116:119], a[236:239], a[152:155], v[116:119]
  buffer_load_dwordx4 a[60:63], v234, s[20:23], s58 offen offset:1024 sc1
  v_mfma_f32_16x16x32_bf16 v[124:127], a[236:239], a[156:159], v[124:127]
  s_waitcnt lgkmcnt(10)
  v_mfma_f32_16x16x32_bf16 v[128:131], a[240:243], a[144:147], v[128:131]
  ds_read_b64_tr_b16 a[224:225], v228 offset:512
  v_mfma_f32_16x16x32_bf16 v[136:139], a[240:243], a[148:151], v[136:139]
  ds_read_b64_tr_b16 a[226:227], v228 offset:1536
  v_mfma_f32_16x16x32_bf16 v[144:147], a[240:243], a[152:155], v[144:147]
  v_mfma_f32_16x16x32_bf16 v[152:155], a[240:243], a[156:159], v[152:155]
  s_waitcnt lgkmcnt(10)
  v_mfma_f32_16x16x32_bf16 v[132:135], a[244:247], a[144:147], v[132:135]
  ds_read_b64_tr_b16 a[228:229], v228 offset:520
  v_mfma_f32_16x16x32_bf16 v[140:143], a[244:247], a[148:151], v[140:143]
  ds_read_b64_tr_b16 a[230:231], v228 offset:1544
  v_mfma_f32_16x16x32_bf16 v[148:151], a[244:247], a[152:155], v[148:151]
  v_mfma_f32_16x16x32_bf16 v[156:159], a[244:247], a[156:159], v[156:159]
  s_waitcnt lgkmcnt(10)
  v_mfma_f32_16x16x32_bf16 v[0:3], a[208:211], a[160:163], v[0:3]
  ds_read_b64_tr_b16 a[232:233], v228 offset:768
  v_mfma_f32_16x16x32_bf16 v[8:11], a[208:211], a[164:167], v[8:11]
  ds_read_b64_tr_b16 a[234:235], v228 offset:1792
  v_mfma_f32_16x16x32_bf16 v[16:19], a[208:211], a[168:171], v[16:19]
  s_bfe_u32 s59, s33, 0x40004
  v_mfma_f32_16x16x32_bf16 v[24:27], a[208:211], a[172:175], v[24:27]
  s_mul_i32 s59, s59, 0x14000
  s_waitcnt lgkmcnt(10)
  v_mfma_f32_16x16x32_bf16 v[4:7], a[212:215], a[160:163], v[4:7]
  ds_read_b64_tr_b16 a[236:237], v228 offset:776
  s_add_u32 s57, s55, s75
  v_mfma_f32_16x16x32_bf16 v[12:15], a[212:215], a[164:167], v[12:15]
  ds_read_b64_tr_b16 a[238:239], v228 offset:1800
  s_add_u32 m0, s57, 0
  v_mfma_f32_16x16x32_bf16 v[20:23], a[212:215], a[168:171], v[20:23]
  buffer_load_dwordx4 v213, s[24:27], s59 offen lds
  s_bfe_u32 s58, s33, 0x40000
  v_mfma_f32_16x16x32_bf16 v[28:31], a[212:215], a[172:175], v[28:31]
  s_lshl_b32 s58, s58, 11
  s_add_u32 s58, s58, s97
  s_waitcnt lgkmcnt(10)
  v_mfma_f32_16x16x32_bf16 v[32:35], a[216:219], a[160:163], v[32:35]
  ds_read_b64_tr_b16 a[240:241], v229 offset:8224
  s_bfe_u32 s84, s34, 0x20010
  v_mfma_f32_16x16x32_bf16 v[40:43], a[216:219], a[164:167], v[40:43]
  s_waitcnt vmcnt(3)
  v_cmp_gt_u32 vcc, s84, v220
  s_cbranch_vccnz L_chk16_far
L_chk16:
  v_mfma_f32_16x16x32_bf16 v[48:51], a[216:219], a[168:171], v[48:51]
  ds_read_b64_tr_b16 a[242:243], v229 offset:8480
  v_mfma_f32_16x16x32_bf16 v[56:59], a[216:219], a[172:175], v[56:59]
  buffer_load_dwordx4 a[64:67], v231, s[20:23], s58 offen sc1
  s_waitcnt lgkmcnt(10)
  v_mfma_f32_16x16x32_bf16 v[36:39], a[220:223], a[160:163], v[36:39]
  ds_read_b64_tr_b16 a[244:245], v229 offset:8232
  v_mfma_f32_16x16x32_bf16 v[44:47], a[220:223], a[164:167], v[44:47]
  ds_read_b64_tr_b16 a[246:247], v229 offset:8488
  s_add_u32 m0, s57, 0x400
  v_mfma_f32_16x16x32_bf16 v[52:55], a[220:223], a[168:171], v[52:55]
  buffer_load_dwordx4 v214, s[24:27], s59 offen lds
  v_mfma_f32_16x16x32_bf16 v[60:63], a[220:223], a[172:175], v[60:63]
  s_waitcnt lgkmcnt(10)
  v_mfma_f32_16x16x32_bf16 v[64:67], a[224:227], a[160:163], v[64:67]
  ds_read_b64_tr_b16 a[208:209], v228 offset:10288
  v_mfma_f32_16x16x32_bf16 v[72:75], a[224:227], a[164:167], v[72:75]
  ds_read_b64_tr_b16 a[210:211], v228 offset:11312
  v_mfma_f32_16x16x32_bf16 v[80:83], a[224:227], a[168:171], v[80:83]
  buffer_load_dwordx4 a[68:71], v232, s[20:23], s58 offen sc1
  v_mfma_f32_16x16x32_bf16 v[88:91], a[224:227], a[172:175], v[88:91]
  s_waitcnt lgkmcnt(10)
  v_mfma_f32_16x16x32_bf16 v[68:71], a[228:231], a[160:163], v[68:71]
  ds_read_b64_tr_b16 a[212:213], v228 offset:10296
  v_mfma_f32_16x16x32_bf16 v[76:79], a[228:231], a[164:167], v[76:79]
  ds_read_b64_tr_b16 a[214:215], v228 offset:11320
  s_add_u32 m0, s57, 0x1010
  v_mfma_f32_16x16x32_bf16 v[84:87], a[228:231], a[168:171], v[84:87]
  buffer_load_dwordx4 v215, s[24:27], s59 offen lds
  v_mfma_f32_16x16x32_bf16 v[92:95], a[228:231], a[172:175], v[92:95]
  s_waitcnt lgkmcnt(10)
  v_mfma_f32_16x16x32_bf16 v[96:99], a[232:235], a[160:163], v[96:99]
  ds_read_b64_tr_b16 a[216:217], v228 offset:10544
  v_mfma_f32_16x16x32_bf16 v[104:107], a[232:235], a[164:167], v[104:107]
  ds_read_b64_tr_b16 a[218:219], v228 offset:11568
  v_mfma_f32_16x16x32_bf16 v[112:115], a[232:235], a[168:171], v[112:115]
  v_mfma_f32_16x16x32_bf16 v[120:123], a[232:235], a[172:175], v[120:123]
  buffer_load_dwordx4 a[72:75], v233, s[20:23], s58 offen sc1
  s_waitcnt lgkmcnt(10)
  v_mfma_f32_16x16x32_bf16 v[100:103], a[236:239], a[160:163], v[100:103]
  ds_read_b64_tr_b16 a[220:221], v228 offset:10552
  v_mfma_f32_16x16x32_bf16 v[108:111], a[236:239], a[164:167], v[108:111]
  ds_read_b64_tr_b16 a[222:223], v228 offset:11576
  s_add_u32 m0, s57, 0x1410
  v_mfma_f32_16x16x32_bf16 v[116:119], a[236:239], a[168:171], v[116:119]
  buffer_load_dwordx4 v216, s[24:27], s59 offen lds
  v_mfma_f32_16x16x32_bf16 v[124:127], a[236:239], a[172:175], v[124:127]
  s_waitcnt lgkmcnt(10)
  v_mfma_f32_16x16x32_bf16 v[128:131], a[240:243], a[160:163], v[128:131]
  ds_read_b64_tr_b16 a[224:225], v228 offset:10800
  v_mfma_f32_16x16x32_bf16 v[136:139], a[240:243], a[164:167], v[136:139]
  ds_read_b64_tr_b16 a[226:227], v228 offset:11824
  v_mfma_f32_16x16x32_bf16 v[144:147], a[240:243], a[168:171], v[144:147]
  v_mfma_f32_16x16x32_bf16 v[152:155], a[240:243], a[172:175], v[152:155]
  buffer_load_dwordx4 a[76:79], v234, s[20:23], s58 offen sc1
  s_waitcnt lgkmcnt(10)
  v_mfma_f32_16x16x32_bf16 v[132:135], a[244:247], a[160:163], v[132:135]
  ds_read_b64_tr_b16 a[228:229], v228 offset:10808
  v_mfma_f32_16x16x32_bf16 v[140:143], a[244:247], a[164:167], v[140:143]
  ds_read_b64_tr_b16 a[230:231], v228 offset:11832
  s_add_u32 m0, s55, s76
  v_mfma_f32_16x16x32_bf16 v[148:151], a[244:247], a[168:171], v[148:151]
  buffer_load_dwordx4 v217, s[24:27], s59 offen lds
  v_mfma_f32_16x16x32_bf16 v[156:159], a[244:247], a[172:175], v[156:159]
  s_waitcnt lgkmcnt(10)
  v_mfma_f32_16x16x32_bf16 v[0:3], a[208:211], a[176:179], v[0:3]
  ds_read_b64_tr_b16 a[232:233], v228 offset:11056
  v_mfma_f32_16x16x32_bf16 v[8:11], a[208:211], a[180:183], v[8:11]
  s_add_u32 s55, s55, 0x6080
  s_cmp_ge_u32 s55, 0x24300
  s_cselect_b32 s55, 0, s55
  v_mfma_f32_16x16x32_bf16 v[16:19], a[208:211], a[184:187], v[16:19]
  ds_read_b64_tr_b16 a[234:235], v228 offset:12080
  v_mfma_f32_16x16x32_bf16 v[24:27], a[208:211], a[188:191], v[24:27]
  s_waitcnt lgkmcnt(10)
  v_mfma_f32_16x16x32_bf16 v[4:7], a[212:215], a[176:179], v[4:7]
  ds_read_b64_tr_b16 a[236:237], v228 offset:11064
  v_mfma_f32_16x16x32_bf16 v[12:15], a[212:215], a[180:183], v[12:15]
  buffer_load_dwordx4 a[80:83], v231, s[20:23], s58 offen offset:1024 sc1
  v_mfma_f32_16x16x32_bf16 v[20:23], a[212:215], a[184:187], v[20:23]
  ds_read_b64_tr_b16 a[238:239], v228 offset:12088
  v_mfma_f32_16x16x32_bf16 v[28:31], a[212:215], a[188:191], v[28:31]
  s_waitcnt lgkmcnt(10)
  v_mfma_f32_16x16x32_bf16 v[32:35], a[216:219], a[176:179], v[32:35]
  ds_read_b64_tr_b16 a[240:241], v229 offset:18512
  v_mfma_f32_16x16x32_bf16 v[40:43], a[216:219], a[180:183], v[40:43]
  ds_read_b64_tr_b16 a[242:243], v229 offset:18768
  v_mfma_f32_16x16x32_bf16 v[48:51], a[216:219], a[184:187], v[48:51]
  v_mfma_f32_16x16x32_bf16 v[56:59], a[216:219], a[188:191], v[56:59]
  s_waitcnt lgkmcnt(10)
  v_mfma_f32_16x16x32_bf16 v[36:39], a[220:223], a[176:179], v[36:39]
  ds_read_b64_tr_b16 a[244:245], v229 offset:18520
  v_mfma_f32_16x16x32_bf16 v[44:47], a[220:223], a[180:183], v[44:47]
  s_add_u32 s54, s54, 0x6080
  s_cmp_ge_u32 s54, 0x24300
  s_cselect_b32 s54, 0, s54
  v_mfma_f32_16x16x32_bf16 v[52:55], a[220:223], a[184:187], v[52:55]
  buffer_load_dwordx4 a[84:87], v232, s[20:23], s58 offen offset:1024 sc1
  v_mfma_f32_16x16x32_bf16 v[60:63], a[220:223], a[188:191], v[60:63]
  ds_read_b64_tr_b16 a[246:247], v229 offset:18776
  s_waitcnt lgkmcnt(10)
  v_mfma_f32_16x16x32_bf16 v[64:67], a[224:227], a[176:179], v[64:67]
  s_barrier
  v_add_u32 v228, s54, v218
  v_add_u32 v229, s54, v219
  v_mfma_f32_16x16x32_bf16 v[72:75], a[224:227], a[180:183], v[72:75]
  ds_read_b64_tr_b16 a[208:209], v228
  v_mfma_f32_16x16x32_bf16 v[80:83], a[224:227], a[184:187], v[80:83]
  ds_read_b64_tr_b16 a[210:211], v228 offset:1024
  v_mfma_f32_16x16x32_bf16 v[88:91], a[224:227], a[188:191], v[88:91]
  s_waitcnt lgkmcnt(10)
  v_mfma_f32_16x16x32_bf16 v[68:71], a[228:231], a[176:179], v[68:71]
  ds_read_b64_tr_b16 a[212:213], v228 offset:8
  v_mfma_f32_16x16x32_bf16 v[76:79], a[228:231], a[180:183], v[76:79]
  buffer_load_dword v220, v221, s[20:23], s83 offen sc1
  v_mfma_f32_16x16x32_bf16 v[84:87], a[228:231], a[184:187], v[84:87]
  ds_read_b64_tr_b16 a[214:215], v228 offset:1032
  v_mfma_f32_16x16x32_bf16 v[92:95], a[228:231], a[188:191], v[92:95]
  buffer_load_dwordx4 a[88:91], v233, s[20:23], s58 offen offset:1024 sc1
  s_waitcnt lgkmcnt(10)
  v_mfma_f32_16x16x32_bf16 v[96:99], a[232:235], a[176:179], v[96:99]
  ds_read_b64_tr_b16 a[216:217], v228 offset:256
  v_mfma_f32_16x16x32_bf16 v[104:107], a[232:235], a[180:183], v[104:107]
  ds_read_b64_tr_b16 a[218:219], v228 offset:1280
  v_mfma_f32_16x16x32_bf16 v[112:115], a[232:235], a[184:187], v[112:115]
  v_mfma_f32_16x16x32_bf16 v[120:123], a[232:235], a[188:191], v[120:123]
  s_waitcnt lgkmcnt(10)
  v_mfma_f32_16x16x32_bf16 v[100:103], a[236:239], a[176:179], v[100:103]
  ds_read_b64_tr_b16 a[220:221], v228 offset:264
  v_mfma_f32_16x16x32_bf16 v[108:111], a[236:239], a[180:183], v[108:111]
  ds_read_b64_tr_b16 a[222:223], v228 offset:1288
  v_mfma_f32_16x16x32_bf16 v[116:119], a[236:239], a[184:187], v[116:119]
  buffer_load_dwordx4 a[92:95], v234, s[20:23], s58 offen offset:1024 sc1
  v_mfma_f32_16x16x32_bf16 v[124:127], a[236:239], a[188:191], v[124:127]
  s_waitcnt lgkmcnt(10)
  v_mfma_f32_16x16x32_bf16 v[128:131], a[240:243], a[176:179], v[128:131]
  ds_read_b64_tr_b16 a[224:225], v228 offset:512
  v_mfma_f32_16x16x32_bf16 v[136:139], a[240:243], a[180:183], v[136:139]
  ds_read_b64_tr_b16 a[226:227], v228 offset:1536
  v_mfma_f32_16x16x32_bf16 v[144:147], a[240:243], a[184:187], v[144:147]
  v_mfma_f32_16x16x32_bf16 v[152:155], a[240:243], a[188:191], v[152:155]
  s_waitcnt lgkmcnt(10)
  v_mfma_f32_16x16x32_bf16 v[132:135], a[244:247], a[176:179], v[132:135]
  ds_read_b64_tr_b16 a[228:229], v228 offset:520
  v_mfma_f32_16x16x32_bf16 v[140:143], a[244:247], a[180:183], v[140:143]
  ds_read_b64_tr_b16 a[230:231], v228 offset:1544
  v_mfma_f32_16x16x32_bf16 v[148:151], a[244:247], a[184:187], v[148:151]
  v_mfma_f32_16x16x32_bf16 v[156:159], a[244:247], a[188:191], v[156:159]
  s_waitcnt lgkmcnt(10)
  v_mfma_f32_16x16x32_bf16 v[0:3], a[208:211], a[0:3], v[0:3]
  ds_read_b64_tr_b16 a[232:233], v228 offset:768
  s_lshl_b32 s73, s47, 7
  v_mfma_f32_16x16x32_bf16 v[8:11], a[208:211], a[4:7], v[8:11]
  ds_read_b64_tr_b16 a[234:235], v228 offset:1792
  s_lshl_b32 s3, s46, 4
  v_mfma_f32_16x16x32_bf16 v[16:19], a[208:211], a[8:11], v[16:19]
  s_bfe_u32 s59, s33, 0x40008
  s_add_u32 s73, s73, s3
  s_lshl_b32 s3, s44, 2
  v_mfma_f32_16x16x32_bf16 v[24:27], a[208:211], a[12:15], v[24:27]
  s_mul_i32 s59, s59, 0x14000
  s_add_u32 s73, s73, s3
  s_waitcnt lgkmcnt(10)
  v_mfma_f32_16x16x32_bf16 v[4:7], a[212:215], a[0:3], v[4:7]
  ds_read_b64_tr_b16 a[236:237], v228 offset:776
  s_add_u32 s57, s55, s75
  v_mfma_f32_16x16x32_bf16 v[12:15], a[212:215], a[4:7], v[12:15]
  ds_read_b64_tr_b16 a[238:239], v228 offset:1800
  s_add_u32 m0, s57, 0
  v_mfma_f32_16x16x32_bf16 v[20:23], a[212:215], a[8:11], v[20:23]
  buffer_load_dwordx4 v213, s[24:27], s59 offen lds
  s_bfe_u32 s58, s33, 0x40004
  v_mfma_f32_16x16x32_bf16 v[28:31], a[212:215], a[12:15], v[28:31]
  s_lshl_b32 s58, s58, 11
  s_add_u32 s58, s58, s97
  s_waitcnt lgkmcnt(10)
  v_mfma_f32_16x16x32_bf16 v[32:35], a[216:219], a[0:3], v[32:35]
  ds_read_b64_tr_b16 a[240:241], v229 offset:8224
  s_bfe_u32 s84, s34, 0x20012
  v_mfma_f32_16x16x32_bf16 v[40:43], a[216:219], a[4:7], v[40:43]
  s_waitcnt vmcnt(3)
  v_cmp_gt_u32 vcc, s84, v220
  s_cbranch_vccnz L_chk18_far
L_chk18:
  s_lshl_b32 s73, s73, 2
  v_mfma_f32_16x16x32_bf16 v[48:51], a[216:219], a[8:11], v[48:51]
  ds_read_b64_tr_b16 a[242:243], v229 offset:8480
  s_add_u32 s73, s73, s48
  v_mfma_f32_16x16x32_bf16 v[56:59], a[216:219], a[12:15], v[56:59]
  buffer_load_dwordx4 a[96:99], v231, s[20:23], s58 offen sc1
  s_waitcnt lgkmcnt(10)
  v_mfma_f32_16x16x32_bf16 v[36:39], a[220:223], a[0:3], v[36:39]
  ds_read_b64_tr_b16 a[244:245], v229 offset:8232
  s_mul_i32 s73, s73, 0x1400
  v_mfma_f32_16x16x32_bf16 v[44:47], a[220:223], a[4:7], v[44:47]
  ds_read_b64_tr_b16 a[246:247], v229 offset:8488
  s_add_u32 m0, s57, 0x400
  v_mfma_f32_16x16x32_bf16 v[52:55], a[220:223], a[8:11], v[52:55]
  buffer_load_dwordx4 v214, s[24:27], s59 offen lds
  s_add_u32 s73, s73, 0x2800000
  v_mfma_f32_16x16x32_bf16 v[60:63], a[220:223], a[12:15], v[60:63]
  s_mov_b32 s69, 0x1000
  s_waitcnt lgkmcnt(10)
  v_add_u32 v208, s73, v245
  v_mfma_f32_16x16x32_bf16 v[64:67], a[224:227], a[0:3], v[64:67]
  ds_read_b64_tr_b16 a[208:209], v228 offset:10288
  v_add_u32 v209, 0x5000, v208
  v_mfma_f32_16x16x32_bf16 v[72:75], a[224:227], a[4:7], v[72:75]
  ds_read_b64_tr_b16 a[210:211], v228 offset:11312
  v_add_u32 v210, 0xa000, v208
  v_mfma_f32_16x16x32_bf16 v[80:83], a[224:227], a[8:11], v[80:83]
  buffer_load_dwordx4 a[100:103], v232, s[20:23], s58 offen sc1
  v_add_u32 v211, 0xf000, v208
  v_mfma_f32_16x16x32_bf16 v[88:91], a[224:227], a[12:15], v[88:91]
  s_lshl_b32 s73, s46, 2
  s_add_u32 s73, s73, s48
  s_waitcnt lgkmcnt(10)
  v_mfma_f32_16x16x32_bf16 v[68:71], a[228:231], a[0:3], v[68:71]
  ds_read_b64_tr_b16 a[212:213], v228 offset:10296
  s_lshl_b32 s73, s73, 2
  v_mfma_f32_16x16x32_bf16 v[76:79], a[228:231], a[4:7], v[76:79]
  ds_read_b64_tr_b16 a[214:215], v228 offset:11320
  s_add_u32 m0, s57, 0x1010
  v_mfma_f32_16x16x32_bf16 v[84:87], a[228:231], a[8:11], v[84:87]
  buffer_load_dwordx4 v215, s[24:27], s59 offen lds
  s_add_u32 s68, s73, s44
  v_mfma_f32_16x16x32_bf16 v[92:95], a[228:231], a[12:15], v[92:95]
  s_lshl_b32 s68, s68, 3
  s_add_u32 s68, s68, s47
  s_waitcnt lgkmcnt(10)
  v_mfma_f32_16x16x32_bf16 v[96:99], a[232:235], a[0:3], v[96:99]
  ds_read_b64_tr_b16 a[216:217], v228 offset:10544
  s_lshl_b32 s68, s68, 2
  v_mfma_f32_16x16x32_bf16 v[104:107], a[232:235], a[4:7], v[104:107]
  ds_read_b64_tr_b16 a[218:219], v228 offset:11568
  s_add_u32 s68, s68, 0x302000
  v_mfma_f32_16x16x32_bf16 v[112:115], a[232:235], a[8:11], v[112:115]
  s_lshr_b32 s3, s47, 1
  s_add_u32 s73, s73, s3
  s_lshl_b32 s73, s73, 5
  v_mfma_f32_16x16x32_bf16 v[120:123], a[232:235], a[12:15], v[120:123]
  buffer_load_dwordx4 a[104:107], v233, s[20:23], s58 offen sc1
  s_waitcnt lgkmcnt(10)
  v_mfma_f32_16x16x32_bf16 v[100:103], a[236:239], a[0:3], v[100:103]
  ds_read_b64_tr_b16 a[220:221], v228 offset:10552
  s_add_u32 s73, s73, 0x302000
  v_mfma_f32_16x16x32_bf16 v[108:111], a[236:239], a[4:7], v[108:111]
  ds_read_b64_tr_b16 a[222:223], v228 offset:11576
  s_add_u32 m0, s57, 0x1410
  v_mfma_f32_16x16x32_bf16 v[116:119], a[236:239], a[8:11], v[116:119]
  buffer_load_dwordx4 v216, s[24:27], s59 offen lds
  v_and_b32 v227, 7, v212
  v_mfma_f32_16x16x32_bf16 v[124:127], a[236:239], a[12:15], v[124:127]
  s_lshr_b32 s49, s44, 1
  s_waitcnt lgkmcnt(10)
  v_lshlrev_b32 v227, 2, v227
  v_mfma_f32_16x16x32_bf16 v[128:131], a[240:243], a[0:3], v[128:131]
  ds_read_b64_tr_b16 a[224:225], v228 offset:10800
  s_add_u32 s49, s49, 0
  v_mfma_f32_16x16x32_bf16 v[136:139], a[240:243], a[4:7], v[136:139]
  ds_read_b64_tr_b16 a[226:227], v228 offset:11824
  s_and_b32 s3, s44, 1
  v_mfma_f32_16x16x32_bf16 v[144:147], a[240:243], a[8:11], v[144:147]
  s_lshl_b32 s80, s46, 4
  s_add_u32 s3, s3, s80
  s_lshl_b32 s80, s47, 1
  v_mfma_f32_16x16x32_bf16 v[152:155], a[240:243], a[12:15], v[152:155]
  buffer_load_dwordx4 a[108:111], v234, s[20:23], s58 offen sc1
  s_waitcnt lgkmcnt(10)
  v_mfma_f32_16x16x32_bf16 v[132:135], a[244:247], a[0:3], v[132:135]
  ds_read_b64_tr_b16 a[228:229], v228 offset:10808
  s_add_u32 s3, s3, s80
  v_mfma_f32_16x16x32_bf16 v[140:143], a[244:247], a[4:7], v[140:143]
  ds_read_b64_tr_b16 a[230:231], v228 offset:11832
  s_add_u32 m0, s55, s76
  v_mfma_f32_16x16x32_bf16 v[148:151], a[244:247], a[8:11], v[148:151]
  buffer_load_dwordx4 v217, s[24:27], s59 offen lds
  s_lshl_b32 s88, s3, 2
  v_mfma_f32_16x16x32_bf16 v[156:159], a[244:247], a[12:15], v[156:159]
  s_add_u32 s88, s88, s48
  s_mul_i32 s88, s88, 0x1400
  s_waitcnt lgkmcnt(10)
  v_mfma_f32_16x16x32_bf16 v[0:3], a[208:211], a[16:19], v[0:3]
  ds_read_b64_tr_b16 a[232:233], v228 offset:11056
  s_lshl_b32 s80, s49, 10
  v_mfma_f32_16x16x32_bf16 v[8:11], a[208:211], a[20:23], v[8:11]
  s_add_u32 s55, s55, 0x6080
  s_cmp_ge_u32 s55, 0x24300
  s_cselect_b32 s55, 0, s55
  v_mfma_f32_16x16x32_bf16 v[16:19], a[208:211], a[24:27], v[16:19]
  ds_read_b64_tr_b16 a[234:235], v228 offset:12080
  s_add_u32 s88, s88, s80
  v_mfma_f32_16x16x32_bf16 v[24:27], a[208:211], a[28:31], v[24:27]
  s_add_u32 s88, s88, 0x2800000
  s_mul_i32 s89, s3, 0x5000
  s_waitcnt lgkmcnt(10)
  v_mfma_f32_16x16x32_bf16 v[4:7], a[212:215], a[16:19], v[4:7]
  ds_read_b64_tr_b16 a[236:237], v228 offset:11064
  s_mul_i32 s80, s48, 0x140
  v_mfma_f32_16x16x32_bf16 v[12:15], a[212:215], a[20:23], v[12:15]
  buffer_load_dwordx4 a[112:115], v231, s[20:23], s58 offen offset:1024 sc1
  s_add_u32 s89, s89, s80
  v_mfma_f32_16x16x32_bf16 v[20:23], a[212:215], a[24:27], v[20:23]
  ds_read_b64_tr_b16 a[238:239], v228 offset:12088
  s_lshl_b32 s80, s49, 6
  v_mfma_f32_16x16x32_bf16 v[28:31], a[212:215], a[28:31], v[28:31]
  s_add_u32 s89, s89, s80
  s_lshr_b32 s49, s44, 1
  s_waitcnt lgkmcnt(10)
  v_mfma_f32_16x16x32_bf16 v[32:35], a[216:219], a[16:19], v[32:35]
  ds_read_b64_tr_b16 a[240:241], v229 offset:18512
  s_add_u32 s49, s49, 2
  v_mfma_f32_16x16x32_bf16 v[40:43], a[216:219], a[20:23], v[40:43]
  ds_read_b64_tr_b16 a[242:243], v229 offset:18768
  s_and_b32 s3, s44, 1
  v_mfma_f32_16x16x32_bf16 v[48:51], a[216:219], a[24:27], v[48:51]
  s_lshl_b32 s80, s46, 4
  s_add_u32 s3, s3, s80
  s_lshl_b32 s80, s47, 1
  v_mfma_f32_16x16x32_bf16 v[56:59], a[216:219], a[28:31], v[56:59]
  s_add_u32 s3, s3, s80
  s_lshl_b32 s90, s3, 2
  s_waitcnt lgkmcnt(10)
  v_mfma_f32_16x16x32_bf16 v[36:39], a[220:223], a[16:19], v[36:39]
  ds_read_b64_tr_b16 a[244:245], v229 offset:18520
  s_add_u32 s90, s90, s48
  v_mfma_f32_16x16x32_bf16 v[44:47], a[220:223], a[20:23], v[44:47]
  s_add_u32 s54, s54, 0x6080
  s_cmp_ge_u32 s54, 0x24300
  s_cselect_b32 s54, 0, s54
  v_mfma_f32_16x16x32_bf16 v[52:55], a[220:223], a[24:27], v[52:55]
  buffer_load_dwordx4 a[116:119], v232, s[20:23], s58 offen offset:1024 sc1
  s_mul_i32 s90, s90, 0x1400
  v_mfma_f32_16x16x32_bf16 v[60:63], a[220:223], a[28:31], v[60:63]
  ds_read_b64_tr_b16 a[246:247], v229 offset:18776
  s_waitcnt lgkmcnt(10)
  v_mfma_f32_16x16x32_bf16 v[64:67], a[224:227], a[16:19], v[64:67]
  s_barrier
  v_add_u32 v228, s54, v218
  v_add_u32 v229, s54, v219
  v_mfma_f32_16x16x32_bf16 v[72:75], a[224:227], a[20:23], v[72:75]
  ds_read_b64_tr_b16 a[208:209], v228
  s_lshl_b32 s80, s49, 10
  v_mfma_f32_16x16x32_bf16 v[80:83], a[224:227], a[24:27], v[80:83]
  ds_read_b64_tr_b16 a[210:211], v228 offset:1024
  s_add_u32 s90, s90, s80
  v_mfma_f32_16x16x32_bf16 v[88:91], a[224:227], a[28:31], v[88:91]
  s_add_u32 s90, s90, 0x2800000
  s_mul_i32 s91, s3, 0x5000
  s_waitcnt lgkmcnt(10)
  v_mfma_f32_16x16x32_bf16 v[68:71], a[228:231], a[16:19], v[68:71]
  ds_read_b64_tr_b16 a[212:213], v228 offset:8
  s_mul_i32 s80, s48, 0x140
  v_mfma_f32_16x16x32_bf16 v[76:79], a[228:231], a[20:23], v[76:79]
  ds_read_b64_tr_b16 a[214:215], v228 offset:1032
  s_add_u32 s91, s91, s80
  v_mfma_f32_16x16x32_bf16 v[84:87], a[228:231], a[24:27], v[84:87]
  buffer_load_dwordx4 a[120:123], v233, s[20:23], s58 offen offset:1024 sc1
  s_lshl_b32 s80, s49, 6
  v_mfma_f32_16x16x32_bf16 v[92:95], a[228:231], a[28:31], v[92:95]
  s_add_u32 s91, s91, s80
  s_lshr_b32 s49, s44, 1
  s_waitcnt lgkmcnt(10)
  v_mfma_f32_16x16x32_bf16 v[96:99], a[232:235], a[16:19], v[96:99]
  ds_read_b64_tr_b16 a[216:217], v228 offset:256
  s_add_u32 s49, s49, 4
  v_mfma_f32_16x16x32_bf16 v[104:107], a[232:235], a[20:23], v[104:107]
  ds_read_b64_tr_b16 a[218:219], v228 offset:1280
  s_and_b32 s3, s44, 1
  v_mfma_f32_16x16x32_bf16 v[112:115], a[232:235], a[24:27], v[112:115]
  s_lshl_b32 s80, s46, 4
  s_add_u32 s3, s3, s80
  s_lshl_b32 s80, s47, 1
  v_mfma_f32_16x16x32_bf16 v[120:123], a[232:235], a[28:31], v[120:123]
  s_add_u32 s3, s3, s80
  s_lshl_b32 s92, s3, 2
  s_waitcnt lgkmcnt(10)
  v_mfma_f32_16x16x32_bf16 v[100:103], a[236:239], a[16:19], v[100:103]
  ds_read_b64_tr_b16 a[220:221], v228 offset:264
  s_add_u32 s92, s92, s48
  v_mfma_f32_16x16x32_bf16 v[108:111], a[236:239], a[20:23], v[108:111]
  ds_read_b64_tr_b16 a[222:223], v228 offset:1288
  s_mul_i32 s92, s92, 0x1400
  v_mfma_f32_16x16x32_bf16 v[116:119], a[236:239], a[24:27], v[116:119]
  buffer_load_dwordx4 a[124:127], v234, s[20:23], s58 offen offset:1024 sc1
  s_lshl_b32 s80, s49, 10
  v_mfma_f32_16x16x32_bf16 v[124:127], a[236:239], a[28:31], v[124:127]
  s_add_u32 s92, s92, s80
  s_add_u32 s92, s92, 0x2800000
  s_waitcnt lgkmcnt(10)
  v_mfma_f32_16x16x32_bf16 v[128:131], a[240:243], a[16:19], v[128:131]
  ds_read_b64_tr_b16 a[224:225], v228 offset:512
  s_mul_i32 s93, s3, 0x5000
  v_mfma_f32_16x16x32_bf16 v[136:139], a[240:243], a[20:23], v[136:139]
  ds_read_b64_tr_b16 a[226:227], v228 offset:1536
  s_mul_i32 s80, s48, 0x140
  v_mfma_f32_16x16x32_bf16 v[144:147], a[240:243], a[24:27], v[144:147]
  s_add_u32 s93, s93, s80
  s_lshl_b32 s80, s49, 6
  s_add_u32 s93, s93, s80
  v_mfma_f32_16x16x32_bf16 v[152:155], a[240:243], a[28:31], v[152:155]
  s_waitcnt lgkmcnt(10)
  v_and_b32 v226, 15, v212
  v_mul_u32_u24 v226, 0x500, v226
  v_mfma_f32_16x16x32_bf16 v[132:135], a[244:247], a[16:19], v[132:135]
  ds_read_b64_tr_b16 a[228:229], v228 offset:520
  v_lshrrev_b32 v247, 4, v212
  v_mfma_f32_16x16x32_bf16 v[140:143], a[244:247], a[20:23], v[140:143]
  ds_read_b64_tr_b16 a[230:231], v228 offset:1544
  v_lshl_add_u32 v226, v247, 4, v226
  v_mfma_f32_16x16x32_bf16 v[148:151], a[244:247], a[24:27], v[148:151]
  s_cmp_ge_u32 s44, 2
  s_cselect_b32 s92, 0x20000000, s92
  s_cselect_b32 s93, 0x20000000, s93
  v_mfma_f32_16x16x32_bf16 v[156:159], a[244:247], a[28:31], v[156:159]
  v_mov_b32 v192, 0
  v_mov_b32 v193, 0
  v_mov_b32 v196, 0
  v_mov_b32 v197, 0
  v_and_b32 v198, 1, v212
  v_lshlrev_b32 v198, 4, v198
  v_mov_b32 v199, 0x3f80
  v_lshlrev_b32 v198, v198, v199
  v_bfe_u32 v199, v212, 2, 2
  v_lshrrev_b32 v194, 4, v212
  v_cmp_eq_u32 vcc, v199, v194
  s_nop 1
  v_cndmask_b32 v198, 0, v198, vcc
  v_bfe_u32 v199, v212, 1, 1
  v_cmp_eq_u32 vcc, 0, v199
  s_nop 1
  s_waitcnt lgkmcnt(10)
  v_cndmask_b32 v194, 0, v198, vcc
  v_sub_u32 v195, v198, v194
  v_mfma_f32_16x16x32_bf16 v[0:3], a[208:211], a[32:35], v[0:3]
  ds_read_b64_tr_b16 a[232:233], v228 offset:768
  v_mov_b32 v172, -1
  v_mfma_f32_16x16x32_bf16 v[8:11], a[208:211], a[36:39], v[8:11]
  ds_read_b64_tr_b16 a[234:235], v228 offset:1792
  v_mov_b32 v173, -1
  v_mfma_f32_16x16x32_bf16 v[16:19], a[208:211], a[40:43], v[16:19]
  s_bfe_u32 s59, s33, 0x4000c
  v_mov_b32 v174, -1
  v_mfma_f32_16x16x32_bf16 v[24:27], a[208:211], a[44:47], v[24:27]
  s_mul_i32 s59, s59, 0x14000
  s_waitcnt lgkmcnt(10)
  v_mov_b32 v175, -1
  v_mfma_f32_16x16x32_bf16 v[4:7], a[212:215], a[32:35], v[4:7]
  ds_read_b64_tr_b16 a[236:237], v228 offset:776
  s_add_u32 s57, s55, s75
  v_mfma_f32_16x16x32_bf16 v[12:15], a[212:215], a[36:39], v[12:15]
  ds_read_b64_tr_b16 a[238:239], v228 offset:1800
  s_add_u32 m0, s57, 0
  v_mfma_f32_16x16x32_bf16 v[20:23], a[212:215], a[40:43], v[20:23]
  buffer_load_dwordx4 v213, s[24:27], s59 offen lds
  s_bfe_u32 s58, s33, 0x40008
  v_mfma_f32_16x16x32_bf16 v[28:31], a[212:215], a[44:47], v[28:31]
  s_lshl_b32 s58, s58, 11
  s_add_u32 s58, s58, s97
  s_waitcnt lgkmcnt(10)
  v_mfma_f32_16x16x32_bf16 v[32:35], a[216:219], a[32:35], v[32:35]
  ds_read_b64_tr_b16 a[240:241], v229 offset:8224
  s_bfe_u32 s84, s34, 0x20014
  v_mfma_f32_16x16x32_bf16 v[40:43], a[216:219], a[36:39], v[40:43]
  v_cmp_gt_u32 vcc, s84, v220
  s_cbranch_vccnz L_chk20_far
L_chk20:
  v_mfma_f32_16x16x32_bf16 v[48:51], a[216:219], a[40:43], v[48:51]
  ds_read_b64_tr_b16 a[242:243], v229 offset:8480
  v_mfma_f32_16x16x32_bf16 v[56:59], a[216:219], a[44:47], v[56:59]
  buffer_load_dwordx4 a[128:131], v231, s[20:23], s58 offen sc1
  s_waitcnt lgkmcnt(10)
  v_mfma_f32_16x16x32_bf16 v[36:39], a[220:223], a[32:35], v[36:39]
  ds_read_b64_tr_b16 a[244:245], v229 offset:8232
  v_mfma_f32_16x16x32_bf16 v[44:47], a[220:223], a[36:39], v[44:47]
  buffer_store_dwordx4 v[172:175], v208, s[20:23], s69 offen sc1
  s_add_u32 m0, s57, 0x400
  v_mfma_f32_16x16x32_bf16 v[52:55], a[220:223], a[40:43], v[52:55]
  ds_read_b64_tr_b16 a[246:247], v229 offset:8488
  v_mfma_f32_16x16x32_bf16 v[60:63], a[220:223], a[44:47], v[60:63]
  buffer_load_dwordx4 v214, s[24:27], s59 offen lds
  s_waitcnt lgkmcnt(10)
  v_mfma_f32_16x16x32_bf16 v[64:67], a[224:227], a[32:35], v[64:67]
  ds_read_b64_tr_b16 a[208:209], v228 offset:10288
  v_mfma_f32_16x16x32_bf16 v[72:75], a[224:227], a[36:39], v[72:75]
  ds_read_b64_tr_b16 a[210:211], v228 offset:11312
  v_mfma_f32_16x16x32_bf16 v[80:83], a[224:227], a[40:43], v[80:83]
  buffer_store_dwordx4 v[172:175], v209, s[20:23], s69 offen sc1
  v_mfma_f32_16x16x32_bf16 v[88:91], a[224:227], a[44:47], v[88:91]
  buffer_load_dwordx4 a[132:135], v232, s[20:23], s58 offen sc1
  s_waitcnt lgkmcnt(10)
  v_mfma_f32_16x16x32_bf16 v[68:71], a[228:231], a[32:35], v[68:71]
  ds_read_b64_tr_b16 a[212:213], v228 offset:10296
  v_mfma_f32_16x16x32_bf16 v[76:79], a[228:231], a[36:39], v[76:79]
  ds_read_b64_tr_b16 a[214:215], v228 offset:11320
  s_add_u32 m0, s57, 0x1010
  v_mfma_f32_16x16x32_bf16 v[84:87], a[228:231], a[40:43], v[84:87]
  buffer_load_dwordx4 v215, s[24:27], s59 offen lds
  v_mfma_f32_16x16x32_bf16 v[92:95], a[228:231], a[44:47], v[92:95]
  buffer_store_dwordx4 v[172:175], v210, s[20:23], s69 offen sc1
  s_waitcnt lgkmcnt(10)
  v_mfma_f32_16x16x32_bf16 v[96:99], a[232:235], a[32:35], v[96:99]
  ds_read_b64_tr_b16 a[216:217], v228 offset:10544
  v_mfma_f32_16x16x32_bf16 v[104:107], a[232:235], a[36:39], v[104:107]
  ds_read_b64_tr_b16 a[218:219], v228 offset:11568
  v_mfma_f32_16x16x32_bf16 v[112:115], a[232:235], a[40:43], v[112:115]
  v_mfma_f32_16x16x32_bf16 v[120:123], a[232:235], a[44:47], v[120:123]
  buffer_load_dwordx4 a[136:139], v233, s[20:23], s58 offen sc1
  s_waitcnt lgkmcnt(10)
  v_mfma_f32_16x16x32_bf16 v[100:103], a[236:239], a[32:35], v[100:103]
  ds_read_b64_tr_b16 a[220:221], v228 offset:10552
  v_mfma_f32_16x16x32_bf16 v[108:111], a[236:239], a[36:39], v[108:111]
  buffer_store_dwordx4 v[172:175], v211, s[20:23], s69 offen sc1
  s_add_u32 m0, s57, 0x1410
  v_mfma_f32_16x16x32_bf16 v[116:119], a[236:239], a[40:43], v[116:119]
  ds_read_b64_tr_b16 a[222:223], v228 offset:11576
  v_mfma_f32_16x16x32_bf16 v[124:127], a[236:239], a[44:47], v[124:127]
  buffer_load_dwordx4 v216, s[24:27], s59 offen lds
  s_waitcnt lgkmcnt(10)
  v_mfma_f32_16x16x32_bf16 v[128:131], a[240:243], a[32:35], v[128:131]
  ds_read_b64_tr_b16 a[224:225], v228 offset:10800
  v_mfma_f32_16x16x32_bf16 v[136:139], a[240:243], a[36:39], v[136:139]
  ds_read_b64_tr_b16 a[226:227], v228 offset:11824
  v_mfma_f32_16x16x32_bf16 v[144:147], a[240:243], a[40:43], v[144:147]
  v_mfma_f32_16x16x32_bf16 v[152:155], a[240:243], a[44:47], v[152:155]
  buffer_load_dwordx4 a[140:143], v234, s[20:23], s58 offen sc1
  s_waitcnt lgkmcnt(10)
  v_mfma_f32_16x16x32_bf16 v[132:135], a[244:247], a[32:35], v[132:135]
  ds_read_b64_tr_b16 a[228:229], v228 offset:10808
  v_mfma_f32_16x16x32_bf16 v[140:143], a[244:247], a[36:39], v[140:143]
  ds_read_b64_tr_b16 a[230:231], v228 offset:11832
  s_add_u32 m0, s55, s76
  v_mfma_f32_16x16x32_bf16 v[148:151], a[244:247], a[40:43], v[148:151]
  buffer_load_dwordx4 v217, s[24:27], s59 offen lds
  v_mfma_f32_16x16x32_bf16 v[156:159], a[244:247], a[44:47], v[156:159]
  s_waitcnt lgkmcnt(10)
  v_mfma_f32_16x16x32_bf16 v[0:3], a[208:211], a[48:51], v[0:3]
  ds_read_b64_tr_b16 a[232:233], v228 offset:11056
  v_mfma_f32_16x16x32_bf16 v[8:11], a[208:211], a[52:55], v[8:11]
  s_add_u32 s55, s55, 0x6080
  s_cmp_ge_u32 s55, 0x24300
  s_cselect_b32 s55, 0, s55
  v_mfma_f32_16x16x32_bf16 v[16:19], a[208:211], a[56:59], v[16:19]
  ds_read_b64_tr_b16 a[234:235], v228 offset:12080
  v_mfma_f32_16x16x32_bf16 v[24:27], a[208:211], a[60:63], v[24:27]
  s_waitcnt lgkmcnt(10)
  v_mfma_f32_16x16x32_bf16 v[4:7], a[212:215], a[48:51], v[4:7]
  ds_read_b64_tr_b16 a[236:237], v228 offset:11064
  v_mfma_f32_16x16x32_bf16 v[12:15], a[212:215], a[52:55], v[12:15]
  buffer_load_dwordx4 a[144:147], v231, s[20:23], s58 offen offset:1024 sc1
  v_mfma_f32_16x16x32_bf16 v[20:23], a[212:215], a[56:59], v[20:23]
  ds_read_b64_tr_b16 a[238:239], v228 offset:12088
  v_mfma_f32_16x16x32_bf16 v[28:31], a[212:215], a[60:63], v[28:31]
  s_waitcnt lgkmcnt(10)
  v_mfma_f32_16x16x32_bf16 v[32:35], a[216:219], a[48:51], v[32:35]
  ds_read_b64_tr_b16 a[240:241], v229 offset:18512
  v_mfma_f32_16x16x32_bf16 v[40:43], a[216:219], a[52:55], v[40:43]
  ds_read_b64_tr_b16 a[242:243], v229 offset:18768
  v_mfma_f32_16x16x32_bf16 v[48:51], a[216:219], a[56:59], v[48:51]
  v_mfma_f32_16x16x32_bf16 v[56:59], a[216:219], a[60:63], v[56:59]
  s_waitcnt lgkmcnt(10)
  v_mfma_f32_16x16x32_bf16 v[36:39], a[220:223], a[48:51], v[36:39]
  ds_read_b64_tr_b16 a[244:245], v229 offset:18520
  v_mfma_f32_16x16x32_bf16 v[44:47], a[220:223], a[52:55], v[44:47]
  s_add_u32 s54, s54, 0x6080
  s_cmp_ge_u32 s54, 0x24300
  s_cselect_b32 s54, 0, s54
  v_mfma_f32_16x16x32_bf16 v[52:55], a[220:223], a[56:59], v[52:55]
  buffer_load_dwordx4 a[148:151], v232, s[20:23], s58 offen offset:1024 sc1
  v_mfma_f32_16x16x32_bf16 v[60:63], a[220:223], a[60:63], v[60:63]
  ds_read_b64_tr_b16 a[246:247], v229 offset:18776
  s_waitcnt lgkmcnt(10)
  v_mfma_f32_16x16x32_bf16 v[64:67], a[224:227], a[48:51], v[64:67]
  s_barrier
  v_add_u32 v228, s54, v218
  v_add_u32 v229, s54, v219
  v_mfma_f32_16x16x32_bf16 v[72:75], a[224:227], a[52:55], v[72:75]
  ds_read_b64_tr_b16 a[208:209], v228
  v_mfma_f32_16x16x32_bf16 v[80:83], a[224:227], a[56:59], v[80:83]
  ds_read_b64_tr_b16 a[210:211], v228 offset:1024
  v_mfma_f32_16x16x32_bf16 v[88:91], a[224:227], a[60:63], v[88:91]
  s_waitcnt lgkmcnt(10)
  v_mfma_f32_16x16x32_bf16 v[68:71], a[228:231], a[48:51], v[68:71]
  ds_read_b64_tr_b16 a[212:213], v228 offset:8
  v_mfma_f32_16x16x32_bf16 v[76:79], a[228:231], a[52:55], v[76:79]
  ds_read_b64_tr_b16 a[214:215], v228 offset:1032
  v_mfma_f32_16x16x32_bf16 v[84:87], a[228:231], a[56:59], v[84:87]
  buffer_load_dwordx4 a[152:155], v233, s[20:23], s58 offen offset:1024 sc1
  v_mfma_f32_16x16x32_bf16 v[92:95], a[228:231], a[60:63], v[92:95]
  s_waitcnt lgkmcnt(10)
  v_mfma_f32_16x16x32_bf16 v[96:99], a[232:235], a[48:51], v[96:99]
  ds_read_b64_tr_b16 a[216:217], v228 offset:256
  v_mfma_f32_16x16x32_bf16 v[104:107], a[232:235], a[52:55], v[104:107]
  ds_read_b64_tr_b16 a[218:219], v228 offset:1280
  v_mfma_f32_16x16x32_bf16 v[112:115], a[232:235], a[56:59], v[112:115]
  v_mfma_f32_16x16x32_bf16 v[120:123], a[232:235], a[60:63], v[120:123]
  s_waitcnt lgkmcnt(10)
  v_mfma_f32_16x16x32_bf16 v[100:103], a[236:239], a[48:51], v[100:103]
  ds_read_b64_tr_b16 a[220:221], v228 offset:264
  v_mfma_f32_16x16x32_bf16 v[108:111], a[236:239], a[52:55], v[108:111]
  ds_read_b64_tr_b16 a[222:223], v228 offset:1288
  v_mfma_f32_16x16x32_bf16 v[116:119], a[236:239], a[56:59], v[116:119]
  buffer_load_dwordx4 a[156:159], v234, s[20:23], s58 offen offset:1024 sc1
  v_mfma_f32_16x16x32_bf16 v[124:127], a[236:239], a[60:63], v[124:127]
  s_waitcnt lgkmcnt(10)
  v_mfma_f32_16x16x32_bf16 v[128:131], a[240:243], a[48:51], v[128:131]
  ds_read_b64_tr_b16 a[224:225], v228 offset:512
  v_mfma_f32_16x16x32_bf16 v[136:139], a[240:243], a[52:55], v[136:139]
  ds_read_b64_tr_b16 a[226:227], v228 offset:1536
  v_mfma_f32_16x16x32_bf16 v[144:147], a[240:243], a[56:59], v[144:147]
  v_mfma_f32_16x16x32_bf16 v[152:155], a[240:243], a[60:63], v[152:155]
  s_waitcnt lgkmcnt(10)
  v_mfma_f32_16x16x32_bf16 v[132:135], a[244:247], a[48:51], v[132:135]
  ds_read_b64_tr_b16 a[228:229], v228 offset:520
  v_mfma_f32_16x16x32_bf16 v[140:143], a[244:247], a[52:55], v[140:143]
  ds_read_b64_tr_b16 a[230:231], v228 offset:1544
  v_mfma_f32_16x16x32_bf16 v[148:151], a[244:247], a[56:59], v[148:151]
  v_mfma_f32_16x16x32_bf16 v[156:159], a[244:247], a[60:63], v[156:159]
  s_waitcnt lgkmcnt(10)
  v_mfma_f32_16x16x32_bf16 v[0:3], a[208:211], a[64:67], v[0:3]
  ds_read_b64_tr_b16 a[232:233], v228 offset:768
  v_mfma_f32_16x16x32_bf16 v[8:11], a[208:211], a[68:71], v[8:11]
  ds_read_b64_tr_b16 a[234:235], v228 offset:1792
  v_mfma_f32_16x16x32_bf16 v[16:19], a[208:211], a[72:75], v[16:19]
  s_cmp_lt_u32 s47, 6
  s_cselect_b32 s26, s98, 0
  s_bfe_u32 s59, s33, 0x40010
  v_mfma_f32_16x16x32_bf16 v[24:27], a[208:211], a[76:79], v[24:27]
  s_mul_i32 s59, s59, 0x14000
  s_waitcnt lgkmcnt(10)
  v_mfma_f32_16x16x32_bf16 v[4:7], a[212:215], a[64:67], v[4:7]
  ds_read_b64_tr_b16 a[236:237], v228 offset:776
  s_add_u32 s57, s55, s75
  v_mfma_f32_16x16x32_bf16 v[12:15], a[212:215], a[68:71], v[12:15]
  ds_read_b64_tr_b16 a[238:239], v228 offset:1800
  s_add_u32 m0, s57, 0
  v_mfma_f32_16x16x32_bf16 v[20:23], a[212:215], a[72:75], v[20:23]
  buffer_load_dwordx4 v213, s[24:27], s59 offen lds
  s_bfe_u32 s58, s33, 0x4000c
  v_mfma_f32_16x16x32_bf16 v[28:31], a[212:215], a[76:79], v[28:31]
  s_lshl_b32 s58, s58, 11
  s_add_u32 s58, s58, s97
  s_waitcnt lgkmcnt(10)
  v_mfma_f32_16x16x32_bf16 v[32:35], a[216:219], a[64:67], v[32:35]
  ds_read_b64_tr_b16 a[240:241], v229 offset:8224
  s_bfe_u32 s84, s34, 0x20016
  v_mfma_f32_16x16x32_bf16 v[40:43], a[216:219], a[68:71], v[40:43]
  v_cmp_gt_u32 vcc, s84, v220
  s_cbranch_vccnz L_chk22_far
L_chk22:
  v_mfma_f32_16x16x32_bf16 v[48:51], a[216:219], a[72:75], v[48:51]
  ds_read_b64_tr_b16 a[242:243], v229 offset:8480
  v_mfma_f32_16x16x32_bf16 v[56:59], a[216:219], a[76:79], v[56:59]
  buffer_load_dwordx4 a[160:163], v231, s[20:23], s58 offen sc1
  s_waitcnt lgkmcnt(10)
  v_mfma_f32_16x16x32_bf16 v[36:39], a[220:223], a[64:67], v[36:39]
  ds_read_b64_tr_b16 a[244:245], v229 offset:8232
  v_mfma_f32_16x16x32_bf16 v[44:47], a[220:223], a[68:71], v[44:47]
  ds_read_b64_tr_b16 a[246:247], v229 offset:8488
  s_add_u32 m0, s57, 0x400
  v_mfma_f32_16x16x32_bf16 v[52:55], a[220:223], a[72:75], v[52:55]
  buffer_load_dwordx4 v214, s[24:27], s59 offen lds
  v_mfma_f32_16x16x32_bf16 v[60:63], a[220:223], a[76:79], v[60:63]
  s_waitcnt lgkmcnt(10)
  v_mfma_f32_16x16x32_bf16 v[64:67], a[224:227], a[64:67], v[64:67]
  ds_read_b64_tr_b16 a[208:209], v228 offset:10288
  v_mfma_f32_16x16x32_bf16 v[72:75], a[224:227], a[68:71], v[72:75]
  ds_read_b64_tr_b16 a[210:211], v228 offset:11312
  v_mfma_f32_16x16x32_bf16 v[80:83], a[224:227], a[72:75], v[80:83]
  buffer_load_dwordx4 a[164:167], v232, s[20:23], s58 offen sc1
  v_mfma_f32_16x16x32_bf16 v[88:91], a[224:227], a[76:79], v[88:91]
  s_waitcnt lgkmcnt(10)
  v_mfma_f32_16x16x32_bf16 v[68:71], a[228:231], a[64:67], v[68:71]
  ds_read_b64_tr_b16 a[212:213], v228 offset:10296
  v_mfma_f32_16x16x32_bf16 v[76:79], a[228:231], a[68:71], v[76:79]
  ds_read_b64_tr_b16 a[214:215], v228 offset:11320
  s_add_u32 m0, s57, 0x1010
  v_mfma_f32_16x16x32_bf16 v[84:87], a[228:231], a[72:75], v[84:87]
  buffer_load_dwordx4 v215, s[24:27], s59 offen lds
  v_mfma_f32_16x16x32_bf16 v[92:95], a[228:231], a[76:79], v[92:95]
  s_waitcnt lgkmcnt(10)
  v_mfma_f32_16x16x32_bf16 v[96:99], a[232:235], a[64:67], v[96:99]
  ds_read_b64_tr_b16 a[216:217], v228 offset:10544
  v_mfma_f32_16x16x32_bf16 v[104:107], a[232:235], a[68:71], v[104:107]
  ds_read_b64_tr_b16 a[218:219], v228 offset:11568
  v_mfma_f32_16x16x32_bf16 v[112:115], a[232:235], a[72:75], v[112:115]
  v_mfma_f32_16x16x32_bf16 v[120:123], a[232:235], a[76:79], v[120:123]
  buffer_load_dwordx4 a[168:171], v233, s[20:23], s58 offen sc1
  s_waitcnt lgkmcnt(10)
  v_mfma_f32_16x16x32_bf16 v[100:103], a[236:239], a[64:67], v[100:103]
  ds_read_b64_tr_b16 a[220:221], v228 offset:10552
  v_mfma_f32_16x16x32_bf16 v[108:111], a[236:239], a[68:71], v[108:111]
  ds_read_b64_tr_b16 a[222:223], v228 offset:11576
  s_add_u32 m0, s57, 0x1410
  v_mfma_f32_16x16x32_bf16 v[116:119], a[236:239], a[72:75], v[116:119]
  buffer_load_dwordx4 v216, s[24:27], s59 offen lds
  v_mfma_f32_16x16x32_bf16 v[124:127], a[236:239], a[76:79], v[124:127]
  s_waitcnt lgkmcnt(10)
  v_mfma_f32_16x16x32_bf16 v[128:131], a[240:243], a[64:67], v[128:131]
  ds_read_b64_tr_b16 a[224:225], v228 offset:10800
  v_mfma_f32_16x16x32_bf16 v[136:139], a[240:243], a[68:71], v[136:139]
  ds_read_b64_tr_b16 a[226:227], v228 offset:11824
  v_mfma_f32_16x16x32_bf16 v[144:147], a[240:243], a[72:75], v[144:147]
  v_mfma_f32_16x16x32_bf16 v[152:155], a[240:243], a[76:79], v[152:155]
  buffer_load_dwordx4 a[172:175], v234, s[20:23], s58 offen sc1
  s_waitcnt lgkmcnt(10)
  v_mfma_f32_16x16x32_bf16 v[132:135], a[244:247], a[64:67], v[132:135]
  ds_read_b64_tr_b16 a[228:229], v228 offset:10808
  v_mfma_f32_16x16x32_bf16 v[140:143], a[244:247], a[68:71], v[140:143]
  ds_read_b64_tr_b16 a[230:231], v228 offset:11832
  s_add_u32 m0, s55, s76
  v_mfma_f32_16x16x32_bf16 v[148:151], a[244:247], a[72:75], v[148:151]
  buffer_load_dwordx4 v217, s[24:27], s59 offen lds
  v_mfma_f32_16x16x32_bf16 v[156:159], a[244:247], a[76:79], v[156:159]
  s_waitcnt vmcnt(39) lgkmcnt(10)
  v_mfma_f32_16x16x32_bf16 v[0:3], a[208:211], a[80:83], v[0:3]
  ds_read_b64_tr_b16 a[232:233], v228 offset:11056
  v_mfma_f32_16x16x32_bf16 v[8:11], a[208:211], a[84:87], v[8:11]
  s_add_u32 s55, s55, 0x6080
  s_cmp_ge_u32 s55, 0x24300
  s_cselect_b32 s55, 0, s55
  v_mfma_f32_16x16x32_bf16 v[16:19], a[208:211], a[88:91], v[16:19]
  ds_read_b64_tr_b16 a[234:235], v228 offset:12080
  v_mfma_f32_16x16x32_bf16 v[24:27], a[208:211], a[92:95], v[24:27]
  s_waitcnt lgkmcnt(10)
  v_mfma_f32_16x16x32_bf16 v[4:7], a[212:215], a[80:83], v[4:7]
  ds_read_b64_tr_b16 a[236:237], v228 offset:11064
  v_mfma_f32_16x16x32_bf16 v[12:15], a[212:215], a[84:87], v[12:15]
  buffer_load_dwordx4 a[176:179], v231, s[20:23], s58 offen offset:1024 sc1
  v_mfma_f32_16x16x32_bf16 v[20:23], a[212:215], a[88:91], v[20:23]
  ds_read_b64_tr_b16 a[238:239], v228 offset:12088
  v_mfma_f32_16x16x32_bf16 v[28:31], a[212:215], a[92:95], v[28:31]
  s_waitcnt lgkmcnt(10)
  v_mfma_f32_16x16x32_bf16 v[32:35], a[216:219], a[80:83], v[32:35]
  ds_read_b64_tr_b16 a[240:241], v229 offset:18512
  v_mfma_f32_16x16x32_bf16 v[40:43], a[216:219], a[84:87], v[40:43]
  ds_read_b64_tr_b16 a[242:243], v229 offset:18768
  v_mfma_f32_16x16x32_bf16 v[48:51], a[216:219], a[88:91], v[48:51]
  v_mfma_f32_16x16x32_bf16 v[56:59], a[216:219], a[92:95], v[56:59]
  s_waitcnt lgkmcnt(10)
  v_mfma_f32_16x16x32_bf16 v[36:39], a[220:223], a[80:83], v[36:39]
  ds_read_b64_tr_b16 a[244:245], v229 offset:18520
  v_mfma_f32_16x16x32_bf16 v[44:47], a[220:223], a[84:87], v[44:47]
  s_add_u32 s54, s54, 0x6080
  s_cmp_ge_u32 s54, 0x24300
  s_cselect_b32 s54, 0, s54
  v_mfma_f32_16x16x32_bf16 v[52:55], a[220:223], a[88:91], v[52:55]
  buffer_load_dwordx4 a[180:183], v232, s[20:23], s58 offen offset:1024 sc1
  v_mfma_f32_16x16x32_bf16 v[60:63], a[220:223], a[92:95], v[60:63]
  ds_read_b64_tr_b16 a[246:247], v229 offset:18776
  s_waitcnt lgkmcnt(10)
  v_mfma_f32_16x16x32_bf16 v[64:67], a[224:227], a[80:83], v[64:67]
  s_barrier
  v_add_u32 v228, s54, v218
  v_add_u32 v229, s54, v219
  v_mfma_f32_16x16x32_bf16 v[72:75], a[224:227], a[84:87], v[72:75]
  ds_read_b64_tr_b16 a[208:209], v228
  v_mfma_f32_16x16x32_bf16 v[80:83], a[224:227], a[88:91], v[80:83]
  ds_read_b64_tr_b16 a[210:211], v228 offset:1024
  v_mfma_f32_16x16x32_bf16 v[88:91], a[224:227], a[92:95], v[88:91]
  s_waitcnt lgkmcnt(10)
  v_mfma_f32_16x16x32_bf16 v[68:71], a[228:231], a[80:83], v[68:71]
  ds_read_b64_tr_b16 a[212:213], v228 offset:8
  v_mfma_f32_16x16x32_bf16 v[76:79], a[228:231], a[84:87], v[76:79]
  ds_read_b64_tr_b16 a[214:215], v228 offset:1032
  v_mfma_f32_16x16x32_bf16 v[84:87], a[228:231], a[88:91], v[84:87]
  buffer_load_dwordx4 a[184:187], v233, s[20:23], s58 offen offset:1024 sc1
  v_mfma_f32_16x16x32_bf16 v[92:95], a[228:231], a[92:95], v[92:95]
  s_waitcnt lgkmcnt(10)
  v_mfma_f32_16x16x32_bf16 v[96:99], a[232:235], a[80:83], v[96:99]
  ds_read_b64_tr_b16 a[216:217], v228 offset:256
  v_mfma_f32_16x16x32_bf16 v[104:107], a[232:235], a[84:87], v[104:107]
  ds_read_b64_tr_b16 a[218:219], v228 offset:1280
  v_mfma_f32_16x16x32_bf16 v[112:115], a[232:235], a[88:91], v[112:115]
  v_mfma_f32_16x16x32_bf16 v[120:123], a[232:235], a[92:95], v[120:123]
  s_waitcnt lgkmcnt(10)
  v_mfma_f32_16x16x32_bf16 v[100:103], a[236:239], a[80:83], v[100:103]
  ds_read_b64_tr_b16 a[220:221], v228 offset:264
  v_mfma_f32_16x16x32_bf16 v[108:111], a[236:239], a[84:87], v[108:111]
  ds_read_b64_tr_b16 a[222:223], v228 offset:1288
  v_mfma_f32_16x16x32_bf16 v[116:119], a[236:239], a[88:91], v[116:119]
  buffer_load_dwordx4 a[188:191], v234, s[20:23], s58 offen offset:1024 sc1
  v_mfma_f32_16x16x32_bf16 v[124:127], a[236:239], a[92:95], v[124:127]
  s_waitcnt lgkmcnt(10)
  v_mfma_f32_16x16x32_bf16 v[128:131], a[240:243], a[80:83], v[128:131]
  ds_read_b64_tr_b16 a[224:225], v228 offset:512
  v_mfma_f32_16x16x32_bf16 v[136:139], a[240:243], a[84:87], v[136:139]
  ds_read_b64_tr_b16 a[226:227], v228 offset:1536
  v_mfma_f32_16x16x32_bf16 v[144:147], a[240:243], a[88:91], v[144:147]
  v_mfma_f32_16x16x32_bf16 v[152:155], a[240:243], a[92:95], v[152:155]
  s_waitcnt lgkmcnt(10)
  v_mfma_f32_16x16x32_bf16 v[132:135], a[244:247], a[80:83], v[132:135]
  ds_read_b64_tr_b16 a[228:229], v228 offset:520
  v_mfma_f32_16x16x32_bf16 v[140:143], a[244:247], a[84:87], v[140:143]
  ds_read_b64_tr_b16 a[230:231], v228 offset:1544
  v_mfma_f32_16x16x32_bf16 v[148:151], a[244:247], a[88:91], v[148:151]
  v_mfma_f32_16x16x32_bf16 v[156:159], a[244:247], a[92:95], v[156:159]
  s_waitcnt vmcnt(35) lgkmcnt(10)
  v_mfma_f32_16x16x32_bf16 v[0:3], a[208:211], a[96:99], v[0:3]
  ds_read_b64_tr_b16 a[232:233], v228 offset:768
  v_mfma_f32_16x16x32_bf16 v[8:11], a[208:211], a[100:103], v[8:11]
  ds_read_b64_tr_b16 a[234:235], v228 offset:1792
  v_mfma_f32_16x16x32_bf16 v[16:19], a[208:211], a[104:107], v[16:19]
  v_mfma_f32_16x16x32_bf16 v[24:27], a[208:211], a[108:111], v[24:27]
  s_waitcnt lgkmcnt(10)
  v_mfma_f32_16x16x32_bf16 v[4:7], a[212:215], a[96:99], v[4:7]
  ds_read_b64_tr_b16 a[236:237], v228 offset:776
  v_mfma_f32_16x16x32_bf16 v[12:15], a[212:215], a[100:103], v[12:15]
  ds_read_b64_tr_b16 a[238:239], v228 offset:1800
  s_bfe_u32 s58, s33, 0x40010
  v_mfma_f32_16x16x32_bf16 v[20:23], a[212:215], a[104:107], v[20:23]
  s_lshl_b32 s58, s58, 11
  v_mfma_f32_16x16x32_bf16 v[28:31], a[212:215], a[108:111], v[28:31]
  s_add_u32 s58, s58, s97
  s_waitcnt lgkmcnt(10)
  v_mfma_f32_16x16x32_bf16 v[32:35], a[216:219], a[96:99], v[32:35]
  ds_read_b64_tr_b16 a[240:241], v229 offset:8224
  s_bfe_u32 s84, s34, 0x20018
  v_mfma_f32_16x16x32_bf16 v[40:43], a[216:219], a[100:103], v[40:43]
  v_cmp_gt_u32 vcc, s84, v220
  s_cbranch_vccnz L_chk24_far
L_chk24:
  v_mfma_f32_16x16x32_bf16 v[48:51], a[216:219], a[104:107], v[48:51]
  ds_read_b64_tr_b16 a[242:243], v229 offset:8480
  v_mfma_f32_16x16x32_bf16 v[56:59], a[216:219], a[108:111], v[56:59]
  buffer_load_dwordx4 a[0:3], v231, s[20:23], s58 offen sc1
  s_waitcnt lgkmcnt(10)
  v_mfma_f32_16x16x32_bf16 v[36:39], a[220:223], a[96:99], v[36:39]
  ds_read_b64_tr_b16 a[244:245], v229 offset:8232
  v_mfma_f32_16x16x32_bf16 v[44:47], a[220:223], a[100:103], v[44:47]
  ds_read_b64_tr_b16 a[246:247], v229 offset:8488
  v_mfma_f32_16x16x32_bf16 v[52:55], a[220:223], a[104:107], v[52:55]
  v_mfma_f32_16x16x32_bf16 v[60:63], a[220:223], a[108:111], v[60:63]
  s_waitcnt lgkmcnt(10)
  v_mfma_f32_16x16x32_bf16 v[64:67], a[224:227], a[96:99], v[64:67]
  ds_read_b64_tr_b16 a[208:209], v228 offset:10288
  v_mfma_f32_16x16x32_bf16 v[72:75], a[224:227], a[100:103], v[72:75]
  ds_read_b64_tr_b16 a[210:211], v228 offset:11312
  v_mfma_f32_16x16x32_bf16 v[80:83], a[224:227], a[104:107], v[80:83]
  buffer_load_dwordx4 a[4:7], v232, s[20:23], s58 offen sc1
  v_mfma_f32_16x16x32_bf16 v[88:91], a[224:227], a[108:111], v[88:91]
  s_waitcnt lgkmcnt(10)
  v_mfma_f32_16x16x32_bf16 v[68:71], a[228:231], a[96:99], v[68:71]
  ds_read_b64_tr_b16 a[212:213], v228 offset:10296
  v_mfma_f32_16x16x32_bf16 v[76:79], a[228:231], a[100:103], v[76:79]
  buffer_load_dwordx4 v[160:163], v226, s[36:39], s89 offen
  v_mfma_f32_16x16x32_bf16 v[84:87], a[228:231], a[104:107], v[84:87]
  ds_read_b64_tr_b16 a[214:215], v228 offset:11320
  v_mfma_f32_16x16x32_bf16 v[92:95], a[228:231], a[108:111], v[92:95]
  s_waitcnt lgkmcnt(10)
  v_mfma_f32_16x16x32_bf16 v[96:99], a[232:235], a[96:99], v[96:99]
  ds_read_b64_tr_b16 a[216:217], v228 offset:10544
  v_mfma_f32_16x16x32_bf16 v[104:107], a[232:235], a[100:103], v[104:107]
  ds_read_b64_tr_b16 a[218:219], v228 offset:11568
  v_mfma_f32_16x16x32_bf16 v[112:115], a[232:235], a[104:107], v[112:115]
  v_mfma_f32_16x16x32_bf16 v[120:123], a[232:235], a[108:111], v[120:123]
  buffer_load_dwordx4 a[8:11], v233, s[20:23], s58 offen sc1
  s_waitcnt lgkmcnt(10)
  v_mfma_f32_16x16x32_bf16 v[100:103], a[236:239], a[96:99], v[100:103]
  ds_read_b64_tr_b16 a[220:221], v228 offset:10552
  v_mfma_f32_16x16x32_bf16 v[108:111], a[236:239], a[100:103], v[108:111]
  buffer_load_dwordx4 v[164:167], v226, s[36:39], s91 offen
  v_mfma_f32_16x16x32_bf16 v[116:119], a[236:239], a[104:107], v[116:119]
  ds_read_b64_tr_b16 a[222:223], v228 offset:11576
  v_mfma_f32_16x16x32_bf16 v[124:127], a[236:239], a[108:111], v[124:127]
  s_waitcnt lgkmcnt(10)
  v_mfma_f32_16x16x32_bf16 v[128:131], a[240:243], a[96:99], v[128:131]
  ds_read_b64_tr_b16 a[224:225], v228 offset:10800
  v_mfma_f32_16x16x32_bf16 v[136:139], a[240:243], a[100:103], v[136:139]
  ds_read_b64_tr_b16 a[226:227], v228 offset:11824
  v_mfma_f32_16x16x32_bf16 v[144:147], a[240:243], a[104:107], v[144:147]
  v_mfma_f32_16x16x32_bf16 v[152:155], a[240:243], a[108:111], v[152:155]
  buffer_load_dwordx4 a[12:15], v234, s[20:23], s58 offen sc1
  s_waitcnt lgkmcnt(10)
  v_mfma_f32_16x16x32_bf16 v[132:135], a[244:247], a[96:99], v[132:135]
  ds_read_b64_tr_b16 a[228:229], v228 offset:10808
  v_mfma_f32_16x16x32_bf16 v[140:143], a[244:247], a[100:103], v[140:143]
  buffer_load_dwordx4 v[168:171], v226, s[36:39], s93 offen
  v_mfma_f32_16x16x32_bf16 v[148:151], a[244:247], a[104:107], v[148:151]
  ds_read_b64_tr_b16 a[230:231], v228 offset:11832
  v_mfma_f32_16x16x32_bf16 v[156:159], a[244:247], a[108:111], v[156:159]
  s_waitcnt vmcnt(37) lgkmcnt(10)
  v_mfma_f32_16x16x32_bf16 v[0:3], a[208:211], a[112:115], v[0:3]
  ds_read_b64_tr_b16 a[232:233], v228 offset:11056
  v_mfma_f32_16x16x32_bf16 v[8:11], a[208:211], a[116:119], v[8:11]
  ds_read_b64_tr_b16 a[234:235], v228 offset:12080
  v_mfma_f32_16x16x32_bf16 v[16:19], a[208:211], a[120:123], v[16:19]
  v_mfma_f32_16x16x32_bf16 v[24:27], a[208:211], a[124:127], v[24:27]
  s_waitcnt lgkmcnt(10)
  v_mfma_f32_16x16x32_bf16 v[4:7], a[212:215], a[112:115], v[4:7]
  ds_read_b64_tr_b16 a[236:237], v228 offset:11064
  v_mfma_f32_16x16x32_bf16 v[12:15], a[212:215], a[116:119], v[12:15]
  buffer_load_dwordx4 a[16:19], v231, s[20:23], s58 offen offset:1024 sc1
  v_mfma_f32_16x16x32_bf16 v[20:23], a[212:215], a[120:123], v[20:23]
  ds_read_b64_tr_b16 a[238:239], v228 offset:12088
  v_mfma_f32_16x16x32_bf16 v[28:31], a[212:215], a[124:127], v[28:31]
  s_waitcnt lgkmcnt(10)
  v_mfma_f32_16x16x32_bf16 v[32:35], a[216:219], a[112:115], v[32:35]
  ds_read_b64_tr_b16 a[240:241], v229 offset:18512
  v_mfma_f32_16x16x32_bf16 v[40:43], a[216:219], a[116:119], v[40:43]
  ds_read_b64_tr_b16 a[242:243], v229 offset:18768
  v_mfma_f32_16x16x32_bf16 v[48:51], a[216:219], a[120:123], v[48:51]
  v_mfma_f32_16x16x32_bf16 v[56:59], a[216:219], a[124:127], v[56:59]
  s_waitcnt lgkmcnt(10)
  v_mfma_f32_16x16x32_bf16 v[36:39], a[220:223], a[112:115], v[36:39]
  ds_read_b64_tr_b16 a[244:245], v229 offset:18520
  v_mfma_f32_16x16x32_bf16 v[44:47], a[220:223], a[116:119], v[44:47]
  buffer_load_dwordx4 a[20:23], v232, s[20:23], s58 offen offset:1024 sc1
  v_mfma_f32_16x16x32_bf16 v[52:55], a[220:223], a[120:123], v[52:55]
  ds_read_b64_tr_b16 a[246:247], v229 offset:18776
  v_mfma_f32_16x16x32_bf16 v[60:63], a[220:223], a[124:127], v[60:63]
  s_waitcnt vmcnt(13)
  s_barrier
  s_waitcnt lgkmcnt(10)
  v_mfma_f32_16x16x32_bf16 v[64:67], a[224:227], a[112:115], v[64:67]
  s_add_u32 s54, s54, 0x6080
  s_cmp_ge_u32 s54, 0x24300
  s_cselect_b32 s54, 0, s54
  v_add_u32 v228, s54, v218
  v_add_u32 v229, s54, v219
  s_add_u32 s54, s54, 0x6080
  s_cmp_ge_u32 s54, 0x24300
  s_cselect_b32 s54, 0, s54
  v_add_u32 v222, s54, v218
  v_add_u32 v224, s54, v219
  s_add_u32 s54, s54, 0x6080
  s_cmp_ge_u32 s54, 0x24300
  s_cselect_b32 s54, 0, s54
  v_add_u32 v223, s54, v218
  v_add_u32 v225, s54, v219
  v_mfma_f32_16x16x32_bf16 v[72:75], a[224:227], a[116:119], v[72:75]
  ds_read_b64_tr_b16 a[208:209], v228
  v_mfma_f32_16x16x32_bf16 v[80:83], a[224:227], a[120:123], v[80:83]
  ds_read_b64_tr_b16 a[210:211], v228 offset:1024
  v_mfma_f32_16x16x32_bf16 v[88:91], a[224:227], a[124:127], v[88:91]
  s_waitcnt lgkmcnt(10)
  v_mfma_f32_16x16x32_bf16 v[68:71], a[228:231], a[112:115], v[68:71]
  ds_read_b64_tr_b16 a[212:213], v228 offset:10288
  v_mfma_f32_16x16x32_bf16 v[76:79], a[228:231], a[116:119], v[76:79]
  ds_read_b64_tr_b16 a[214:215], v228 offset:11312
  v_mfma_f32_16x16x32_bf16 v[84:87], a[228:231], a[120:123], v[84:87]
  buffer_load_dwordx4 a[24:27], v233, s[20:23], s58 offen offset:1024 sc1
  v_mfma_f32_16x16x32_bf16 v[92:95], a[228:231], a[124:127], v[92:95]
  s_waitcnt lgkmcnt(10)
  v_mfma_f32_16x16x32_bf16 v[96:99], a[232:235], a[112:115], v[96:99]
  ds_read_b64_tr_b16 a[216:217], v222
  v_mfma_f32_16x16x32_bf16 v[104:107], a[232:235], a[116:119], v[104:107]
  ds_read_b64_tr_b16 a[218:219], v222 offset:1024
  v_mfma_f32_16x16x32_bf16 v[112:115], a[232:235], a[120:123], v[112:115]
  v_mfma_f32_16x16x32_bf16 v[120:123], a[232:235], a[124:127], v[120:123]
  s_waitcnt lgkmcnt(10)
  v_mfma_f32_16x16x32_bf16 v[100:103], a[236:239], a[112:115], v[100:103]
  ds_read_b64_tr_b16 a[220:221], v222 offset:10288
  v_mfma_f32_16x16x32_bf16 v[108:111], a[236:239], a[116:119], v[108:111]
  ds_read_b64_tr_b16 a[222:223], v222 offset:11312
  v_mfma_f32_16x16x32_bf16 v[116:119], a[236:239], a[120:123], v[116:119]
  buffer_load_dwordx4 a[28:31], v234, s[20:23], s58 offen offset:1024 sc1
  v_mfma_f32_16x16x32_bf16 v[124:127], a[236:239], a[124:127], v[124:127]
  s_waitcnt lgkmcnt(10)
  v_mfma_f32_16x16x32_bf16 v[128:131], a[240:243], a[112:115], v[128:131]
  ds_read_b64_tr_b16 a[224:225], v223
  v_mfma_f32_16x16x32_bf16 v[136:139], a[240:243], a[116:119], v[136:139]
  ds_read_b64_tr_b16 a[226:227], v223 offset:1024
  v_mfma_f32_16x16x32_bf16 v[144:147], a[240:243], a[120:123], v[144:147]
  v_mfma_f32_16x16x32_bf16 v[152:155], a[240:243], a[124:127], v[152:155]
  s_waitcnt lgkmcnt(10)
  v_mfma_f32_16x16x32_bf16 v[132:135], a[244:247], a[112:115], v[132:135]
  ds_read_b64_tr_b16 a[228:229], v223 offset:10288
  v_mfma_f32_16x16x32_bf16 v[140:143], a[244:247], a[116:119], v[140:143]
  ds_read_b64_tr_b16 a[230:231], v223 offset:11312
  v_mfma_f32_16x16x32_bf16 v[148:151], a[244:247], a[120:123], v[148:151]
  v_mfma_f32_16x16x32_bf16 v[156:159], a[244:247], a[124:127], v[156:159]
  s_waitcnt lgkmcnt(10)
  v_mfma_f32_16x16x32_bf16 v[0:3], a[208:211], a[128:131], v[0:3]
  ds_read_b64_tr_b16 a[232:233], v228 offset:8
  v_mfma_f32_16x16x32_bf16 v[8:11], a[208:211], a[132:135], v[8:11]
  ds_read_b64_tr_b16 a[234:235], v228 offset:1032
  v_mfma_f32_16x16x32_bf16 v[16:19], a[208:211], a[136:139], v[16:19]
  s_waitcnt vmcnt(8)
  v_lshlrev_b32 v176, 16, v160
  v_and_b32 v177, 0xffff0000, v160
  v_mfma_f32_16x16x32_bf16 v[24:27], a[208:211], a[140:143], v[24:27]
  s_waitcnt lgkmcnt(10)
  v_lshlrev_b32 v178, 16, v161
  v_mfma_f32_16x16x32_bf16 v[0:3], a[212:215], a[144:147], v[0:3]
  ds_read_b64_tr_b16 a[236:237], v228 offset:10296
  v_and_b32 v179, 0xffff0000, v161
  v_mfma_f32_16x16x32_bf16 v[8:11], a[212:215], a[148:151], v[8:11]
  ds_read_b64_tr_b16 a[238:239], v228 offset:11320
  v_lshlrev_b32 v180, 16, v162
  v_mfma_f32_16x16x32_bf16 v[16:19], a[212:215], a[152:155], v[16:19]
  v_and_b32 v181, 0xffff0000, v162
  v_lshlrev_b32 v182, 16, v163
  v_mfma_f32_16x16x32_bf16 v[24:27], a[212:215], a[156:159], v[24:27]
  s_waitcnt lgkmcnt(10)
  v_and_b32 v183, 0xffff0000, v163
  v_mfma_f32_16x16x32_bf16 v[0:3], a[216:219], a[160:163], v[0:3]
  ds_read_b64_tr_b16 a[240:241], v222 offset:8
  s_waitcnt vmcnt(6)
  v_lshlrev_b32 v184, 16, v164
  v_mfma_f32_16x16x32_bf16 v[8:11], a[216:219], a[164:167], v[8:11]
  ds_read_b64_tr_b16 a[242:243], v222 offset:1032
  v_and_b32 v185, 0xffff0000, v164
  v_mfma_f32_16x16x32_bf16 v[16:19], a[216:219], a[168:171], v[16:19]
  v_lshlrev_b32 v186, 16, v165
  v_and_b32 v187, 0xffff0000, v165
  v_mfma_f32_16x16x32_bf16 v[24:27], a[216:219], a[172:175], v[24:27]
  s_waitcnt lgkmcnt(10)
  v_lshlrev_b32 v188, 16, v166
  v_and_b32 v189, 0xffff0000, v166
  v_mfma_f32_16x16x32_bf16 v[0:3], a[220:223], a[176:179], v[0:3]
  ds_read_b64_tr_b16 a[244:245], v222 offset:10296
  v_lshlrev_b32 v190, 16, v167
  v_mfma_f32_16x16x32_bf16 v[8:11], a[220:223], a[180:183], v[8:11]
  ds_read_b64_tr_b16 a[246:247], v222 offset:11320
  v_and_b32 v191, 0xffff0000, v167
  v_mfma_f32_16x16x32_bf16 v[16:19], a[220:223], a[184:187], v[16:19]
  s_waitcnt vmcnt(4)
  v_lshlrev_b32 v200, 16, v168
  v_and_b32 v201, 0xffff0000, v168
  v_mfma_f32_16x16x32_bf16 v[24:27], a[220:223], a[188:191], v[24:27]
  s_waitcnt lgkmcnt(10)
  v_lshlrev_b32 v202, 16, v169
  v_mfma_f32_16x16x32_bf16 v[0:3], a[224:227], a[0:3], v[0:3]
  ds_read_b64_tr_b16 a[208:209], v223 offset:8
  v_and_b32 v203, 0xffff0000, v169
  v_mfma_f32_16x16x32_bf16 v[8:11], a[224:227], a[4:7], v[8:11]
  ds_read_b64_tr_b16 a[210:211], v223 offset:1032
  v_lshlrev_b32 v204, 16, v170
  v_mfma_f32_16x16x32_bf16 v[16:19], a[224:227], a[8:11], v[16:19]
  v_and_b32 v205, 0xffff0000, v170
  v_lshlrev_b32 v206, 16, v171
  v_mfma_f32_16x16x32_bf16 v[24:27], a[224:227], a[12:15], v[24:27]
  s_waitcnt vmcnt(0) lgkmcnt(10)
  v_and_b32 v207, 0xffff0000, v171
  v_mfma_f32_16x16x32_bf16 v[0:3], a[228:231], a[16:19], v[0:3]
  ds_read_b64_tr_b16 a[212:213], v223 offset:10296
  v_mfma_f32_16x16x32_bf16 v[8:11], a[228:231], a[20:23], v[8:11]
  ds_read_b64_tr_b16 a[214:215], v223 offset:11320
  v_mfma_f32_16x16x32_bf16 v[16:19], a[228:231], a[24:27], v[16:19]
  v_mfma_f32_16x16x32_bf16 v[24:27], a[228:231], a[28:31], v[24:27]
  s_waitcnt lgkmcnt(10)
  v_mfma_f32_16x16x32_bf16 v[4:7], a[232:235], a[128:131], v[4:7]
  ds_read_b64_tr_b16 a[216:217], v228 offset:256
  v_mfma_f32_16x16x32_bf16 v[12:15], a[232:235], a[132:135], v[12:15]
  ds_read_b64_tr_b16 a[218:219], v228 offset:1280
  v_mfma_f32_16x16x32_bf16 v[20:23], a[232:235], a[136:139], v[20:23]
  v_mfma_f32_16x16x32_bf16 v[28:31], a[232:235], a[140:143], v[28:31]
  s_waitcnt lgkmcnt(10)
  v_cvt_pk_bf16_f32 v0, v0, v1
  v_cvt_pk_bf16_f32 v1, v2, v3
  v_mfma_f32_16x16x32_bf16 v[4:7], a[236:239], a[144:147], v[4:7]
  ds_read_b64_tr_b16 a[220:221], v228 offset:10544
  v_cvt_pk_bf16_f32 v8, v8, v9
  v_mfma_f32_16x16x32_bf16 v[12:15], a[236:239], a[148:151], v[12:15]
  ds_read_b64_tr_b16 a[222:223], v228 offset:11568
  v_cvt_pk_bf16_f32 v9, v10, v11
  v_mfma_f32_16x16x32_bf16 v[20:23], a[236:239], a[152:155], v[20:23]
  v_cvt_pk_bf16_f32 v16, v16, v17
  v_cvt_pk_bf16_f32 v17, v18, v19
  v_mfma_f32_16x16x32_bf16 v[28:31], a[236:239], a[156:159], v[28:31]
  s_waitcnt lgkmcnt(10)
  v_cvt_pk_bf16_f32 v24, v24, v25
  v_cvt_pk_bf16_f32 v25, v26, v27
  v_mfma_f32_16x16x32_bf16 v[4:7], a[240:243], a[160:163], v[4:7]
  ds_read_b64_tr_b16 a[224:225], v222 offset:256
  v_mfma_f32_16x16x32_bf16 v[12:15], a[240:243], a[164:167], v[12:15]
  ds_read_b64_tr_b16 a[226:227], v222 offset:1280
  v_mfma_f32_16x16x32_bf16 v[20:23], a[240:243], a[168:171], v[20:23]
  v_mfma_f32_16x16x32_bf16 v[28:31], a[240:243], a[172:175], v[28:31]
  s_waitcnt lgkmcnt(10)
  v_mfma_f32_16x16x32_bf16 v[4:7], a[244:247], a[176:179], v[4:7]
  ds_read_b64_tr_b16 a[228:229], v222 offset:10544
  v_mfma_f32_16x16x32_bf16 v[12:15], a[244:247], a[180:183], v[12:15]
  ds_read_b64_tr_b16 a[230:231], v222 offset:11568
  v_mfma_f32_16x16x32_bf16 v[20:23], a[244:247], a[184:187], v[20:23]
  v_mfma_f32_16x16x32_bf16 v[28:31], a[244:247], a[188:191], v[28:31]
  s_waitcnt lgkmcnt(10)
  v_mfma_f32_16x16x32_bf16 v[4:7], a[208:211], a[0:3], v[4:7]
  ds_read_b64_tr_b16 a[232:233], v223 offset:256
  v_mfma_f32_16x16x32_bf16 v[12:15], a[208:211], a[4:7], v[12:15]
  ds_read_b64_tr_b16 a[234:235], v223 offset:1280
  v_mfma_f32_16x16x32_bf16 v[20:23], a[208:211], a[8:11], v[20:23]
  v_mfma_f32_16x16x32_bf16 v[28:31], a[208:211], a[12:15], v[28:31]
  s_waitcnt lgkmcnt(10)
  v_mfma_f32_16x16x32_bf16 v[4:7], a[212:215], a[16:19], v[4:7]
  ds_read_b64_tr_b16 a[236:237], v223 offset:10544
  v_mfma_f32_16x16x32_bf16 v[12:15], a[212:215], a[20:23], v[12:15]
  ds_read_b64_tr_b16 a[238:239], v223 offset:11568
  v_mfma_f32_16x16x32_bf16 v[20:23], a[212:215], a[24:27], v[20:23]
  v_mfma_f32_16x16x32_bf16 v[28:31], a[212:215], a[28:31], v[28:31]
  s_waitcnt lgkmcnt(10)
  v_mfma_f32_16x16x32_bf16 v[32:35], a[216:219], a[128:131], v[32:35]
  ds_read_b64_tr_b16 a[240:241], v228 offset:264
  v_mfma_f32_16x16x32_bf16 v[40:43], a[216:219], a[132:135], v[40:43]
  ds_read_b64_tr_b16 a[242:243], v228 offset:1288
  v_mfma_f32_16x16x32_bf16 v[48:51], a[216:219], a[136:139], v[48:51]
  v_mfma_f32_16x16x32_bf16 v[56:59], a[216:219], a[140:143], v[56:59]
  s_waitcnt lgkmcnt(10)
  v_cvt_pk_bf16_f32 v2, v4, v5
  v_cvt_pk_bf16_f32 v3, v6, v7
  v_mfma_f32_16x16x32_bf16 v[32:35], a[220:223], a[144:147], v[32:35]
  ds_read_b64_tr_b16 a[244:245], v228 offset:10552
  v_cvt_pk_bf16_f32 v10, v12, v13
  v_mfma_f32_16x16x32_bf16 v[40:43], a[220:223], a[148:151], v[40:43]
  ds_read_b64_tr_b16 a[246:247], v228 offset:11576
  v_cvt_pk_bf16_f32 v11, v14, v15
  v_mfma_f32_16x16x32_bf16 v[48:51], a[220:223], a[152:155], v[48:51]
  v_cvt_pk_bf16_f32 v18, v20, v21
  v_cvt_pk_bf16_f32 v19, v22, v23
  v_mfma_f32_16x16x32_bf16 v[56:59], a[220:223], a[156:159], v[56:59]
  s_waitcnt lgkmcnt(10)
  v_cvt_pk_bf16_f32 v26, v28, v29
  v_cvt_pk_bf16_f32 v27, v30, v31
  v_mfma_f32_16x16x32_bf16 v[32:35], a[224:227], a[160:163], v[32:35]
  ds_read_b64_tr_b16 a[208:209], v222 offset:264
  v_mfma_f32_16x16x32_bf16 v[40:43], a[224:227], a[164:167], v[40:43]
  ds_read_b64_tr_b16 a[210:211], v222 offset:1288
  v_mfma_f32_16x16x32_bf16 v[48:51], a[224:227], a[168:171], v[48:51]
  buffer_store_dwordx4 v[0:3], v208, s[20:23], 0 offen sc1
  v_mfma_f32_16x16x32_bf16 v[56:59], a[224:227], a[172:175], v[56:59]
  buffer_store_dwordx4 v[8:11], v209, s[20:23], 0 offen sc1
  s_waitcnt lgkmcnt(10)
  v_mfma_f32_16x16x32_bf16 v[32:35], a[228:231], a[176:179], v[32:35]
  ds_read_b64_tr_b16 a[212:213], v222 offset:10552
  v_mfma_f32_16x16x32_bf16 v[40:43], a[228:231], a[180:183], v[40:43]
  ds_read_b64_tr_b16 a[214:215], v222 offset:11576
  v_mfma_f32_16x16x32_bf16 v[48:51], a[228:231], a[184:187], v[48:51]
  buffer_store_dwordx4 v[16:19], v210, s[20:23], 0 offen sc1
  v_mfma_f32_16x16x32_bf16 v[56:59], a[228:231], a[188:191], v[56:59]
  s_waitcnt lgkmcnt(10)
  v_mfma_f32_16x16x32_bf16 v[32:35], a[232:235], a[0:3], v[32:35]
  ds_read_b64_tr_b16 a[216:217], v223 offset:264
  v_mfma_f32_16x16x32_bf16 v[40:43], a[232:235], a[4:7], v[40:43]
  ds_read_b64_tr_b16 a[218:219], v223 offset:1288
  v_mfma_f32_16x16x32_bf16 v[48:51], a[232:235], a[8:11], v[48:51]
  buffer_store_dwordx4 v[24:27], v211, s[20:23], 0 offen sc1
  v_mfma_f32_16x16x32_bf16 v[56:59], a[232:235], a[12:15], v[56:59]
  s_waitcnt lgkmcnt(10)
  v_mfma_f32_16x16x32_bf16 v[32:35], a[236:239], a[16:19], v[32:35]
  ds_read_b64_tr_b16 a[220:221], v223 offset:10552
  v_mfma_f32_16x16x32_bf16 v[40:43], a[236:239], a[20:23], v[40:43]
  ds_read_b64_tr_b16 a[222:223], v223 offset:11576
  v_mfma_f32_16x16x32_bf16 v[48:51], a[236:239], a[24:27], v[48:51]
  v_mfma_f32_16x16x32_bf16 v[56:59], a[236:239], a[28:31], v[56:59]
  s_waitcnt lgkmcnt(10)
  v_mfma_f32_16x16x32_bf16 v[36:39], a[240:243], a[128:131], v[36:39]
  ds_read_b64_tr_b16 a[224:225], v228 offset:512
  v_mfma_f32_16x16x32_bf16 v[44:47], a[240:243], a[132:135], v[44:47]
  ds_read_b64_tr_b16 a[226:227], v228 offset:1536
  v_mfma_f32_16x16x32_bf16 v[52:55], a[240:243], a[136:139], v[52:55]
  v_mfma_f32_16x16x32_bf16 v[60:63], a[240:243], a[140:143], v[60:63]
  s_waitcnt lgkmcnt(10)
  v_cvt_pk_bf16_f32 v32, v32, v33
  v_cvt_pk_bf16_f32 v33, v34, v35
  v_mfma_f32_16x16x32_bf16 v[36:39], a[244:247], a[144:147], v[36:39]
  ds_read_b64_tr_b16 a[228:229], v228 offset:10800
  v_cvt_pk_bf16_f32 v40, v40, v41
  v_mfma_f32_16x16x32_bf16 v[44:47], a[244:247], a[148:151], v[44:47]
  ds_read_b64_tr_b16 a[230:231], v228 offset:11824
  v_cvt_pk_bf16_f32 v41, v42, v43
  v_mfma_f32_16x16x32_bf16 v[52:55], a[244:247], a[152:155], v[52:55]
  v_cvt_pk_bf16_f32 v48, v48, v49
  v_cvt_pk_bf16_f32 v49, v50, v51
  v_mfma_f32_16x16x32_bf16 v[60:63], a[244:247], a[156:159], v[60:63]
  s_waitcnt lgkmcnt(10)
  v_cvt_pk_bf16_f32 v56, v56, v57
  v_cvt_pk_bf16_f32 v57, v58, v59
  v_mfma_f32_16x16x32_bf16 v[36:39], a[208:211], a[160:163], v[36:39]
  ds_read_b64_tr_b16 a[232:233], v222 offset:512
  v_mfma_f32_16x16x32_bf16 v[44:47], a[208:211], a[164:167], v[44:47]
  ds_read_b64_tr_b16 a[234:235], v222 offset:1536
  v_mfma_f32_16x16x32_bf16 v[52:55], a[208:211], a[168:171], v[52:55]
  v_mfma_f32_16x16x32_bf16 v[60:63], a[208:211], a[172:175], v[60:63]
  s_waitcnt lgkmcnt(10)
  v_mfma_f32_16x16x32_bf16 v[36:39], a[212:215], a[176:179], v[36:39]
  ds_read_b64_tr_b16 a[236:237], v222 offset:10800
  v_mfma_f32_16x16x32_bf16 v[44:47], a[212:215], a[180:183], v[44:47]
  ds_read_b64_tr_b16 a[238:239], v222 offset:11824
  v_mfma_f32_16x16x32_bf16 v[52:55], a[212:215], a[184:187], v[52:55]
  v_mfma_f32_16x16x32_bf16 v[60:63], a[212:215], a[188:191], v[60:63]
  s_waitcnt lgkmcnt(10)
  v_mfma_f32_16x16x32_bf16 v[36:39], a[216:219], a[0:3], v[36:39]
  ds_read_b64_tr_b16 a[240:241], v223 offset:512
  v_mfma_f32_16x16x32_bf16 v[44:47], a[216:219], a[4:7], v[44:47]
  ds_read_b64_tr_b16 a[242:243], v223 offset:1536
  v_mfma_f32_16x16x32_bf16 v[52:55], a[216:219], a[8:11], v[52:55]
  v_mfma_f32_16x16x32_bf16 v[60:63], a[216:219], a[12:15], v[60:63]
  s_waitcnt lgkmcnt(10)
  v_mfma_f32_16x16x32_bf16 v[36:39], a[220:223], a[16:19], v[36:39]
  ds_read_b64_tr_b16 a[244:245], v223 offset:10800
  v_mfma_f32_16x16x32_bf16 v[44:47], a[220:223], a[20:23], v[44:47]
  ds_read_b64_tr_b16 a[246:247], v223 offset:11824
  v_mfma_f32_16x16x32_bf16 v[52:55], a[220:223], a[24:27], v[52:55]
  v_mfma_f32_16x16x32_bf16 v[60:63], a[220:223], a[28:31], v[60:63]
  s_waitcnt lgkmcnt(10)
  v_mfma_f32_16x16x32_bf16 v[64:67], a[224:227], a[128:131], v[64:67]
  ds_read_b64_tr_b16 a[208:209], v228 offset:520
  v_mfma_f32_16x16x32_bf16 v[72:75], a[224:227], a[132:135], v[72:75]
  ds_read_b64_tr_b16 a[210:211], v228 offset:1544
  v_mfma_f32_16x16x32_bf16 v[80:83], a[224:227], a[136:139], v[80:83]
  v_mfma_f32_16x16x32_bf16 v[88:91], a[224:227], a[140:143], v[88:91]
  s_waitcnt lgkmcnt(10)
  v_cvt_pk_bf16_f32 v34, v36, v37
  v_cvt_pk_bf16_f32 v35, v38, v39
  v_mfma_f32_16x16x32_bf16 v[64:67], a[228:231], a[144:147], v[64:67]
  ds_read_b64_tr_b16 a[212:213], v228 offset:10808
  v_cvt_pk_bf16_f32 v42, v44, v45
  v_mfma_f32_16x16x32_bf16 v[72:75], a[228:231], a[148:151], v[72:75]
  ds_read_b64_tr_b16 a[214:215], v228 offset:11832
  v_cvt_pk_bf16_f32 v43, v46, v47
  v_mfma_f32_16x16x32_bf16 v[80:83], a[228:231], a[152:155], v[80:83]
  v_cvt_pk_bf16_f32 v50, v52, v53
  v_cvt_pk_bf16_f32 v51, v54, v55
  v_mfma_f32_16x16x32_bf16 v[88:91], a[228:231], a[156:159], v[88:91]
  s_waitcnt lgkmcnt(10)
  v_cvt_pk_bf16_f32 v58, v60, v61
  v_cvt_pk_bf16_f32 v59, v62, v63
  v_mfma_f32_16x16x32_bf16 v[64:67], a[232:235], a[160:163], v[64:67]
  ds_read_b64_tr_b16 a[216:217], v222 offset:520
  v_mfma_f32_16x16x32_bf16 v[72:75], a[232:235], a[164:167], v[72:75]
  ds_read_b64_tr_b16 a[218:219], v222 offset:1544
  v_mfma_f32_16x16x32_bf16 v[80:83], a[232:235], a[168:171], v[80:83]
  buffer_store_dwordx4 v[32:35], v208, s[20:23], 0 offen offset:1024 sc1
  v_mfma_f32_16x16x32_bf16 v[88:91], a[232:235], a[172:175], v[88:91]
  buffer_store_dwordx4 v[40:43], v209, s[20:23], 0 offen offset:1024 sc1
  s_waitcnt lgkmcnt(10)
  v_mfma_f32_16x16x32_bf16 v[64:67], a[236:239], a[176:179], v[64:67]
  ds_read_b64_tr_b16 a[220:221], v222 offset:10808
  v_mfma_f32_16x16x32_bf16 v[72:75], a[236:239], a[180:183], v[72:75]
  ds_read_b64_tr_b16 a[222:223], v222 offset:11832
  v_mfma_f32_16x16x32_bf16 v[80:83], a[236:239], a[184:187], v[80:83]
  buffer_store_dwordx4 v[48:51], v210, s[20:23], 0 offen offset:1024 sc1
  v_mfma_f32_16x16x32_bf16 v[88:91], a[236:239], a[188:191], v[88:91]
  s_waitcnt lgkmcnt(10)
  v_mfma_f32_16x16x32_bf16 v[64:67], a[240:243], a[0:3], v[64:67]
  ds_read_b64_tr_b16 a[224:225], v223 offset:520
  v_mfma_f32_16x16x32_bf16 v[72:75], a[240:243], a[4:7], v[72:75]
  ds_read_b64_tr_b16 a[226:227], v223 offset:1544
  v_mfma_f32_16x16x32_bf16 v[80:83], a[240:243], a[8:11], v[80:83]
  buffer_store_dwordx4 v[56:59], v211, s[20:23], 0 offen offset:1024 sc1
  v_mfma_f32_16x16x32_bf16 v[88:91], a[240:243], a[12:15], v[88:91]
  s_waitcnt lgkmcnt(10)
  v_mfma_f32_16x16x32_bf16 v[64:67], a[244:247], a[16:19], v[64:67]
  ds_read_b64_tr_b16 a[228:229], v223 offset:10808
  v_mfma_f32_16x16x32_bf16 v[72:75], a[244:247], a[20:23], v[72:75]
  ds_read_b64_tr_b16 a[230:231], v223 offset:11832
  v_mfma_f32_16x16x32_bf16 v[80:83], a[244:247], a[24:27], v[80:83]
  v_mfma_f32_16x16x32_bf16 v[88:91], a[244:247], a[28:31], v[88:91]
  s_waitcnt lgkmcnt(10)
  v_mfma_f32_16x16x32_bf16 v[68:71], a[208:211], a[128:131], v[68:71]
  ds_read_b64_tr_b16 a[232:233], v228 offset:768
  v_mfma_f32_16x16x32_bf16 v[76:79], a[208:211], a[132:135], v[76:79]
  ds_read_b64_tr_b16 a[234:235], v228 offset:1792
  v_mfma_f32_16x16x32_bf16 v[84:87], a[208:211], a[136:139], v[84:87]
  v_mfma_f32_16x16x32_bf16 v[92:95], a[208:211], a[140:143], v[92:95]
  s_waitcnt lgkmcnt(10)
  v_cvt_pk_bf16_f32 v64, v64, v65
  v_cvt_pk_bf16_f32 v65, v66, v67
  v_mfma_f32_16x16x32_bf16 v[68:71], a[212:215], a[144:147], v[68:71]
  ds_read_b64_tr_b16 a[236:237], v228 offset:11056
  v_cvt_pk_bf16_f32 v72, v72, v73
  v_mfma_f32_16x16x32_bf16 v[76:79], a[212:215], a[148:151], v[76:79]
  ds_read_b64_tr_b16 a[238:239], v228 offset:12080
  v_cvt_pk_bf16_f32 v73, v74, v75
  v_mfma_f32_16x16x32_bf16 v[84:87], a[212:215], a[152:155], v[84:87]
  v_cvt_pk_bf16_f32 v80, v80, v81
  v_cvt_pk_bf16_f32 v81, v82, v83
  v_mfma_f32_16x16x32_bf16 v[92:95], a[212:215], a[156:159], v[92:95]
  s_waitcnt lgkmcnt(10)
  v_cvt_pk_bf16_f32 v88, v88, v89
  v_cvt_pk_bf16_f32 v89, v90, v91
  v_mfma_f32_16x16x32_bf16 v[68:71], a[216:219], a[160:163], v[68:71]
  ds_read_b64_tr_b16 a[240:241], v222 offset:768
  v_mfma_f32_16x16x32_bf16 v[76:79], a[216:219], a[164:167], v[76:79]
  ds_read_b64_tr_b16 a[242:243], v222 offset:1792
  v_mfma_f32_16x16x32_bf16 v[84:87], a[216:219], a[168:171], v[84:87]
  v_mfma_f32_16x16x32_bf16 v[92:95], a[216:219], a[172:175], v[92:95]
  s_waitcnt lgkmcnt(10)
  v_mfma_f32_16x16x32_bf16 v[68:71], a[220:223], a[176:179], v[68:71]
  ds_read_b64_tr_b16 a[244:245], v222 offset:11056
  v_mfma_f32_16x16x32_bf16 v[76:79], a[220:223], a[180:183], v[76:79]
  ds_read_b64_tr_b16 a[246:247], v222 offset:12080
  v_mfma_f32_16x16x32_bf16 v[84:87], a[220:223], a[184:187], v[84:87]
  v_mfma_f32_16x16x32_bf16 v[92:95], a[220:223], a[188:191], v[92:95]
  s_waitcnt lgkmcnt(10)
  v_mfma_f32_16x16x32_bf16 v[68:71], a[224:227], a[0:3], v[68:71]
  ds_read_b64_tr_b16 a[208:209], v223 offset:768
  v_mfma_f32_16x16x32_bf16 v[76:79], a[224:227], a[4:7], v[76:79]
  ds_read_b64_tr_b16 a[210:211], v223 offset:1792
  v_mfma_f32_16x16x32_bf16 v[84:87], a[224:227], a[8:11], v[84:87]
  v_mfma_f32_16x16x32_bf16 v[92:95], a[224:227], a[12:15], v[92:95]
  s_waitcnt lgkmcnt(10)
  v_mfma_f32_16x16x32_bf16 v[68:71], a[228:231], a[16:19], v[68:71]
  ds_read_b64_tr_b16 a[212:213], v223 offset:11056
  v_mfma_f32_16x16x32_bf16 v[76:79], a[228:231], a[20:23], v[76:79]
  ds_read_b64_tr_b16 a[214:215], v223 offset:12080
  v_mfma_f32_16x16x32_bf16 v[84:87], a[228:231], a[24:27], v[84:87]
  v_mfma_f32_16x16x32_bf16 v[92:95], a[228:231], a[28:31], v[92:95]
  s_waitcnt lgkmcnt(10)
  v_mfma_f32_16x16x32_bf16 v[96:99], a[232:235], a[128:131], v[96:99]
  ds_read_b64_tr_b16 a[216:217], v228 offset:776
  v_mfma_f32_16x16x32_bf16 v[104:107], a[232:235], a[132:135], v[104:107]
  ds_read_b64_tr_b16 a[218:219], v228 offset:1800
  v_mfma_f32_16x16x32_bf16 v[112:115], a[232:235], a[136:139], v[112:115]
  v_mfma_f32_16x16x32_bf16 v[120:123], a[232:235], a[140:143], v[120:123]
  s_waitcnt lgkmcnt(10)
  v_cvt_pk_bf16_f32 v66, v68, v69
  v_cvt_pk_bf16_f32 v67, v70, v71
  v_mfma_f32_16x16x32_bf16 v[96:99], a[236:239], a[144:147], v[96:99]
  ds_read_b64_tr_b16 a[220:221], v228 offset:11064
  v_cvt_pk_bf16_f32 v74, v76, v77
  v_mfma_f32_16x16x32_bf16 v[104:107], a[236:239], a[148:151], v[104:107]
  ds_read_b64_tr_b16 a[222:223], v228 offset:12088
  v_cvt_pk_bf16_f32 v75, v78, v79
  v_mfma_f32_16x16x32_bf16 v[112:115], a[236:239], a[152:155], v[112:115]
  v_cvt_pk_bf16_f32 v82, v84, v85
  v_cvt_pk_bf16_f32 v83, v86, v87
  v_mfma_f32_16x16x32_bf16 v[120:123], a[236:239], a[156:159], v[120:123]
  s_waitcnt lgkmcnt(10)
  v_cvt_pk_bf16_f32 v90, v92, v93
  v_cvt_pk_bf16_f32 v91, v94, v95
  v_mfma_f32_16x16x32_bf16 v[96:99], a[240:243], a[160:163], v[96:99]
  ds_read_b64_tr_b16 a[224:225], v222 offset:776
  v_mfma_f32_16x16x32_bf16 v[104:107], a[240:243], a[164:167], v[104:107]
  ds_read_b64_tr_b16 a[226:227], v222 offset:1800
  v_mfma_f32_16x16x32_bf16 v[112:115], a[240:243], a[168:171], v[112:115]
  buffer_store_dwordx4 v[64:67], v208, s[20:23], 0 offen offset:2048 sc1
  v_mfma_f32_16x16x32_bf16 v[120:123], a[240:243], a[172:175], v[120:123]
  buffer_store_dwordx4 v[72:75], v209, s[20:23], 0 offen offset:2048 sc1
  s_waitcnt lgkmcnt(10)
  v_mfma_f32_16x16x32_bf16 v[96:99], a[244:247], a[176:179], v[96:99]
  ds_read_b64_tr_b16 a[228:229], v222 offset:11064
  v_mfma_f32_16x16x32_bf16 v[104:107], a[244:247], a[180:183], v[104:107]
  ds_read_b64_tr_b16 a[230:231], v222 offset:12088
  v_mfma_f32_16x16x32_bf16 v[112:115], a[244:247], a[184:187], v[112:115]
  buffer_store_dwordx4 v[80:83], v210, s[20:23], 0 offen offset:2048 sc1
  v_mfma_f32_16x16x32_bf16 v[120:123], a[244:247], a[188:191], v[120:123]
  s_waitcnt lgkmcnt(10)
  v_mfma_f32_16x16x32_bf16 v[96:99], a[208:211], a[0:3], v[96:99]
  ds_read_b64_tr_b16 a[232:233], v223 offset:776
  v_mfma_f32_16x16x32_bf16 v[104:107], a[208:211], a[4:7], v[104:107]
  ds_read_b64_tr_b16 a[234:235], v223 offset:1800
  v_mfma_f32_16x16x32_bf16 v[112:115], a[208:211], a[8:11], v[112:115]
  buffer_store_dwordx4 v[88:91], v211, s[20:23], 0 offen offset:2048 sc1
  v_mfma_f32_16x16x32_bf16 v[120:123], a[208:211], a[12:15], v[120:123]
  s_waitcnt lgkmcnt(10)
  v_mfma_f32_16x16x32_bf16 v[96:99], a[212:215], a[16:19], v[96:99]
  ds_read_b64_tr_b16 a[236:237], v223 offset:11064
  v_mfma_f32_16x16x32_bf16 v[104:107], a[212:215], a[20:23], v[104:107]
  ds_read_b64_tr_b16 a[238:239], v223 offset:12088
  v_mfma_f32_16x16x32_bf16 v[112:115], a[212:215], a[24:27], v[112:115]
  s_waitcnt vmcnt(4)
  v_mov_b32 v248, 1
  v_mfma_f32_16x16x32_bf16 v[120:123], a[212:215], a[28:31], v[120:123]
  buffer_store_dword v248, v250, s[20:23], s68 offen sc1
  s_waitcnt lgkmcnt(10)
  v_mfma_f32_16x16x32_bf16 v[100:103], a[216:219], a[128:131], v[100:103]
  ds_read_b64_tr_b16 a[240:241], v229 offset:8224
  v_mfma_f32_16x16x32_bf16 v[108:111], a[216:219], a[132:135], v[108:111]
  ds_read_b64_tr_b16 a[242:243], v229 offset:8480
  v_mfma_f32_16x16x32_bf16 v[116:119], a[216:219], a[136:139], v[116:119]
  v_mfma_f32_16x16x32_bf16 v[124:127], a[216:219], a[140:143], v[124:127]
  s_waitcnt lgkmcnt(10)
  v_cvt_pk_bf16_f32 v96, v96, v97
  v_cvt_pk_bf16_f32 v97, v98, v99
  v_mfma_f32_16x16x32_bf16 v[100:103], a[220:223], a[144:147], v[100:103]
  ds_read_b64_tr_b16 a[244:245], v229 offset:18512
  v_cvt_pk_bf16_f32 v104, v104, v105
  v_mfma_f32_16x16x32_bf16 v[108:111], a[220:223], a[148:151], v[108:111]
  ds_read_b64_tr_b16 a[246:247], v229 offset:18768
  v_cvt_pk_bf16_f32 v105, v106, v107
  v_mfma_f32_16x16x32_bf16 v[116:119], a[220:223], a[152:155], v[116:119]
  v_cvt_pk_bf16_f32 v112, v112, v113
  v_cvt_pk_bf16_f32 v113, v114, v115
  v_mfma_f32_16x16x32_bf16 v[124:127], a[220:223], a[156:159], v[124:127]
  s_waitcnt lgkmcnt(10)
  v_cvt_pk_bf16_f32 v120, v120, v121
  v_cvt_pk_bf16_f32 v121, v122, v123
  v_mfma_f32_16x16x32_bf16 v[100:103], a[224:227], a[160:163], v[100:103]
  ds_read_b64_tr_b16 a[208:209], v224 offset:8224
  v_mfma_f32_16x16x32_bf16 v[108:111], a[224:227], a[164:167], v[108:111]
  ds_read_b64_tr_b16 a[210:211], v224 offset:8480
  v_mfma_f32_16x16x32_bf16 v[116:119], a[224:227], a[168:171], v[116:119]
  v_mfma_f32_16x16x32_bf16 v[124:127], a[224:227], a[172:175], v[124:127]
  s_waitcnt lgkmcnt(10)
  v_mfma_f32_16x16x32_bf16 v[100:103], a[228:231], a[176:179], v[100:103]
  ds_read_b64_tr_b16 a[212:213], v224 offset:18512
  v_mfma_f32_16x16x32_bf16 v[108:111], a[228:231], a[180:183], v[108:111]
  ds_read_b64_tr_b16 a[214:215], v224 offset:18768
  v_mfma_f32_16x16x32_bf16 v[116:119], a[228:231], a[184:187], v[116:119]
  v_mfma_f32_16x16x32_bf16 v[124:127], a[228:231], a[188:191], v[124:127]
  s_waitcnt lgkmcnt(10)
  v_mfma_f32_16x16x32_bf16 v[100:103], a[232:235], a[0:3], v[100:103]
  ds_read_b64_tr_b16 a[216:217], v225 offset:8224
  v_mfma_f32_16x16x32_bf16 v[108:111], a[232:235], a[4:7], v[108:111]
  ds_read_b64_tr_b16 a[218:219], v225 offset:8480
  v_mfma_f32_16x16x32_bf16 v[116:119], a[232:235], a[8:11], v[116:119]
  v_mfma_f32_16x16x32_bf16 v[124:127], a[232:235], a[12:15], v[124:127]
  s_waitcnt lgkmcnt(10)
  v_mfma_f32_16x16x32_bf16 v[100:103], a[236:239], a[16:19], v[100:103]
  ds_read_b64_tr_b16 a[220:221], v225 offset:18512
  v_mfma_f32_16x16x32_bf16 v[108:111], a[236:239], a[20:23], v[108:111]
  ds_read_b64_tr_b16 a[222:223], v225 offset:18768
  v_mfma_f32_16x16x32_bf16 v[116:119], a[236:239], a[24:27], v[116:119]
  v_mfma_f32_16x16x32_bf16 v[124:127], a[236:239], a[28:31], v[124:127]
  s_waitcnt lgkmcnt(10)
  v_mfma_f32_16x16x32_bf16 v[128:131], a[240:243], a[128:131], v[128:131]
  ds_read_b64_tr_b16 a[224:225], v229 offset:8232
  v_mfma_f32_16x16x32_bf16 v[136:139], a[240:243], a[132:135], v[136:139]
  ds_read_b64_tr_b16 a[226:227], v229 offset:8488
  v_mfma_f32_16x16x32_bf16 v[144:147], a[240:243], a[136:139], v[144:147]
  v_mfma_f32_16x16x32_bf16 v[152:155], a[240:243], a[140:143], v[152:155]
  s_waitcnt lgkmcnt(10)
  v_cvt_pk_bf16_f32 v98, v100, v101
  v_cvt_pk_bf16_f32 v99, v102, v103
  v_mfma_f32_16x16x32_bf16 v[128:131], a[244:247], a[144:147], v[128:131]
  ds_read_b64_tr_b16 a[228:229], v229 offset:18520
  v_cvt_pk_bf16_f32 v106, v108, v109
  v_mfma_f32_16x16x32_bf16 v[136:139], a[244:247], a[148:151], v[136:139]
  ds_read_b64_tr_b16 a[230:231], v229 offset:18776
  v_cvt_pk_bf16_f32 v107, v110, v111
  v_mfma_f32_16x16x32_bf16 v[144:147], a[244:247], a[152:155], v[144:147]
  v_cvt_pk_bf16_f32 v114, v116, v117
  v_cvt_pk_bf16_f32 v115, v118, v119
  v_mfma_f32_16x16x32_bf16 v[152:155], a[244:247], a[156:159], v[152:155]
  s_waitcnt lgkmcnt(10)
  v_cvt_pk_bf16_f32 v122, v124, v125
  v_cvt_pk_bf16_f32 v123, v126, v127
  v_mfma_f32_16x16x32_bf16 v[128:131], a[208:211], a[160:163], v[128:131]
  ds_read_b64_tr_b16 a[232:233], v224 offset:8232
  v_mfma_f32_16x16x32_bf16 v[136:139], a[208:211], a[164:167], v[136:139]
  ds_read_b64_tr_b16 a[234:235], v224 offset:8488
  v_mfma_f32_16x16x32_bf16 v[144:147], a[208:211], a[168:171], v[144:147]
  buffer_store_dwordx4 v[96:99], v208, s[20:23], 0 offen offset:3072 sc1
  v_mfma_f32_16x16x32_bf16 v[152:155], a[208:211], a[172:175], v[152:155]
  buffer_store_dwordx4 v[104:107], v209, s[20:23], 0 offen offset:3072 sc1
  s_waitcnt lgkmcnt(10)
  v_mfma_f32_16x16x32_bf16 v[128:131], a[212:215], a[176:179], v[128:131]
  ds_read_b64_tr_b16 a[236:237], v224 offset:18520
  v_mfma_f32_16x16x32_bf16 v[136:139], a[212:215], a[180:183], v[136:139]
  ds_read_b64_tr_b16 a[238:239], v224 offset:18776
  v_mfma_f32_16x16x32_bf16 v[144:147], a[212:215], a[184:187], v[144:147]
  buffer_store_dwordx4 v[112:115], v210, s[20:23], 0 offen offset:3072 sc1
  v_mfma_f32_16x16x32_bf16 v[152:155], a[212:215], a[188:191], v[152:155]
  s_waitcnt lgkmcnt(10)
  v_mfma_f32_16x16x32_bf16 v[128:131], a[216:219], a[0:3], v[128:131]
  ds_read_b64_tr_b16 a[240:241], v225 offset:8232
  v_mfma_f32_16x16x32_bf16 v[136:139], a[216:219], a[4:7], v[136:139]
  ds_read_b64_tr_b16 a[242:243], v225 offset:8488
  v_mfma_f32_16x16x32_bf16 v[144:147], a[216:219], a[8:11], v[144:147]
  buffer_store_dwordx4 v[120:123], v211, s[20:23], 0 offen offset:3072 sc1
  v_mfma_f32_16x16x32_bf16 v[152:155], a[216:219], a[12:15], v[152:155]
  s_waitcnt lgkmcnt(10)
  v_mfma_f32_16x16x32_bf16 v[128:131], a[220:223], a[16:19], v[128:131]
  ds_read_b64_tr_b16 a[244:245], v225 offset:18520
  v_mfma_f32_16x16x32_bf16 v[136:139], a[220:223], a[20:23], v[136:139]
  ds_read_b64_tr_b16 a[246:247], v225 offset:18776
  v_mfma_f32_16x16x32_bf16 v[144:147], a[220:223], a[24:27], v[144:147]
  v_mfma_f32_16x16x32_bf16 v[152:155], a[220:223], a[28:31], v[152:155]
  s_waitcnt lgkmcnt(10)
  v_mfma_f32_16x16x32_bf16 v[132:135], a[224:227], a[128:131], v[132:135]
  v_mfma_f32_16x16x32_bf16 v[140:143], a[224:227], a[132:135], v[140:143]
  v_mfma_f32_16x16x32_bf16 v[148:151], a[224:227], a[136:139], v[148:151]
  v_mfma_f32_16x16x32_bf16 v[156:159], a[224:227], a[140:143], v[156:159]
  s_waitcnt lgkmcnt(8)
  v_cvt_pk_bf16_f32 v128, v128, v129
  v_cvt_pk_bf16_f32 v129, v130, v131
  v_mfma_f32_16x16x32_bf16 v[132:135], a[228:231], a[144:147], v[132:135]
  v_cvt_pk_bf16_f32 v136, v136, v137
  v_cvt_pk_bf16_f32 v137, v138, v139
  v_mfma_f32_16x16x32_bf16 v[140:143], a[228:231], a[148:151], v[140:143]
  v_cvt_pk_bf16_f32 v144, v144, v145
  v_cvt_pk_bf16_f32 v145, v146, v147
  v_mfma_f32_16x16x32_bf16 v[148:151], a[228:231], a[152:155], v[148:151]
  v_cvt_pk_bf16_f32 v152, v152, v153
  v_cvt_pk_bf16_f32 v153, v154, v155
  v_mfma_f32_16x16x32_bf16 v[156:159], a[228:231], a[156:159], v[156:159]
  s_waitcnt lgkmcnt(6)
  v_mfma_f32_16x16x32_bf16 v[132:135], a[232:235], a[160:163], v[132:135]
  v_mfma_f32_16x16x32_bf16 v[140:143], a[232:235], a[164:167], v[140:143]
  buffer_load_dword v220, v227, s[20:23], s73 offen sc1
  v_mfma_f32_16x16x32_bf16 v[148:151], a[232:235], a[168:171], v[148:151]
  v_mfma_f32_16x16x32_bf16 v[156:159], a[232:235], a[172:175], v[156:159]
  s_waitcnt lgkmcnt(4)
  v_mfma_f32_16x16x32_bf16 v[132:135], a[236:239], a[176:179], v[132:135]
  v_mfma_f32_16x16x32_bf16 v[140:143], a[236:239], a[180:183], v[140:143]
  v_mfma_f32_16x16x32_bf16 v[148:151], a[236:239], a[184:187], v[148:151]
  v_mfma_f32_16x16x32_bf16 v[156:159], a[236:239], a[188:191], v[156:159]
  s_waitcnt lgkmcnt(2)
  v_mfma_f32_16x16x32_bf16 v[132:135], a[240:243], a[0:3], v[132:135]
  v_mfma_f32_16x16x32_bf16 v[140:143], a[240:243], a[4:7], v[140:143]
  v_mfma_f32_16x16x32_bf16 v[148:151], a[240:243], a[8:11], v[148:151]
  v_mfma_f32_16x16x32_bf16 v[156:159], a[240:243], a[12:15], v[156:159]
  s_waitcnt lgkmcnt(0)
  v_mfma_f32_16x16x32_bf16 v[132:135], a[244:247], a[16:19], v[132:135]
  v_mfma_f32_16x16x32_bf16 v[140:143], a[244:247], a[20:23], v[140:143]
  v_mfma_f32_16x16x32_bf16 v[148:151], a[244:247], a[24:27], v[148:151]
  v_mfma_f32_16x16x32_bf16 v[156:159], a[244:247], a[28:31], v[156:159]
  s_nop 4
  v_cvt_pk_bf16_f32 v130, v132, v133
  v_cvt_pk_bf16_f32 v131, v134, v135
  v_cvt_pk_bf16_f32 v138, v140, v141
  v_cvt_pk_bf16_f32 v139, v142, v143
  v_cvt_pk_bf16_f32 v146, v148, v149
  v_cvt_pk_bf16_f32 v147, v150, v151
  v_cvt_pk_bf16_f32 v154, v156, v157
  v_cvt_pk_bf16_f32 v155, v158, v159
  buffer_store_dwordx4 v[128:131], v208, s[20:23], s69 offen sc1
  buffer_store_dwordx4 v[136:139], v209, s[20:23], s69 offen sc1
  buffer_store_dwordx4 v[144:147], v210, s[20:23], s69 offen sc1
  buffer_store_dwordx4 v[152:155], v211, s[20:23], s69 offen sc1
  s_waitcnt vmcnt(5)
  v_mov_b32 v248, 2
  buffer_store_dword v248, v250, s[20:23], s68 offen sc1
  s_waitcnt vmcnt(5)
  v_cmp_gt_u32 vcc, 1, v220
  s_cbranch_vccnz L_chkP_far
L_chkP:
  s_add_u32 s71, s88, 0xf00000
  buffer_load_dwordx4 v[24:27], v245, s[20:23], s71 offen sc1
  s_add_u32 s71, s71, 0x280000
  buffer_load_dwordx4 v[28:31], v245, s[20:23], s71 offen sc1
  s_mov_b32 s71, s88
  buffer_load_dwordx4 v[0:3], v245, s[20:23], s71 offen sc1
  s_add_u32 s71, s71, 0x280000
  buffer_load_dwordx4 v[4:7], v245, s[20:23], s71 offen sc1
  s_add_u32 s71, s71, 0x280000
  buffer_load_dwordx4 v[8:11], v245, s[20:23], s71 offen sc1
  s_add_u32 s71, s71, 0x280000
  buffer_load_dwordx4 v[12:15], v245, s[20:23], s71 offen sc1
  s_add_u32 s71, s71, 0x280000
  buffer_load_dwordx4 v[16:19], v245, s[20:23], s71 offen sc1
  s_add_u32 s71, s71, 0x280000
  buffer_load_dwordx4 v[20:23], v245, s[20:23], s71 offen sc1
  s_add_u32 s71, s71, 0x280000
  s_waitcnt vmcnt(7)
  v_mfma_f32_16x16x32_bf16 v[160:163], v[194:197], v[24:27], 0
  v_mfma_f32_16x16x32_bf16 v[164:167], v[192:195], v[24:27], 0
  s_waitcnt vmcnt(6)
  v_mfma_f32_16x16x32_bf16 v[160:163], v[194:197], v[28:31], v[160:163]
  v_mfma_f32_16x16x32_bf16 v[164:167], v[192:195], v[28:31], v[164:167]
  s_waitcnt vmcnt(5)
  v_mfma_f32_16x16x32_bf16 v[168:171], v[194:197], v[0:3], 0
  v_mfma_f32_16x16x32_bf16 v[172:175], v[192:195], v[0:3], 0
  s_waitcnt vmcnt(4)
  v_mfma_f32_16x16x32_bf16 v[168:171], v[194:197], v[4:7], v[168:171]
  v_mfma_f32_16x16x32_bf16 v[172:175], v[192:195], v[4:7], v[172:175]
  s_waitcnt vmcnt(3)
  v_mfma_f32_16x16x32_bf16 v[168:171], v[194:197], v[8:11], v[168:171]
  v_mfma_f32_16x16x32_bf16 v[172:175], v[192:195], v[8:11], v[172:175]
  s_waitcnt vmcnt(2)
  v_mfma_f32_16x16x32_bf16 v[168:171], v[194:197], v[12:15], v[168:171]
  v_mfma_f32_16x16x32_bf16 v[172:175], v[192:195], v[12:15], v[172:175]
  s_waitcnt vmcnt(1)
  v_mfma_f32_16x16x32_bf16 v[168:171], v[194:197], v[16:19], v[168:171]
  v_mfma_f32_16x16x32_bf16 v[172:175], v[192:195], v[16:19], v[172:175]
  s_waitcnt vmcnt(0)
  v_mfma_f32_16x16x32_bf16 v[168:171], v[194:197], v[20:23], v[168:171]
  v_mfma_f32_16x16x32_bf16 v[172:175], v[192:195], v[20:23], v[172:175]
  v_mul_f32 v230, 0xbfb8aa3b, v160
  v_mul_f32 v231, 0xbfb8aa3b, v161
  v_mul_f32 v232, 0xbfb8aa3b, v162
  v_mul_f32 v233, 0xbfb8aa3b, v163
  v_mul_f32 v234, 0xbfb8aa3b, v164
  v_mul_f32 v235, 0xbfb8aa3b, v165
  v_mul_f32 v236, 0xbfb8aa3b, v166
  v_mul_f32 v237, 0xbfb8aa3b, v167
  v_exp_f32 v230, v230
  v_exp_f32 v231, v231
  v_exp_f32 v232, v232
  v_exp_f32 v233, v233
  v_exp_f32 v234, v234
  v_exp_f32 v235, v235
  v_exp_f32 v236, v236
  v_exp_f32 v237, v237
  v_add_f32 v230, 1.0, v230
  v_add_f32 v231, 1.0, v231
  v_add_f32 v232, 1.0, v232
  v_add_f32 v233, 1.0, v233
  v_add_f32 v234, 1.0, v234
  v_add_f32 v235, 1.0, v235
  v_add_f32 v236, 1.0, v236
  v_add_f32 v237, 1.0, v237
  v_rcp_f32 v230, v230
  v_rcp_f32 v231, v231
  v_rcp_f32 v232, v232
  v_rcp_f32 v233, v233
  v_rcp_f32 v234, v234
  v_rcp_f32 v235, v235
  v_rcp_f32 v236, v236
  v_rcp_f32 v237, v237
  v_mul_f32 v160, v160, v168
  v_mul_f32 v161, v161, v169
  v_mul_f32 v162, v162, v170
  v_mul_f32 v163, v163, v171
  v_mul_f32 v164, v164, v172
  v_mul_f32 v165, v165, v173
  v_mul_f32 v166, v166, v174
  v_mul_f32 v167, v167, v175
  v_fmac_f32 v176, v160, v230
  v_fmac_f32 v177, v161, v231
  v_fmac_f32 v178, v162, v232
  v_fmac_f32 v179, v163, v233
  v_fmac_f32 v180, v164, v234
  v_fmac_f32 v181, v165, v235
  v_fmac_f32 v182, v166, v236
  v_fmac_f32 v183, v167, v237
  v_cvt_pk_bf16_f32 v0, v176, v177
  v_cvt_pk_bf16_f32 v1, v178, v179
  v_cvt_pk_bf16_f32 v2, v180, v181
  v_cvt_pk_bf16_f32 v3, v182, v183
  buffer_store_dwordx4 v[0:3], v226, s[40:43], s89 offen
  s_nop 4
  s_mov_b32 s82, 0x40000
  L_pollP2:
  buffer_load_dword v220, v227, s[20:23], s73 offen offset:0 sc1
  s_waitcnt vmcnt(0)
  v_cmp_gt_u32 vcc, 2, v220
  s_cbranch_vccz L_pollP2_done
  s_sleep 1
  s_sub_u32 s82, s82, 1
  s_cmp_lg_u32 s82, 0
  s_cbranch_scc1 L_pollP2
  L_pollP2_done:
  s_waitcnt vmcnt(0)
  s_add_u32 s71, s90, 0xf00000
  buffer_load_dwordx4 v[56:59], v245, s[20:23], s71 offen sc1
  s_add_u32 s71, s71, 0x280000
  buffer_load_dwordx4 v[60:63], v245, s[20:23], s71 offen sc1
  s_mov_b32 s71, s90
  buffer_load_dwordx4 v[32:35], v245, s[20:23], s71 offen sc1
  s_add_u32 s71, s71, 0x280000
  buffer_load_dwordx4 v[36:39], v245, s[20:23], s71 offen sc1
  s_add_u32 s71, s71, 0x280000
  buffer_load_dwordx4 v[40:43], v245, s[20:23], s71 offen sc1
  s_add_u32 s71, s71, 0x280000
  buffer_load_dwordx4 v[44:47], v245, s[20:23], s71 offen sc1
  s_add_u32 s71, s71, 0x280000
  buffer_load_dwordx4 v[48:51], v245, s[20:23], s71 offen sc1
  s_add_u32 s71, s71, 0x280000
  buffer_load_dwordx4 v[52:55], v245, s[20:23], s71 offen sc1
  s_add_u32 s71, s71, 0x280000
  s_add_u32 s71, s92, 0xf00000
  buffer_load_dwordx4 v[88:91], v245, s[20:23], s71 offen sc1
  s_add_u32 s71, s71, 0x280000
  buffer_load_dwordx4 v[92:95], v245, s[20:23], s71 offen sc1
  s_mov_b32 s71, s92
  buffer_load_dwordx4 v[64:67], v245, s[20:23], s71 offen sc1
  s_add_u32 s71, s71, 0x280000
  buffer_load_dwordx4 v[68:71], v245, s[20:23], s71 offen sc1
  s_add_u32 s71, s71, 0x280000
  buffer_load_dwordx4 v[72:75], v245, s[20:23], s71 offen sc1
  s_add_u32 s71, s71, 0x280000
  buffer_load_dwordx4 v[76:79], v245, s[20:23], s71 offen sc1
  s_add_u32 s71, s71, 0x280000
  buffer_load_dwordx4 v[80:83], v245, s[20:23], s71 offen sc1
  s_add_u32 s71, s71, 0x280000
  buffer_load_dwordx4 v[84:87], v245, s[20:23], s71 offen sc1
  s_add_u32 s71, s71, 0x280000
  s_waitcnt vmcnt(15)
  v_mfma_f32_16x16x32_bf16 v[112:115], v[194:197], v[56:59], 0
  v_mfma_f32_16x16x32_bf16 v[116:119], v[192:195], v[56:59], 0
  s_waitcnt vmcnt(14)
  v_mfma_f32_16x16x32_bf16 v[112:115], v[194:197], v[60:63], v[112:115]
  v_mfma_f32_16x16x32_bf16 v[116:119], v[192:195], v[60:63], v[116:119]
  s_waitcnt vmcnt(13)
  v_mfma_f32_16x16x32_bf16 v[120:123], v[194:197], v[32:35], 0
  v_mfma_f32_16x16x32_bf16 v[124:127], v[192:195], v[32:35], 0
  s_waitcnt vmcnt(12)
  v_mfma_f32_16x16x32_bf16 v[120:123], v[194:197], v[36:39], v[120:123]
  v_mfma_f32_16x16x32_bf16 v[124:127], v[192:195], v[36:39], v[124:127]
  s_waitcnt vmcnt(11)
  v_mfma_f32_16x16x32_bf16 v[120:123], v[194:197], v[40:43], v[120:123]
  v_mfma_f32_16x16x32_bf16 v[124:127], v[192:195], v[40:43], v[124:127]
  s_waitcnt vmcnt(10)
  v_mfma_f32_16x16x32_bf16 v[120:123], v[194:197], v[44:47], v[120:123]
  v_mfma_f32_16x16x32_bf16 v[124:127], v[192:195], v[44:47], v[124:127]
  s_waitcnt vmcnt(9)
  v_mfma_f32_16x16x32_bf16 v[120:123], v[194:197], v[48:51], v[120:123]
  v_mfma_f32_16x16x32_bf16 v[124:127], v[192:195], v[48:51], v[124:127]
  s_waitcnt vmcnt(8)
  v_mfma_f32_16x16x32_bf16 v[120:123], v[194:197], v[52:55], v[120:123]
  v_mfma_f32_16x16x32_bf16 v[124:127], v[192:195], v[52:55], v[124:127]
  v_mul_f32 v230, 0xbfb8aa3b, v112
  v_mul_f32 v231, 0xbfb8aa3b, v113
  v_mul_f32 v232, 0xbfb8aa3b, v114
  v_mul_f32 v233, 0xbfb8aa3b, v115
  v_mul_f32 v234, 0xbfb8aa3b, v116
  v_mul_f32 v235, 0xbfb8aa3b, v117
  v_mul_f32 v236, 0xbfb8aa3b, v118
  v_mul_f32 v237, 0xbfb8aa3b, v119
  v_exp_f32 v230, v230
  v_exp_f32 v231, v231
  v_exp_f32 v232, v232
  v_exp_f32 v233, v233
  v_exp_f32 v234, v234
  v_exp_f32 v235, v235
  v_exp_f32 v236, v236
  v_exp_f32 v237, v237
  v_add_f32 v230, 1.0, v230
  v_add_f32 v231, 1.0, v231
  v_add_f32 v232, 1.0, v232
  v_add_f32 v233, 1.0, v233
  v_add_f32 v234, 1.0, v234
  v_add_f32 v235, 1.0, v235
  v_add_f32 v236, 1.0, v236
  v_add_f32 v237, 1.0, v237
  v_rcp_f32 v230, v230
  v_rcp_f32 v231, v231
  v_rcp_f32 v232, v232
  v_rcp_f32 v233, v233
  v_rcp_f32 v234, v234
  v_rcp_f32 v235, v235
  v_rcp_f32 v236, v236
  v_rcp_f32 v237, v237
  v_mul_f32 v112, v112, v120
  v_mul_f32 v113, v113, v121
  v_mul_f32 v114, v114, v122
  v_mul_f32 v115, v115, v123
  v_mul_f32 v116, v116, v124
  v_mul_f32 v117, v117, v125
  v_mul_f32 v118, v118, v126
  v_mul_f32 v119, v119, v127
  v_fmac_f32 v184, v112, v230
  v_fmac_f32 v185, v113, v231
  v_fmac_f32 v186, v114, v232
  v_fmac_f32 v187, v115, v233
  v_fmac_f32 v188, v116, v234
  v_fmac_f32 v189, v117, v235
  v_fmac_f32 v190, v118, v236
  v_fmac_f32 v191, v119, v237
  v_cvt_pk_bf16_f32 v32, v184, v185
  v_cvt_pk_bf16_f32 v33, v186, v187
  v_cvt_pk_bf16_f32 v34, v188, v189
  v_cvt_pk_bf16_f32 v35, v190, v191
  buffer_store_dwordx4 v[32:35], v226, s[40:43], s91 offen
  s_waitcnt vmcnt(6)
  v_max3_u32 v247, v64, v65, v66
  s_waitcnt vmcnt(5)
  v_max3_u32 v247, v247, v67, v68
  v_max3_u32 v247, v247, v69, v70
  s_waitcnt vmcnt(4)
  v_max3_u32 v247, v247, v71, v72
  v_max3_u32 v247, v247, v73, v74
  s_waitcnt vmcnt(3)
  v_max3_u32 v247, v247, v75, v76
  v_max3_u32 v247, v247, v77, v78
  s_waitcnt vmcnt(2)
  v_max3_u32 v247, v247, v79, v80
  v_max3_u32 v247, v247, v81, v82
  s_waitcnt vmcnt(1)
  v_max3_u32 v247, v247, v83, v84
  v_max3_u32 v247, v247, v85, v86
  v_max3_u32 v247, v247, v87, v88
  v_max3_u32 v247, v247, v89, v90
  v_max3_u32 v247, v247, v91, v92
  v_max3_u32 v247, v247, v93, v94
  v_max_u32 v247, v247, v95
  v_cmp_eq_u32 vcc, -1, v247
  s_cbranch_vccnz L_snt2_far
L_snt2:
  s_nop 1
  v_mfma_f32_16x16x32_bf16 v[128:131], v[194:197], v[88:91], 0
  v_mfma_f32_16x16x32_bf16 v[132:135], v[192:195], v[88:91], 0
  v_mfma_f32_16x16x32_bf16 v[128:131], v[194:197], v[92:95], v[128:131]
  v_mfma_f32_16x16x32_bf16 v[132:135], v[192:195], v[92:95], v[132:135]
  v_mfma_f32_16x16x32_bf16 v[136:139], v[194:197], v[64:67], 0
  v_mfma_f32_16x16x32_bf16 v[140:143], v[192:195], v[64:67], 0
  v_mfma_f32_16x16x32_bf16 v[136:139], v[194:197], v[68:71], v[136:139]
  v_mfma_f32_16x16x32_bf16 v[140:143], v[192:195], v[68:71], v[140:143]
  v_mfma_f32_16x16x32_bf16 v[136:139], v[194:197], v[72:75], v[136:139]
  v_mfma_f32_16x16x32_bf16 v[140:143], v[192:195], v[72:75], v[140:143]
  v_mfma_f32_16x16x32_bf16 v[136:139], v[194:197], v[76:79], v[136:139]
  v_mfma_f32_16x16x32_bf16 v[140:143], v[192:195], v[76:79], v[140:143]
  v_mfma_f32_16x16x32_bf16 v[136:139], v[194:197], v[80:83], v[136:139]
  v_mfma_f32_16x16x32_bf16 v[140:143], v[192:195], v[80:83], v[140:143]
  v_mfma_f32_16x16x32_bf16 v[136:139], v[194:197], v[84:87], v[136:139]
  v_mfma_f32_16x16x32_bf16 v[140:143], v[192:195], v[84:87], v[140:143]
  v_mul_f32 v230, 0xbfb8aa3b, v128
  v_mul_f32 v231, 0xbfb8aa3b, v129
  v_mul_f32 v232, 0xbfb8aa3b, v130
  v_mul_f32 v233, 0xbfb8aa3b, v131
  v_mul_f32 v234, 0xbfb8aa3b, v132
  v_mul_f32 v235, 0xbfb8aa3b, v133
  v_mul_f32 v236, 0xbfb8aa3b, v134
  v_mul_f32 v237, 0xbfb8aa3b, v135
  v_exp_f32 v230, v230
  v_exp_f32 v231, v231
  v_exp_f32 v232, v232
  v_exp_f32 v233, v233
  v_exp_f32 v234, v234
  v_exp_f32 v235, v235
  v_exp_f32 v236, v236
  v_exp_f32 v237, v237
  v_add_f32 v230, 1.0, v230
  v_add_f32 v231, 1.0, v231
  v_add_f32 v232, 1.0, v232
  v_add_f32 v233, 1.0, v233
  v_add_f32 v234, 1.0, v234
  v_add_f32 v235, 1.0, v235
  v_add_f32 v236, 1.0, v236
  v_add_f32 v237, 1.0, v237
  v_rcp_f32 v230, v230
  v_rcp_f32 v231, v231
  v_rcp_f32 v232, v232
  v_rcp_f32 v233, v233
  v_rcp_f32 v234, v234
  v_rcp_f32 v235, v235
  v_rcp_f32 v236, v236
  v_rcp_f32 v237, v237
  v_mul_f32 v128, v128, v136
  v_mul_f32 v129, v129, v137
  v_mul_f32 v130, v130, v138
  v_mul_f32 v131, v131, v139
  v_mul_f32 v132, v132, v140
  v_mul_f32 v133, v133, v141
  v_mul_f32 v134, v134, v142
  v_mul_f32 v135, v135, v143
  v_fmac_f32 v200, v128, v230
  v_fmac_f32 v201, v129, v231
  v_fmac_f32 v202, v130, v232
  v_fmac_f32 v203, v131, v233
  v_fmac_f32 v204, v132, v234
  v_fmac_f32 v205, v133, v235
  v_fmac_f32 v206, v134, v236
  v_fmac_f32 v207, v135, v237
  v_cvt_pk_bf16_f32 v64, v200, v201
  v_cvt_pk_bf16_f32 v65, v202, v203
  v_cvt_pk_bf16_f32 v66, v204, v205
  v_cvt_pk_bf16_f32 v67, v206, v207
  buffer_store_dwordx4 v[64:67], v226, s[40:43], s93 offen
L_k2_end:
  s_endpgm
L_newmax0:
  s_nop 7
  v_max3_f32 v239, v96, v97, v98
  v_max3_f32 v239, v239, v99, v100
  v_max3_f32 v239, v239, v101, v102
  v_max_f32 v239, v239, v103
  v_mov_b32 v247, v239
  s_nop 1
  v_permlane16_swap_b32 v247, v239
  s_nop 1
  v_max_f32 v239, v239, v247
  v_mov_b32 v247, v239
  s_nop 1
  v_permlane32_swap_b32 v247, v239
  s_nop 1
  v_max3_f32 v239, v239, v247, v244
  v_sub_f32 v96, v96, v239
  v_sub_f32 v97, v97, v239
  v_sub_f32 v98, v98, v239
  v_sub_f32 v99, v99, v239
  v_sub_f32 v100, v100, v239
  v_sub_f32 v101, v101, v239
  v_sub_f32 v102, v102, v239
  v_sub_f32 v103, v103, v239
  v_max3_f32 v240, v104, v105, v106
  v_max3_f32 v240, v240, v107, v108
  v_max3_f32 v240, v240, v109, v110
  v_max_f32 v240, v240, v111
  v_mov_b32 v247, v240
  s_nop 1
  v_permlane16_swap_b32 v247, v240
  s_nop 1
  v_max_f32 v240, v240, v247
  v_mov_b32 v247, v240
  s_nop 1
  v_permlane32_swap_b32 v247, v240
  s_nop 1
  v_max3_f32 v240, v240, v247, v244
  v_sub_f32 v104, v104, v240
  v_sub_f32 v105, v105, v240
  v_sub_f32 v106, v106, v240
  v_sub_f32 v107, v107, v240
  v_sub_f32 v108, v108, v240
  v_sub_f32 v109, v109, v240
  v_sub_f32 v110, v110, v240
  v_sub_f32 v111, v111, v240
  v_max3_f32 v241, v112, v113, v114
  v_max3_f32 v241, v241, v115, v116
  v_max3_f32 v241, v241, v117, v118
  v_max_f32 v241, v241, v119
  v_mov_b32 v247, v241
  s_nop 1
  v_permlane16_swap_b32 v247, v241
  s_nop 1
  v_max_f32 v241, v241, v247
  v_mov_b32 v247, v241
  s_nop 1
  v_permlane32_swap_b32 v247, v241
  s_nop 1
  v_max3_f32 v241, v241, v247, v244
  v_sub_f32 v112, v112, v241
  v_sub_f32 v113, v113, v241
  v_sub_f32 v114, v114, v241
  v_sub_f32 v115, v115, v241
  v_sub_f32 v116, v116, v241
  v_sub_f32 v117, v117, v241
  v_sub_f32 v118, v118, v241
  v_sub_f32 v119, v119, v241
  v_max3_f32 v242, v120, v121, v122
  v_max3_f32 v242, v242, v123, v124
  v_max3_f32 v242, v242, v125, v126
  v_max_f32 v242, v242, v127
  v_mov_b32 v247, v242
  s_nop 1
  v_permlane16_swap_b32 v247, v242
  s_nop 1
  v_max_f32 v242, v242, v247
  v_mov_b32 v247, v242
  s_nop 1
  v_permlane32_swap_b32 v247, v242
  s_nop 1
  v_max3_f32 v242, v242, v247, v244
  v_sub_f32 v120, v120, v242
  v_sub_f32 v121, v121, v242
  v_sub_f32 v122, v122, v242
  v_sub_f32 v123, v123, v242
  v_sub_f32 v124, v124, v242
  v_sub_f32 v125, v125, v242
  v_sub_f32 v126, v126, v242
  v_sub_f32 v127, v127, v242
  s_mov_b32 s66, 1
  s_nop 4
  s_setpc_b64 s[60:61]
L_newmax1:
  s_nop 7
  v_max3_f32 v239, v128, v129, v130
  v_max3_f32 v239, v239, v131, v132
  v_max3_f32 v239, v239, v133, v134
  v_max_f32 v239, v239, v135
  v_mov_b32 v247, v239
  s_nop 1
  v_permlane16_swap_b32 v247, v239
  s_nop 1
  v_max_f32 v239, v239, v247
  v_mov_b32 v247, v239
  s_nop 1
  v_permlane32_swap_b32 v247, v239
  s_nop 1
  v_max3_f32 v239, v239, v247, v244
  v_sub_f32 v128, v128, v239
  v_sub_f32 v129, v129, v239
  v_sub_f32 v130, v130, v239
  v_sub_f32 v131, v131, v239
  v_sub_f32 v132, v132, v239
  v_sub_f32 v133, v133, v239
  v_sub_f32 v134, v134, v239
  v_sub_f32 v135, v135, v239
  v_max3_f32 v240, v136, v137, v138
  v_max3_f32 v240, v240, v139, v140
  v_max3_f32 v240, v240, v141, v142
  v_max_f32 v240, v240, v143
  v_mov_b32 v247, v240
  s_nop 1
  v_permlane16_swap_b32 v247, v240
  s_nop 1
  v_max_f32 v240, v240, v247
  v_mov_b32 v247, v240
  s_nop 1
  v_permlane32_swap_b32 v247, v240
  s_nop 1
  v_max3_f32 v240, v240, v247, v244
  v_sub_f32 v136, v136, v240
  v_sub_f32 v137, v137, v240
  v_sub_f32 v138, v138, v240
  v_sub_f32 v139, v139, v240
  v_sub_f32 v140, v140, v240
  v_sub_f32 v141, v141, v240
  v_sub_f32 v142, v142, v240
  v_sub_f32 v143, v143, v240
  v_max3_f32 v241, v144, v145, v146
  v_max3_f32 v241, v241, v147, v148
  v_max3_f32 v241, v241, v149, v150
  v_max_f32 v241, v241, v151
  v_mov_b32 v247, v241
  s_nop 1
  v_permlane16_swap_b32 v247, v241
  s_nop 1
  v_max_f32 v241, v241, v247
  v_mov_b32 v247, v241
  s_nop 1
  v_permlane32_swap_b32 v247, v241
  s_nop 1
  v_max3_f32 v241, v241, v247, v244
  v_sub_f32 v144, v144, v241
  v_sub_f32 v145, v145, v241
  v_sub_f32 v146, v146, v241
  v_sub_f32 v147, v147, v241
  v_sub_f32 v148, v148, v241
  v_sub_f32 v149, v149, v241
  v_sub_f32 v150, v150, v241
  v_sub_f32 v151, v151, v241
  v_max3_f32 v242, v152, v153, v154
  v_max3_f32 v242, v242, v155, v156
  v_max3_f32 v242, v242, v157, v158
  v_max_f32 v242, v242, v159
  v_mov_b32 v247, v242
  s_nop 1
  v_permlane16_swap_b32 v247, v242
  s_nop 1
  v_max_f32 v242, v242, v247
  v_mov_b32 v247, v242
  s_nop 1
  v_permlane32_swap_b32 v247, v242
  s_nop 1
  v_max3_f32 v242, v242, v247, v244
  v_sub_f32 v152, v152, v242
  v_sub_f32 v153, v153, v242
  v_sub_f32 v154, v154, v242
  v_sub_f32 v155, v155, v242
  v_sub_f32 v156, v156, v242
  v_sub_f32 v157, v157, v242
  v_sub_f32 v158, v158, v242
  v_sub_f32 v159, v159, v242
  s_mov_b32 s66, 1
  s_nop 4
  s_setpc_b64 s[60:61]
L_fixs1:
  s_nop 15
  v_sub_f32 v128, v128, v239
  v_sub_f32 v129, v129, v239
  v_sub_f32 v130, v130, v239
  v_sub_f32 v131, v131, v239
  v_sub_f32 v132, v132, v239
  v_sub_f32 v133, v133, v239
  v_sub_f32 v134, v134, v239
  v_sub_f32 v135, v135, v239
  v_sub_f32 v192, v192, v239
  v_sub_f32 v193, v193, v239
  v_sub_f32 v194, v194, v239
  v_sub_f32 v195, v195, v239
  v_sub_f32 v136, v136, v240
  v_sub_f32 v137, v137, v240
  v_sub_f32 v138, v138, v240
  v_sub_f32 v139, v139, v240
  v_sub_f32 v140, v140, v240
  v_sub_f32 v141, v141, v240
  v_sub_f32 v142, v142, v240
  v_sub_f32 v143, v143, v240
  v_sub_f32 v196, v196, v240
  v_sub_f32 v197, v197, v240
  v_sub_f32 v198, v198, v240
  v_sub_f32 v199, v199, v240
  v_sub_f32 v144, v144, v241
  v_sub_f32 v145, v145, v241
  v_sub_f32 v146, v146, v241
  v_sub_f32 v147, v147, v241
  v_sub_f32 v148, v148, v241
  v_sub_f32 v149, v149, v241
  v_sub_f32 v150, v150, v241
  v_sub_f32 v151, v151, v241
  v_sub_f32 v200, v200, v241
  v_sub_f32 v201, v201, v241
  v_sub_f32 v202, v202, v241
  v_sub_f32 v203, v203, v241
  v_sub_f32 v152, v152, v242
  v_sub_f32 v153, v153, v242
  v_sub_f32 v154, v154, v242
  v_sub_f32 v155, v155, v242
  v_sub_f32 v156, v156, v242
  v_sub_f32 v157, v157, v242
  v_sub_f32 v158, v158, v242
  v_sub_f32 v159, v159, v242
  v_sub_f32 v204, v204, v242
  v_sub_f32 v205, v205, v242
  v_sub_f32 v206, v206, v242
  v_sub_f32 v207, v207, v242
  s_mov_b32 s66, 0
  s_nop 4
  s_setpc_b64 s[60:61]
CODE_END:
L_rescale1:
  s_nop 15
  v_sub_f32 v128, v128, v239
  v_sub_f32 v129, v129, v239
  v_sub_f32 v130, v130, v239
  v_sub_f32 v131, v131, v239
  v_sub_f32 v132, v132, v239
  v_sub_f32 v133, v133, v239
  v_sub_f32 v134, v134, v239
  v_sub_f32 v135, v135, v239
  v_sub_f32 v192, v192, v239
  v_sub_f32 v193, v193, v239
  v_sub_f32 v194, v194, v239
  v_sub_f32 v195, v195, v239
  v_sub_f32 v136, v136, v240
  v_sub_f32 v137, v137, v240
  v_sub_f32 v138, v138, v240
  v_sub_f32 v139, v139, v240
  v_sub_f32 v140, v140, v240
  v_sub_f32 v141, v141, v240
  v_sub_f32 v142, v142, v240
  v_sub_f32 v143, v143, v240
  v_sub_f32 v196, v196, v240
  v_sub_f32 v197, v197, v240
  v_sub_f32 v198, v198, v240
  v_sub_f32 v199, v199, v240
  v_sub_f32 v144, v144, v241
  v_sub_f32 v145, v145, v241
  v_sub_f32 v146, v146, v241
  v_sub_f32 v147, v147, v241
  v_sub_f32 v148, v148, v241
  v_sub_f32 v149, v149, v241
  v_sub_f32 v150, v150, v241
  v_sub_f32 v151, v151, v241
  v_sub_f32 v200, v200, v241
  v_sub_f32 v201, v201, v241
  v_sub_f32 v202, v202, v241
  v_sub_f32 v203, v203, v241
  v_sub_f32 v152, v152, v242
  v_sub_f32 v153, v153, v242
  v_sub_f32 v154, v154, v242
  v_sub_f32 v155, v155, v242
  v_sub_f32 v156, v156, v242
  v_sub_f32 v157, v157, v242
  v_sub_f32 v158, v158, v242
  v_sub_f32 v159, v159, v242
  v_sub_f32 v204, v204, v242
  v_sub_f32 v205, v205, v242
  v_sub_f32 v206, v206, v242
  v_sub_f32 v207, v207, v242
  s_branch L_rescale_o
L_rescale_nos1:
  s_nop 15
  s_branch L_rescale_o
L_fixs0:
  s_nop 15
  v_sub_f32 v96, v96, v239
  v_sub_f32 v97, v97, v239
  v_sub_f32 v98, v98, v239
  v_sub_f32 v99, v99, v239
  v_sub_f32 v100, v100, v239
  v_sub_f32 v101, v101, v239
  v_sub_f32 v102, v102, v239
  v_sub_f32 v103, v103, v239
  v_sub_f32 v192, v192, v239
  v_sub_f32 v193, v193, v239
  v_sub_f32 v194, v194, v239
  v_sub_f32 v195, v195, v239
  v_sub_f32 v104, v104, v240
  v_sub_f32 v105, v105, v240
  v_sub_f32 v106, v106, v240
  v_sub_f32 v107, v107, v240
  v_sub_f32 v108, v108, v240
  v_sub_f32 v109, v109, v240
  v_sub_f32 v110, v110, v240
  v_sub_f32 v111, v111, v240
  v_sub_f32 v196, v196, v240
  v_sub_f32 v197, v197, v240
  v_sub_f32 v198, v198, v240
  v_sub_f32 v199, v199, v240
  v_sub_f32 v112, v112, v241
  v_sub_f32 v113, v113, v241
  v_sub_f32 v114, v114, v241
  v_sub_f32 v115, v115, v241
  v_sub_f32 v116, v116, v241
  v_sub_f32 v117, v117, v241
  v_sub_f32 v118, v118, v241
  v_sub_f32 v119, v119, v241
  v_sub_f32 v200, v200, v241
  v_sub_f32 v201, v201, v241
  v_sub_f32 v202, v202, v241
  v_sub_f32 v203, v203, v241
  v_sub_f32 v120, v120, v242
  v_sub_f32 v121, v121, v242
  v_sub_f32 v122, v122, v242
  v_sub_f32 v123, v123, v242
  v_sub_f32 v124, v124, v242
  v_sub_f32 v125, v125, v242
  v_sub_f32 v126, v126, v242
  v_sub_f32 v127, v127, v242
  v_sub_f32 v204, v204, v242
  v_sub_f32 v205, v205, v242
  v_sub_f32 v206, v206, v242
  v_sub_f32 v207, v207, v242
  s_mov_b32 s66, 0
  s_nop 4
  s_setpc_b64 s[60:61]
L_rescale0:
  s_nop 15
  v_sub_f32 v96, v96, v239
  v_sub_f32 v97, v97, v239
  v_sub_f32 v98, v98, v239
  v_sub_f32 v99, v99, v239
  v_sub_f32 v100, v100, v239
  v_sub_f32 v101, v101, v239
  v_sub_f32 v102, v102, v239
  v_sub_f32 v103, v103, v239
  v_sub_f32 v192, v192, v239
  v_sub_f32 v193, v193, v239
  v_sub_f32 v194, v194, v239
  v_sub_f32 v195, v195, v239
  v_sub_f32 v104, v104, v240
  v_sub_f32 v105, v105, v240
  v_sub_f32 v106, v106, v240
  v_sub_f32 v107, v107, v240
  v_sub_f32 v108, v108, v240
  v_sub_f32 v109, v109, v240
  v_sub_f32 v110, v110, v240
  v_sub_f32 v111, v111, v240
  v_sub_f32 v196, v196, v240
  v_sub_f32 v197, v197, v240
  v_sub_f32 v198, v198, v240
  v_sub_f32 v199, v199, v240
  v_sub_f32 v112, v112, v241
  v_sub_f32 v113, v113, v241
  v_sub_f32 v114, v114, v241
  v_sub_f32 v115, v115, v241
  v_sub_f32 v116, v116, v241
  v_sub_f32 v117, v117, v241
  v_sub_f32 v118, v118, v241
  v_sub_f32 v119, v119, v241
  v_sub_f32 v200, v200, v241
  v_sub_f32 v201, v201, v241
  v_sub_f32 v202, v202, v241
  v_sub_f32 v203, v203, v241
  v_sub_f32 v120, v120, v242
  v_sub_f32 v121, v121, v242
  v_sub_f32 v122, v122, v242
  v_sub_f32 v123, v123, v242
  v_sub_f32 v124, v124, v242
  v_sub_f32 v125, v125, v242
  v_sub_f32 v126, v126, v242
  v_sub_f32 v127, v127, v242
  v_sub_f32 v204, v204, v242
  v_sub_f32 v205, v205, v242
  v_sub_f32 v206, v206, v242
  v_sub_f32 v207, v207, v242
  s_branch L_rescale_o
L_rescale_nos0:
  s_nop 15
  s_branch L_rescale_o
L_rescale_o:
  v_exp_f32 v239, -v239
  v_exp_f32 v240, -v240
  v_exp_f32 v241, -v241
  v_exp_f32 v242, -v242
  s_nop 1
  v_accvgpr_read_b32 v247, a0
  v_accvgpr_read_b32 v248, a1
  v_accvgpr_read_b32 v249, a2
  v_accvgpr_read_b32 v243, a3
  v_mul_f32 v247, v247, v239
  v_mul_f32 v248, v248, v239
  v_mul_f32 v249, v249, v239
  v_mul_f32 v243, v243, v239
  v_accvgpr_write_b32 a0, v247
  v_accvgpr_write_b32 a1, v248
  v_accvgpr_write_b32 a2, v249
  v_accvgpr_write_b32 a3, v243
  v_accvgpr_read_b32 v247, a4
  v_accvgpr_read_b32 v248, a5
  v_accvgpr_read_b32 v249, a6
  v_accvgpr_read_b32 v243, a7
  v_mul_f32 v247, v247, v239
  v_mul_f32 v248, v248, v239
  v_mul_f32 v249, v249, v239
  v_mul_f32 v243, v243, v239
  v_accvgpr_write_b32 a4, v247
  v_accvgpr_write_b32 a5, v248
  v_accvgpr_write_b32 a6, v249
  v_accvgpr_write_b32 a7, v243
  v_accvgpr_read_b32 v247, a32
  v_accvgpr_read_b32 v248, a33
  v_accvgpr_read_b32 v249, a34
  v_accvgpr_read_b32 v243, a35
  v_mul_f32 v247, v247, v239
  v_mul_f32 v248, v248, v239
  v_mul_f32 v249, v249, v239
  v_mul_f32 v243, v243, v239
  v_accvgpr_write_b32 a32, v247
  v_accvgpr_write_b32 a33, v248
  v_accvgpr_write_b32 a34, v249
  v_accvgpr_write_b32 a35, v243
  v_accvgpr_read_b32 v247, a36
  v_accvgpr_read_b32 v248, a37
  v_accvgpr_read_b32 v249, a38
  v_accvgpr_read_b32 v243, a39
  v_mul_f32 v247, v247, v239
  v_mul_f32 v248, v248, v239
  v_mul_f32 v249, v249, v239
  v_mul_f32 v243, v243, v239
  v_accvgpr_write_b32 a36, v247
  v_accvgpr_write_b32 a37, v248
  v_accvgpr_write_b32 a38, v249
  v_accvgpr_write_b32 a39, v243
  v_accvgpr_read_b32 v247, a64
  v_accvgpr_read_b32 v248, a65
  v_accvgpr_read_b32 v249, a66
  v_accvgpr_read_b32 v243, a67
  v_mul_f32 v247, v247, v239
  v_mul_f32 v248, v248, v239
  v_mul_f32 v249, v249, v239
  v_mul_f32 v243, v243, v239
  v_accvgpr_write_b32 a64, v247
  v_accvgpr_write_b32 a65, v248
  v_accvgpr_write_b32 a66, v249
  v_accvgpr_write_b32 a67, v243
  v_accvgpr_read_b32 v247, a68
  v_accvgpr_read_b32 v248, a69
  v_accvgpr_read_b32 v249, a70
  v_accvgpr_read_b32 v243, a71
  v_mul_f32 v247, v247, v239
  v_mul_f32 v248, v248, v239
  v_mul_f32 v249, v249, v239
  v_mul_f32 v243, v243, v239
  v_accvgpr_write_b32 a68, v247
  v_accvgpr_write_b32 a69, v248
  v_accvgpr_write_b32 a70, v249
  v_accvgpr_write_b32 a71, v243
  v_accvgpr_read_b32 v247, a96
  v_accvgpr_read_b32 v248, a97
  v_accvgpr_read_b32 v249, a98
  v_accvgpr_read_b32 v243, a99
  v_mul_f32 v247, v247, v239
  v_mul_f32 v248, v248, v239
  v_mul_f32 v249, v249, v239
  v_mul_f32 v243, v243, v239
  v_accvgpr_write_b32 a96, v247
  v_accvgpr_write_b32 a97, v248
  v_accvgpr_write_b32 a98, v249
  v_accvgpr_write_b32 a99, v243
  v_accvgpr_read_b32 v247, a100
  v_accvgpr_read_b32 v248, a101
  v_accvgpr_read_b32 v249, a102
  v_accvgpr_read_b32 v243, a103
  v_mul_f32 v247, v247, v239
  v_mul_f32 v248, v248, v239
  v_mul_f32 v249, v249, v239
  v_mul_f32 v243, v243, v239
  v_accvgpr_write_b32 a100, v247
  v_accvgpr_write_b32 a101, v248
  v_accvgpr_write_b32 a102, v249
  v_accvgpr_write_b32 a103, v243
  v_accvgpr_read_b32 v247, a128
  v_accvgpr_read_b32 v248, a129
  v_accvgpr_read_b32 v249, a130
  v_accvgpr_read_b32 v243, a131
  v_mul_f32 v247, v247, v239
  v_mul_f32 v248, v248, v239
  v_mul_f32 v249, v249, v239
  v_mul_f32 v243, v243, v239
  v_accvgpr_write_b32 a128, v247
  v_accvgpr_write_b32 a129, v248
  v_accvgpr_write_b32 a130, v249
  v_accvgpr_write_b32 a131, v243
  v_accvgpr_read_b32 v247, a132
  v_accvgpr_read_b32 v248, a133
  v_accvgpr_read_b32 v249, a134
  v_accvgpr_read_b32 v243, a135
  v_mul_f32 v247, v247, v239
  v_mul_f32 v248, v248, v239
  v_mul_f32 v249, v249, v239
  v_mul_f32 v243, v243, v239
  v_accvgpr_write_b32 a132, v247
  v_accvgpr_write_b32 a133, v248
  v_accvgpr_write_b32 a134, v249
  v_accvgpr_write_b32 a135, v243
  v_accvgpr_read_b32 v247, a160
  v_accvgpr_read_b32 v248, a161
  v_accvgpr_read_b32 v249, a162
  v_accvgpr_read_b32 v243, a163
  v_mul_f32 v247, v247, v239
  v_mul_f32 v248, v248, v239
  v_mul_f32 v249, v249, v239
  v_mul_f32 v243, v243, v239
  v_accvgpr_write_b32 a160, v247
  v_accvgpr_write_b32 a161, v248
  v_accvgpr_write_b32 a162, v249
  v_accvgpr_write_b32 a163, v243
  v_accvgpr_read_b32 v247, a164
  v_accvgpr_read_b32 v248, a165
  v_accvgpr_read_b32 v249, a166
  v_accvgpr_read_b32 v243, a167
  v_mul_f32 v247, v247, v239
  v_mul_f32 v248, v248, v239
  v_mul_f32 v249, v249, v239
  v_mul_f32 v243, v243, v239
  v_accvgpr_write_b32 a164, v247
  v_accvgpr_write_b32 a165, v248
  v_accvgpr_write_b32 a166, v249
  v_accvgpr_write_b32 a167, v243
  v_accvgpr_read_b32 v247, a192
  v_accvgpr_read_b32 v248, a193
  v_accvgpr_read_b32 v249, a194
  v_accvgpr_read_b32 v243, a195
  v_mul_f32 v247, v247, v239
  v_mul_f32 v248, v248, v239
  v_mul_f32 v249, v249, v239
  v_mul_f32 v243, v243, v239
  v_accvgpr_write_b32 a192, v247
  v_accvgpr_write_b32 a193, v248
  v_accvgpr_write_b32 a194, v249
  v_accvgpr_write_b32 a195, v243
  v_accvgpr_read_b32 v247, a8
  v_accvgpr_read_b32 v248, a9
  v_accvgpr_read_b32 v249, a10
  v_accvgpr_read_b32 v243, a11
  v_mul_f32 v247, v247, v240
  v_mul_f32 v248, v248, v240
  v_mul_f32 v249, v249, v240
  v_mul_f32 v243, v243, v240
  v_accvgpr_write_b32 a8, v247
  v_accvgpr_write_b32 a9, v248
  v_accvgpr_write_b32 a10, v249
  v_accvgpr_write_b32 a11, v243
  v_accvgpr_read_b32 v247, a12
  v_accvgpr_read_b32 v248, a13
  v_accvgpr_read_b32 v249, a14
  v_accvgpr_read_b32 v243, a15
  v_mul_f32 v247, v247, v240
  v_mul_f32 v248, v248, v240
  v_mul_f32 v249, v249, v240
  v_mul_f32 v243, v243, v240
  v_accvgpr_write_b32 a12, v247
  v_accvgpr_write_b32 a13, v248
  v_accvgpr_write_b32 a14, v249
  v_accvgpr_write_b32 a15, v243
  v_accvgpr_read_b32 v247, a40
  v_accvgpr_read_b32 v248, a41
  v_accvgpr_read_b32 v249, a42
  v_accvgpr_read_b32 v243, a43
  v_mul_f32 v247, v247, v240
  v_mul_f32 v248, v248, v240
  v_mul_f32 v249, v249, v240
  v_mul_f32 v243, v243, v240
  v_accvgpr_write_b32 a40, v247
  v_accvgpr_write_b32 a41, v248
  v_accvgpr_write_b32 a42, v249
  v_accvgpr_write_b32 a43, v243
  v_accvgpr_read_b32 v247, a44
  v_accvgpr_read_b32 v248, a45
  v_accvgpr_read_b32 v249, a46
  v_accvgpr_read_b32 v243, a47
  v_mul_f32 v247, v247, v240
  v_mul_f32 v248, v248, v240
  v_mul_f32 v249, v249, v240
  v_mul_f32 v243, v243, v240
  v_accvgpr_write_b32 a44, v247
  v_accvgpr_write_b32 a45, v248
  v_accvgpr_write_b32 a46, v249
  v_accvgpr_write_b32 a47, v243
  v_accvgpr_read_b32 v247, a72
  v_accvgpr_read_b32 v248, a73
  v_accvgpr_read_b32 v249, a74
  v_accvgpr_read_b32 v243, a75
  v_mul_f32 v247, v247, v240
  v_mul_f32 v248, v248, v240
  v_mul_f32 v249, v249, v240
  v_mul_f32 v243, v243, v240
  v_accvgpr_write_b32 a72, v247
  v_accvgpr_write_b32 a73, v248
  v_accvgpr_write_b32 a74, v249
  v_accvgpr_write_b32 a75, v243
  v_accvgpr_read_b32 v247, a76
  v_accvgpr_read_b32 v248, a77
  v_accvgpr_read_b32 v249, a78
  v_accvgpr_read_b32 v243, a79
  v_mul_f32 v247, v247, v240
  v_mul_f32 v248, v248, v240
  v_mul_f32 v249, v249, v240
  v_mul_f32 v243, v243, v240
  v_accvgpr_write_b32 a76, v247
  v_accvgpr_write_b32 a77, v248
  v_accvgpr_write_b32 a78, v249
  v_accvgpr_write_b32 a79, v243
  v_accvgpr_read_b32 v247, a104
  v_accvgpr_read_b32 v248, a105
  v_accvgpr_read_b32 v249, a106
  v_accvgpr_read_b32 v243, a107
  v_mul_f32 v247, v247, v240
  v_mul_f32 v248, v248, v240
  v_mul_f32 v249, v249, v240
  v_mul_f32 v243, v243, v240
  v_accvgpr_write_b32 a104, v247
  v_accvgpr_write_b32 a105, v248
  v_accvgpr_write_b32 a106, v249
  v_accvgpr_write_b32 a107, v243
  v_accvgpr_read_b32 v247, a108
  v_accvgpr_read_b32 v248, a109
  v_accvgpr_read_b32 v249, a110
  v_accvgpr_read_b32 v243, a111
  v_mul_f32 v247, v247, v240
  v_mul_f32 v248, v248, v240
  v_mul_f32 v249, v249, v240
  v_mul_f32 v243, v243, v240
  v_accvgpr_write_b32 a108, v247
  v_accvgpr_write_b32 a109, v248
  v_accvgpr_write_b32 a110, v249
  v_accvgpr_write_b32 a111, v243
  v_accvgpr_read_b32 v247, a136
  v_accvgpr_read_b32 v248, a137
  v_accvgpr_read_b32 v249, a138
  v_accvgpr_read_b32 v243, a139
  v_mul_f32 v247, v247, v240
  v_mul_f32 v248, v248, v240
  v_mul_f32 v249, v249, v240
  v_mul_f32 v243, v243, v240
  v_accvgpr_write_b32 a136, v247
  v_accvgpr_write_b32 a137, v248
  v_accvgpr_write_b32 a138, v249
  v_accvgpr_write_b32 a139, v243
  v_accvgpr_read_b32 v247, a140
  v_accvgpr_read_b32 v248, a141
  v_accvgpr_read_b32 v249, a142
  v_accvgpr_read_b32 v243, a143
  v_mul_f32 v247, v247, v240
  v_mul_f32 v248, v248, v240
  v_mul_f32 v249, v249, v240
  v_mul_f32 v243, v243, v240
  v_accvgpr_write_b32 a140, v247
  v_accvgpr_write_b32 a141, v248
  v_accvgpr_write_b32 a142, v249
  v_accvgpr_write_b32 a143, v243
  v_accvgpr_read_b32 v247, a168
  v_accvgpr_read_b32 v248, a169
  v_accvgpr_read_b32 v249, a170
  v_accvgpr_read_b32 v243, a171
  v_mul_f32 v247, v247, v240
  v_mul_f32 v248, v248, v240
  v_mul_f32 v249, v249, v240
  v_mul_f32 v243, v243, v240
  v_accvgpr_write_b32 a168, v247
  v_accvgpr_write_b32 a169, v248
  v_accvgpr_write_b32 a170, v249
  v_accvgpr_write_b32 a171, v243
  v_accvgpr_read_b32 v247, a172
  v_accvgpr_read_b32 v248, a173
  v_accvgpr_read_b32 v249, a174
  v_accvgpr_read_b32 v243, a175
  v_mul_f32 v247, v247, v240
  v_mul_f32 v248, v248, v240
  v_mul_f32 v249, v249, v240
  v_mul_f32 v243, v243, v240
  v_accvgpr_write_b32 a172, v247
  v_accvgpr_write_b32 a173, v248
  v_accvgpr_write_b32 a174, v249
  v_accvgpr_write_b32 a175, v243
  v_accvgpr_read_b32 v247, a196
  v_accvgpr_read_b32 v248, a197
  v_accvgpr_read_b32 v249, a198
  v_accvgpr_read_b32 v243, a199
  v_mul_f32 v247, v247, v240
  v_mul_f32 v248, v248, v240
  v_mul_f32 v249, v249, v240
  v_mul_f32 v243, v243, v240
  v_accvgpr_write_b32 a196, v247
  v_accvgpr_write_b32 a197, v248
  v_accvgpr_write_b32 a198, v249
  v_accvgpr_write_b32 a199, v243
  v_accvgpr_read_b32 v247, a16
  v_accvgpr_read_b32 v248, a17
  v_accvgpr_read_b32 v249, a18
  v_accvgpr_read_b32 v243, a19
  v_mul_f32 v247, v247, v241
  v_mul_f32 v248, v248, v241
  v_mul_f32 v249, v249, v241
  v_mul_f32 v243, v243, v241
  v_accvgpr_write_b32 a16, v247
  v_accvgpr_write_b32 a17, v248
  v_accvgpr_write_b32 a18, v249
  v_accvgpr_write_b32 a19, v243
  v_accvgpr_read_b32 v247, a20
  v_accvgpr_read_b32 v248, a21
  v_accvgpr_read_b32 v249, a22
  v_accvgpr_read_b32 v243, a23
  v_mul_f32 v247, v247, v241
  v_mul_f32 v248, v248, v241
  v_mul_f32 v249, v249, v241
  v_mul_f32 v243, v243, v241
  v_accvgpr_write_b32 a20, v247
  v_accvgpr_write_b32 a21, v248
  v_accvgpr_write_b32 a22, v249
  v_accvgpr_write_b32 a23, v243
  v_accvgpr_read_b32 v247, a48
  v_accvgpr_read_b32 v248, a49
  v_accvgpr_read_b32 v249, a50
  v_accvgpr_read_b32 v243, a51
  v_mul_f32 v247, v247, v241
  v_mul_f32 v248, v248, v241
  v_mul_f32 v249, v249, v241
  v_mul_f32 v243, v243, v241
  v_accvgpr_write_b32 a48, v247
  v_accvgpr_write_b32 a49, v248
  v_accvgpr_write_b32 a50, v249
  v_accvgpr_write_b32 a51, v243
  v_accvgpr_read_b32 v247, a52
  v_accvgpr_read_b32 v248, a53
  v_accvgpr_read_b32 v249, a54
  v_accvgpr_read_b32 v243, a55
  v_mul_f32 v247, v247, v241
  v_mul_f32 v248, v248, v241
  v_mul_f32 v249, v249, v241
  v_mul_f32 v243, v243, v241
  v_accvgpr_write_b32 a52, v247
  v_accvgpr_write_b32 a53, v248
  v_accvgpr_write_b32 a54, v249
  v_accvgpr_write_b32 a55, v243
  v_accvgpr_read_b32 v247, a80
  v_accvgpr_read_b32 v248, a81
  v_accvgpr_read_b32 v249, a82
  v_accvgpr_read_b32 v243, a83
  v_mul_f32 v247, v247, v241
  v_mul_f32 v248, v248, v241
  v_mul_f32 v249, v249, v241
  v_mul_f32 v243, v243, v241
  v_accvgpr_write_b32 a80, v247
  v_accvgpr_write_b32 a81, v248
  v_accvgpr_write_b32 a82, v249
  v_accvgpr_write_b32 a83, v243
  v_accvgpr_read_b32 v247, a84
  v_accvgpr_read_b32 v248, a85
  v_accvgpr_read_b32 v249, a86
  v_accvgpr_read_b32 v243, a87
  v_mul_f32 v247, v247, v241
  v_mul_f32 v248, v248, v241
  v_mul_f32 v249, v249, v241
  v_mul_f32 v243, v243, v241
  v_accvgpr_write_b32 a84, v247
  v_accvgpr_write_b32 a85, v248
  v_accvgpr_write_b32 a86, v249
  v_accvgpr_write_b32 a87, v243
  v_accvgpr_read_b32 v247, a112
  v_accvgpr_read_b32 v248, a113
  v_accvgpr_read_b32 v249, a114
  v_accvgpr_read_b32 v243, a115
  v_mul_f32 v247, v247, v241
  v_mul_f32 v248, v248, v241
  v_mul_f32 v249, v249, v241
  v_mul_f32 v243, v243, v241
  v_accvgpr_write_b32 a112, v247
  v_accvgpr_write_b32 a113, v248
  v_accvgpr_write_b32 a114, v249
  v_accvgpr_write_b32 a115, v243
  v_accvgpr_read_b32 v247, a116
  v_accvgpr_read_b32 v248, a117
  v_accvgpr_read_b32 v249, a118
  v_accvgpr_read_b32 v243, a119
  v_mul_f32 v247, v247, v241
  v_mul_f32 v248, v248, v241
  v_mul_f32 v249, v249, v241
  v_mul_f32 v243, v243, v241
  v_accvgpr_write_b32 a116, v247
  v_accvgpr_write_b32 a117, v248
  v_accvgpr_write_b32 a118, v249
  v_accvgpr_write_b32 a119, v243
  v_accvgpr_read_b32 v247, a144
  v_accvgpr_read_b32 v248, a145
  v_accvgpr_read_b32 v249, a146
  v_accvgpr_read_b32 v243, a147
  v_mul_f32 v247, v247, v241
  v_mul_f32 v248, v248, v241
  v_mul_f32 v249, v249, v241
  v_mul_f32 v243, v243, v241
  v_accvgpr_write_b32 a144, v247
  v_accvgpr_write_b32 a145, v248
  v_accvgpr_write_b32 a146, v249
  v_accvgpr_write_b32 a147, v243
  v_accvgpr_read_b32 v247, a148
  v_accvgpr_read_b32 v248, a149
  v_accvgpr_read_b32 v249, a150
  v_accvgpr_read_b32 v243, a151
  v_mul_f32 v247, v247, v241
  v_mul_f32 v248, v248, v241
  v_mul_f32 v249, v249, v241
  v_mul_f32 v243, v243, v241
  v_accvgpr_write_b32 a148, v247
  v_accvgpr_write_b32 a149, v248
  v_accvgpr_write_b32 a150, v249
  v_accvgpr_write_b32 a151, v243
  v_accvgpr_read_b32 v247, a176
  v_accvgpr_read_b32 v248, a177
  v_accvgpr_read_b32 v249, a178
  v_accvgpr_read_b32 v243, a179
  v_mul_f32 v247, v247, v241
  v_mul_f32 v248, v248, v241
  v_mul_f32 v249, v249, v241
  v_mul_f32 v243, v243, v241
  v_accvgpr_write_b32 a176, v247
  v_accvgpr_write_b32 a177, v248
  v_accvgpr_write_b32 a178, v249
  v_accvgpr_write_b32 a179, v243
  v_accvgpr_read_b32 v247, a180
  v_accvgpr_read_b32 v248, a181
  v_accvgpr_read_b32 v249, a182
  v_accvgpr_read_b32 v243, a183
  v_mul_f32 v247, v247, v241
  v_mul_f32 v248, v248, v241
  v_mul_f32 v249, v249, v241
  v_mul_f32 v243, v243, v241
  v_accvgpr_write_b32 a180, v247
  v_accvgpr_write_b32 a181, v248
  v_accvgpr_write_b32 a182, v249
  v_accvgpr_write_b32 a183, v243
  v_accvgpr_read_b32 v247, a200
  v_accvgpr_read_b32 v248, a201
  v_accvgpr_read_b32 v249, a202
  v_accvgpr_read_b32 v243, a203
  v_mul_f32 v247, v247, v241
  v_mul_f32 v248, v248, v241
  v_mul_f32 v249, v249, v241
  v_mul_f32 v243, v243, v241
  v_accvgpr_write_b32 a200, v247
  v_accvgpr_write_b32 a201, v248
  v_accvgpr_write_b32 a202, v249
  v_accvgpr_write_b32 a203, v243
  v_accvgpr_read_b32 v247, a24
  v_accvgpr_read_b32 v248, a25
  v_accvgpr_read_b32 v249, a26
  v_accvgpr_read_b32 v243, a27
  v_mul_f32 v247, v247, v242
  v_mul_f32 v248, v248, v242
  v_mul_f32 v249, v249, v242
  v_mul_f32 v243, v243, v242
  v_accvgpr_write_b32 a24, v247
  v_accvgpr_write_b32 a25, v248
  v_accvgpr_write_b32 a26, v249
  v_accvgpr_write_b32 a27, v243
  v_accvgpr_read_b32 v247, a28
  v_accvgpr_read_b32 v248, a29
  v_accvgpr_read_b32 v249, a30
  v_accvgpr_read_b32 v243, a31
  v_mul_f32 v247, v247, v242
  v_mul_f32 v248, v248, v242
  v_mul_f32 v249, v249, v242
  v_mul_f32 v243, v243, v242
  v_accvgpr_write_b32 a28, v247
  v_accvgpr_write_b32 a29, v248
  v_accvgpr_write_b32 a30, v249
  v_accvgpr_write_b32 a31, v243
  v_accvgpr_read_b32 v247, a56
  v_accvgpr_read_b32 v248, a57
  v_accvgpr_read_b32 v249, a58
  v_accvgpr_read_b32 v243, a59
  v_mul_f32 v247, v247, v242
  v_mul_f32 v248, v248, v242
  v_mul_f32 v249, v249, v242
  v_mul_f32 v243, v243, v242
  v_accvgpr_write_b32 a56, v247
  v_accvgpr_write_b32 a57, v248
  v_accvgpr_write_b32 a58, v249
  v_accvgpr_write_b32 a59, v243
  v_accvgpr_read_b32 v247, a60
  v_accvgpr_read_b32 v248, a61
  v_accvgpr_read_b32 v249, a62
  v_accvgpr_read_b32 v243, a63
  v_mul_f32 v247, v247, v242
  v_mul_f32 v248, v248, v242
  v_mul_f32 v249, v249, v242
  v_mul_f32 v243, v243, v242
  v_accvgpr_write_b32 a60, v247
  v_accvgpr_write_b32 a61, v248
  v_accvgpr_write_b32 a62, v249
  v_accvgpr_write_b32 a63, v243
  v_accvgpr_read_b32 v247, a88
  v_accvgpr_read_b32 v248, a89
  v_accvgpr_read_b32 v249, a90
  v_accvgpr_read_b32 v243, a91
  v_mul_f32 v247, v247, v242
  v_mul_f32 v248, v248, v242
  v_mul_f32 v249, v249, v242
  v_mul_f32 v243, v243, v242
  v_accvgpr_write_b32 a88, v247
  v_accvgpr_write_b32 a89, v248
  v_accvgpr_write_b32 a90, v249
  v_accvgpr_write_b32 a91, v243
  v_accvgpr_read_b32 v247, a92
  v_accvgpr_read_b32 v248, a93
  v_accvgpr_read_b32 v249, a94
  v_accvgpr_read_b32 v243, a95
  v_mul_f32 v247, v247, v242
  v_mul_f32 v248, v248, v242
  v_mul_f32 v249, v249, v242
  v_mul_f32 v243, v243, v242
  v_accvgpr_write_b32 a92, v247
  v_accvgpr_write_b32 a93, v248
  v_accvgpr_write_b32 a94, v249
  v_accvgpr_write_b32 a95, v243
  v_accvgpr_read_b32 v247, a120
  v_accvgpr_read_b32 v248, a121
  v_accvgpr_read_b32 v249, a122
  v_accvgpr_read_b32 v243, a123
  v_mul_f32 v247, v247, v242
  v_mul_f32 v248, v248, v242
  v_mul_f32 v249, v249, v242
  v_mul_f32 v243, v243, v242
  v_accvgpr_write_b32 a120, v247
  v_accvgpr_write_b32 a121, v248
  v_accvgpr_write_b32 a122, v249
  v_accvgpr_write_b32 a123, v243
  v_accvgpr_read_b32 v247, a124
  v_accvgpr_read_b32 v248, a125
  v_accvgpr_read_b32 v249, a126
  v_accvgpr_read_b32 v243, a127
  v_mul_f32 v247, v247, v242
  v_mul_f32 v248, v248, v242
  v_mul_f32 v249, v249, v242
  v_mul_f32 v243, v243, v242
  v_accvgpr_write_b32 a124, v247
  v_accvgpr_write_b32 a125, v248
  v_accvgpr_write_b32 a126, v249
  v_accvgpr_write_b32 a127, v243
  v_accvgpr_read_b32 v247, a152
  v_accvgpr_read_b32 v248, a153
  v_accvgpr_read_b32 v249, a154
  v_accvgpr_read_b32 v243, a155
  v_mul_f32 v247, v247, v242
  v_mul_f32 v248, v248, v242
  v_mul_f32 v249, v249, v242
  v_mul_f32 v243, v243, v242
  v_accvgpr_write_b32 a152, v247
  v_accvgpr_write_b32 a153, v248
  v_accvgpr_write_b32 a154, v249
  v_accvgpr_write_b32 a155, v243
  v_accvgpr_read_b32 v247, a156
  v_accvgpr_read_b32 v248, a157
  v_accvgpr_read_b32 v249, a158
  v_accvgpr_read_b32 v243, a159
  v_mul_f32 v247, v247, v242
  v_mul_f32 v248, v248, v242
  v_mul_f32 v249, v249, v242
  v_mul_f32 v243, v243, v242
  v_accvgpr_write_b32 a156, v247
  v_accvgpr_write_b32 a157, v248
  v_accvgpr_write_b32 a158, v249
  v_accvgpr_write_b32 a159, v243
  v_accvgpr_read_b32 v247, a184
  v_accvgpr_read_b32 v248, a185
  v_accvgpr_read_b32 v249, a186
  v_accvgpr_read_b32 v243, a187
  v_mul_f32 v247, v247, v242
  v_mul_f32 v248, v248, v242
  v_mul_f32 v249, v249, v242
  v_mul_f32 v243, v243, v242
  v_accvgpr_write_b32 a184, v247
  v_accvgpr_write_b32 a185, v248
  v_accvgpr_write_b32 a186, v249
  v_accvgpr_write_b32 a187, v243
  v_accvgpr_read_b32 v247, a188
  v_accvgpr_read_b32 v248, a189
  v_accvgpr_read_b32 v249, a190
  v_accvgpr_read_b32 v243, a191
  v_mul_f32 v247, v247, v242
  v_mul_f32 v248, v248, v242
  v_mul_f32 v249, v249, v242
  v_mul_f32 v243, v243, v242
  v_accvgpr_write_b32 a188, v247
  v_accvgpr_write_b32 a189, v248
  v_accvgpr_write_b32 a190, v249
  v_accvgpr_write_b32 a191, v243
  v_accvgpr_read_b32 v247, a204
  v_accvgpr_read_b32 v248, a205
  v_accvgpr_read_b32 v249, a206
  v_accvgpr_read_b32 v243, a207
  v_mul_f32 v247, v247, v242
  v_mul_f32 v248, v248, v242
  v_mul_f32 v249, v249, v242
  v_mul_f32 v243, v243, v242
  v_accvgpr_write_b32 a204, v247
  v_accvgpr_write_b32 a205, v248
  v_accvgpr_write_b32 a206, v249
  v_accvgpr_write_b32 a207, v243
  s_mov_b32 s66, 0
  s_nop 4
  s_setpc_b64 s[60:61]
L_sk0_far:
  s_call_b64 s[60:61], L_newmax1
  s_branch L_sk0
L_rs1_far:
  s_call_b64 s[60:61], L_rescale0
  s_branch L_rs1
L_sk2_far:
  s_call_b64 s[60:61], L_newmax0
  s_branch L_sk2
L_rs3_far:
  s_call_b64 s[60:61], L_rescale1
  s_branch L_rs3
L_sk4_far:
  s_call_b64 s[60:61], L_newmax1
  s_branch L_sk4
L_rs5_far:
  s_call_b64 s[60:61], L_rescale0
  s_branch L_rs5
L_sk6_far:
  s_call_b64 s[60:61], L_newmax0
  s_branch L_sk6
L_rs7_far:
  s_call_b64 s[60:61], L_rescale1
  s_branch L_rs7
L_sk8_far:
  s_call_b64 s[60:61], L_newmax1
  s_branch L_sk8
L_rs9_far:
  s_call_b64 s[60:61], L_rescale0
  s_branch L_rs9
L_sk10_far:
  s_call_b64 s[60:61], L_newmax0
  s_branch L_sk10
L_rs11_far:
  s_call_b64 s[60:61], L_rescale1
  s_branch L_rs11
L_sk12_far:
  s_call_b64 s[60:61], L_newmax1
  s_branch L_sk12
L_rs13_far:
  s_call_b64 s[60:61], L_rescale_nos0
  s_branch L_rs13
L_chk0_far:
  s_mov_b32 s82, 0x40000
  L_chk0_p:
  buffer_load_dword v220, v221, s[20:23], s83 offen offset:0 sc1
  s_waitcnt vmcnt(0)
  v_cmp_gt_u32 vcc, s84, v220
  s_cbranch_vccz L_chk0_p_done
  s_sleep 1
  s_sub_u32 s82, s82, 1
  s_cmp_lg_u32 s82, 0
  s_cbranch_scc1 L_chk0_p
  L_chk0_p_done:
  s_branch L_chk0
L_chk2_far:
  s_mov_b32 s82, 0x40000
  L_chk2_p:
  buffer_load_dword v220, v221, s[20:23], s83 offen offset:0 sc1
  s_waitcnt vmcnt(0)
  v_cmp_gt_u32 vcc, s84, v220
  s_cbranch_vccz L_chk2_p_done
  s_sleep 1
  s_sub_u32 s82, s82, 1
  s_cmp_lg_u32 s82, 0
  s_cbranch_scc1 L_chk2_p
  L_chk2_p_done:
  s_branch L_chk2
L_chk4_far:
  s_mov_b32 s82, 0x40000
  L_chk4_p:
  buffer_load_dword v220, v221, s[20:23], s83 offen offset:0 sc1
  s_waitcnt vmcnt(0)
  v_cmp_gt_u32 vcc, s84, v220
  s_cbranch_vccz L_chk4_p_done
  s_sleep 1
  s_sub_u32 s82, s82, 1
  s_cmp_lg_u32 s82, 0
  s_cbranch_scc1 L_chk4_p
  L_chk4_p_done:
  s_branch L_chk4
L_chk6_far:
  s_mov_b32 s82, 0x40000
  L_chk6_p:
  buffer_load_dword v220, v221, s[20:23], s83 offen offset:0 sc1
  s_waitcnt vmcnt(0)
  v_cmp_gt_u32 vcc, s84, v220
  s_cbranch_vccz L_chk6_p_done
  s_sleep 1
  s_sub_u32 s82, s82, 1
  s_cmp_lg_u32 s82, 0
  s_cbranch_scc1 L_chk6_p
  L_chk6_p_done:
  s_branch L_chk6
L_chk8_far:
  s_mov_b32 s82, 0x40000
  L_chk8_p:
  buffer_load_dword v220, v221, s[20:23], s83 offen offset:0 sc1
  s_waitcnt vmcnt(0)
  v_cmp_gt_u32 vcc, s84, v220
  s_cbranch_vccz L_chk8_p_done
  s_sleep 1
  s_sub_u32 s82, s82, 1
  s_cmp_lg_u32 s82, 0
  s_cbranch_scc1 L_chk8_p
  L_chk8_p_done:
  s_branch L_chk8
L_chk10_far:
  s_mov_b32 s82, 0x40000
  L_chk10_p:
  buffer_load_dword v220, v221, s[20:23], s83 offen offset:0 sc1
  s_waitcnt vmcnt(0)
  v_cmp_gt_u32 vcc, s84, v220
  s_cbranch_vccz L_chk10_p_done
  s_sleep 1
  s_sub_u32 s82, s82, 1
  s_cmp_lg_u32 s82, 0
  s_cbranch_scc1 L_chk10_p
  L_chk10_p_done:
  s_branch L_chk10
L_chk12_far:
  s_mov_b32 s82, 0x40000
  L_chk12_p:
  buffer_load_dword v220, v221, s[20:23], s83 offen offset:0 sc1
  s_waitcnt vmcnt(0)
  v_cmp_gt_u32 vcc, s84, v220
  s_cbranch_vccz L_chk12_p_done
  s_sleep 1
  s_sub_u32 s82, s82, 1
  s_cmp_lg_u32 s82, 0
  s_cbranch_scc1 L_chk12_p
  L_chk12_p_done:
  s_branch L_chk12
L_chk14_far:
  s_mov_b32 s82, 0x40000
  L_chk14_p:
  buffer_load_dword v220, v221, s[20:23], s83 offen offset:0 sc1
  s_waitcnt vmcnt(0)
  v_cmp_gt_u32 vcc, s84, v220
  s_cbranch_vccz L_chk14_p_done
  s_sleep 1
  s_sub_u32 s82, s82, 1
  s_cmp_lg_u32 s82, 0
  s_cbranch_scc1 L_chk14_p
  L_chk14_p_done:
  s_branch L_chk14
L_chk16_far:
  s_mov_b32 s82, 0x40000
  L_chk16_p:
  buffer_load_dword v220, v221, s[20:23], s83 offen offset:0 sc1
  s_waitcnt vmcnt(0)
  v_cmp_gt_u32 vcc, s84, v220
  s_cbranch_vccz L_chk16_p_done
  s_sleep 1
  s_sub_u32 s82, s82, 1
  s_cmp_lg_u32 s82, 0
  s_cbranch_scc1 L_chk16_p
  L_chk16_p_done:
  s_branch L_chk16
L_chk18_far:
  s_mov_b32 s82, 0x40000
  L_chk18_p:
  buffer_load_dword v220, v221, s[20:23], s83 offen offset:0 sc1
  s_waitcnt vmcnt(0)
  v_cmp_gt_u32 vcc, s84, v220
  s_cbranch_vccz L_chk18_p_done
  s_sleep 1
  s_sub_u32 s82, s82, 1
  s_cmp_lg_u32 s82, 0
  s_cbranch_scc1 L_chk18_p
  L_chk18_p_done:
  s_branch L_chk18
L_chk20_far:
  s_mov_b32 s82, 0x40000
  L_chk20_p:
  buffer_load_dword v220, v221, s[20:23], s83 offen offset:0 sc1
  s_waitcnt vmcnt(0)
  v_cmp_gt_u32 vcc, s84, v220
  s_cbranch_vccz L_chk20_p_done
  s_sleep 1
  s_sub_u32 s82, s82, 1
  s_cmp_lg_u32 s82, 0
  s_cbranch_scc1 L_chk20_p
  L_chk20_p_done:
  s_branch L_chk20
L_chk22_far:
  s_mov_b32 s82, 0x40000
  L_chk22_p:
  buffer_load_dword v220, v221, s[20:23], s83 offen offset:0 sc1
  s_waitcnt vmcnt(0)
  v_cmp_gt_u32 vcc, s84, v220
  s_cbranch_vccz L_chk22_p_done
  s_sleep 1
  s_sub_u32 s82, s82, 1
  s_cmp_lg_u32 s82, 0
  s_cbranch_scc1 L_chk22_p
  L_chk22_p_done:
  s_branch L_chk22
L_chk24_far:
  s_mov_b32 s82, 0x40000
  L_chk24_p:
  buffer_load_dword v220, v221, s[20:23], s83 offen offset:0 sc1
  s_waitcnt vmcnt(0)
  v_cmp_gt_u32 vcc, s84, v220
  s_cbranch_vccz L_chk24_p_done
  s_sleep 1
  s_sub_u32 s82, s82, 1
  s_cmp_lg_u32 s82, 0
  s_cbranch_scc1 L_chk24_p
  L_chk24_p_done:
  s_branch L_chk24
L_chkP_far:
  s_mov_b32 s82, 0x40000
  L_chkP_p:
  buffer_load_dword v220, v227, s[20:23], s73 offen offset:0 sc1
  s_waitcnt vmcnt(0)
  v_cmp_gt_u32 vcc, 1, v220
  s_cbranch_vccz L_chkP_p_done
  s_sleep 1
  s_sub_u32 s82, s82, 1
  s_cmp_lg_u32 s82, 0
  s_cbranch_scc1 L_chkP_p
  L_chkP_p_done:
  s_branch L_chkP
L_snt2_far:
  s_mov_b32 s82, 0x40000
L_snt2_l:
  s_add_u32 s71, s92, 0xf00000
  buffer_load_dwordx4 v[88:91], v245, s[20:23], s71 offen sc1
  s_add_u32 s71, s71, 0x280000
  buffer_load_dwordx4 v[92:95], v245, s[20:23], s71 offen sc1
  s_mov_b32 s71, s92
  buffer_load_dwordx4 v[64:67], v245, s[20:23], s71 offen sc1
  s_add_u32 s71, s71, 0x280000
  buffer_load_dwordx4 v[68:71], v245, s[20:23], s71 offen sc1
  s_add_u32 s71, s71, 0x280000
  buffer_load_dwordx4 v[72:75], v245, s[20:23], s71 offen sc1
  s_add_u32 s71, s71, 0x280000
  buffer_load_dwordx4 v[76:79], v245, s[20:23], s71 offen sc1
  s_add_u32 s71, s71, 0x280000
  buffer_load_dwordx4 v[80:83], v245, s[20:23], s71 offen sc1
  s_add_u32 s71, s71, 0x280000
  buffer_load_dwordx4 v[84:87], v245, s[20:23], s71 offen sc1
  s_add_u32 s71, s71, 0x280000
  s_waitcnt vmcnt(0)
  v_max3_u32 v247, v64, v65, v66
  v_max3_u32 v247, v247, v67, v68
  v_max3_u32 v247, v247, v69, v70
  v_max3_u32 v247, v247, v71, v72
  v_max3_u32 v247, v247, v73, v74
  v_max3_u32 v247, v247, v75, v76
  v_max3_u32 v247, v247, v77, v78
  v_max3_u32 v247, v247, v79, v80
  v_max3_u32 v247, v247, v81, v82
  v_max3_u32 v247, v247, v83, v84
  v_max3_u32 v247, v247, v85, v86
  v_max3_u32 v247, v247, v87, v88
  v_max3_u32 v247, v247, v89, v90
  v_max3_u32 v247, v247, v91, v92
  v_max3_u32 v247, v247, v93, v94
  v_max_u32 v247, v247, v95
  v_cmp_eq_u32 vcc, -1, v247
  s_cbranch_vccz L_snt2
  s_sub_u32 s82, s82, 1
  s_cmp_lg_u32 s82, 0
  s_cbranch_scc1 L_snt2_l
  s_branch L_snt2
.p2align 4
.type STAGE_TBL,@object
STAGE_TBL:
  .long 0xa74fc963, 0x000eb85d, 0x03fea955, 0
  .long 0xc960eb85, 0x000da71f, 0x03feaa55, 0
  .long 0xeb85da74, 0x000fc960, 0x03ffaa55, 0
  .long 0xa74fc963, 0x000eb85d, 0x03fea955, 0
  .long 0xc960eb85, 0x000da71f, 0x03feaa55, 0
  .long 0xeb85da74, 0x000fc960, 0x03ffaa55, 0
  .long 0xa7419630, 0x0000b852, 0x01ffaa55, 0
  .long 0xa7419630, 0x0000b852, 0x01ffaa55, 0
  .long 0xa71fc960, 0x000eb82d, 0x03fea955, 0
  .long 0xc930eb82, 0x000da41f, 0x03feaa55, 0
  .long 0xeb82da71, 0x000fc930, 0x03ffaa55, 0
  .long 0xa71fc960, 0x000eb82d, 0x03fea955, 0
  .long 0xc930eb82, 0x000da41f, 0x03feaa55, 0
  .long 0xeb82da71, 0x000fc930, 0x03ffaa55, 0
  .long 0xa7419630, 0x0000b852, 0x01ffaa55, 0
  .long 0xa7419630, 0x0000b852, 0x01ffaa55, 0
  .long 0xa41fc930, 0x000eb52d, 0x03fea955, 0
  .long 0xc630eb52, 0x000d741f, 0x03feaa55, 0
  .long 0xeb52da41, 0x000fc630, 0x03ffaa55, 0
  .long 0xa41fc930, 0x000eb52d, 0x03fea955, 0
  .long 0xc630eb52, 0x000d741f, 0x03feaa55, 0
  .long 0xeb52da41, 0x000fc630, 0x03ffaa55, 0
  .long 0xa7419630, 0x0000b852, 0x01ffaa55, 0
  .long 0xa7419630, 0x0000b852, 0x01ffaa55, 0
  .long 0x741fc630, 0x000e852d, 0x03fea955, 0
  .long 0x9630e852, 0x000a741f, 0x03feaa55, 0
  .long 0xe852d741, 0x000f9630, 0x03ffaa55, 0
  .long 0x741fc630, 0x000e852d, 0x03fea955, 0
  .long 0x9630e852, 0x000a741f, 0x03feaa55, 0
  .long 0xe852d741, 0x000f9630, 0x03ffaa55, 0
  .long 0xa7419630, 0x0000b852, 0x01ffaa55, 0
  .long 0xa7419630, 0x0000b852, 0x01ffaa55, 0
.section .rodata,"a"
.p2align 6
.amdhsa_kernel k1_ln_kernel
  .amdhsa_next_free_vgpr 64
  .amdhsa_next_free_sgpr 102
  .amdhsa_accum_offset 64
  .amdhsa_group_segment_fixed_size 0
  .amdhsa_kernarg_size 96
  .amdhsa_user_sgpr_count 2
  .amdhsa_user_sgpr_kernarg_segment_ptr 1
  .amdhsa_system_sgpr_workgroup_id_x 1
.end_amdhsa_kernel
.p2align 6
.amdhsa_kernel k2_main_kernel
  .amdhsa_next_free_vgpr 512
  .amdhsa_next_free_sgpr 102
  .amdhsa_accum_offset 256
  .amdhsa_group_segment_fixed_size 0
  .amdhsa_kernarg_size 96
  .amdhsa_user_sgpr_count 2
  .amdhsa_user_sgpr_kernarg_segment_ptr 1
  .amdhsa_system_sgpr_workgroup_id_x 1
.end_amdhsa_kernel
```
